```python
import torch

def _softmax(x, axis=-1):
    return torch.softmax(x, dim=axis)

def _gelu(x):
    return torch.nn.functional.gelu(x, approximate='tanh')

def _silu(x):
    return torch.nn.functional.silu(x)

def _sigmoid(x):
    return torch.sigmoid(x)

def _layernorm(x, axis=-1, eps=1e-05):
    m = x.mean(dim=axis, keepdim=True)
    v = x.var(dim=axis, keepdim=True, unbiased=False)
    return (x - m) / torch.sqrt(v + eps)

def _scatter_add(tgt, idx, src, axis=0):
    return tgt.clone().index_add_(axis, idx, src)

def _segment_sum(src, seg, n):
    out = torch.zeros((n,) + src.shape[1:], dtype=src.dtype)
    return out.index_add_(0, seg, src)

def _pad(x, pw):
    flat = tuple((v for pair in reversed(pw) for v in pair))
    return torch.nn.functional.pad(x, flat)
kernel_name = 'adaLN_cond__sliding_block_cached__glu_gated_geglu__prompt'

def setup_inputs():

    _w = lambda a: (lambda t: t.to(torch.bfloat16) if t.is_floating_point() else t)(torch.as_tensor(a))

    def _A_setup():
        B, Sq, D = (1, 2048, 576)
        Hq, Hkv, Sk, Dh = (32, 16, 2048, 128)
        assert Hq % Hkv == 0, (Hq, Hkv)
        return {'x': _w((lambda *s: torch.randn(*s, dtype=torch.bfloat16) * 0.05)(B, Sq, D)), 'k_cache': _w((lambda *s: torch.randn(*s, dtype=torch.bfloat16) * 1.6)(B, Hkv, Sk, Dh)), 'v_cache': _w((lambda *s: torch.randn(*s, dtype=torch.bfloat16) * 0.8)(B, Hkv, Sk, Dh)), 'wq': _w((lambda *s: torch.randn(*s, dtype=torch.bfloat16) * 1.6)(D, Hq * Dh) * D ** (-0.5)), 'wo': _w((lambda *s: torch.randn(*s, dtype=torch.bfloat16) * 0.8)(Hq * Dh, D) * (Hq * Dh) ** (-0.5))}
    _A_in = _A_setup()

    def _B_setup():
        B, S, Dm, Df = (1, 2048, 576, 4608)
        return {'x': _w((lambda *s: torch.randn(*s, dtype=torch.bfloat16) * 0.05)(B, S, Dm)), 'w_gate': _w((lambda *s: torch.randn(*s, dtype=torch.bfloat16) * 0.8)(Dm, Df) * Dm ** (-0.5)), 'w_up': _w((lambda *s: torch.randn(*s, dtype=torch.bfloat16) * 0.8)(Dm, Df) * Dm ** (-0.5)), 'w_down': _w((lambda *s: torch.randn(*s, dtype=torch.bfloat16) * 0.8)(Df, Dm) * Df ** (-0.5))}
    _B_in = _B_setup()
    return {'A_x': _A_in['x'], 'A_k_cache': _A_in['k_cache'], 'A_v_cache': _A_in['v_cache'], 'A_wq': _A_in['wq'], 'A_wo': _A_in['wo'], 'B_x': _B_in['x'], 'B_w_gate': _B_in['w_gate'], 'B_w_up': _B_in['w_up'], 'B_w_down': _B_in['w_down'], 'c': _w((lambda *s: torch.randn(*s, dtype=torch.bfloat16) * 0.1)(1, 576) * 8.0), 'w_mod': _w((lambda *s: torch.randn(*s, dtype=torch.bfloat16) * 0.1)(576, 6 * 576) * 576 ** (-0.5) * 8.0)}

def reference(A_x, A_k_cache, A_v_cache, A_wq, A_wo, B_x, B_w_gate, B_w_up, B_w_down, c, w_mod):

    def _A_ref(x, k_cache, v_cache, wq, wo):
        B, Sq, D = x.shape
        Hq, Dh = (32, 128)
        Hkv, Sk = (k_cache.shape[1], k_cache.shape[2])
        W = min(4096, max(256, Sk // 4))
        rep = Hq // Hkv
        q = (lambda x, *d: x.permute(*d))((x @ wq).reshape(B, Sq, Hq, Dh), 0, 2, 1, 3)
        k = (lambda x, n, axis: torch.repeat_interleave(x, n, dim=axis))(k_cache[:, :, Sk - W:, :], rep, axis=1)
        v = (lambda x, n, axis: torch.repeat_interleave(x, n, dim=axis))(v_cache[:, :, Sk - W:, :], rep, axis=1)
        scores = torch.einsum('bhqd,bhkd->bhqk', q, k) * Dh ** (-0.5)
        p = _softmax(scores, axis=-1)
        o = torch.einsum('bhqk,bhkd->bhqd', p, v)
        return (lambda x, *d: x.permute(*d))(o, 0, 2, 1, 3).reshape(B, Sq, Hq * Dh) @ wo

    def _B_ref(x, w_gate, w_up, w_down):
        g = torch.einsum('bsd,df->bsf', x, w_gate)
        u = torch.einsum('bsd,df->bsf', x, w_up)
        h = _gelu(g) * u
        return torch.einsum('bsf,fd->bsd', h, w_down)
    x = A_x
    mod = (_silu(c) @ w_mod).reshape(c.shape[0], 6, 1, -1)
    sa, ca, ga, sb, cb, gb = (mod[:, 0].clone(), mod[:, 1].clone(), mod[:, 2].clone(), mod[:, 3].clone(), mod[:, 4].clone(), mod[:, 5].clone())
    h = _layernorm(x, axis=-1) * (1 + ca) + sa
    x = x + ga * _A_ref(h, A_k_cache, A_v_cache, A_wq, A_wo)
    h = _layernorm(x, axis=-1) * (1 + cb) + sb
    x = x + gb * _B_ref(h, B_w_gate, B_w_up, B_w_down)
    return x
```

```asm
; @launch kernel=k0a_kernel grid=(320,1,1) block=(512,1,1) lds=8192
; @launch kernel=k0b_kernel grid=(256,1,1) block=(576,1,1) lds=1024
; @launch kernel=k1_kernel grid=(256,1,1) block=(512,1,1) lds=147456
; @launch kernel=k2_kernel grid=(256,1,1) block=(512,1,1) lds=147456
; @launch kernel=r1_kernel grid=(256,1,1) block=(576,1,1) lds=1024
; @launch kernel=k3_kernel grid=(256,1,1) block=(512,1,1) lds=150016
; @launch kernel=k4_kernel grid=(256,1,1) block=(512,1,1) lds=147456
; @launch kernel=r2_kernel grid=(256,1,1) block=(576,1,1) lds=1024
.amdgcn_target "amdgcn-amd-amdhsa--gfx950"
.text
.globl k0a_kernel
.p2align 8
.type k0a_kernel,@function
k0a_kernel:
s_cmp_ge_u32 s2, 320
s_cbranch_scc1 L_k0a_kernel_end
s_cmp_lt_u32 s2, 54
s_cbranch_scc1 L_k0a_main
s_cmp_lt_u32 s2, 64
s_cbranch_scc1 L_k0a_kernel_end
s_load_dwordx2 s[4:5], s[0:1], 24
s_mov_b32 s6, 0x480000
s_mov_b32 s7, 0x00020000
s_load_dwordx2 s[8:9], s[0:1], 0
s_mov_b32 s10, 0x240000
s_mov_b32 s11, 0x00020000
s_sub_u32 s20, s2, 64
s_and_b32 s21, s20, 3
s_lshr_b32 s20, s20, 3
v_lshrrev_b32 v1, 7, v0
v_and_b32 v2, 127, v0
v_lshlrev_b32 v2, 4, v2
v_lshl_add_u32 v2, v1, 13, v2
s_mul_i32 s22, s20, 18*8192
s_lshl_b32 s23, s21, 11
s_add_u32 s22, s22, s23
v_lshlrev_b32 v3, 4, v0
s_lshl_b32 s23, s21, 2
s_lshr_b32 s24, s20, 3
s_add_u32 s23, s23, s24
s_lshl_b32 s23, s23, 19
s_and_b32 s24, s20, 7
s_lshl_b32 s24, s24, 14
s_add_u32 s23, s23, s24
s_add_u32 s23, s23, 1536*256
s_waitcnt lgkmcnt(0)
buffer_load_dwordx4 v[4:7], v2, s[4:7], s22 offen
s_add_u32 s22, s22, 32768
buffer_load_dwordx4 v[8:11], v2, s[4:7], s22 offen
s_add_u32 s22, s22, 32768
buffer_load_dwordx4 v[12:15], v2, s[4:7], s22 offen
s_add_u32 s22, s22, 32768
buffer_load_dwordx4 v[16:19], v2, s[4:7], s22 offen
s_add_u32 s22, s22, 16384
buffer_load_dwordx4 v[20:23], v2, s[4:7], s22 offen
s_add_u32 s22, s22, 16384
v_min_u32 v3, 71, v0
v_lshlrev_b32 v3, 7, v3
s_sub_u32 s23, s2, 64
s_mul_i32 s23, s23, 9216
buffer_load_dword v24, v3, s[8:11], s23 offen
s_waitcnt vmcnt(0)
s_endpgm
L_k0a_main:
s_load_dwordx2 s[4:5], s[0:1], 72
s_mov_b32 s6, 0x480
s_mov_b32 s7, 0x00020000
s_load_dwordx2 s[8:9], s[0:1], 80
s_mov_b32 s10, 0x3cc000
s_mov_b32 s11, 0x00020000
s_load_dwordx2 s[12:13], s[0:1], 104
s_mov_b32 s14, 0x10000000
s_mov_b32 s15, 0x00020000
v_lshrrev_b32 v1, 6, v0
v_and_b32 v2, 63, v0
v_lshrrev_b32 v3, 3, v2
v_mul_u32_u24 v4, 72, v1
v_add_u32 v4, v4, v3
v_lshlrev_b32 v5, 1, v4
v_mul_u32_u24 v6, 6912, v4
v_and_b32 v7, 7, v0
v_lshlrev_b32 v7, 4, v7
v_add_u32 v6, v6, v7
s_lshl_b32 s16, s2, 7
s_waitcnt lgkmcnt(0)
buffer_load_ushort v10, v5, s[4:7], 0 offen offset:0
buffer_load_ushort v11, v5, s[4:7], 0 offen offset:16
buffer_load_ushort v12, v5, s[4:7], 0 offen offset:32
buffer_load_ushort v13, v5, s[4:7], 0 offen offset:48
buffer_load_ushort v14, v5, s[4:7], 0 offen offset:64
buffer_load_ushort v15, v5, s[4:7], 0 offen offset:80
buffer_load_ushort v16, v5, s[4:7], 0 offen offset:96
buffer_load_ushort v17, v5, s[4:7], 0 offen offset:112
buffer_load_ushort v18, v5, s[4:7], 0 offen offset:128
buffer_load_dwordx4 v[20:23], v6, s[8:11], s16 offen
s_add_u32 s16, s16, 55296
buffer_load_dwordx4 v[24:27], v6, s[8:11], s16 offen
s_add_u32 s16, s16, 55296
buffer_load_dwordx4 v[28:31], v6, s[8:11], s16 offen
s_add_u32 s16, s16, 55296
buffer_load_dwordx4 v[32:35], v6, s[8:11], s16 offen
s_add_u32 s16, s16, 55296
buffer_load_dwordx4 v[36:39], v6, s[8:11], s16 offen
s_add_u32 s16, s16, 55296
buffer_load_dwordx4 v[40:43], v6, s[8:11], s16 offen
s_add_u32 s16, s16, 55296
buffer_load_dwordx4 v[44:47], v6, s[8:11], s16 offen
s_add_u32 s16, s16, 55296
buffer_load_dwordx4 v[48:51], v6, s[8:11], s16 offen
s_add_u32 s16, s16, 55296
buffer_load_dwordx4 v[52:55], v6, s[8:11], s16 offen
s_add_u32 s16, s16, 55296
s_waitcnt vmcnt(9)
v_lshlrev_b32 v10, 16, v10
v_mul_f32 v60, 0xbfb8aa3b, v10
v_exp_f32 v60, v60
s_nop 0
v_add_f32 v60, 1.0, v60
v_rcp_f32 v60, v60
s_nop 0
v_mul_f32 v10, v10, v60
v_cvt_pk_bf16_f32 v10, v10, v10
v_lshlrev_b32 v10, 16, v10
v_lshlrev_b32 v11, 16, v11
v_mul_f32 v60, 0xbfb8aa3b, v11
v_exp_f32 v60, v60
s_nop 0
v_add_f32 v60, 1.0, v60
v_rcp_f32 v60, v60
s_nop 0
v_mul_f32 v11, v11, v60
v_cvt_pk_bf16_f32 v11, v11, v11
v_lshlrev_b32 v11, 16, v11
v_lshlrev_b32 v12, 16, v12
v_mul_f32 v60, 0xbfb8aa3b, v12
v_exp_f32 v60, v60
s_nop 0
v_add_f32 v60, 1.0, v60
v_rcp_f32 v60, v60
s_nop 0
v_mul_f32 v12, v12, v60
v_cvt_pk_bf16_f32 v12, v12, v12
v_lshlrev_b32 v12, 16, v12
v_lshlrev_b32 v13, 16, v13
v_mul_f32 v60, 0xbfb8aa3b, v13
v_exp_f32 v60, v60
s_nop 0
v_add_f32 v60, 1.0, v60
v_rcp_f32 v60, v60
s_nop 0
v_mul_f32 v13, v13, v60
v_cvt_pk_bf16_f32 v13, v13, v13
v_lshlrev_b32 v13, 16, v13
v_lshlrev_b32 v14, 16, v14
v_mul_f32 v60, 0xbfb8aa3b, v14
v_exp_f32 v60, v60
s_nop 0
v_add_f32 v60, 1.0, v60
v_rcp_f32 v60, v60
s_nop 0
v_mul_f32 v14, v14, v60
v_cvt_pk_bf16_f32 v14, v14, v14
v_lshlrev_b32 v14, 16, v14
v_lshlrev_b32 v15, 16, v15
v_mul_f32 v60, 0xbfb8aa3b, v15
v_exp_f32 v60, v60
s_nop 0
v_add_f32 v60, 1.0, v60
v_rcp_f32 v60, v60
s_nop 0
v_mul_f32 v15, v15, v60
v_cvt_pk_bf16_f32 v15, v15, v15
v_lshlrev_b32 v15, 16, v15
v_lshlrev_b32 v16, 16, v16
v_mul_f32 v60, 0xbfb8aa3b, v16
v_exp_f32 v60, v60
s_nop 0
v_add_f32 v60, 1.0, v60
v_rcp_f32 v60, v60
s_nop 0
v_mul_f32 v16, v16, v60
v_cvt_pk_bf16_f32 v16, v16, v16
v_lshlrev_b32 v16, 16, v16
v_lshlrev_b32 v17, 16, v17
v_mul_f32 v60, 0xbfb8aa3b, v17
v_exp_f32 v60, v60
s_nop 0
v_add_f32 v60, 1.0, v60
v_rcp_f32 v60, v60
s_nop 0
v_mul_f32 v17, v17, v60
v_cvt_pk_bf16_f32 v17, v17, v17
v_lshlrev_b32 v17, 16, v17
v_lshlrev_b32 v18, 16, v18
v_mul_f32 v60, 0xbfb8aa3b, v18
v_exp_f32 v60, v60
s_nop 0
v_add_f32 v60, 1.0, v60
v_rcp_f32 v60, v60
s_nop 0
v_mul_f32 v18, v18, v60
v_cvt_pk_bf16_f32 v18, v18, v18
v_lshlrev_b32 v18, 16, v18
v_mov_b32 v64, 0
v_mov_b32 v65, 0
v_mov_b32 v66, 0
v_mov_b32 v67, 0
v_mov_b32 v68, 0
v_mov_b32 v69, 0
v_mov_b32 v70, 0
v_mov_b32 v71, 0
s_waitcnt vmcnt(8)
v_lshlrev_b32 v72, 16, v20
v_and_b32 v73, 0xffff0000, v20
v_lshlrev_b32 v74, 16, v21
v_and_b32 v75, 0xffff0000, v21
v_lshlrev_b32 v76, 16, v22
v_and_b32 v77, 0xffff0000, v22
v_lshlrev_b32 v78, 16, v23
v_and_b32 v79, 0xffff0000, v23
v_fmac_f32 v64, v72, v10
v_fmac_f32 v65, v73, v10
v_fmac_f32 v66, v74, v10
v_fmac_f32 v67, v75, v10
v_fmac_f32 v68, v76, v10
v_fmac_f32 v69, v77, v10
v_fmac_f32 v70, v78, v10
v_fmac_f32 v71, v79, v10
s_waitcnt vmcnt(7)
v_lshlrev_b32 v72, 16, v24
v_and_b32 v73, 0xffff0000, v24
v_lshlrev_b32 v74, 16, v25
v_and_b32 v75, 0xffff0000, v25
v_lshlrev_b32 v76, 16, v26
v_and_b32 v77, 0xffff0000, v26
v_lshlrev_b32 v78, 16, v27
v_and_b32 v79, 0xffff0000, v27
v_fmac_f32 v64, v72, v11
v_fmac_f32 v65, v73, v11
v_fmac_f32 v66, v74, v11
v_fmac_f32 v67, v75, v11
v_fmac_f32 v68, v76, v11
v_fmac_f32 v69, v77, v11
v_fmac_f32 v70, v78, v11
v_fmac_f32 v71, v79, v11
s_waitcnt vmcnt(6)
v_lshlrev_b32 v72, 16, v28
v_and_b32 v73, 0xffff0000, v28
v_lshlrev_b32 v74, 16, v29
v_and_b32 v75, 0xffff0000, v29
v_lshlrev_b32 v76, 16, v30
v_and_b32 v77, 0xffff0000, v30
v_lshlrev_b32 v78, 16, v31
v_and_b32 v79, 0xffff0000, v31
v_fmac_f32 v64, v72, v12
v_fmac_f32 v65, v73, v12
v_fmac_f32 v66, v74, v12
v_fmac_f32 v67, v75, v12
v_fmac_f32 v68, v76, v12
v_fmac_f32 v69, v77, v12
v_fmac_f32 v70, v78, v12
v_fmac_f32 v71, v79, v12
s_waitcnt vmcnt(5)
v_lshlrev_b32 v72, 16, v32
v_and_b32 v73, 0xffff0000, v32
v_lshlrev_b32 v74, 16, v33
v_and_b32 v75, 0xffff0000, v33
v_lshlrev_b32 v76, 16, v34
v_and_b32 v77, 0xffff0000, v34
v_lshlrev_b32 v78, 16, v35
v_and_b32 v79, 0xffff0000, v35
v_fmac_f32 v64, v72, v13
v_fmac_f32 v65, v73, v13
v_fmac_f32 v66, v74, v13
v_fmac_f32 v67, v75, v13
v_fmac_f32 v68, v76, v13
v_fmac_f32 v69, v77, v13
v_fmac_f32 v70, v78, v13
v_fmac_f32 v71, v79, v13
s_waitcnt vmcnt(4)
v_lshlrev_b32 v72, 16, v36
v_and_b32 v73, 0xffff0000, v36
v_lshlrev_b32 v74, 16, v37
v_and_b32 v75, 0xffff0000, v37
v_lshlrev_b32 v76, 16, v38
v_and_b32 v77, 0xffff0000, v38
v_lshlrev_b32 v78, 16, v39
v_and_b32 v79, 0xffff0000, v39
v_fmac_f32 v64, v72, v14
v_fmac_f32 v65, v73, v14
v_fmac_f32 v66, v74, v14
v_fmac_f32 v67, v75, v14
v_fmac_f32 v68, v76, v14
v_fmac_f32 v69, v77, v14
v_fmac_f32 v70, v78, v14
v_fmac_f32 v71, v79, v14
s_waitcnt vmcnt(3)
v_lshlrev_b32 v72, 16, v40
v_and_b32 v73, 0xffff0000, v40
v_lshlrev_b32 v74, 16, v41
v_and_b32 v75, 0xffff0000, v41
v_lshlrev_b32 v76, 16, v42
v_and_b32 v77, 0xffff0000, v42
v_lshlrev_b32 v78, 16, v43
v_and_b32 v79, 0xffff0000, v43
v_fmac_f32 v64, v72, v15
v_fmac_f32 v65, v73, v15
v_fmac_f32 v66, v74, v15
v_fmac_f32 v67, v75, v15
v_fmac_f32 v68, v76, v15
v_fmac_f32 v69, v77, v15
v_fmac_f32 v70, v78, v15
v_fmac_f32 v71, v79, v15
s_waitcnt vmcnt(2)
v_lshlrev_b32 v72, 16, v44
v_and_b32 v73, 0xffff0000, v44
v_lshlrev_b32 v74, 16, v45
v_and_b32 v75, 0xffff0000, v45
v_lshlrev_b32 v76, 16, v46
v_and_b32 v77, 0xffff0000, v46
v_lshlrev_b32 v78, 16, v47
v_and_b32 v79, 0xffff0000, v47
v_fmac_f32 v64, v72, v16
v_fmac_f32 v65, v73, v16
v_fmac_f32 v66, v74, v16
v_fmac_f32 v67, v75, v16
v_fmac_f32 v68, v76, v16
v_fmac_f32 v69, v77, v16
v_fmac_f32 v70, v78, v16
v_fmac_f32 v71, v79, v16
s_waitcnt vmcnt(1)
v_lshlrev_b32 v72, 16, v48
v_and_b32 v73, 0xffff0000, v48
v_lshlrev_b32 v74, 16, v49
v_and_b32 v75, 0xffff0000, v49
v_lshlrev_b32 v76, 16, v50
v_and_b32 v77, 0xffff0000, v50
v_lshlrev_b32 v78, 16, v51
v_and_b32 v79, 0xffff0000, v51
v_fmac_f32 v64, v72, v17
v_fmac_f32 v65, v73, v17
v_fmac_f32 v66, v74, v17
v_fmac_f32 v67, v75, v17
v_fmac_f32 v68, v76, v17
v_fmac_f32 v69, v77, v17
v_fmac_f32 v70, v78, v17
v_fmac_f32 v71, v79, v17
s_waitcnt vmcnt(0)
v_lshlrev_b32 v72, 16, v52
v_and_b32 v73, 0xffff0000, v52
v_lshlrev_b32 v74, 16, v53
v_and_b32 v75, 0xffff0000, v53
v_lshlrev_b32 v76, 16, v54
v_and_b32 v77, 0xffff0000, v54
v_lshlrev_b32 v78, 16, v55
v_and_b32 v79, 0xffff0000, v55
v_fmac_f32 v64, v72, v18
v_fmac_f32 v65, v73, v18
v_fmac_f32 v66, v74, v18
v_fmac_f32 v67, v75, v18
v_fmac_f32 v68, v76, v18
v_fmac_f32 v69, v77, v18
v_fmac_f32 v70, v78, v18
v_fmac_f32 v71, v79, v18
v_add_f32_dpp v64, v64, v64 row_ror:8 row_mask:0xf bank_mask:0xf
v_mov_b32 v80, v64
s_nop 1
v_permlane16_swap_b32 v64, v80
v_add_f32 v64, v64, v80
v_mov_b32 v80, v64
s_nop 1
v_permlane32_swap_b32 v64, v80
v_add_f32 v64, v64, v80
v_add_f32_dpp v65, v65, v65 row_ror:8 row_mask:0xf bank_mask:0xf
v_mov_b32 v81, v65
s_nop 1
v_permlane16_swap_b32 v65, v81
v_add_f32 v65, v65, v81
v_mov_b32 v81, v65
s_nop 1
v_permlane32_swap_b32 v65, v81
v_add_f32 v65, v65, v81
v_add_f32_dpp v66, v66, v66 row_ror:8 row_mask:0xf bank_mask:0xf
v_mov_b32 v82, v66
s_nop 1
v_permlane16_swap_b32 v66, v82
v_add_f32 v66, v66, v82
v_mov_b32 v82, v66
s_nop 1
v_permlane32_swap_b32 v66, v82
v_add_f32 v66, v66, v82
v_add_f32_dpp v67, v67, v67 row_ror:8 row_mask:0xf bank_mask:0xf
v_mov_b32 v83, v67
s_nop 1
v_permlane16_swap_b32 v67, v83
v_add_f32 v67, v67, v83
v_mov_b32 v83, v67
s_nop 1
v_permlane32_swap_b32 v67, v83
v_add_f32 v67, v67, v83
v_add_f32_dpp v68, v68, v68 row_ror:8 row_mask:0xf bank_mask:0xf
v_mov_b32 v84, v68
s_nop 1
v_permlane16_swap_b32 v68, v84
v_add_f32 v68, v68, v84
v_mov_b32 v84, v68
s_nop 1
v_permlane32_swap_b32 v68, v84
v_add_f32 v68, v68, v84
v_add_f32_dpp v69, v69, v69 row_ror:8 row_mask:0xf bank_mask:0xf
v_mov_b32 v85, v69
s_nop 1
v_permlane16_swap_b32 v69, v85
v_add_f32 v69, v69, v85
v_mov_b32 v85, v69
s_nop 1
v_permlane32_swap_b32 v69, v85
v_add_f32 v69, v69, v85
v_add_f32_dpp v70, v70, v70 row_ror:8 row_mask:0xf bank_mask:0xf
v_mov_b32 v86, v70
s_nop 1
v_permlane16_swap_b32 v70, v86
v_add_f32 v70, v70, v86
v_mov_b32 v86, v70
s_nop 1
v_permlane32_swap_b32 v70, v86
v_add_f32 v70, v70, v86
v_add_f32_dpp v71, v71, v71 row_ror:8 row_mask:0xf bank_mask:0xf
v_mov_b32 v87, v71
s_nop 1
v_permlane16_swap_b32 v71, v87
v_add_f32 v71, v71, v87
v_mov_b32 v87, v71
s_nop 1
v_permlane32_swap_b32 v71, v87
v_add_f32 v71, v71, v87
v_lshlrev_b32 v8, 8, v1
v_lshlrev_b32 v9, 5, v2
v_add_u32 v8, v8, v9
v_cmp_gt_u32 vcc, 8, v2
s_nop 1
s_and_saveexec_b64 s[20:21], vcc
ds_write_b128 v8, v[64:67]
ds_write_b128 v8, v[68:71] offset:16
s_mov_b64 exec, s[20:21]
s_waitcnt lgkmcnt(0)
s_barrier
v_readfirstlane_b32 s22, v1
s_nop 1
s_cmp_lg_u32 s22, 0
s_cbranch_scc1 L_k0a_kernel_end
v_lshlrev_b32 v8, 2, v2
ds_read_b32 v64, v8 offset:0
ds_read_b32 v65, v8 offset:256
ds_read_b32 v66, v8 offset:512
ds_read_b32 v67, v8 offset:768
ds_read_b32 v68, v8 offset:1024
ds_read_b32 v69, v8 offset:1280
ds_read_b32 v70, v8 offset:1536
ds_read_b32 v71, v8 offset:1792
s_waitcnt lgkmcnt(0)
v_add_f32 v64, v64, v65
v_add_f32 v64, v64, v66
v_add_f32 v64, v64, v67
v_add_f32 v64, v64, v68
v_add_f32 v64, v64, v69
v_add_f32 v64, v64, v70
v_add_f32 v64, v64, v71
v_cvt_pk_bf16_f32 v64, v64, v64
v_lshlrev_b32 v64, 16, v64
s_lshl_b32 s16, s2, 8
buffer_store_dword v64, v8, s[12:15], s16 offen offset:0 sc1
L_k0a_kernel_end:
s_endpgm
.globl k0b_kernel
.p2align 8
.type k0b_kernel,@function
k0b_kernel:
s_cmp_ge_u32 s2, 256
s_cbranch_scc1 L_k0b_kernel_end
s_cmp_lt_u32 s2, 256
s_cbranch_scc1 L_k0b_main
s_load_dwordx2 s[8:9], s[0:1], 8
s_mov_b32 s10, 0x800000
s_mov_b32 s11, 0x00020000
s_load_dwordx2 s[16:17], s[0:1], 16
s_mov_b32 s18, 0x800000
s_mov_b32 s19, 0x00020000
s_sub_u32 s20, s2, 256
s_and_b32 s21, s20, 3
s_lshr_b32 s20, s20, 3
v_min_u32 v3, 511, v0
v_lshlrev_b32 v3, 4, v3
s_lshl_b32 s23, s21, 2
s_lshr_b32 s24, s20, 3
s_add_u32 s23, s23, s24
s_lshl_b32 s23, s23, 19
s_and_b32 s24, s20, 7
s_lshl_b32 s24, s24, 14
s_add_u32 s23, s23, s24
s_add_u32 s23, s23, 1536*256
s_waitcnt lgkmcnt(0)
buffer_load_dwordx4 v[24:27], v3, s[8:11], s23 offen
buffer_load_dwordx4 v[28:31], v3, s[16:19], s23 offen
s_add_u32 s23, s23, 8192
buffer_load_dwordx4 v[32:35], v3, s[8:11], s23 offen
buffer_load_dwordx4 v[36:39], v3, s[16:19], s23 offen
s_add_u32 s23, s23, 8192
s_waitcnt vmcnt(0)
s_endpgm
L_k0b_main:
s_load_dwordx2 s[4:5], s[0:1], 0
s_mov_b32 s6, 0x240000
s_mov_b32 s7, 0x00020000
s_load_dwordx2 s[12:13], s[0:1], 104
s_mov_b32 s14, 0x10000000
s_mov_b32 s15, 0x00020000
v_lshrrev_b32 v1, 3, v0
v_and_b32 v2, 7, v0
s_lshl_b32 s16, s2, 3
v_add_u32 v3, s16, v2
v_mul_u32_u24 v4, 1152, v3
v_lshl_add_u32 v4, v1, 4, v4
s_lshr_b32 s17, s2, 2
s_mul_i32 s17, s17, 72*512
v_and_b32 v5, 31, v3
v_lshlrev_b32 v5, 4, v5
v_lshl_add_u32 v5, v1, 9, v5
v_add_u32 v5, s17, v5
v_lshlrev_b32 v6, 5, v1
s_waitcnt lgkmcnt(0)
buffer_load_dwordx4 v[8:11], v4, s[4:7], 0 offen
s_movk_i32 s18, 2304
buffer_load_dwordx4 v[40:43], v6, s[12:15], s18 offen
buffer_load_dwordx4 v[44:47], v6, s[12:15], s18 offen offset:16
s_movk_i32 s18, 0
buffer_load_dwordx4 v[48:51], v6, s[12:15], s18 offen
buffer_load_dwordx4 v[52:55], v6, s[12:15], s18 offen offset:16
s_waitcnt vmcnt(4)
v_lshlrev_b32 v56, 16, v8
v_and_b32 v57, 0xffff0000, v8
v_lshlrev_b32 v58, 16, v9
v_and_b32 v59, 0xffff0000, v9
v_lshlrev_b32 v60, 16, v10
v_and_b32 v61, 0xffff0000, v10
v_lshlrev_b32 v62, 16, v11
v_and_b32 v63, 0xffff0000, v11
v_add_f32 v80, v56, v57
v_mul_f32 v81, v56, v56
v_fmac_f32 v81, v57, v57
v_add_f32 v80, v80, v58
v_fmac_f32 v81, v58, v58
v_add_f32 v80, v80, v59
v_fmac_f32 v81, v59, v59
v_add_f32 v80, v80, v60
v_fmac_f32 v81, v60, v60
v_add_f32 v80, v80, v61
v_fmac_f32 v81, v61, v61
v_add_f32 v80, v80, v62
v_fmac_f32 v81, v62, v62
v_add_f32 v80, v80, v63
v_fmac_f32 v81, v63, v63
s_nop 0
v_add_f32_dpp v80, v80, v80 row_ror:8 row_mask:0xf bank_mask:0xf
v_mov_b32 v82, v80
s_nop 1
v_permlane16_swap_b32 v80, v82
v_add_f32 v80, v80, v82
v_mov_b32 v82, v80
s_nop 1
v_permlane32_swap_b32 v80, v82
v_add_f32 v80, v80, v82
v_add_f32_dpp v81, v81, v81 row_ror:8 row_mask:0xf bank_mask:0xf
v_mov_b32 v83, v81
s_nop 1
v_permlane16_swap_b32 v81, v83
v_add_f32 v81, v81, v83
v_mov_b32 v83, v81
s_nop 1
v_permlane32_swap_b32 v81, v83
v_add_f32 v81, v81, v83
v_lshrrev_b32 v84, 6, v0
v_lshlrev_b32 v84, 3, v84
v_lshl_add_u32 v84, v2, 7, v84
v_lshlrev_b32 v85, 7, v2
ds_write_b64 v84, v[80:81]
s_waitcnt lgkmcnt(0)
s_barrier
ds_read_b64 v[88:89], v85 offset:0
ds_read_b64 v[90:91], v85 offset:8
ds_read_b64 v[92:93], v85 offset:16
ds_read_b64 v[94:95], v85 offset:24
ds_read_b64 v[96:97], v85 offset:32
ds_read_b64 v[98:99], v85 offset:40
ds_read_b64 v[100:101], v85 offset:48
ds_read_b64 v[102:103], v85 offset:56
ds_read_b64 v[104:105], v85 offset:64
s_waitcnt vmcnt(0)
v_add_f32 v40, 1.0, v40
v_add_f32 v41, 1.0, v41
v_add_f32 v42, 1.0, v42
v_add_f32 v43, 1.0, v43
v_add_f32 v44, 1.0, v44
v_add_f32 v45, 1.0, v45
v_add_f32 v46, 1.0, v46
v_add_f32 v47, 1.0, v47
v_cvt_pk_bf16_f32 v12, v40, v41
v_cvt_pk_bf16_f32 v13, v42, v43
v_cvt_pk_bf16_f32 v14, v44, v45
v_cvt_pk_bf16_f32 v15, v46, v47
v_lshlrev_b32 v40, 16, v12
v_and_b32 v41, 0xffff0000, v12
v_lshlrev_b32 v42, 16, v13
v_and_b32 v43, 0xffff0000, v13
v_lshlrev_b32 v44, 16, v14
v_and_b32 v45, 0xffff0000, v14
v_lshlrev_b32 v46, 16, v15
v_and_b32 v47, 0xffff0000, v15
s_waitcnt lgkmcnt(0)
v_add_f32 v88, v88, v90
v_add_f32 v89, v89, v91
v_add_f32 v88, v88, v92
v_add_f32 v89, v89, v93
v_add_f32 v88, v88, v94
v_add_f32 v89, v89, v95
v_add_f32 v88, v88, v96
v_add_f32 v89, v89, v97
v_add_f32 v88, v88, v98
v_add_f32 v89, v89, v99
v_add_f32 v88, v88, v100
v_add_f32 v89, v89, v101
v_add_f32 v88, v88, v102
v_add_f32 v89, v89, v103
v_add_f32 v88, v88, v104
v_add_f32 v89, v89, v105
v_mul_f32 v88, 0x3ae38e39, v88
v_mul_f32 v89, 0x3ae38e39, v89
v_fma_f32 v89, -v88, v88, v89
v_max_f32 v89, 0, v89
v_add_f32 v89, 0x3727c5ac, v89
v_rsq_f32 v89, v89
v_sub_f32 v56, v56, v88
v_mul_f32 v40, v40, v89
v_fma_f32 v56, v56, v40, v48
v_sub_f32 v57, v57, v88
v_mul_f32 v41, v41, v89
v_fma_f32 v57, v57, v41, v49
v_sub_f32 v58, v58, v88
v_mul_f32 v42, v42, v89
v_fma_f32 v58, v58, v42, v50
v_sub_f32 v59, v59, v88
v_mul_f32 v43, v43, v89
v_fma_f32 v59, v59, v43, v51
v_sub_f32 v60, v60, v88
v_mul_f32 v44, v44, v89
v_fma_f32 v60, v60, v44, v52
v_sub_f32 v61, v61, v88
v_mul_f32 v45, v45, v89
v_fma_f32 v61, v61, v45, v53
v_sub_f32 v62, v62, v88
v_mul_f32 v46, v46, v89
v_fma_f32 v62, v62, v46, v54
v_sub_f32 v63, v63, v88
v_mul_f32 v47, v47, v89
v_fma_f32 v63, v63, v47, v55
v_cvt_pk_bf16_f32 v16, v56, v57
v_cvt_pk_bf16_f32 v17, v58, v59
v_cvt_pk_bf16_f32 v18, v60, v61
v_cvt_pk_bf16_f32 v19, v62, v63
s_mov_b32 s19, 65536
buffer_store_dwordx4 v[16:19], v5, s[12:15], s19 offen sc1
s_waitcnt vmcnt(0)
L_k0b_kernel_end:
s_endpgm
.globl k1_kernel
.p2align 8
.type k1_kernel,@function
k1_kernel:
s_cmp_ge_u32 s2, 256
s_cbranch_scc1 L_k1_kernel_end
s_load_dwordx2 s[4:5], s[0:1], 24
s_mov_b32 s6, 0x480000
s_mov_b32 s7, 0x00020000
s_load_dwordx2 s[8:9], s[0:1], 8
s_mov_b32 s10, 0x800000
s_mov_b32 s11, 0x00020000
s_load_dwordx2 s[16:17], s[0:1], 16
s_mov_b32 s18, 0x800000
s_mov_b32 s19, 0x00020000
s_load_dwordx2 s[12:13], s[0:1], 104
s_mov_b32 s14, 0x10000000
s_mov_b32 s15, 0x00020000
s_load_dwordx2 s[48:49], s[0:1], 32
s_mov_b32 s50, 0x480000
s_mov_b32 s51, 0x00020000
s_load_dwordx2 s[52:53], s[0:1], 0
s_mov_b32 s54, 0x240000
s_mov_b32 s55, 0x00020000
s_load_dwordx2 s[56:57], s[0:1], 96
s_mov_b32 s58, 0x100
s_mov_b32 s59, 0x00020000
s_load_dwordx2 s[72:73], s[0:1], 72
s_mov_b32 s74, 0x480
s_mov_b32 s75, 0x00020000
s_load_dwordx2 s[96:97], s[0:1], 80
s_mov_b32 s98, 0x3cc000
s_mov_b32 s99, 0x00020000
s_and_b32 s20, s2, 3
s_lshl_b32 s20, s20, 3
s_bfe_u32 s21, s2, 0x30003
s_add_u32 s20, s20, s21
s_bfe_u32 s21, s2, 0x10002
s_lshl_b32 s21, s21, 2
s_lshr_b32 s22, s2, 6
s_add_u32 s21, s21, s22
v_lshrrev_b32 v1, 6, v0
v_and_b32 v0, 63, v0
v_readfirstlane_b32 s22, v1
s_lshl_b32 s23, s21, 3
s_nop 0
s_add_u32 s23, s23, s22
s_lshl_b32 s30, s22, 10
s_lshl_b32 s31, s20, 8
s_lshl_b32 s24, s22, 15
s_add_u32 s31, s31, s24
s_lshr_b32 s32, s20, 1
s_lshl_b32 s32, s32, 19
s_add_u32 s32, s32, 393216
s_add_u32 s32, s32, s30
s_mul_i32 s33, s23, 36864
s_add_u32 s33, s33, 65536
s_lshl_b32 s34, s23, 18
s_lshl_b32 s24, s20, 13
s_add_u32 s34, s34, s24
s_add_u32 s34, s34, 20971520
s_mov_b32 s40, 0x3f803f80
s_mov_b32 s41, 0x4b800000
s_mov_b32 s42, 0x3e0293ee
s_bfe_u32 s25, s2, 0x20003
v_lshlrev_b32 v7, 4, v0
v_lshrrev_b32 v1, 4, v0
v_and_b32 v2, 15, v0
v_lshlrev_b32 v3, 2, v1
v_xor_b32 v3, v3, v2
v_lshlrev_b32 v3, 4, v3
v_lshl_add_u32 v4, v1, 8, v3
v_lshl_add_u32 v6, v1, 13, v3
s_and_b32 s24, s22, 3
s_lshl_b32 s24, s24, 2
v_add_u32 v3, s24, v1
v_xor_b32 v3, v3, v2
v_lshlrev_b32 v3, 4, v3
v_lshl_add_u32 v5, v1, 8, v3
s_waitcnt lgkmcnt(0)
s_add_u32 s26, s25, 0
s_and_b32 s26, s26, 3
s_lshl_b32 s27, s26, 20
s_add_u32 s60, s31, s27
s_lshl_b32 s27, s26, 13
s_add_u32 s64, s33, s27
s_add_u32 s26, s25, 1
s_and_b32 s26, s26, 3
s_lshl_b32 s27, s26, 20
s_add_u32 s61, s31, s27
s_lshl_b32 s27, s26, 13
s_add_u32 s65, s33, s27
s_add_u32 s26, s25, 2
s_and_b32 s26, s26, 3
s_lshl_b32 s27, s26, 20
s_add_u32 s62, s31, s27
s_lshl_b32 s27, s26, 13
s_add_u32 s66, s33, s27
s_add_u32 s26, s25, 3
s_and_b32 s26, s26, 3
s_lshl_b32 s27, s26, 20
s_add_u32 s63, s31, s27
s_lshl_b32 s27, s26, 13
s_add_u32 s67, s33, s27
s_add_u32 s68, s33, 32768
s_lshl_b32 s77, s21, 8
s_lshl_b32 s45, s20, 3
s_add_u32 s77, s77, s45
s_lshl_b32 s47, s21, 4
s_add_u32 s35, s60, 0
s_add_u32 m0, s30, 0
s_nop 0
buffer_load_dwordx4 v6, s[4:7], s35 offen lds
s_add_u32 s35, s60, 262144
s_add_u32 m0, s30, 8192
s_nop 0
buffer_load_dwordx4 v6, s[4:7], s35 offen lds
s_add_u32 s35, s60, 524288
s_add_u32 m0, s30, 16384
s_nop 0
buffer_load_dwordx4 v6, s[4:7], s35 offen lds
s_add_u32 s35, s60, 786432
s_add_u32 m0, s30, 24576
s_nop 0
buffer_load_dwordx4 v6, s[4:7], s35 offen lds
s_add_u32 s36, s64, 0
buffer_load_dwordx4 v[120:123], v7, s[12:15], s36 offen offset:0
buffer_load_dwordx4 v[124:127], v7, s[12:15], s36 offen offset:1024
buffer_load_dwordx4 v[128:131], v7, s[12:15], s36 offen offset:2048
buffer_load_dwordx4 v[132:135], v7, s[12:15], s36 offen offset:3072
s_add_u32 s36, s64, 4096
buffer_load_dwordx4 v[136:139], v7, s[12:15], s36 offen offset:0
buffer_load_dwordx4 v[140:143], v7, s[12:15], s36 offen offset:1024
buffer_load_dwordx4 v[144:147], v7, s[12:15], s36 offen offset:2048
buffer_load_dwordx4 v[148:151], v7, s[12:15], s36 offen offset:3072
v_lshrrev_b32 v1, 5, v0
v_bfe_u32 v2, v0, 2, 2
v_lshl_add_u32 v1, v1, 3, v2
v_lshlrev_b32 v1, 8, v1
v_bfe_u32 v3, v0, 4, 1
v_lshl_add_u32 v1, v3, 5, v1
v_and_b32 v3, 1, v0
v_lshl_add_u32 v1, v3, 4, v1
v_bfe_u32 v3, v0, 1, 1
v_lshl_add_u32 v1, v3, 3, v1
v_add_u32 v1, 0, v1
v_xor_b32 v3, 0, v2
v_lshl_add_u32 v44, v3, 6, v1
v_xor_b32 v3, 1, v2
v_lshl_add_u32 v45, v3, 6, v1
v_xor_b32 v3, 2, v2
v_lshl_add_u32 v46, v3, 6, v1
v_xor_b32 v3, 3, v2
v_lshl_add_u32 v47, v3, 6, v1
v_lshrrev_b32 v1, 5, v0
v_bfe_u32 v2, v0, 2, 2
v_lshl_add_u32 v1, v1, 3, v2
v_lshlrev_b32 v1, 8, v1
v_bfe_u32 v3, v0, 4, 1
v_lshl_add_u32 v1, v3, 5, v1
v_and_b32 v3, 1, v0
v_lshl_add_u32 v1, v3, 4, v1
v_bfe_u32 v3, v0, 1, 1
v_lshl_add_u32 v1, v3, 3, v1
v_add_u32 v1, 65536, v1
v_xor_b32 v3, 0, v2
v_lshl_add_u32 v8, v3, 6, v1
v_xor_b32 v3, 1, v2
v_lshl_add_u32 v9, v3, 6, v1
v_xor_b32 v3, 2, v2
v_lshl_add_u32 v10, v3, 6, v1
v_xor_b32 v3, 3, v2
v_lshl_add_u32 v11, v3, 6, v1
v_and_b32 v1, 0x13, v0
v_and_b32 v2, 4, v0
v_lshl_or_b32 v1, v2, 1, v1
v_bfe_u32 v2, v0, 3, 1
v_lshl_or_b32 v1, v2, 2, v1
v_and_b32 v2, 15, v1
v_lshrrev_b32 v3, 5, v0
v_xor_b32 v2, v2, v3
v_lshlrev_b32 v2, 4, v2
v_lshl_add_u32 v12, v1, 8, v2
v_xor_b32 v13, 32, v12
v_xor_b32 v14, 64, v12
v_xor_b32 v15, 96, v12
v_xor_b32 v16, 128, v12
v_xor_b32 v17, 160, v12
v_xor_b32 v18, 192, v12
v_xor_b32 v19, 224, v12
s_waitcnt vmcnt(8)
s_barrier
ds_read_b64_tr_b16 v[20:21], v44 offset:0
ds_read_b64_tr_b16 v[22:23], v44 offset:1024
ds_read_b64_tr_b16 v[24:25], v45 offset:0
ds_read_b64_tr_b16 v[26:27], v45 offset:1024
ds_read_b64_tr_b16 v[28:29], v46 offset:0
ds_read_b64_tr_b16 v[30:31], v46 offset:1024
ds_read_b64_tr_b16 v[32:33], v47 offset:0
ds_read_b64_tr_b16 v[34:35], v47 offset:1024
s_waitcnt vmcnt(7)
s_waitcnt lgkmcnt(6)
v_mfma_f32_32x32x16_bf16 v[56:71], v[20:23], v[120:123], 0
ds_read_b64_tr_b16 v[36:37], v44 offset:4096
ds_read_b64_tr_b16 v[38:39], v44 offset:5120
s_add_u32 s35, s61, 0
s_add_u32 m0, s30, 65536
s_nop 0
buffer_load_dwordx4 v6, s[4:7], s35 offen lds
s_waitcnt lgkmcnt(6)
v_mfma_f32_32x32x16_bf16 v[72:87], v[24:27], v[120:123], 0
ds_read_b64_tr_b16 v[40:41], v45 offset:4096
ds_read_b64_tr_b16 v[42:43], v45 offset:5120
s_waitcnt lgkmcnt(6)
v_mfma_f32_32x32x16_bf16 v[88:103], v[28:31], v[120:123], 0
ds_read_b64_tr_b16 v[20:21], v46 offset:4096
ds_read_b64_tr_b16 v[22:23], v46 offset:5120
s_add_u32 s35, s61, 262144
s_add_u32 m0, s30, 73728
s_nop 0
buffer_load_dwordx4 v6, s[4:7], s35 offen lds
s_waitcnt lgkmcnt(6)
v_mfma_f32_32x32x16_bf16 v[104:119], v[32:35], v[120:123], 0
ds_read_b64_tr_b16 v[24:25], v47 offset:4096
ds_read_b64_tr_b16 v[26:27], v47 offset:5120
s_waitcnt vmcnt(8)
s_waitcnt lgkmcnt(6)
v_mfma_f32_32x32x16_bf16 v[56:71], v[36:39], v[124:127], v[56:71]
ds_read_b64_tr_b16 v[28:29], v44 offset:8192
ds_read_b64_tr_b16 v[30:31], v44 offset:9216
s_add_u32 s35, s61, 524288
s_add_u32 m0, s30, 81920
s_nop 0
buffer_load_dwordx4 v6, s[4:7], s35 offen lds
s_waitcnt lgkmcnt(6)
v_mfma_f32_32x32x16_bf16 v[72:87], v[40:43], v[124:127], v[72:87]
ds_read_b64_tr_b16 v[32:33], v45 offset:8192
ds_read_b64_tr_b16 v[34:35], v45 offset:9216
s_waitcnt lgkmcnt(6)
v_mfma_f32_32x32x16_bf16 v[88:103], v[20:23], v[124:127], v[88:103]
ds_read_b64_tr_b16 v[36:37], v46 offset:8192
ds_read_b64_tr_b16 v[38:39], v46 offset:9216
s_add_u32 s35, s61, 786432
s_add_u32 m0, s30, 90112
s_nop 0
buffer_load_dwordx4 v6, s[4:7], s35 offen lds
s_waitcnt lgkmcnt(6)
v_mfma_f32_32x32x16_bf16 v[104:119], v[24:27], v[124:127], v[104:119]
ds_read_b64_tr_b16 v[40:41], v47 offset:8192
ds_read_b64_tr_b16 v[42:43], v47 offset:9216
s_waitcnt vmcnt(9)
s_waitcnt lgkmcnt(6)
v_mfma_f32_32x32x16_bf16 v[56:71], v[28:31], v[128:131], v[56:71]
ds_read_b64_tr_b16 v[20:21], v44 offset:12288
ds_read_b64_tr_b16 v[22:23], v44 offset:13312
s_add_u32 s36, s65, 0
buffer_load_dwordx4 v[152:155], v7, s[12:15], s36 offen offset:0
s_waitcnt lgkmcnt(6)
v_mfma_f32_32x32x16_bf16 v[72:87], v[32:35], v[128:131], v[72:87]
ds_read_b64_tr_b16 v[24:25], v45 offset:12288
ds_read_b64_tr_b16 v[26:27], v45 offset:13312
s_waitcnt lgkmcnt(6)
v_mfma_f32_32x32x16_bf16 v[88:103], v[36:39], v[128:131], v[88:103]
ds_read_b64_tr_b16 v[28:29], v46 offset:12288
ds_read_b64_tr_b16 v[30:31], v46 offset:13312
buffer_load_dwordx4 v[156:159], v7, s[12:15], s36 offen offset:1024
s_waitcnt lgkmcnt(6)
v_mfma_f32_32x32x16_bf16 v[104:119], v[40:43], v[128:131], v[104:119]
ds_read_b64_tr_b16 v[32:33], v47 offset:12288
ds_read_b64_tr_b16 v[34:35], v47 offset:13312
s_waitcnt vmcnt(10)
s_waitcnt lgkmcnt(6)
v_mfma_f32_32x32x16_bf16 v[56:71], v[20:23], v[132:135], v[56:71]
ds_read_b64_tr_b16 v[36:37], v44 offset:16384
ds_read_b64_tr_b16 v[38:39], v44 offset:17408
buffer_load_dwordx4 v[160:163], v7, s[12:15], s36 offen offset:2048
s_waitcnt lgkmcnt(6)
v_mfma_f32_32x32x16_bf16 v[72:87], v[24:27], v[132:135], v[72:87]
ds_read_b64_tr_b16 v[40:41], v45 offset:16384
ds_read_b64_tr_b16 v[42:43], v45 offset:17408
s_waitcnt lgkmcnt(6)
v_mfma_f32_32x32x16_bf16 v[88:103], v[28:31], v[132:135], v[88:103]
ds_read_b64_tr_b16 v[20:21], v46 offset:16384
ds_read_b64_tr_b16 v[22:23], v46 offset:17408
buffer_load_dwordx4 v[164:167], v7, s[12:15], s36 offen offset:3072
s_waitcnt lgkmcnt(6)
v_mfma_f32_32x32x16_bf16 v[104:119], v[32:35], v[132:135], v[104:119]
ds_read_b64_tr_b16 v[24:25], v47 offset:16384
ds_read_b64_tr_b16 v[26:27], v47 offset:17408
s_waitcnt vmcnt(11)
s_waitcnt lgkmcnt(6)
v_mfma_f32_32x32x16_bf16 v[56:71], v[36:39], v[136:139], v[56:71]
ds_read_b64_tr_b16 v[28:29], v44 offset:20480
ds_read_b64_tr_b16 v[30:31], v44 offset:21504
s_add_u32 s36, s65, 4096
buffer_load_dwordx4 v[168:171], v7, s[12:15], s36 offen offset:0
s_waitcnt lgkmcnt(6)
v_mfma_f32_32x32x16_bf16 v[72:87], v[40:43], v[136:139], v[72:87]
ds_read_b64_tr_b16 v[32:33], v45 offset:20480
ds_read_b64_tr_b16 v[34:35], v45 offset:21504
s_waitcnt lgkmcnt(6)
v_mfma_f32_32x32x16_bf16 v[88:103], v[20:23], v[136:139], v[88:103]
ds_read_b64_tr_b16 v[36:37], v46 offset:20480
ds_read_b64_tr_b16 v[38:39], v46 offset:21504
buffer_load_dwordx4 v[172:175], v7, s[12:15], s36 offen offset:1024
s_waitcnt lgkmcnt(6)
v_mfma_f32_32x32x16_bf16 v[104:119], v[24:27], v[136:139], v[104:119]
ds_read_b64_tr_b16 v[40:41], v47 offset:20480
ds_read_b64_tr_b16 v[42:43], v47 offset:21504
s_waitcnt vmcnt(12)
s_waitcnt lgkmcnt(6)
v_mfma_f32_32x32x16_bf16 v[56:71], v[28:31], v[140:143], v[56:71]
ds_read_b64_tr_b16 v[20:21], v44 offset:24576
ds_read_b64_tr_b16 v[22:23], v44 offset:25600
buffer_load_dwordx4 v[176:179], v7, s[12:15], s36 offen offset:2048
s_waitcnt lgkmcnt(6)
v_mfma_f32_32x32x16_bf16 v[72:87], v[32:35], v[140:143], v[72:87]
ds_read_b64_tr_b16 v[24:25], v45 offset:24576
ds_read_b64_tr_b16 v[26:27], v45 offset:25600
s_waitcnt lgkmcnt(6)
v_mfma_f32_32x32x16_bf16 v[88:103], v[36:39], v[140:143], v[88:103]
ds_read_b64_tr_b16 v[28:29], v46 offset:24576
ds_read_b64_tr_b16 v[30:31], v46 offset:25600
buffer_load_dwordx4 v[180:183], v7, s[12:15], s36 offen offset:3072
s_waitcnt lgkmcnt(6)
v_mfma_f32_32x32x16_bf16 v[104:119], v[40:43], v[140:143], v[104:119]
ds_read_b64_tr_b16 v[32:33], v47 offset:24576
ds_read_b64_tr_b16 v[34:35], v47 offset:25600
s_waitcnt vmcnt(13)
s_waitcnt lgkmcnt(6)
v_mfma_f32_32x32x16_bf16 v[56:71], v[20:23], v[144:147], v[56:71]
ds_read_b64_tr_b16 v[36:37], v44 offset:28672
ds_read_b64_tr_b16 v[38:39], v44 offset:29696
s_add_u32 s35, s62, 0
s_add_u32 m0, s30, 32768
s_nop 0
buffer_load_dwordx4 v6, s[4:7], s35 offen lds
s_waitcnt lgkmcnt(6)
v_mfma_f32_32x32x16_bf16 v[72:87], v[24:27], v[144:147], v[72:87]
ds_read_b64_tr_b16 v[40:41], v45 offset:28672
ds_read_b64_tr_b16 v[42:43], v45 offset:29696
s_waitcnt lgkmcnt(6)
v_mfma_f32_32x32x16_bf16 v[88:103], v[28:31], v[144:147], v[88:103]
ds_read_b64_tr_b16 v[20:21], v46 offset:28672
ds_read_b64_tr_b16 v[22:23], v46 offset:29696
s_add_u32 s35, s62, 262144
s_add_u32 m0, s30, 40960
s_nop 0
buffer_load_dwordx4 v6, s[4:7], s35 offen lds
s_waitcnt lgkmcnt(6)
v_mfma_f32_32x32x16_bf16 v[104:119], v[32:35], v[144:147], v[104:119]
ds_read_b64_tr_b16 v[24:25], v47 offset:28672
ds_read_b64_tr_b16 v[26:27], v47 offset:29696
s_waitcnt vmcnt(14)
s_waitcnt lgkmcnt(6)
v_mfma_f32_32x32x16_bf16 v[56:71], v[36:39], v[148:151], v[56:71]
s_waitcnt vmcnt(10)
s_barrier
ds_read_b64_tr_b16 v[28:29], v8 offset:0
ds_read_b64_tr_b16 v[30:31], v8 offset:1024
s_add_u32 s35, s62, 524288
s_add_u32 m0, s30, 49152
s_nop 0
buffer_load_dwordx4 v6, s[4:7], s35 offen lds
s_waitcnt lgkmcnt(6)
v_mfma_f32_32x32x16_bf16 v[72:87], v[40:43], v[148:151], v[72:87]
ds_read_b64_tr_b16 v[32:33], v9 offset:0
ds_read_b64_tr_b16 v[34:35], v9 offset:1024
s_waitcnt lgkmcnt(6)
v_mfma_f32_32x32x16_bf16 v[88:103], v[20:23], v[148:151], v[88:103]
ds_read_b64_tr_b16 v[36:37], v10 offset:0
ds_read_b64_tr_b16 v[38:39], v10 offset:1024
s_add_u32 s35, s62, 786432
s_add_u32 m0, s30, 57344
s_nop 0
buffer_load_dwordx4 v6, s[4:7], s35 offen lds
s_waitcnt lgkmcnt(6)
v_mfma_f32_32x32x16_bf16 v[104:119], v[24:27], v[148:151], v[104:119]
ds_read_b64_tr_b16 v[40:41], v11 offset:0
ds_read_b64_tr_b16 v[42:43], v11 offset:1024
s_waitcnt vmcnt(11)
s_waitcnt lgkmcnt(6)
v_mfma_f32_32x32x16_bf16 v[56:71], v[28:31], v[152:155], v[56:71]
ds_read_b64_tr_b16 v[20:21], v8 offset:4096
ds_read_b64_tr_b16 v[22:23], v8 offset:5120
s_add_u32 s36, s66, 0
buffer_load_dwordx4 v[184:187], v7, s[12:15], s36 offen offset:0
s_waitcnt lgkmcnt(6)
v_mfma_f32_32x32x16_bf16 v[72:87], v[32:35], v[152:155], v[72:87]
ds_read_b64_tr_b16 v[24:25], v9 offset:4096
ds_read_b64_tr_b16 v[26:27], v9 offset:5120
s_waitcnt lgkmcnt(6)
v_mfma_f32_32x32x16_bf16 v[88:103], v[36:39], v[152:155], v[88:103]
ds_read_b64_tr_b16 v[28:29], v10 offset:4096
ds_read_b64_tr_b16 v[30:31], v10 offset:5120
buffer_load_dwordx4 v[188:191], v7, s[12:15], s36 offen offset:1024
s_waitcnt lgkmcnt(6)
v_mfma_f32_32x32x16_bf16 v[104:119], v[40:43], v[152:155], v[104:119]
ds_read_b64_tr_b16 v[32:33], v11 offset:4096
ds_read_b64_tr_b16 v[34:35], v11 offset:5120
s_waitcnt vmcnt(12)
s_waitcnt lgkmcnt(6)
v_mfma_f32_32x32x16_bf16 v[56:71], v[20:23], v[156:159], v[56:71]
ds_read_b64_tr_b16 v[36:37], v8 offset:8192
ds_read_b64_tr_b16 v[38:39], v8 offset:9216
buffer_load_dwordx4 v[192:195], v7, s[12:15], s36 offen offset:2048
s_waitcnt lgkmcnt(6)
v_mfma_f32_32x32x16_bf16 v[72:87], v[24:27], v[156:159], v[72:87]
ds_read_b64_tr_b16 v[40:41], v9 offset:8192
ds_read_b64_tr_b16 v[42:43], v9 offset:9216
s_waitcnt lgkmcnt(6)
v_mfma_f32_32x32x16_bf16 v[88:103], v[28:31], v[156:159], v[88:103]
ds_read_b64_tr_b16 v[20:21], v10 offset:8192
ds_read_b64_tr_b16 v[22:23], v10 offset:9216
buffer_load_dwordx4 v[196:199], v7, s[12:15], s36 offen offset:3072
s_waitcnt lgkmcnt(6)
v_mfma_f32_32x32x16_bf16 v[104:119], v[32:35], v[156:159], v[104:119]
ds_read_b64_tr_b16 v[24:25], v11 offset:8192
ds_read_b64_tr_b16 v[26:27], v11 offset:9216
s_waitcnt vmcnt(13)
s_waitcnt lgkmcnt(6)
v_mfma_f32_32x32x16_bf16 v[56:71], v[36:39], v[160:163], v[56:71]
ds_read_b64_tr_b16 v[28:29], v8 offset:12288
ds_read_b64_tr_b16 v[30:31], v8 offset:13312
s_add_u32 s36, s66, 4096
buffer_load_dwordx4 v[200:203], v7, s[12:15], s36 offen offset:0
s_waitcnt lgkmcnt(6)
v_mfma_f32_32x32x16_bf16 v[72:87], v[40:43], v[160:163], v[72:87]
ds_read_b64_tr_b16 v[32:33], v9 offset:12288
ds_read_b64_tr_b16 v[34:35], v9 offset:13312
s_waitcnt lgkmcnt(6)
v_mfma_f32_32x32x16_bf16 v[88:103], v[20:23], v[160:163], v[88:103]
ds_read_b64_tr_b16 v[36:37], v10 offset:12288
ds_read_b64_tr_b16 v[38:39], v10 offset:13312
buffer_load_dwordx4 v[204:207], v7, s[12:15], s36 offen offset:1024
s_waitcnt lgkmcnt(6)
v_mfma_f32_32x32x16_bf16 v[104:119], v[24:27], v[160:163], v[104:119]
ds_read_b64_tr_b16 v[40:41], v11 offset:12288
ds_read_b64_tr_b16 v[42:43], v11 offset:13312
s_waitcnt vmcnt(14)
s_waitcnt lgkmcnt(6)
v_mfma_f32_32x32x16_bf16 v[56:71], v[28:31], v[164:167], v[56:71]
ds_read_b64_tr_b16 v[20:21], v8 offset:16384
ds_read_b64_tr_b16 v[22:23], v8 offset:17408
buffer_load_dwordx4 v[208:211], v7, s[12:15], s36 offen offset:2048
s_waitcnt lgkmcnt(6)
v_mfma_f32_32x32x16_bf16 v[72:87], v[32:35], v[164:167], v[72:87]
ds_read_b64_tr_b16 v[24:25], v9 offset:16384
ds_read_b64_tr_b16 v[26:27], v9 offset:17408
s_waitcnt lgkmcnt(6)
v_mfma_f32_32x32x16_bf16 v[88:103], v[36:39], v[164:167], v[88:103]
ds_read_b64_tr_b16 v[28:29], v10 offset:16384
ds_read_b64_tr_b16 v[30:31], v10 offset:17408
buffer_load_dwordx4 v[212:215], v7, s[12:15], s36 offen offset:3072
s_waitcnt lgkmcnt(6)
v_mfma_f32_32x32x16_bf16 v[104:119], v[40:43], v[164:167], v[104:119]
ds_read_b64_tr_b16 v[32:33], v11 offset:16384
ds_read_b64_tr_b16 v[34:35], v11 offset:17408
s_waitcnt vmcnt(15)
s_waitcnt lgkmcnt(6)
v_mfma_f32_32x32x16_bf16 v[56:71], v[20:23], v[168:171], v[56:71]
ds_read_b64_tr_b16 v[36:37], v8 offset:20480
ds_read_b64_tr_b16 v[38:39], v8 offset:21504
s_add_u32 s35, s63, 0
s_add_u32 m0, s30, 98304
s_nop 0
buffer_load_dwordx4 v6, s[4:7], s35 offen lds
s_waitcnt lgkmcnt(6)
v_mfma_f32_32x32x16_bf16 v[72:87], v[24:27], v[168:171], v[72:87]
ds_read_b64_tr_b16 v[40:41], v9 offset:20480
ds_read_b64_tr_b16 v[42:43], v9 offset:21504
s_waitcnt lgkmcnt(6)
v_mfma_f32_32x32x16_bf16 v[88:103], v[28:31], v[168:171], v[88:103]
ds_read_b64_tr_b16 v[20:21], v10 offset:20480
ds_read_b64_tr_b16 v[22:23], v10 offset:21504
s_add_u32 s35, s63, 262144
s_add_u32 m0, s30, 106496
s_nop 0
buffer_load_dwordx4 v6, s[4:7], s35 offen lds
s_waitcnt lgkmcnt(6)
v_mfma_f32_32x32x16_bf16 v[104:119], v[32:35], v[168:171], v[104:119]
ds_read_b64_tr_b16 v[24:25], v11 offset:20480
ds_read_b64_tr_b16 v[26:27], v11 offset:21504
s_waitcnt vmcnt(16)
s_waitcnt lgkmcnt(6)
v_mfma_f32_32x32x16_bf16 v[56:71], v[36:39], v[172:175], v[56:71]
ds_read_b64_tr_b16 v[28:29], v8 offset:24576
ds_read_b64_tr_b16 v[30:31], v8 offset:25600
s_add_u32 s35, s63, 524288
s_add_u32 m0, s30, 114688
s_nop 0
buffer_load_dwordx4 v6, s[4:7], s35 offen lds
s_waitcnt lgkmcnt(6)
v_mfma_f32_32x32x16_bf16 v[72:87], v[40:43], v[172:175], v[72:87]
ds_read_b64_tr_b16 v[32:33], v9 offset:24576
ds_read_b64_tr_b16 v[34:35], v9 offset:25600
s_waitcnt lgkmcnt(6)
v_mfma_f32_32x32x16_bf16 v[88:103], v[20:23], v[172:175], v[88:103]
ds_read_b64_tr_b16 v[36:37], v10 offset:24576
ds_read_b64_tr_b16 v[38:39], v10 offset:25600
s_add_u32 s35, s63, 786432
s_add_u32 m0, s30, 122880
s_nop 0
buffer_load_dwordx4 v6, s[4:7], s35 offen lds
s_waitcnt lgkmcnt(6)
v_mfma_f32_32x32x16_bf16 v[104:119], v[24:27], v[172:175], v[104:119]
ds_read_b64_tr_b16 v[40:41], v11 offset:24576
ds_read_b64_tr_b16 v[42:43], v11 offset:25600
s_waitcnt vmcnt(17)
s_waitcnt lgkmcnt(6)
v_mfma_f32_32x32x16_bf16 v[56:71], v[28:31], v[176:179], v[56:71]
ds_read_b64_tr_b16 v[20:21], v8 offset:28672
ds_read_b64_tr_b16 v[22:23], v8 offset:29696
s_add_u32 s36, s67, 0
buffer_load_dwordx4 v[216:219], v7, s[12:15], s36 offen offset:0
s_waitcnt lgkmcnt(6)
v_mfma_f32_32x32x16_bf16 v[72:87], v[32:35], v[176:179], v[72:87]
ds_read_b64_tr_b16 v[24:25], v9 offset:28672
ds_read_b64_tr_b16 v[26:27], v9 offset:29696
s_waitcnt lgkmcnt(6)
v_mfma_f32_32x32x16_bf16 v[88:103], v[36:39], v[176:179], v[88:103]
ds_read_b64_tr_b16 v[28:29], v10 offset:28672
ds_read_b64_tr_b16 v[30:31], v10 offset:29696
buffer_load_dwordx4 v[220:223], v7, s[12:15], s36 offen offset:1024
s_waitcnt lgkmcnt(6)
v_mfma_f32_32x32x16_bf16 v[104:119], v[40:43], v[176:179], v[104:119]
ds_read_b64_tr_b16 v[32:33], v11 offset:28672
ds_read_b64_tr_b16 v[34:35], v11 offset:29696
s_waitcnt vmcnt(18)
s_waitcnt lgkmcnt(6)
v_mfma_f32_32x32x16_bf16 v[56:71], v[20:23], v[180:183], v[56:71]
s_waitcnt vmcnt(14)
s_barrier
ds_read_b64_tr_b16 v[36:37], v44 offset:32768
ds_read_b64_tr_b16 v[38:39], v44 offset:33792
buffer_load_dwordx4 v[224:227], v7, s[12:15], s36 offen offset:2048
s_waitcnt lgkmcnt(6)
v_mfma_f32_32x32x16_bf16 v[72:87], v[24:27], v[180:183], v[72:87]
ds_read_b64_tr_b16 v[40:41], v45 offset:32768
ds_read_b64_tr_b16 v[42:43], v45 offset:33792
s_waitcnt lgkmcnt(6)
v_mfma_f32_32x32x16_bf16 v[88:103], v[28:31], v[180:183], v[88:103]
ds_read_b64_tr_b16 v[20:21], v46 offset:32768
ds_read_b64_tr_b16 v[22:23], v46 offset:33792
buffer_load_dwordx4 v[228:231], v7, s[12:15], s36 offen offset:3072
s_waitcnt lgkmcnt(6)
v_mfma_f32_32x32x16_bf16 v[104:119], v[32:35], v[180:183], v[104:119]
ds_read_b64_tr_b16 v[24:25], v47 offset:32768
ds_read_b64_tr_b16 v[26:27], v47 offset:33792
s_waitcnt vmcnt(15)
s_waitcnt lgkmcnt(6)
v_mfma_f32_32x32x16_bf16 v[56:71], v[36:39], v[184:187], v[56:71]
ds_read_b64_tr_b16 v[28:29], v44 offset:36864
ds_read_b64_tr_b16 v[30:31], v44 offset:37888
s_add_u32 s36, s67, 4096
buffer_load_dwordx4 v[232:235], v7, s[12:15], s36 offen offset:0
s_waitcnt lgkmcnt(6)
v_mfma_f32_32x32x16_bf16 v[72:87], v[40:43], v[184:187], v[72:87]
ds_read_b64_tr_b16 v[32:33], v45 offset:36864
ds_read_b64_tr_b16 v[34:35], v45 offset:37888
s_waitcnt lgkmcnt(6)
v_mfma_f32_32x32x16_bf16 v[88:103], v[20:23], v[184:187], v[88:103]
ds_read_b64_tr_b16 v[36:37], v46 offset:36864
ds_read_b64_tr_b16 v[38:39], v46 offset:37888
buffer_load_dwordx4 v[236:239], v7, s[12:15], s36 offen offset:1024
s_waitcnt lgkmcnt(6)
v_mfma_f32_32x32x16_bf16 v[104:119], v[24:27], v[184:187], v[104:119]
ds_read_b64_tr_b16 v[40:41], v47 offset:36864
ds_read_b64_tr_b16 v[42:43], v47 offset:37888
s_waitcnt vmcnt(16)
s_waitcnt lgkmcnt(6)
v_mfma_f32_32x32x16_bf16 v[56:71], v[28:31], v[188:191], v[56:71]
ds_read_b64_tr_b16 v[20:21], v44 offset:40960
ds_read_b64_tr_b16 v[22:23], v44 offset:41984
buffer_load_dwordx4 v[240:243], v7, s[12:15], s36 offen offset:2048
s_waitcnt lgkmcnt(6)
v_mfma_f32_32x32x16_bf16 v[72:87], v[32:35], v[188:191], v[72:87]
ds_read_b64_tr_b16 v[24:25], v45 offset:40960
ds_read_b64_tr_b16 v[26:27], v45 offset:41984
s_waitcnt lgkmcnt(6)
v_mfma_f32_32x32x16_bf16 v[88:103], v[36:39], v[188:191], v[88:103]
ds_read_b64_tr_b16 v[28:29], v46 offset:40960
ds_read_b64_tr_b16 v[30:31], v46 offset:41984
buffer_load_dwordx4 v[244:247], v7, s[12:15], s36 offen offset:3072
s_waitcnt lgkmcnt(6)
v_mfma_f32_32x32x16_bf16 v[104:119], v[40:43], v[188:191], v[104:119]
ds_read_b64_tr_b16 v[32:33], v47 offset:40960
ds_read_b64_tr_b16 v[34:35], v47 offset:41984
s_waitcnt vmcnt(17)
s_waitcnt lgkmcnt(6)
v_mfma_f32_32x32x16_bf16 v[56:71], v[20:23], v[192:195], v[56:71]
ds_read_b64_tr_b16 v[36:37], v44 offset:45056
ds_read_b64_tr_b16 v[38:39], v44 offset:46080
s_add_u32 s35, s31, 4194304
s_add_u32 m0, s30, 131072
s_nop 0
buffer_load_dwordx4 v6, s[4:7], s35 offen lds
s_waitcnt lgkmcnt(6)
v_mfma_f32_32x32x16_bf16 v[72:87], v[24:27], v[192:195], v[72:87]
ds_read_b64_tr_b16 v[40:41], v45 offset:45056
ds_read_b64_tr_b16 v[42:43], v45 offset:46080
s_waitcnt lgkmcnt(6)
v_mfma_f32_32x32x16_bf16 v[88:103], v[28:31], v[192:195], v[88:103]
ds_read_b64_tr_b16 v[20:21], v46 offset:45056
ds_read_b64_tr_b16 v[22:23], v46 offset:46080
s_add_u32 s35, s31, 4456448
s_add_u32 m0, s30, 139264
s_nop 0
buffer_load_dwordx4 v6, s[4:7], s35 offen lds
s_waitcnt lgkmcnt(6)
v_mfma_f32_32x32x16_bf16 v[104:119], v[32:35], v[192:195], v[104:119]
ds_read_b64_tr_b16 v[24:25], v47 offset:45056
ds_read_b64_tr_b16 v[26:27], v47 offset:46080
s_waitcnt vmcnt(18)
s_waitcnt lgkmcnt(6)
v_mfma_f32_32x32x16_bf16 v[56:71], v[36:39], v[196:199], v[56:71]
ds_read_b64_tr_b16 v[28:29], v44 offset:49152
ds_read_b64_tr_b16 v[30:31], v44 offset:50176
s_add_u32 s36, s68, 0
buffer_load_dwordx4 v[120:123], v7, s[12:15], s36 offen offset:0
s_waitcnt lgkmcnt(6)
v_mfma_f32_32x32x16_bf16 v[72:87], v[40:43], v[196:199], v[72:87]
ds_read_b64_tr_b16 v[32:33], v45 offset:49152
ds_read_b64_tr_b16 v[34:35], v45 offset:50176
s_waitcnt lgkmcnt(6)
v_mfma_f32_32x32x16_bf16 v[88:103], v[20:23], v[196:199], v[88:103]
ds_read_b64_tr_b16 v[36:37], v46 offset:49152
ds_read_b64_tr_b16 v[38:39], v46 offset:50176
buffer_load_dwordx4 v[124:127], v7, s[12:15], s36 offen offset:1024
s_waitcnt lgkmcnt(6)
v_mfma_f32_32x32x16_bf16 v[104:119], v[24:27], v[196:199], v[104:119]
ds_read_b64_tr_b16 v[40:41], v47 offset:49152
ds_read_b64_tr_b16 v[42:43], v47 offset:50176
s_waitcnt vmcnt(19)
s_waitcnt lgkmcnt(6)
v_mfma_f32_32x32x16_bf16 v[56:71], v[28:31], v[200:203], v[56:71]
ds_read_b64_tr_b16 v[20:21], v44 offset:53248
ds_read_b64_tr_b16 v[22:23], v44 offset:54272
buffer_load_dwordx4 v[128:131], v7, s[12:15], s36 offen offset:2048
s_waitcnt lgkmcnt(6)
v_mfma_f32_32x32x16_bf16 v[72:87], v[32:35], v[200:203], v[72:87]
ds_read_b64_tr_b16 v[24:25], v45 offset:53248
ds_read_b64_tr_b16 v[26:27], v45 offset:54272
s_waitcnt lgkmcnt(6)
v_mfma_f32_32x32x16_bf16 v[88:103], v[36:39], v[200:203], v[88:103]
ds_read_b64_tr_b16 v[28:29], v46 offset:53248
ds_read_b64_tr_b16 v[30:31], v46 offset:54272
buffer_load_dwordx4 v[132:135], v7, s[12:15], s36 offen offset:3072
s_waitcnt lgkmcnt(6)
v_mfma_f32_32x32x16_bf16 v[104:119], v[40:43], v[200:203], v[104:119]
ds_read_b64_tr_b16 v[32:33], v47 offset:53248
ds_read_b64_tr_b16 v[34:35], v47 offset:54272
s_waitcnt vmcnt(20)
s_waitcnt lgkmcnt(6)
v_mfma_f32_32x32x16_bf16 v[56:71], v[20:23], v[204:207], v[56:71]
ds_read_b64_tr_b16 v[36:37], v44 offset:57344
ds_read_b64_tr_b16 v[38:39], v44 offset:58368
s_add_u32 s35, s32, 0
s_add_u32 m0, s30, 0
s_nop 0
buffer_load_dwordx4 v5, s[8:11], s35 offen lds
s_waitcnt lgkmcnt(6)
v_mfma_f32_32x32x16_bf16 v[72:87], v[24:27], v[204:207], v[72:87]
ds_read_b64_tr_b16 v[40:41], v45 offset:57344
ds_read_b64_tr_b16 v[42:43], v45 offset:58368
s_waitcnt lgkmcnt(6)
v_mfma_f32_32x32x16_bf16 v[88:103], v[28:31], v[204:207], v[88:103]
ds_read_b64_tr_b16 v[20:21], v46 offset:57344
ds_read_b64_tr_b16 v[22:23], v46 offset:58368
s_add_u32 s35, s32, 8192
s_add_u32 m0, s30, 8192
s_nop 0
buffer_load_dwordx4 v5, s[8:11], s35 offen lds
s_waitcnt lgkmcnt(6)
v_mfma_f32_32x32x16_bf16 v[104:119], v[32:35], v[204:207], v[104:119]
ds_read_b64_tr_b16 v[24:25], v47 offset:57344
ds_read_b64_tr_b16 v[26:27], v47 offset:58368
s_waitcnt vmcnt(21)
s_waitcnt lgkmcnt(6)
v_mfma_f32_32x32x16_bf16 v[56:71], v[36:39], v[208:211], v[56:71]
ds_read_b64_tr_b16 v[28:29], v44 offset:61440
ds_read_b64_tr_b16 v[30:31], v44 offset:62464
s_add_u32 s35, s32, 16384
s_add_u32 m0, s30, 16384
s_nop 0
buffer_load_dwordx4 v5, s[8:11], s35 offen lds
s_waitcnt lgkmcnt(6)
v_mfma_f32_32x32x16_bf16 v[72:87], v[40:43], v[208:211], v[72:87]
ds_read_b64_tr_b16 v[32:33], v45 offset:61440
ds_read_b64_tr_b16 v[34:35], v45 offset:62464
s_waitcnt lgkmcnt(6)
v_mfma_f32_32x32x16_bf16 v[88:103], v[20:23], v[208:211], v[88:103]
ds_read_b64_tr_b16 v[36:37], v46 offset:61440
ds_read_b64_tr_b16 v[38:39], v46 offset:62464
s_add_u32 s35, s32, 24576
s_add_u32 m0, s30, 24576
s_nop 0
buffer_load_dwordx4 v5, s[8:11], s35 offen lds
s_waitcnt lgkmcnt(6)
v_mfma_f32_32x32x16_bf16 v[104:119], v[24:27], v[208:211], v[104:119]
ds_read_b64_tr_b16 v[40:41], v47 offset:61440
ds_read_b64_tr_b16 v[42:43], v47 offset:62464
s_waitcnt vmcnt(22)
s_waitcnt lgkmcnt(6)
v_mfma_f32_32x32x16_bf16 v[56:71], v[28:31], v[212:215], v[56:71]
s_waitcnt vmcnt(18)
s_barrier
ds_read_b64_tr_b16 v[20:21], v8 offset:32768
ds_read_b64_tr_b16 v[22:23], v8 offset:33792
s_add_u32 s35, s32, 0
s_add_u32 m0, s30, 65536
s_nop 0
buffer_load_dwordx4 v4, s[16:19], s35 offen lds
s_waitcnt lgkmcnt(6)
v_mfma_f32_32x32x16_bf16 v[72:87], v[32:35], v[212:215], v[72:87]
ds_read_b64_tr_b16 v[24:25], v9 offset:32768
ds_read_b64_tr_b16 v[26:27], v9 offset:33792
s_waitcnt lgkmcnt(6)
v_mfma_f32_32x32x16_bf16 v[88:103], v[36:39], v[212:215], v[88:103]
ds_read_b64_tr_b16 v[28:29], v10 offset:32768
ds_read_b64_tr_b16 v[30:31], v10 offset:33792
s_add_u32 s35, s32, 8192
s_add_u32 m0, s30, 73728
s_nop 0
buffer_load_dwordx4 v4, s[16:19], s35 offen lds
s_waitcnt lgkmcnt(6)
v_mfma_f32_32x32x16_bf16 v[104:119], v[40:43], v[212:215], v[104:119]
ds_read_b64_tr_b16 v[32:33], v11 offset:32768
ds_read_b64_tr_b16 v[34:35], v11 offset:33792
s_waitcnt vmcnt(19)
s_waitcnt lgkmcnt(6)
v_mfma_f32_32x32x16_bf16 v[56:71], v[20:23], v[216:219], v[56:71]
ds_read_b64_tr_b16 v[36:37], v8 offset:36864
ds_read_b64_tr_b16 v[38:39], v8 offset:37888
s_add_u32 s35, s32, 16384
s_add_u32 m0, s30, 81920
s_nop 0
buffer_load_dwordx4 v4, s[16:19], s35 offen lds
s_waitcnt lgkmcnt(6)
v_mfma_f32_32x32x16_bf16 v[72:87], v[24:27], v[216:219], v[72:87]
ds_read_b64_tr_b16 v[40:41], v9 offset:36864
ds_read_b64_tr_b16 v[42:43], v9 offset:37888
s_waitcnt lgkmcnt(6)
v_mfma_f32_32x32x16_bf16 v[88:103], v[28:31], v[216:219], v[88:103]
ds_read_b64_tr_b16 v[20:21], v10 offset:36864
ds_read_b64_tr_b16 v[22:23], v10 offset:37888
s_add_u32 s35, s32, 24576
s_add_u32 m0, s30, 90112
s_nop 0
buffer_load_dwordx4 v4, s[16:19], s35 offen lds
s_waitcnt lgkmcnt(6)
v_mfma_f32_32x32x16_bf16 v[104:119], v[32:35], v[216:219], v[104:119]
ds_read_b64_tr_b16 v[24:25], v11 offset:36864
ds_read_b64_tr_b16 v[26:27], v11 offset:37888
s_waitcnt vmcnt(20)
s_waitcnt lgkmcnt(6)
v_mfma_f32_32x32x16_bf16 v[56:71], v[36:39], v[220:223], v[56:71]
ds_read_b64_tr_b16 v[28:29], v8 offset:40960
ds_read_b64_tr_b16 v[30:31], v8 offset:41984
s_add_u32 s35, s32, 32768
s_add_u32 m0, s30, 32768
s_nop 0
buffer_load_dwordx4 v5, s[8:11], s35 offen lds
s_waitcnt lgkmcnt(6)
v_mfma_f32_32x32x16_bf16 v[72:87], v[40:43], v[220:223], v[72:87]
ds_read_b64_tr_b16 v[32:33], v9 offset:40960
ds_read_b64_tr_b16 v[34:35], v9 offset:41984
s_waitcnt lgkmcnt(6)
v_mfma_f32_32x32x16_bf16 v[88:103], v[20:23], v[220:223], v[88:103]
ds_read_b64_tr_b16 v[36:37], v10 offset:40960
ds_read_b64_tr_b16 v[38:39], v10 offset:41984
s_add_u32 s35, s32, 40960
s_add_u32 m0, s30, 40960
s_nop 0
buffer_load_dwordx4 v5, s[8:11], s35 offen lds
s_waitcnt lgkmcnt(6)
v_mfma_f32_32x32x16_bf16 v[104:119], v[24:27], v[220:223], v[104:119]
ds_read_b64_tr_b16 v[40:41], v11 offset:40960
ds_read_b64_tr_b16 v[42:43], v11 offset:41984
s_waitcnt vmcnt(21)
s_waitcnt lgkmcnt(6)
v_mfma_f32_32x32x16_bf16 v[56:71], v[28:31], v[224:227], v[56:71]
ds_read_b64_tr_b16 v[20:21], v8 offset:45056
ds_read_b64_tr_b16 v[22:23], v8 offset:46080
s_add_u32 s35, s32, 49152
s_add_u32 m0, s30, 49152
s_nop 0
buffer_load_dwordx4 v5, s[8:11], s35 offen lds
v_add_u32 v44, 0x20000, v44
v_add_u32 v45, 0x20000, v45
v_add_u32 v46, 0x20000, v46
v_add_u32 v47, 0x20000, v47
s_waitcnt lgkmcnt(6)
v_mfma_f32_32x32x16_bf16 v[72:87], v[32:35], v[224:227], v[72:87]
ds_read_b64_tr_b16 v[24:25], v9 offset:45056
ds_read_b64_tr_b16 v[26:27], v9 offset:46080
s_waitcnt lgkmcnt(6)
v_mfma_f32_32x32x16_bf16 v[88:103], v[36:39], v[224:227], v[88:103]
ds_read_b64_tr_b16 v[28:29], v10 offset:45056
ds_read_b64_tr_b16 v[30:31], v10 offset:46080
s_add_u32 s35, s32, 57344
s_add_u32 m0, s30, 57344
s_nop 0
buffer_load_dwordx4 v5, s[8:11], s35 offen lds
s_waitcnt lgkmcnt(6)
v_mfma_f32_32x32x16_bf16 v[104:119], v[40:43], v[224:227], v[104:119]
ds_read_b64_tr_b16 v[32:33], v11 offset:45056
ds_read_b64_tr_b16 v[34:35], v11 offset:46080
s_waitcnt vmcnt(22)
s_waitcnt lgkmcnt(6)
v_mfma_f32_32x32x16_bf16 v[56:71], v[20:23], v[228:231], v[56:71]
ds_read_b64_tr_b16 v[36:37], v8 offset:49152
ds_read_b64_tr_b16 v[38:39], v8 offset:50176
s_waitcnt lgkmcnt(6)
v_mfma_f32_32x32x16_bf16 v[72:87], v[24:27], v[228:231], v[72:87]
ds_read_b64_tr_b16 v[40:41], v9 offset:49152
ds_read_b64_tr_b16 v[42:43], v9 offset:50176
s_waitcnt lgkmcnt(6)
v_mfma_f32_32x32x16_bf16 v[88:103], v[28:31], v[228:231], v[88:103]
ds_read_b64_tr_b16 v[20:21], v10 offset:49152
ds_read_b64_tr_b16 v[22:23], v10 offset:50176
s_waitcnt lgkmcnt(6)
v_mfma_f32_32x32x16_bf16 v[104:119], v[32:35], v[228:231], v[104:119]
ds_read_b64_tr_b16 v[24:25], v11 offset:49152
ds_read_b64_tr_b16 v[26:27], v11 offset:50176
s_waitcnt vmcnt(21)
s_waitcnt lgkmcnt(6)
v_mfma_f32_32x32x16_bf16 v[56:71], v[36:39], v[232:235], v[56:71]
ds_read_b64_tr_b16 v[28:29], v8 offset:53248
ds_read_b64_tr_b16 v[30:31], v8 offset:54272
s_waitcnt lgkmcnt(6)
v_mfma_f32_32x32x16_bf16 v[72:87], v[40:43], v[232:235], v[72:87]
ds_read_b64_tr_b16 v[32:33], v9 offset:53248
ds_read_b64_tr_b16 v[34:35], v9 offset:54272
s_waitcnt lgkmcnt(6)
v_mfma_f32_32x32x16_bf16 v[88:103], v[20:23], v[232:235], v[88:103]
ds_read_b64_tr_b16 v[36:37], v10 offset:53248
ds_read_b64_tr_b16 v[38:39], v10 offset:54272
s_waitcnt lgkmcnt(6)
v_mfma_f32_32x32x16_bf16 v[104:119], v[24:27], v[232:235], v[104:119]
ds_read_b64_tr_b16 v[40:41], v11 offset:53248
ds_read_b64_tr_b16 v[42:43], v11 offset:54272
s_waitcnt vmcnt(20)
s_waitcnt lgkmcnt(6)
v_mfma_f32_32x32x16_bf16 v[56:71], v[28:31], v[236:239], v[56:71]
ds_read_b64_tr_b16 v[20:21], v8 offset:57344
ds_read_b64_tr_b16 v[22:23], v8 offset:58368
s_waitcnt lgkmcnt(6)
v_mfma_f32_32x32x16_bf16 v[72:87], v[32:35], v[236:239], v[72:87]
ds_read_b64_tr_b16 v[24:25], v9 offset:57344
ds_read_b64_tr_b16 v[26:27], v9 offset:58368
s_waitcnt lgkmcnt(6)
v_mfma_f32_32x32x16_bf16 v[88:103], v[36:39], v[236:239], v[88:103]
ds_read_b64_tr_b16 v[28:29], v10 offset:57344
ds_read_b64_tr_b16 v[30:31], v10 offset:58368
s_waitcnt lgkmcnt(6)
v_mfma_f32_32x32x16_bf16 v[104:119], v[40:43], v[236:239], v[104:119]
ds_read_b64_tr_b16 v[32:33], v11 offset:57344
ds_read_b64_tr_b16 v[34:35], v11 offset:58368
s_waitcnt vmcnt(19)
s_waitcnt lgkmcnt(6)
v_mfma_f32_32x32x16_bf16 v[56:71], v[20:23], v[240:243], v[56:71]
ds_read_b64_tr_b16 v[36:37], v8 offset:61440
ds_read_b64_tr_b16 v[38:39], v8 offset:62464
s_waitcnt lgkmcnt(6)
v_mfma_f32_32x32x16_bf16 v[72:87], v[24:27], v[240:243], v[72:87]
ds_read_b64_tr_b16 v[40:41], v9 offset:61440
ds_read_b64_tr_b16 v[42:43], v9 offset:62464
s_waitcnt lgkmcnt(6)
v_mfma_f32_32x32x16_bf16 v[88:103], v[28:31], v[240:243], v[88:103]
ds_read_b64_tr_b16 v[20:21], v10 offset:61440
ds_read_b64_tr_b16 v[22:23], v10 offset:62464
s_waitcnt lgkmcnt(6)
v_mfma_f32_32x32x16_bf16 v[104:119], v[32:35], v[240:243], v[104:119]
ds_read_b64_tr_b16 v[24:25], v11 offset:61440
ds_read_b64_tr_b16 v[26:27], v11 offset:62464
s_waitcnt vmcnt(18)
s_waitcnt lgkmcnt(6)
v_mfma_f32_32x32x16_bf16 v[56:71], v[36:39], v[244:247], v[56:71]
s_waitcnt vmcnt(16)
s_waitcnt vmcnt(8)
s_barrier
ds_read_b64_tr_b16 v[28:29], v44 offset:0
ds_read_b64_tr_b16 v[30:31], v44 offset:1024
s_waitcnt lgkmcnt(6)
v_mfma_f32_32x32x16_bf16 v[72:87], v[40:43], v[244:247], v[72:87]
ds_read_b64_tr_b16 v[32:33], v44 offset:4096
ds_read_b64_tr_b16 v[34:35], v44 offset:5120
s_waitcnt lgkmcnt(6)
v_mfma_f32_32x32x16_bf16 v[88:103], v[20:23], v[244:247], v[88:103]
ds_read_b64_tr_b16 v[36:37], v44 offset:8192
ds_read_b64_tr_b16 v[38:39], v44 offset:9216
s_waitcnt lgkmcnt(6)
v_mfma_f32_32x32x16_bf16 v[104:119], v[24:27], v[244:247], v[104:119]
ds_read_b64_tr_b16 v[40:41], v44 offset:12288
ds_read_b64_tr_b16 v[42:43], v44 offset:13312
s_waitcnt lgkmcnt(6)
v_mfma_f32_32x32x16_bf16 v[56:71], v[28:31], v[120:123], v[56:71]
ds_read_b64_tr_b16 v[20:21], v45 offset:0
ds_read_b64_tr_b16 v[22:23], v45 offset:1024
s_waitcnt lgkmcnt(6)
v_mfma_f32_32x32x16_bf16 v[56:71], v[32:35], v[124:127], v[56:71]
ds_read_b64_tr_b16 v[24:25], v45 offset:4096
ds_read_b64_tr_b16 v[26:27], v45 offset:5120
s_waitcnt lgkmcnt(6)
v_mfma_f32_32x32x16_bf16 v[56:71], v[36:39], v[128:131], v[56:71]
ds_read_b64_tr_b16 v[28:29], v45 offset:8192
ds_read_b64_tr_b16 v[30:31], v45 offset:9216
s_add_u32 s35, s32, 32768
s_add_u32 m0, s30, 98304
s_nop 0
buffer_load_dwordx4 v4, s[16:19], s35 offen lds
s_waitcnt lgkmcnt(6)
v_mfma_f32_32x32x16_bf16 v[56:71], v[40:43], v[132:135], v[56:71]
ds_read_b64_tr_b16 v[32:33], v45 offset:12288
ds_read_b64_tr_b16 v[34:35], v45 offset:13312
s_waitcnt lgkmcnt(6)
v_mfma_f32_32x32x16_bf16 v[72:87], v[20:23], v[120:123], v[72:87]
ds_read_b64_tr_b16 v[36:37], v46 offset:0
ds_read_b64_tr_b16 v[38:39], v46 offset:1024
s_add_u32 s35, s32, 40960
s_add_u32 m0, s30, 106496
s_nop 0
buffer_load_dwordx4 v4, s[16:19], s35 offen lds
s_nop 1
v_mul_f32 v56, s42, v56
v_mul_f32 v57, s42, v57
v_cvt_pk_bf16_f32 v136, v56, v57
v_mul_f32 v58, s42, v58
v_mul_f32 v59, s42, v59
v_cvt_pk_bf16_f32 v137, v58, v59
s_waitcnt lgkmcnt(6)
v_mfma_f32_32x32x16_bf16 v[72:87], v[24:27], v[124:127], v[72:87]
ds_read_b64_tr_b16 v[40:41], v46 offset:4096
ds_read_b64_tr_b16 v[42:43], v46 offset:5120
v_mul_f32 v60, s42, v60
v_mul_f32 v61, s42, v61
v_cvt_pk_bf16_f32 v138, v60, v61
v_mul_f32 v62, s42, v62
v_mul_f32 v63, s42, v63
v_cvt_pk_bf16_f32 v139, v62, v63
s_waitcnt lgkmcnt(6)
v_mfma_f32_32x32x16_bf16 v[72:87], v[28:31], v[128:131], v[72:87]
ds_read_b64_tr_b16 v[20:21], v46 offset:8192
ds_read_b64_tr_b16 v[22:23], v46 offset:9216
s_add_u32 s35, s32, 49152
s_add_u32 m0, s30, 114688
s_nop 0
buffer_load_dwordx4 v4, s[16:19], s35 offen lds
v_mul_f32 v64, s42, v64
v_mul_f32 v65, s42, v65
v_cvt_pk_bf16_f32 v140, v64, v65
v_mul_f32 v66, s42, v66
v_mul_f32 v67, s42, v67
v_cvt_pk_bf16_f32 v141, v66, v67
s_waitcnt lgkmcnt(6)
v_mfma_f32_32x32x16_bf16 v[72:87], v[32:35], v[132:135], v[72:87]
ds_read_b64_tr_b16 v[24:25], v46 offset:12288
ds_read_b64_tr_b16 v[26:27], v46 offset:13312
v_mul_f32 v68, s42, v68
v_mul_f32 v69, s42, v69
v_cvt_pk_bf16_f32 v142, v68, v69
v_mul_f32 v70, s42, v70
v_mul_f32 v71, s42, v71
v_cvt_pk_bf16_f32 v143, v70, v71
s_waitcnt lgkmcnt(6)
v_mfma_f32_32x32x16_bf16 v[88:103], v[36:39], v[120:123], v[88:103]
ds_read_b64_tr_b16 v[28:29], v47 offset:0
ds_read_b64_tr_b16 v[30:31], v47 offset:1024
s_add_u32 s35, s32, 57344
s_add_u32 m0, s30, 122880
s_nop 0
buffer_load_dwordx4 v4, s[16:19], s35 offen lds
v_mul_f32 v72, s42, v72
v_mul_f32 v73, s42, v73
v_cvt_pk_bf16_f32 v144, v72, v73
v_mul_f32 v74, s42, v74
v_mul_f32 v75, s42, v75
v_cvt_pk_bf16_f32 v145, v74, v75
s_waitcnt lgkmcnt(6)
v_mfma_f32_32x32x16_bf16 v[88:103], v[40:43], v[124:127], v[88:103]
ds_read_b64_tr_b16 v[32:33], v47 offset:4096
ds_read_b64_tr_b16 v[34:35], v47 offset:5120
v_mul_f32 v76, s42, v76
v_mul_f32 v77, s42, v77
v_cvt_pk_bf16_f32 v146, v76, v77
v_mul_f32 v78, s42, v78
v_mul_f32 v79, s42, v79
v_cvt_pk_bf16_f32 v147, v78, v79
s_waitcnt lgkmcnt(6)
v_mfma_f32_32x32x16_bf16 v[88:103], v[20:23], v[128:131], v[88:103]
ds_read_b64_tr_b16 v[36:37], v47 offset:8192
ds_read_b64_tr_b16 v[38:39], v47 offset:9216
v_mul_f32 v80, s42, v80
v_mul_f32 v81, s42, v81
v_cvt_pk_bf16_f32 v148, v80, v81
v_mul_f32 v82, s42, v82
v_mul_f32 v83, s42, v83
v_cvt_pk_bf16_f32 v149, v82, v83
s_waitcnt lgkmcnt(6)
v_mfma_f32_32x32x16_bf16 v[88:103], v[24:27], v[132:135], v[88:103]
ds_read_b64_tr_b16 v[40:41], v47 offset:12288
ds_read_b64_tr_b16 v[42:43], v47 offset:13312
v_mul_f32 v84, s42, v84
v_mul_f32 v85, s42, v85
v_cvt_pk_bf16_f32 v150, v84, v85
v_mul_f32 v86, s42, v86
v_mul_f32 v87, s42, v87
v_cvt_pk_bf16_f32 v151, v86, v87
s_waitcnt lgkmcnt(6)
v_mfma_f32_32x32x16_bf16 v[104:119], v[28:31], v[120:123], v[104:119]
ds_read_b128 v[20:23], v12 offset:0
s_nop 0
v_mul_f32 v88, s42, v88
v_mul_f32 v89, s42, v89
v_cvt_pk_bf16_f32 v152, v88, v89
v_mul_f32 v90, s42, v90
v_mul_f32 v91, s42, v91
v_cvt_pk_bf16_f32 v153, v90, v91
s_waitcnt lgkmcnt(5)
v_mfma_f32_32x32x16_bf16 v[104:119], v[32:35], v[124:127], v[104:119]
ds_read_b128 v[24:27], v12 offset:8192
v_mul_f32 v92, s42, v92
v_mul_f32 v93, s42, v93
v_cvt_pk_bf16_f32 v154, v92, v93
v_mul_f32 v94, s42, v94
v_mul_f32 v95, s42, v95
v_cvt_pk_bf16_f32 v155, v94, v95
s_waitcnt lgkmcnt(4)
v_mfma_f32_32x32x16_bf16 v[104:119], v[36:39], v[128:131], v[104:119]
ds_read_b128 v[28:31], v13 offset:0
v_mul_f32 v96, s42, v96
v_mul_f32 v97, s42, v97
v_cvt_pk_bf16_f32 v156, v96, v97
v_mul_f32 v98, s42, v98
v_mul_f32 v99, s42, v99
v_cvt_pk_bf16_f32 v157, v98, v99
s_waitcnt lgkmcnt(3)
v_mfma_f32_32x32x16_bf16 v[104:119], v[40:43], v[132:135], v[104:119]
ds_read_b128 v[32:35], v13 offset:8192
v_mul_f32 v100, s42, v100
v_mul_f32 v101, s42, v101
v_cvt_pk_bf16_f32 v158, v100, v101
v_mul_f32 v102, s42, v102
v_mul_f32 v103, s42, v103
v_cvt_pk_bf16_f32 v159, v102, v103
s_waitcnt lgkmcnt(3)
v_mfma_f32_32x32x16_bf16 v[168:183], v[20:23], v[136:139], 0
ds_read_b128 v[36:39], v14 offset:0
s_waitcnt lgkmcnt(3)
v_mfma_f32_32x32x16_bf16 v[184:199], v[24:27], v[136:139], 0
ds_read_b128 v[40:43], v14 offset:8192
s_waitcnt lgkmcnt(3)
v_mfma_f32_32x32x16_bf16 v[168:183], v[28:31], v[140:143], v[168:183]
ds_read_b128 v[20:23], v15 offset:0
v_mul_f32 v104, s42, v104
v_mul_f32 v105, s42, v105
v_cvt_pk_bf16_f32 v160, v104, v105
v_mul_f32 v106, s42, v106
s_waitcnt lgkmcnt(3)
v_mfma_f32_32x32x16_bf16 v[184:199], v[32:35], v[140:143], v[184:199]
ds_read_b128 v[24:27], v15 offset:8192
v_mul_f32 v107, s42, v107
v_cvt_pk_bf16_f32 v161, v106, v107
v_mul_f32 v108, s42, v108
v_mul_f32 v109, s42, v109
s_waitcnt lgkmcnt(3)
v_mfma_f32_32x32x16_bf16 v[168:183], v[36:39], v[144:147], v[168:183]
ds_read_b128 v[28:31], v16 offset:0
v_cvt_pk_bf16_f32 v162, v108, v109
v_mul_f32 v110, s42, v110
v_mul_f32 v111, s42, v111
v_cvt_pk_bf16_f32 v163, v110, v111
s_waitcnt lgkmcnt(3)
v_mfma_f32_32x32x16_bf16 v[184:199], v[40:43], v[144:147], v[184:199]
ds_read_b128 v[32:35], v16 offset:8192
v_mul_f32 v112, s42, v112
v_mul_f32 v113, s42, v113
v_cvt_pk_bf16_f32 v164, v112, v113
v_mul_f32 v114, s42, v114
s_waitcnt lgkmcnt(3)
v_mfma_f32_32x32x16_bf16 v[168:183], v[20:23], v[148:151], v[168:183]
ds_read_b128 v[36:39], v17 offset:0
v_mul_f32 v115, s42, v115
v_cvt_pk_bf16_f32 v165, v114, v115
v_mul_f32 v116, s42, v116
v_mul_f32 v117, s42, v117
s_waitcnt lgkmcnt(3)
v_mfma_f32_32x32x16_bf16 v[184:199], v[24:27], v[148:151], v[184:199]
ds_read_b128 v[40:43], v17 offset:8192
v_cvt_pk_bf16_f32 v166, v116, v117
v_mul_f32 v118, s42, v118
v_mul_f32 v119, s42, v119
v_cvt_pk_bf16_f32 v167, v118, v119
s_waitcnt lgkmcnt(3)
v_mfma_f32_32x32x16_bf16 v[168:183], v[28:31], v[152:155], v[168:183]
ds_read_b128 v[20:23], v18 offset:0
s_waitcnt lgkmcnt(3)
v_mfma_f32_32x32x16_bf16 v[184:199], v[32:35], v[152:155], v[184:199]
ds_read_b128 v[24:27], v18 offset:8192
s_waitcnt lgkmcnt(3)
v_mfma_f32_32x32x16_bf16 v[168:183], v[36:39], v[156:159], v[168:183]
ds_read_b128 v[28:31], v19 offset:0
s_waitcnt lgkmcnt(3)
v_mfma_f32_32x32x16_bf16 v[184:199], v[40:43], v[156:159], v[184:199]
ds_read_b128 v[32:35], v19 offset:8192
s_waitcnt lgkmcnt(3)
v_mfma_f32_32x32x16_bf16 v[168:183], v[20:23], v[160:163], v[168:183]
ds_read_b128 v[36:39], v12 offset:16384
s_waitcnt lgkmcnt(3)
v_mfma_f32_32x32x16_bf16 v[184:199], v[24:27], v[160:163], v[184:199]
ds_read_b128 v[40:43], v12 offset:24576
s_waitcnt lgkmcnt(3)
v_mfma_f32_32x32x16_bf16 v[168:183], v[28:31], v[164:167], v[168:183]
ds_read_b128 v[20:23], v13 offset:16384
s_waitcnt lgkmcnt(3)
v_mfma_f32_32x32x16_bf16 v[184:199], v[32:35], v[164:167], v[184:199]
ds_read_b128 v[24:27], v13 offset:24576
s_nop 7
v_max3_f32 v54, v168, v169, v170
v_max3_f32 v55, v171, v172, v173
v_max3_f32 v54, v54, v174, v175
v_max3_f32 v55, v55, v176, v177
v_max3_f32 v54, v54, v178, v179
v_max3_f32 v55, v55, v180, v181
v_max3_f32 v54, v54, v182, v183
v_max3_f32 v55, v55, v184, v185
v_max3_f32 v54, v54, v186, v187
v_max3_f32 v55, v55, v188, v189
v_max3_f32 v54, v54, v190, v191
v_max3_f32 v55, v55, v192, v193
v_max3_f32 v54, v54, v194, v195
v_max3_f32 v55, v55, v196, v197
v_max3_f32 v54, v54, v198, v199
v_max_f32 v54, v54, v55
v_mov_b32 v55, v54
s_nop 1
v_permlane32_swap_b32 v54, v55
v_max_f32 v54, v54, v55
v_sub_f32 v120, 0, v54
v_sub_f32 v121, 0, v54
v_sub_f32 v122, 0, v54
v_sub_f32 v123, 0, v54
v_sub_f32 v124, 0, v54
v_sub_f32 v125, 0, v54
v_sub_f32 v126, 0, v54
v_sub_f32 v127, 0, v54
v_sub_f32 v128, 0, v54
v_sub_f32 v129, 0, v54
v_sub_f32 v130, 0, v54
v_sub_f32 v131, 0, v54
v_sub_f32 v132, 0, v54
v_sub_f32 v133, 0, v54
v_sub_f32 v134, 0, v54
v_sub_f32 v135, 0, v54
v_mov_b32 v52, 0
s_waitcnt lgkmcnt(3)
v_mfma_f32_32x32x16_bf16 v[200:215], v[36:39], v[136:139], v[120:135]
ds_read_b128 v[28:31], v14 offset:16384
v_sub_f32 v168, v168, v54
v_sub_f32 v169, v169, v54
v_exp_f32 v44, v168
v_exp_f32 v45, v169
s_waitcnt lgkmcnt(3)
v_mfma_f32_32x32x16_bf16 v[216:231], v[40:43], v[136:139], v[120:135]
ds_read_b128 v[32:35], v14 offset:24576
v_cvt_pk_bf16_f32 v232, v44, v45
v_add_f32 v53, v44, v45
v_sub_f32 v170, v170, v54
v_sub_f32 v171, v171, v54
v_exp_f32 v46, v170
v_exp_f32 v47, v171
s_waitcnt lgkmcnt(3)
v_mfma_f32_32x32x16_bf16 v[200:215], v[20:23], v[140:143], v[200:215]
ds_read_b128 v[36:39], v15 offset:16384
v_cvt_pk_bf16_f32 v233, v46, v47
v_add_f32 v53, v53, v46
v_add_f32 v53, v53, v47
v_sub_f32 v172, v172, v54
v_sub_f32 v173, v173, v54
v_exp_f32 v48, v172
v_exp_f32 v49, v173
s_waitcnt lgkmcnt(3)
v_mfma_f32_32x32x16_bf16 v[216:231], v[24:27], v[140:143], v[216:231]
ds_read_b128 v[40:43], v15 offset:24576
v_cvt_pk_bf16_f32 v234, v48, v49
v_add_f32 v53, v53, v48
v_add_f32 v53, v53, v49
v_sub_f32 v174, v174, v54
v_sub_f32 v175, v175, v54
v_exp_f32 v50, v174
v_exp_f32 v51, v175
s_waitcnt lgkmcnt(3)
v_mfma_f32_32x32x16_bf16 v[200:215], v[28:31], v[144:147], v[200:215]
ds_read_b128 v[20:23], v16 offset:16384
v_cvt_pk_bf16_f32 v235, v50, v51
v_add_f32 v53, v53, v50
v_add_f32 v53, v53, v51
v_sub_f32 v176, v176, v54
v_sub_f32 v177, v177, v54
v_exp_f32 v44, v176
v_exp_f32 v45, v177
s_waitcnt lgkmcnt(3)
v_mfma_f32_32x32x16_bf16 v[216:231], v[32:35], v[144:147], v[216:231]
ds_read_b128 v[24:27], v16 offset:24576
v_cvt_pk_bf16_f32 v236, v44, v45
v_add_f32 v53, v53, v44
v_add_f32 v53, v53, v45
v_sub_f32 v178, v178, v54
v_sub_f32 v179, v179, v54
v_exp_f32 v46, v178
v_exp_f32 v47, v179
s_waitcnt lgkmcnt(3)
v_mfma_f32_32x32x16_bf16 v[200:215], v[36:39], v[148:151], v[200:215]
ds_read_b128 v[28:31], v17 offset:16384
v_cvt_pk_bf16_f32 v237, v46, v47
v_add_f32 v53, v53, v46
v_add_f32 v53, v53, v47
v_sub_f32 v180, v180, v54
v_sub_f32 v181, v181, v54
v_exp_f32 v48, v180
v_exp_f32 v49, v181
s_waitcnt lgkmcnt(3)
v_mfma_f32_32x32x16_bf16 v[216:231], v[40:43], v[148:151], v[216:231]
ds_read_b128 v[32:35], v17 offset:24576
v_cvt_pk_bf16_f32 v238, v48, v49
v_add_f32 v53, v53, v48
v_add_f32 v53, v53, v49
v_sub_f32 v182, v182, v54
v_sub_f32 v183, v183, v54
v_exp_f32 v50, v182
v_exp_f32 v51, v183
s_waitcnt lgkmcnt(3)
v_mfma_f32_32x32x16_bf16 v[200:215], v[20:23], v[152:155], v[200:215]
ds_read_b128 v[36:39], v18 offset:16384
v_cvt_pk_bf16_f32 v239, v50, v51
v_add_f32 v53, v53, v50
v_add_f32 v53, v53, v51
v_sub_f32 v184, v184, v54
v_sub_f32 v185, v185, v54
v_exp_f32 v44, v184
v_exp_f32 v45, v185
s_waitcnt lgkmcnt(3)
v_mfma_f32_32x32x16_bf16 v[216:231], v[24:27], v[152:155], v[216:231]
ds_read_b128 v[40:43], v18 offset:24576
v_cvt_pk_bf16_f32 v240, v44, v45
v_add_f32 v53, v53, v44
v_add_f32 v53, v53, v45
v_sub_f32 v186, v186, v54
v_sub_f32 v187, v187, v54
v_exp_f32 v46, v186
v_exp_f32 v47, v187
s_waitcnt lgkmcnt(3)
v_mfma_f32_32x32x16_bf16 v[200:215], v[28:31], v[156:159], v[200:215]
ds_read_b128 v[20:23], v19 offset:16384
v_cvt_pk_bf16_f32 v241, v46, v47
v_add_f32 v53, v53, v46
v_add_f32 v53, v53, v47
v_sub_f32 v188, v188, v54
v_sub_f32 v189, v189, v54
v_exp_f32 v48, v188
v_exp_f32 v49, v189
s_waitcnt lgkmcnt(3)
v_mfma_f32_32x32x16_bf16 v[216:231], v[32:35], v[156:159], v[216:231]
ds_read_b128 v[24:27], v19 offset:24576
v_cvt_pk_bf16_f32 v242, v48, v49
v_add_f32 v53, v53, v48
v_add_f32 v53, v53, v49
v_sub_f32 v190, v190, v54
v_sub_f32 v191, v191, v54
v_exp_f32 v50, v190
v_exp_f32 v51, v191
s_waitcnt lgkmcnt(3)
v_mfma_f32_32x32x16_bf16 v[200:215], v[36:39], v[160:163], v[200:215]
s_waitcnt vmcnt(4)
s_barrier
ds_read_b64_tr_b16 v[28:29], v8 offset:0
ds_read_b64_tr_b16 v[30:31], v8 offset:1024
v_cvt_pk_bf16_f32 v243, v50, v51
v_add_f32 v53, v53, v50
v_add_f32 v53, v53, v51
v_sub_f32 v192, v192, v54
v_sub_f32 v193, v193, v54
v_exp_f32 v44, v192
v_exp_f32 v45, v193
s_waitcnt lgkmcnt(4)
v_mfma_f32_32x32x16_bf16 v[216:231], v[40:43], v[160:163], v[216:231]
ds_read_b64_tr_b16 v[32:33], v9 offset:0
ds_read_b64_tr_b16 v[34:35], v9 offset:1024
v_cvt_pk_bf16_f32 v244, v44, v45
v_add_f32 v53, v53, v44
v_add_f32 v53, v53, v45
v_sub_f32 v194, v194, v54
v_sub_f32 v195, v195, v54
v_exp_f32 v46, v194
v_exp_f32 v47, v195
s_waitcnt lgkmcnt(5)
v_mfma_f32_32x32x16_bf16 v[200:215], v[20:23], v[164:167], v[200:215]
ds_read_b64_tr_b16 v[36:37], v10 offset:0
ds_read_b64_tr_b16 v[38:39], v10 offset:1024
v_cvt_pk_bf16_f32 v245, v46, v47
v_add_f32 v53, v53, v46
v_add_f32 v53, v53, v47
v_sub_f32 v196, v196, v54
v_sub_f32 v197, v197, v54
v_exp_f32 v48, v196
v_exp_f32 v49, v197
v_sub_f32 v198, v198, v54
v_sub_f32 v199, v199, v54
v_exp_f32 v50, v198
v_exp_f32 v51, v199
s_waitcnt lgkmcnt(6)
v_mfma_f32_32x32x16_bf16 v[216:231], v[24:27], v[164:167], v[216:231]
ds_read_b64_tr_b16 v[40:41], v11 offset:0
ds_read_b64_tr_b16 v[42:43], v11 offset:1024
v_cvt_pk_bf16_f32 v246, v48, v49
v_add_f32 v53, v53, v48
v_add_f32 v53, v53, v49
v_cvt_pk_bf16_f32 v247, v50, v51
v_add_f32 v53, v53, v50
v_add_f32 v53, v53, v51
v_add_f32 v52, v52, v53
s_waitcnt lgkmcnt(6)
v_mfma_f32_32x32x16_bf16 v[56:71], v[28:31], v[232:235], 0
ds_read_b64_tr_b16 v[20:21], v8 offset:4096
ds_read_b64_tr_b16 v[22:23], v8 offset:5120
v_exp_f32 v44, v200
v_exp_f32 v45, v201
s_waitcnt lgkmcnt(6)
v_mfma_f32_32x32x16_bf16 v[72:87], v[32:35], v[232:235], 0
ds_read_b64_tr_b16 v[24:25], v9 offset:4096
ds_read_b64_tr_b16 v[26:27], v9 offset:5120
v_exp_f32 v46, v202
v_exp_f32 v47, v203
s_waitcnt lgkmcnt(6)
v_mfma_f32_32x32x16_bf16 v[88:103], v[36:39], v[232:235], 0
ds_read_b64_tr_b16 v[28:29], v10 offset:4096
ds_read_b64_tr_b16 v[30:31], v10 offset:5120
s_add_u32 s35, s32, 65536
s_add_u32 m0, s30, 0
s_nop 0
buffer_load_dwordx4 v5, s[8:11], s35 offen lds
s_waitcnt lgkmcnt(6)
v_mfma_f32_32x32x16_bf16 v[104:119], v[40:43], v[232:235], 0
ds_read_b64_tr_b16 v[32:33], v11 offset:4096
ds_read_b64_tr_b16 v[34:35], v11 offset:5120
v_exp_f32 v48, v204
v_exp_f32 v49, v205
s_waitcnt lgkmcnt(6)
v_mfma_f32_32x32x16_bf16 v[56:71], v[20:23], v[236:239], v[56:71]
ds_read_b64_tr_b16 v[36:37], v8 offset:8192
ds_read_b64_tr_b16 v[38:39], v8 offset:9216
s_add_u32 s35, s32, 73728
s_add_u32 m0, s30, 8192
s_nop 0
buffer_load_dwordx4 v5, s[8:11], s35 offen lds
v_cvt_pk_bf16_f32 v232, v44, v45
v_add_f32 v53, v44, v45
v_cvt_pk_bf16_f32 v233, v46, v47
v_add_f32 v53, v53, v46
v_add_f32 v53, v53, v47
s_waitcnt lgkmcnt(6)
v_mfma_f32_32x32x16_bf16 v[72:87], v[24:27], v[236:239], v[72:87]
ds_read_b64_tr_b16 v[40:41], v9 offset:8192
ds_read_b64_tr_b16 v[42:43], v9 offset:9216
v_cvt_pk_bf16_f32 v234, v48, v49
v_add_f32 v53, v53, v48
v_add_f32 v53, v53, v49
v_exp_f32 v50, v206
v_exp_f32 v51, v207
s_waitcnt lgkmcnt(6)
v_mfma_f32_32x32x16_bf16 v[88:103], v[28:31], v[236:239], v[88:103]
ds_read_b64_tr_b16 v[20:21], v10 offset:8192
ds_read_b64_tr_b16 v[22:23], v10 offset:9216
s_add_u32 s35, s32, 81920
s_add_u32 m0, s30, 16384
s_nop 0
buffer_load_dwordx4 v5, s[8:11], s35 offen lds
s_waitcnt lgkmcnt(6)
v_mfma_f32_32x32x16_bf16 v[104:119], v[32:35], v[236:239], v[104:119]
ds_read_b64_tr_b16 v[24:25], v11 offset:8192
ds_read_b64_tr_b16 v[26:27], v11 offset:9216
v_cvt_pk_bf16_f32 v235, v50, v51
v_add_f32 v53, v53, v50
v_add_f32 v53, v53, v51
v_exp_f32 v44, v208
v_exp_f32 v45, v209
s_waitcnt lgkmcnt(6)
v_mfma_f32_32x32x16_bf16 v[56:71], v[36:39], v[240:243], v[56:71]
ds_read_b64_tr_b16 v[28:29], v8 offset:12288
ds_read_b64_tr_b16 v[30:31], v8 offset:13312
s_add_u32 s35, s32, 90112
s_add_u32 m0, s30, 24576
s_nop 0
buffer_load_dwordx4 v5, s[8:11], s35 offen lds
v_exp_f32 v46, v210
v_exp_f32 v47, v211
s_waitcnt lgkmcnt(6)
v_mfma_f32_32x32x16_bf16 v[72:87], v[40:43], v[240:243], v[72:87]
ds_read_b64_tr_b16 v[32:33], v9 offset:12288
ds_read_b64_tr_b16 v[34:35], v9 offset:13312
v_cvt_pk_bf16_f32 v236, v44, v45
v_add_f32 v53, v53, v44
v_add_f32 v53, v53, v45
s_waitcnt lgkmcnt(6)
v_mfma_f32_32x32x16_bf16 v[88:103], v[20:23], v[240:243], v[88:103]
ds_read_b64_tr_b16 v[36:37], v10 offset:12288
ds_read_b64_tr_b16 v[38:39], v10 offset:13312
v_cvt_pk_bf16_f32 v237, v46, v47
v_add_f32 v53, v53, v46
v_add_f32 v53, v53, v47
v_exp_f32 v48, v212
v_exp_f32 v49, v213
s_waitcnt lgkmcnt(6)
v_mfma_f32_32x32x16_bf16 v[104:119], v[24:27], v[240:243], v[104:119]
ds_read_b64_tr_b16 v[40:41], v11 offset:12288
ds_read_b64_tr_b16 v[42:43], v11 offset:13312
s_waitcnt lgkmcnt(6)
v_mfma_f32_32x32x16_bf16 v[56:71], v[28:31], v[244:247], v[56:71]
ds_read_b128 v[20:23], v12 offset:32768
v_cvt_pk_bf16_f32 v238, v48, v49
v_add_f32 v53, v53, v48
v_add_f32 v53, v53, v49
v_exp_f32 v50, v214
v_exp_f32 v51, v215
s_waitcnt lgkmcnt(5)
v_mfma_f32_32x32x16_bf16 v[72:87], v[32:35], v[244:247], v[72:87]
ds_read_b128 v[24:27], v12 offset:40960
s_waitcnt lgkmcnt(4)
v_mfma_f32_32x32x16_bf16 v[88:103], v[36:39], v[244:247], v[88:103]
ds_read_b128 v[28:31], v13 offset:32768
v_cvt_pk_bf16_f32 v239, v50, v51
v_add_f32 v53, v53, v50
v_add_f32 v53, v53, v51
v_exp_f32 v44, v216
v_exp_f32 v45, v217
s_waitcnt lgkmcnt(3)
v_mfma_f32_32x32x16_bf16 v[104:119], v[40:43], v[244:247], v[104:119]
ds_read_b128 v[32:35], v13 offset:40960
v_exp_f32 v46, v218
v_exp_f32 v47, v219
s_waitcnt lgkmcnt(3)
v_mfma_f32_32x32x16_bf16 v[168:183], v[20:23], v[136:139], v[120:135]
ds_read_b128 v[36:39], v14 offset:32768
v_cvt_pk_bf16_f32 v240, v44, v45
v_add_f32 v53, v53, v44
v_add_f32 v53, v53, v45
s_waitcnt lgkmcnt(3)
v_mfma_f32_32x32x16_bf16 v[184:199], v[24:27], v[136:139], v[120:135]
ds_read_b128 v[40:43], v14 offset:40960
v_cvt_pk_bf16_f32 v241, v46, v47
v_add_f32 v53, v53, v46
v_add_f32 v53, v53, v47
v_exp_f32 v48, v220
v_exp_f32 v49, v221
s_waitcnt lgkmcnt(3)
v_mfma_f32_32x32x16_bf16 v[168:183], v[28:31], v[140:143], v[168:183]
ds_read_b128 v[20:23], v15 offset:32768
s_waitcnt lgkmcnt(3)
v_mfma_f32_32x32x16_bf16 v[184:199], v[32:35], v[140:143], v[184:199]
ds_read_b128 v[24:27], v15 offset:40960
v_cvt_pk_bf16_f32 v242, v48, v49
v_add_f32 v53, v53, v48
v_add_f32 v53, v53, v49
v_exp_f32 v50, v222
v_exp_f32 v51, v223
s_waitcnt lgkmcnt(3)
v_mfma_f32_32x32x16_bf16 v[168:183], v[36:39], v[144:147], v[168:183]
ds_read_b128 v[28:31], v16 offset:32768
s_waitcnt lgkmcnt(3)
v_mfma_f32_32x32x16_bf16 v[184:199], v[40:43], v[144:147], v[184:199]
ds_read_b128 v[32:35], v16 offset:40960
v_cvt_pk_bf16_f32 v243, v50, v51
v_add_f32 v53, v53, v50
v_add_f32 v53, v53, v51
v_exp_f32 v44, v224
v_exp_f32 v45, v225
s_waitcnt lgkmcnt(3)
v_mfma_f32_32x32x16_bf16 v[168:183], v[20:23], v[148:151], v[168:183]
ds_read_b128 v[36:39], v17 offset:32768
v_exp_f32 v46, v226
v_exp_f32 v47, v227
s_waitcnt lgkmcnt(3)
v_mfma_f32_32x32x16_bf16 v[184:199], v[24:27], v[148:151], v[184:199]
ds_read_b128 v[40:43], v17 offset:40960
v_cvt_pk_bf16_f32 v244, v44, v45
v_add_f32 v53, v53, v44
v_add_f32 v53, v53, v45
s_waitcnt lgkmcnt(3)
v_mfma_f32_32x32x16_bf16 v[168:183], v[28:31], v[152:155], v[168:183]
ds_read_b128 v[20:23], v18 offset:32768
v_cvt_pk_bf16_f32 v245, v46, v47
v_add_f32 v53, v53, v46
v_add_f32 v53, v53, v47
v_exp_f32 v48, v228
v_exp_f32 v49, v229
s_waitcnt lgkmcnt(3)
v_mfma_f32_32x32x16_bf16 v[184:199], v[32:35], v[152:155], v[184:199]
ds_read_b128 v[24:27], v18 offset:40960
s_waitcnt lgkmcnt(3)
v_mfma_f32_32x32x16_bf16 v[168:183], v[36:39], v[156:159], v[168:183]
ds_read_b128 v[28:31], v19 offset:32768
v_cvt_pk_bf16_f32 v246, v48, v49
v_add_f32 v53, v53, v48
v_add_f32 v53, v53, v49
v_exp_f32 v50, v230
v_exp_f32 v51, v231
s_waitcnt lgkmcnt(3)
v_mfma_f32_32x32x16_bf16 v[184:199], v[40:43], v[156:159], v[184:199]
ds_read_b128 v[32:35], v19 offset:40960
s_waitcnt lgkmcnt(3)
v_mfma_f32_32x32x16_bf16 v[168:183], v[20:23], v[160:163], v[168:183]
ds_read_b64_tr_b16 v[36:37], v8 offset:16384
ds_read_b64_tr_b16 v[38:39], v8 offset:17408
v_cvt_pk_bf16_f32 v247, v50, v51
v_add_f32 v53, v53, v50
v_add_f32 v53, v53, v51
s_waitcnt lgkmcnt(4)
v_mfma_f32_32x32x16_bf16 v[184:199], v[24:27], v[160:163], v[184:199]
ds_read_b64_tr_b16 v[40:41], v9 offset:16384
ds_read_b64_tr_b16 v[42:43], v9 offset:17408
s_waitcnt lgkmcnt(5)
v_mfma_f32_32x32x16_bf16 v[168:183], v[28:31], v[164:167], v[168:183]
ds_read_b64_tr_b16 v[20:21], v10 offset:16384
ds_read_b64_tr_b16 v[22:23], v10 offset:17408
s_waitcnt lgkmcnt(6)
v_mfma_f32_32x32x16_bf16 v[184:199], v[32:35], v[164:167], v[184:199]
ds_read_b64_tr_b16 v[24:25], v11 offset:16384
ds_read_b64_tr_b16 v[26:27], v11 offset:17408
v_cmp_nle_f32 vcc, v53, s41
s_nop 1
s_cbranch_vccnz L_fb1
L_ret1:
v_add_f32 v52, v52, v53
s_waitcnt lgkmcnt(6)
v_mfma_f32_32x32x16_bf16 v[56:71], v[36:39], v[232:235], v[56:71]
ds_read_b64_tr_b16 v[28:29], v8 offset:20480
ds_read_b64_tr_b16 v[30:31], v8 offset:21504
v_exp_f32 v44, v168
v_exp_f32 v45, v169
s_waitcnt lgkmcnt(6)
v_mfma_f32_32x32x16_bf16 v[72:87], v[40:43], v[232:235], v[72:87]
ds_read_b64_tr_b16 v[32:33], v9 offset:20480
ds_read_b64_tr_b16 v[34:35], v9 offset:21504
v_exp_f32 v46, v170
v_exp_f32 v47, v171
s_waitcnt lgkmcnt(6)
v_mfma_f32_32x32x16_bf16 v[88:103], v[20:23], v[232:235], v[88:103]
ds_read_b64_tr_b16 v[36:37], v10 offset:20480
ds_read_b64_tr_b16 v[38:39], v10 offset:21504
s_waitcnt lgkmcnt(6)
v_mfma_f32_32x32x16_bf16 v[104:119], v[24:27], v[232:235], v[104:119]
ds_read_b64_tr_b16 v[40:41], v11 offset:20480
ds_read_b64_tr_b16 v[42:43], v11 offset:21504
v_exp_f32 v48, v172
v_exp_f32 v49, v173
s_waitcnt lgkmcnt(6)
v_mfma_f32_32x32x16_bf16 v[56:71], v[28:31], v[236:239], v[56:71]
ds_read_b64_tr_b16 v[20:21], v8 offset:24576
ds_read_b64_tr_b16 v[22:23], v8 offset:25600
v_cvt_pk_bf16_f32 v232, v44, v45
v_add_f32 v53, v44, v45
v_cvt_pk_bf16_f32 v233, v46, v47
v_add_f32 v53, v53, v46
v_add_f32 v53, v53, v47
s_waitcnt lgkmcnt(6)
v_mfma_f32_32x32x16_bf16 v[72:87], v[32:35], v[236:239], v[72:87]
ds_read_b64_tr_b16 v[24:25], v9 offset:24576
ds_read_b64_tr_b16 v[26:27], v9 offset:25600
v_cvt_pk_bf16_f32 v234, v48, v49
v_add_f32 v53, v53, v48
v_add_f32 v53, v53, v49
v_exp_f32 v50, v174
v_exp_f32 v51, v175
s_waitcnt lgkmcnt(6)
v_mfma_f32_32x32x16_bf16 v[88:103], v[36:39], v[236:239], v[88:103]
ds_read_b64_tr_b16 v[28:29], v10 offset:24576
ds_read_b64_tr_b16 v[30:31], v10 offset:25600
s_waitcnt lgkmcnt(6)
v_mfma_f32_32x32x16_bf16 v[104:119], v[40:43], v[236:239], v[104:119]
ds_read_b64_tr_b16 v[32:33], v11 offset:24576
ds_read_b64_tr_b16 v[34:35], v11 offset:25600
v_cvt_pk_bf16_f32 v235, v50, v51
v_add_f32 v53, v53, v50
v_add_f32 v53, v53, v51
v_exp_f32 v44, v176
v_exp_f32 v45, v177
s_waitcnt lgkmcnt(6)
v_mfma_f32_32x32x16_bf16 v[56:71], v[20:23], v[240:243], v[56:71]
ds_read_b64_tr_b16 v[36:37], v8 offset:28672
ds_read_b64_tr_b16 v[38:39], v8 offset:29696
v_exp_f32 v46, v178
v_exp_f32 v47, v179
s_waitcnt lgkmcnt(6)
v_mfma_f32_32x32x16_bf16 v[72:87], v[24:27], v[240:243], v[72:87]
ds_read_b64_tr_b16 v[40:41], v9 offset:28672
ds_read_b64_tr_b16 v[42:43], v9 offset:29696
v_cvt_pk_bf16_f32 v236, v44, v45
v_add_f32 v53, v53, v44
v_add_f32 v53, v53, v45
s_waitcnt lgkmcnt(6)
v_mfma_f32_32x32x16_bf16 v[88:103], v[28:31], v[240:243], v[88:103]
ds_read_b64_tr_b16 v[20:21], v10 offset:28672
ds_read_b64_tr_b16 v[22:23], v10 offset:29696
v_cvt_pk_bf16_f32 v237, v46, v47
v_add_f32 v53, v53, v46
v_add_f32 v53, v53, v47
v_exp_f32 v48, v180
v_exp_f32 v49, v181
s_waitcnt lgkmcnt(6)
v_mfma_f32_32x32x16_bf16 v[104:119], v[32:35], v[240:243], v[104:119]
ds_read_b64_tr_b16 v[24:25], v11 offset:28672
ds_read_b64_tr_b16 v[26:27], v11 offset:29696
s_waitcnt lgkmcnt(6)
v_mfma_f32_32x32x16_bf16 v[56:71], v[36:39], v[244:247], v[56:71]
ds_read_b128 v[28:31], v12 offset:49152
v_cvt_pk_bf16_f32 v238, v48, v49
v_add_f32 v53, v53, v48
v_add_f32 v53, v53, v49
v_exp_f32 v50, v182
v_exp_f32 v51, v183
s_waitcnt lgkmcnt(5)
v_mfma_f32_32x32x16_bf16 v[72:87], v[40:43], v[244:247], v[72:87]
ds_read_b128 v[32:35], v12 offset:57344
s_waitcnt lgkmcnt(4)
v_mfma_f32_32x32x16_bf16 v[88:103], v[20:23], v[244:247], v[88:103]
ds_read_b128 v[36:39], v13 offset:49152
v_cvt_pk_bf16_f32 v239, v50, v51
v_add_f32 v53, v53, v50
v_add_f32 v53, v53, v51
v_exp_f32 v44, v184
v_exp_f32 v45, v185
s_waitcnt lgkmcnt(3)
v_mfma_f32_32x32x16_bf16 v[104:119], v[24:27], v[244:247], v[104:119]
ds_read_b128 v[40:43], v13 offset:57344
v_exp_f32 v46, v186
v_exp_f32 v47, v187
s_waitcnt lgkmcnt(3)
v_mfma_f32_32x32x16_bf16 v[200:215], v[28:31], v[136:139], v[120:135]
ds_read_b128 v[20:23], v14 offset:49152
v_cvt_pk_bf16_f32 v240, v44, v45
v_add_f32 v53, v53, v44
v_add_f32 v53, v53, v45
s_waitcnt lgkmcnt(3)
v_mfma_f32_32x32x16_bf16 v[216:231], v[32:35], v[136:139], v[120:135]
ds_read_b128 v[24:27], v14 offset:57344
v_cvt_pk_bf16_f32 v241, v46, v47
v_add_f32 v53, v53, v46
v_add_f32 v53, v53, v47
v_exp_f32 v48, v188
v_exp_f32 v49, v189
s_waitcnt lgkmcnt(3)
v_mfma_f32_32x32x16_bf16 v[200:215], v[36:39], v[140:143], v[200:215]
ds_read_b128 v[28:31], v15 offset:49152
s_waitcnt lgkmcnt(3)
v_mfma_f32_32x32x16_bf16 v[216:231], v[40:43], v[140:143], v[216:231]
ds_read_b128 v[32:35], v15 offset:57344
v_cvt_pk_bf16_f32 v242, v48, v49
v_add_f32 v53, v53, v48
v_add_f32 v53, v53, v49
v_exp_f32 v50, v190
v_exp_f32 v51, v191
s_waitcnt lgkmcnt(3)
v_mfma_f32_32x32x16_bf16 v[200:215], v[20:23], v[144:147], v[200:215]
ds_read_b128 v[36:39], v16 offset:49152
s_waitcnt lgkmcnt(3)
v_mfma_f32_32x32x16_bf16 v[216:231], v[24:27], v[144:147], v[216:231]
ds_read_b128 v[40:43], v16 offset:57344
v_cvt_pk_bf16_f32 v243, v50, v51
v_add_f32 v53, v53, v50
v_add_f32 v53, v53, v51
v_exp_f32 v44, v192
v_exp_f32 v45, v193
s_waitcnt lgkmcnt(3)
v_mfma_f32_32x32x16_bf16 v[200:215], v[28:31], v[148:151], v[200:215]
ds_read_b128 v[20:23], v17 offset:49152
v_exp_f32 v46, v194
v_exp_f32 v47, v195
s_waitcnt lgkmcnt(3)
v_mfma_f32_32x32x16_bf16 v[216:231], v[32:35], v[148:151], v[216:231]
ds_read_b128 v[24:27], v17 offset:57344
v_cvt_pk_bf16_f32 v244, v44, v45
v_add_f32 v53, v53, v44
v_add_f32 v53, v53, v45
s_waitcnt lgkmcnt(3)
v_mfma_f32_32x32x16_bf16 v[200:215], v[36:39], v[152:155], v[200:215]
ds_read_b128 v[28:31], v18 offset:49152
v_cvt_pk_bf16_f32 v245, v46, v47
v_add_f32 v53, v53, v46
v_add_f32 v53, v53, v47
v_exp_f32 v48, v196
v_exp_f32 v49, v197
s_waitcnt lgkmcnt(3)
v_mfma_f32_32x32x16_bf16 v[216:231], v[40:43], v[152:155], v[216:231]
ds_read_b128 v[32:35], v18 offset:57344
s_waitcnt lgkmcnt(3)
v_mfma_f32_32x32x16_bf16 v[200:215], v[20:23], v[156:159], v[200:215]
ds_read_b128 v[36:39], v19 offset:49152
v_cvt_pk_bf16_f32 v246, v48, v49
v_add_f32 v53, v53, v48
v_add_f32 v53, v53, v49
v_exp_f32 v50, v198
v_exp_f32 v51, v199
s_waitcnt lgkmcnt(3)
v_mfma_f32_32x32x16_bf16 v[216:231], v[24:27], v[156:159], v[216:231]
ds_read_b128 v[40:43], v19 offset:57344
s_waitcnt lgkmcnt(3)
v_mfma_f32_32x32x16_bf16 v[200:215], v[28:31], v[160:163], v[200:215]
s_waitcnt vmcnt(0)
s_barrier
ds_read_b64_tr_b16 v[20:21], v8 offset:32768
ds_read_b64_tr_b16 v[22:23], v8 offset:33792
v_cvt_pk_bf16_f32 v247, v50, v51
v_add_f32 v53, v53, v50
v_add_f32 v53, v53, v51
s_waitcnt lgkmcnt(4)
v_mfma_f32_32x32x16_bf16 v[216:231], v[32:35], v[160:163], v[216:231]
ds_read_b64_tr_b16 v[24:25], v9 offset:32768
ds_read_b64_tr_b16 v[26:27], v9 offset:33792
s_waitcnt lgkmcnt(5)
v_mfma_f32_32x32x16_bf16 v[200:215], v[36:39], v[164:167], v[200:215]
ds_read_b64_tr_b16 v[28:29], v10 offset:32768
ds_read_b64_tr_b16 v[30:31], v10 offset:33792
s_waitcnt lgkmcnt(6)
v_mfma_f32_32x32x16_bf16 v[216:231], v[40:43], v[164:167], v[216:231]
ds_read_b64_tr_b16 v[32:33], v11 offset:32768
ds_read_b64_tr_b16 v[34:35], v11 offset:33792
v_cmp_nle_f32 vcc, v53, s41
s_nop 1
s_cbranch_vccnz L_fb2
L_ret2:
v_add_f32 v52, v52, v53
s_waitcnt lgkmcnt(6)
v_mfma_f32_32x32x16_bf16 v[56:71], v[20:23], v[232:235], v[56:71]
ds_read_b64_tr_b16 v[36:37], v8 offset:36864
ds_read_b64_tr_b16 v[38:39], v8 offset:37888
v_exp_f32 v44, v200
v_exp_f32 v45, v201
s_waitcnt lgkmcnt(6)
v_mfma_f32_32x32x16_bf16 v[72:87], v[24:27], v[232:235], v[72:87]
ds_read_b64_tr_b16 v[40:41], v9 offset:36864
ds_read_b64_tr_b16 v[42:43], v9 offset:37888
v_exp_f32 v46, v202
v_exp_f32 v47, v203
s_waitcnt lgkmcnt(6)
v_mfma_f32_32x32x16_bf16 v[88:103], v[28:31], v[232:235], v[88:103]
ds_read_b64_tr_b16 v[20:21], v10 offset:36864
ds_read_b64_tr_b16 v[22:23], v10 offset:37888
s_add_u32 s35, s32, 98304
s_add_u32 m0, s30, 32768
s_nop 0
buffer_load_dwordx4 v5, s[8:11], s35 offen lds
s_waitcnt lgkmcnt(6)
v_mfma_f32_32x32x16_bf16 v[104:119], v[32:35], v[232:235], v[104:119]
ds_read_b64_tr_b16 v[24:25], v11 offset:36864
ds_read_b64_tr_b16 v[26:27], v11 offset:37888
v_exp_f32 v48, v204
v_exp_f32 v49, v205
s_waitcnt lgkmcnt(6)
v_mfma_f32_32x32x16_bf16 v[56:71], v[36:39], v[236:239], v[56:71]
ds_read_b64_tr_b16 v[28:29], v8 offset:40960
ds_read_b64_tr_b16 v[30:31], v8 offset:41984
s_add_u32 s35, s32, 106496
s_add_u32 m0, s30, 40960
s_nop 0
buffer_load_dwordx4 v5, s[8:11], s35 offen lds
v_cvt_pk_bf16_f32 v232, v44, v45
v_add_f32 v53, v44, v45
v_cvt_pk_bf16_f32 v233, v46, v47
v_add_f32 v53, v53, v46
v_add_f32 v53, v53, v47
s_waitcnt lgkmcnt(6)
v_mfma_f32_32x32x16_bf16 v[72:87], v[40:43], v[236:239], v[72:87]
ds_read_b64_tr_b16 v[32:33], v9 offset:40960
ds_read_b64_tr_b16 v[34:35], v9 offset:41984
v_cvt_pk_bf16_f32 v234, v48, v49
v_add_f32 v53, v53, v48
v_add_f32 v53, v53, v49
v_exp_f32 v50, v206
v_exp_f32 v51, v207
s_waitcnt lgkmcnt(6)
v_mfma_f32_32x32x16_bf16 v[88:103], v[20:23], v[236:239], v[88:103]
ds_read_b64_tr_b16 v[36:37], v10 offset:40960
ds_read_b64_tr_b16 v[38:39], v10 offset:41984
s_add_u32 s35, s32, 114688
s_add_u32 m0, s30, 49152
s_nop 0
buffer_load_dwordx4 v5, s[8:11], s35 offen lds
s_waitcnt lgkmcnt(6)
v_mfma_f32_32x32x16_bf16 v[104:119], v[24:27], v[236:239], v[104:119]
ds_read_b64_tr_b16 v[40:41], v11 offset:40960
ds_read_b64_tr_b16 v[42:43], v11 offset:41984
v_cvt_pk_bf16_f32 v235, v50, v51
v_add_f32 v53, v53, v50
v_add_f32 v53, v53, v51
v_exp_f32 v44, v208
v_exp_f32 v45, v209
s_waitcnt lgkmcnt(6)
v_mfma_f32_32x32x16_bf16 v[56:71], v[28:31], v[240:243], v[56:71]
ds_read_b64_tr_b16 v[20:21], v8 offset:45056
ds_read_b64_tr_b16 v[22:23], v8 offset:46080
s_add_u32 s35, s32, 122880
s_add_u32 m0, s30, 57344
s_nop 0
buffer_load_dwordx4 v5, s[8:11], s35 offen lds
v_exp_f32 v46, v210
v_exp_f32 v47, v211
s_waitcnt lgkmcnt(6)
v_mfma_f32_32x32x16_bf16 v[72:87], v[32:35], v[240:243], v[72:87]
ds_read_b64_tr_b16 v[24:25], v9 offset:45056
ds_read_b64_tr_b16 v[26:27], v9 offset:46080
v_cvt_pk_bf16_f32 v236, v44, v45
v_add_f32 v53, v53, v44
v_add_f32 v53, v53, v45
s_waitcnt lgkmcnt(6)
v_mfma_f32_32x32x16_bf16 v[88:103], v[36:39], v[240:243], v[88:103]
ds_read_b64_tr_b16 v[28:29], v10 offset:45056
ds_read_b64_tr_b16 v[30:31], v10 offset:46080
s_add_u32 s35, s32, 65536
s_add_u32 m0, s30, 65536
s_nop 0
buffer_load_dwordx4 v4, s[16:19], s35 offen lds
v_cvt_pk_bf16_f32 v237, v46, v47
v_add_f32 v53, v53, v46
v_add_f32 v53, v53, v47
v_exp_f32 v48, v212
v_exp_f32 v49, v213
s_waitcnt lgkmcnt(6)
v_mfma_f32_32x32x16_bf16 v[104:119], v[40:43], v[240:243], v[104:119]
ds_read_b64_tr_b16 v[32:33], v11 offset:45056
ds_read_b64_tr_b16 v[34:35], v11 offset:46080
s_waitcnt lgkmcnt(6)
v_mfma_f32_32x32x16_bf16 v[56:71], v[20:23], v[244:247], v[56:71]
ds_read_b128 v[36:39], v12 offset:0
s_add_u32 s35, s32, 73728
s_add_u32 m0, s30, 73728
s_nop 0
buffer_load_dwordx4 v4, s[16:19], s35 offen lds
v_cvt_pk_bf16_f32 v238, v48, v49
v_add_f32 v53, v53, v48
v_add_f32 v53, v53, v49
v_exp_f32 v50, v214
v_exp_f32 v51, v215
s_waitcnt lgkmcnt(5)
v_mfma_f32_32x32x16_bf16 v[72:87], v[24:27], v[244:247], v[72:87]
ds_read_b128 v[40:43], v12 offset:8192
s_waitcnt lgkmcnt(4)
v_mfma_f32_32x32x16_bf16 v[88:103], v[28:31], v[244:247], v[88:103]
ds_read_b128 v[20:23], v13 offset:0
s_add_u32 s35, s32, 81920
s_add_u32 m0, s30, 81920
s_nop 0
buffer_load_dwordx4 v4, s[16:19], s35 offen lds
v_cvt_pk_bf16_f32 v239, v50, v51
v_add_f32 v53, v53, v50
v_add_f32 v53, v53, v51
v_exp_f32 v44, v216
v_exp_f32 v45, v217
s_waitcnt lgkmcnt(3)
v_mfma_f32_32x32x16_bf16 v[104:119], v[32:35], v[244:247], v[104:119]
ds_read_b128 v[24:27], v13 offset:8192
v_exp_f32 v46, v218
v_exp_f32 v47, v219
s_waitcnt lgkmcnt(3)
v_mfma_f32_32x32x16_bf16 v[168:183], v[36:39], v[136:139], v[120:135]
ds_read_b128 v[28:31], v14 offset:0
s_add_u32 s35, s32, 90112
s_add_u32 m0, s30, 90112
s_nop 0
buffer_load_dwordx4 v4, s[16:19], s35 offen lds
v_cvt_pk_bf16_f32 v240, v44, v45
v_add_f32 v53, v53, v44
v_add_f32 v53, v53, v45
s_waitcnt lgkmcnt(3)
v_mfma_f32_32x32x16_bf16 v[184:199], v[40:43], v[136:139], v[120:135]
ds_read_b128 v[32:35], v14 offset:8192
v_cvt_pk_bf16_f32 v241, v46, v47
v_add_f32 v53, v53, v46
v_add_f32 v53, v53, v47
v_exp_f32 v48, v220
v_exp_f32 v49, v221
s_waitcnt lgkmcnt(3)
v_mfma_f32_32x32x16_bf16 v[168:183], v[20:23], v[140:143], v[168:183]
ds_read_b128 v[36:39], v15 offset:0
s_waitcnt lgkmcnt(3)
v_mfma_f32_32x32x16_bf16 v[184:199], v[24:27], v[140:143], v[184:199]
ds_read_b128 v[40:43], v15 offset:8192
v_cvt_pk_bf16_f32 v242, v48, v49
v_add_f32 v53, v53, v48
v_add_f32 v53, v53, v49
v_exp_f32 v50, v222
v_exp_f32 v51, v223
s_waitcnt lgkmcnt(3)
v_mfma_f32_32x32x16_bf16 v[168:183], v[28:31], v[144:147], v[168:183]
ds_read_b128 v[20:23], v16 offset:0
s_waitcnt lgkmcnt(3)
v_mfma_f32_32x32x16_bf16 v[184:199], v[32:35], v[144:147], v[184:199]
ds_read_b128 v[24:27], v16 offset:8192
v_cvt_pk_bf16_f32 v243, v50, v51
v_add_f32 v53, v53, v50
v_add_f32 v53, v53, v51
v_exp_f32 v44, v224
v_exp_f32 v45, v225
s_waitcnt lgkmcnt(3)
v_mfma_f32_32x32x16_bf16 v[168:183], v[36:39], v[148:151], v[168:183]
ds_read_b128 v[28:31], v17 offset:0
v_exp_f32 v46, v226
v_exp_f32 v47, v227
s_waitcnt lgkmcnt(3)
v_mfma_f32_32x32x16_bf16 v[184:199], v[40:43], v[148:151], v[184:199]
ds_read_b128 v[32:35], v17 offset:8192
v_cvt_pk_bf16_f32 v244, v44, v45
v_add_f32 v53, v53, v44
v_add_f32 v53, v53, v45
s_waitcnt lgkmcnt(3)
v_mfma_f32_32x32x16_bf16 v[168:183], v[20:23], v[152:155], v[168:183]
ds_read_b128 v[36:39], v18 offset:0
v_cvt_pk_bf16_f32 v245, v46, v47
v_add_f32 v53, v53, v46
v_add_f32 v53, v53, v47
v_exp_f32 v48, v228
v_exp_f32 v49, v229
s_waitcnt lgkmcnt(3)
v_mfma_f32_32x32x16_bf16 v[184:199], v[24:27], v[152:155], v[184:199]
ds_read_b128 v[40:43], v18 offset:8192
s_waitcnt lgkmcnt(3)
v_mfma_f32_32x32x16_bf16 v[168:183], v[28:31], v[156:159], v[168:183]
ds_read_b128 v[20:23], v19 offset:0
v_cvt_pk_bf16_f32 v246, v48, v49
v_add_f32 v53, v53, v48
v_add_f32 v53, v53, v49
v_exp_f32 v50, v230
v_exp_f32 v51, v231
s_waitcnt lgkmcnt(3)
v_mfma_f32_32x32x16_bf16 v[184:199], v[32:35], v[156:159], v[184:199]
ds_read_b128 v[24:27], v19 offset:8192
s_waitcnt lgkmcnt(3)
v_mfma_f32_32x32x16_bf16 v[168:183], v[36:39], v[160:163], v[168:183]
ds_read_b64_tr_b16 v[28:29], v8 offset:49152
ds_read_b64_tr_b16 v[30:31], v8 offset:50176
v_cvt_pk_bf16_f32 v247, v50, v51
v_add_f32 v53, v53, v50
v_add_f32 v53, v53, v51
s_waitcnt lgkmcnt(4)
v_mfma_f32_32x32x16_bf16 v[184:199], v[40:43], v[160:163], v[184:199]
ds_read_b64_tr_b16 v[32:33], v9 offset:49152
ds_read_b64_tr_b16 v[34:35], v9 offset:50176
s_waitcnt lgkmcnt(5)
v_mfma_f32_32x32x16_bf16 v[168:183], v[20:23], v[164:167], v[168:183]
ds_read_b64_tr_b16 v[36:37], v10 offset:49152
ds_read_b64_tr_b16 v[38:39], v10 offset:50176
s_waitcnt lgkmcnt(6)
v_mfma_f32_32x32x16_bf16 v[184:199], v[24:27], v[164:167], v[184:199]
ds_read_b64_tr_b16 v[40:41], v11 offset:49152
ds_read_b64_tr_b16 v[42:43], v11 offset:50176
v_cmp_nle_f32 vcc, v53, s41
s_nop 1
s_cbranch_vccnz L_fb3
L_ret3:
v_add_f32 v52, v52, v53
s_waitcnt lgkmcnt(6)
v_mfma_f32_32x32x16_bf16 v[56:71], v[28:31], v[232:235], v[56:71]
ds_read_b64_tr_b16 v[20:21], v8 offset:53248
ds_read_b64_tr_b16 v[22:23], v8 offset:54272
v_exp_f32 v44, v168
v_exp_f32 v45, v169
s_waitcnt lgkmcnt(6)
v_mfma_f32_32x32x16_bf16 v[72:87], v[32:35], v[232:235], v[72:87]
ds_read_b64_tr_b16 v[24:25], v9 offset:53248
ds_read_b64_tr_b16 v[26:27], v9 offset:54272
v_exp_f32 v46, v170
v_exp_f32 v47, v171
s_waitcnt lgkmcnt(6)
v_mfma_f32_32x32x16_bf16 v[88:103], v[36:39], v[232:235], v[88:103]
ds_read_b64_tr_b16 v[28:29], v10 offset:53248
ds_read_b64_tr_b16 v[30:31], v10 offset:54272
s_waitcnt lgkmcnt(6)
v_mfma_f32_32x32x16_bf16 v[104:119], v[40:43], v[232:235], v[104:119]
ds_read_b64_tr_b16 v[32:33], v11 offset:53248
ds_read_b64_tr_b16 v[34:35], v11 offset:54272
v_exp_f32 v48, v172
v_exp_f32 v49, v173
s_waitcnt lgkmcnt(6)
v_mfma_f32_32x32x16_bf16 v[56:71], v[20:23], v[236:239], v[56:71]
ds_read_b64_tr_b16 v[36:37], v8 offset:57344
ds_read_b64_tr_b16 v[38:39], v8 offset:58368
v_cvt_pk_bf16_f32 v232, v44, v45
v_add_f32 v53, v44, v45
v_cvt_pk_bf16_f32 v233, v46, v47
v_add_f32 v53, v53, v46
v_add_f32 v53, v53, v47
s_waitcnt lgkmcnt(6)
v_mfma_f32_32x32x16_bf16 v[72:87], v[24:27], v[236:239], v[72:87]
ds_read_b64_tr_b16 v[40:41], v9 offset:57344
ds_read_b64_tr_b16 v[42:43], v9 offset:58368
v_cvt_pk_bf16_f32 v234, v48, v49
v_add_f32 v53, v53, v48
v_add_f32 v53, v53, v49
v_exp_f32 v50, v174
v_exp_f32 v51, v175
s_waitcnt lgkmcnt(6)
v_mfma_f32_32x32x16_bf16 v[88:103], v[28:31], v[236:239], v[88:103]
ds_read_b64_tr_b16 v[20:21], v10 offset:57344
ds_read_b64_tr_b16 v[22:23], v10 offset:58368
s_waitcnt lgkmcnt(6)
v_mfma_f32_32x32x16_bf16 v[104:119], v[32:35], v[236:239], v[104:119]
ds_read_b64_tr_b16 v[24:25], v11 offset:57344
ds_read_b64_tr_b16 v[26:27], v11 offset:58368
v_cvt_pk_bf16_f32 v235, v50, v51
v_add_f32 v53, v53, v50
v_add_f32 v53, v53, v51
v_exp_f32 v44, v176
v_exp_f32 v45, v177
s_waitcnt lgkmcnt(6)
v_mfma_f32_32x32x16_bf16 v[56:71], v[36:39], v[240:243], v[56:71]
ds_read_b64_tr_b16 v[28:29], v8 offset:61440
ds_read_b64_tr_b16 v[30:31], v8 offset:62464
v_exp_f32 v46, v178
v_exp_f32 v47, v179
s_waitcnt lgkmcnt(6)
v_mfma_f32_32x32x16_bf16 v[72:87], v[40:43], v[240:243], v[72:87]
ds_read_b64_tr_b16 v[32:33], v9 offset:61440
ds_read_b64_tr_b16 v[34:35], v9 offset:62464
v_cvt_pk_bf16_f32 v236, v44, v45
v_add_f32 v53, v53, v44
v_add_f32 v53, v53, v45
s_waitcnt lgkmcnt(6)
v_mfma_f32_32x32x16_bf16 v[88:103], v[20:23], v[240:243], v[88:103]
ds_read_b64_tr_b16 v[36:37], v10 offset:61440
ds_read_b64_tr_b16 v[38:39], v10 offset:62464
v_cvt_pk_bf16_f32 v237, v46, v47
v_add_f32 v53, v53, v46
v_add_f32 v53, v53, v47
v_exp_f32 v48, v180
v_exp_f32 v49, v181
s_waitcnt lgkmcnt(6)
v_mfma_f32_32x32x16_bf16 v[104:119], v[24:27], v[240:243], v[104:119]
ds_read_b64_tr_b16 v[40:41], v11 offset:61440
ds_read_b64_tr_b16 v[42:43], v11 offset:62464
s_waitcnt lgkmcnt(6)
v_mfma_f32_32x32x16_bf16 v[56:71], v[28:31], v[244:247], v[56:71]
ds_read_b128 v[20:23], v12 offset:16384
v_cvt_pk_bf16_f32 v238, v48, v49
v_add_f32 v53, v53, v48
v_add_f32 v53, v53, v49
v_exp_f32 v50, v182
v_exp_f32 v51, v183
s_waitcnt lgkmcnt(5)
v_mfma_f32_32x32x16_bf16 v[72:87], v[32:35], v[244:247], v[72:87]
ds_read_b128 v[24:27], v12 offset:24576
s_waitcnt lgkmcnt(4)
v_mfma_f32_32x32x16_bf16 v[88:103], v[36:39], v[244:247], v[88:103]
ds_read_b128 v[28:31], v13 offset:16384
v_cvt_pk_bf16_f32 v239, v50, v51
v_add_f32 v53, v53, v50
v_add_f32 v53, v53, v51
v_exp_f32 v44, v184
v_exp_f32 v45, v185
s_waitcnt lgkmcnt(3)
v_mfma_f32_32x32x16_bf16 v[104:119], v[40:43], v[244:247], v[104:119]
ds_read_b128 v[32:35], v13 offset:24576
v_exp_f32 v46, v186
v_exp_f32 v47, v187
s_waitcnt lgkmcnt(3)
v_mfma_f32_32x32x16_bf16 v[200:215], v[20:23], v[136:139], v[120:135]
ds_read_b128 v[36:39], v14 offset:16384
v_cvt_pk_bf16_f32 v240, v44, v45
v_add_f32 v53, v53, v44
v_add_f32 v53, v53, v45
s_waitcnt lgkmcnt(3)
v_mfma_f32_32x32x16_bf16 v[216:231], v[24:27], v[136:139], v[120:135]
ds_read_b128 v[40:43], v14 offset:24576
v_cvt_pk_bf16_f32 v241, v46, v47
v_add_f32 v53, v53, v46
v_add_f32 v53, v53, v47
v_exp_f32 v48, v188
v_exp_f32 v49, v189
s_waitcnt lgkmcnt(3)
v_mfma_f32_32x32x16_bf16 v[200:215], v[28:31], v[140:143], v[200:215]
ds_read_b128 v[20:23], v15 offset:16384
s_waitcnt lgkmcnt(3)
v_mfma_f32_32x32x16_bf16 v[216:231], v[32:35], v[140:143], v[216:231]
ds_read_b128 v[24:27], v15 offset:24576
v_cvt_pk_bf16_f32 v242, v48, v49
v_add_f32 v53, v53, v48
v_add_f32 v53, v53, v49
v_exp_f32 v50, v190
v_exp_f32 v51, v191
s_waitcnt lgkmcnt(3)
v_mfma_f32_32x32x16_bf16 v[200:215], v[36:39], v[144:147], v[200:215]
ds_read_b128 v[28:31], v16 offset:16384
s_waitcnt lgkmcnt(3)
v_mfma_f32_32x32x16_bf16 v[216:231], v[40:43], v[144:147], v[216:231]
ds_read_b128 v[32:35], v16 offset:24576
v_cvt_pk_bf16_f32 v243, v50, v51
v_add_f32 v53, v53, v50
v_add_f32 v53, v53, v51
v_exp_f32 v44, v192
v_exp_f32 v45, v193
s_waitcnt lgkmcnt(3)
v_mfma_f32_32x32x16_bf16 v[200:215], v[20:23], v[148:151], v[200:215]
ds_read_b128 v[36:39], v17 offset:16384
v_exp_f32 v46, v194
v_exp_f32 v47, v195
s_waitcnt lgkmcnt(3)
v_mfma_f32_32x32x16_bf16 v[216:231], v[24:27], v[148:151], v[216:231]
ds_read_b128 v[40:43], v17 offset:24576
v_cvt_pk_bf16_f32 v244, v44, v45
v_add_f32 v53, v53, v44
v_add_f32 v53, v53, v45
s_waitcnt lgkmcnt(3)
v_mfma_f32_32x32x16_bf16 v[200:215], v[28:31], v[152:155], v[200:215]
ds_read_b128 v[20:23], v18 offset:16384
v_cvt_pk_bf16_f32 v245, v46, v47
v_add_f32 v53, v53, v46
v_add_f32 v53, v53, v47
v_exp_f32 v48, v196
v_exp_f32 v49, v197
s_waitcnt lgkmcnt(3)
v_mfma_f32_32x32x16_bf16 v[216:231], v[32:35], v[152:155], v[216:231]
ds_read_b128 v[24:27], v18 offset:24576
s_waitcnt lgkmcnt(3)
v_mfma_f32_32x32x16_bf16 v[200:215], v[36:39], v[156:159], v[200:215]
ds_read_b128 v[28:31], v19 offset:16384
v_cvt_pk_bf16_f32 v246, v48, v49
v_add_f32 v53, v53, v48
v_add_f32 v53, v53, v49
v_exp_f32 v50, v198
v_exp_f32 v51, v199
s_waitcnt lgkmcnt(3)
v_mfma_f32_32x32x16_bf16 v[216:231], v[40:43], v[156:159], v[216:231]
ds_read_b128 v[32:35], v19 offset:24576
s_waitcnt lgkmcnt(3)
v_mfma_f32_32x32x16_bf16 v[200:215], v[20:23], v[160:163], v[200:215]
s_waitcnt vmcnt(4)
s_waitcnt vmcnt(0)
s_barrier
ds_read_b64_tr_b16 v[36:37], v8 offset:0
ds_read_b64_tr_b16 v[38:39], v8 offset:1024
v_cvt_pk_bf16_f32 v247, v50, v51
v_add_f32 v53, v53, v50
v_add_f32 v53, v53, v51
s_waitcnt lgkmcnt(4)
v_mfma_f32_32x32x16_bf16 v[216:231], v[24:27], v[160:163], v[216:231]
ds_read_b64_tr_b16 v[40:41], v9 offset:0
ds_read_b64_tr_b16 v[42:43], v9 offset:1024
s_waitcnt lgkmcnt(5)
v_mfma_f32_32x32x16_bf16 v[200:215], v[28:31], v[164:167], v[200:215]
ds_read_b64_tr_b16 v[20:21], v10 offset:0
ds_read_b64_tr_b16 v[22:23], v10 offset:1024
s_waitcnt lgkmcnt(6)
v_mfma_f32_32x32x16_bf16 v[216:231], v[32:35], v[164:167], v[216:231]
ds_read_b64_tr_b16 v[24:25], v11 offset:0
ds_read_b64_tr_b16 v[26:27], v11 offset:1024
v_cmp_nle_f32 vcc, v53, s41
s_nop 1
s_cbranch_vccnz L_fb4
L_ret4:
v_add_f32 v52, v52, v53
s_waitcnt lgkmcnt(6)
v_mfma_f32_32x32x16_bf16 v[56:71], v[36:39], v[232:235], v[56:71]
ds_read_b64_tr_b16 v[28:29], v8 offset:4096
ds_read_b64_tr_b16 v[30:31], v8 offset:5120
v_exp_f32 v44, v200
v_exp_f32 v45, v201
s_waitcnt lgkmcnt(6)
v_mfma_f32_32x32x16_bf16 v[72:87], v[40:43], v[232:235], v[72:87]
ds_read_b64_tr_b16 v[32:33], v9 offset:4096
ds_read_b64_tr_b16 v[34:35], v9 offset:5120
v_exp_f32 v46, v202
v_exp_f32 v47, v203
s_waitcnt lgkmcnt(6)
v_mfma_f32_32x32x16_bf16 v[88:103], v[20:23], v[232:235], v[88:103]
ds_read_b64_tr_b16 v[36:37], v10 offset:4096
ds_read_b64_tr_b16 v[38:39], v10 offset:5120
s_add_u32 s35, s32, 98304
s_add_u32 m0, s30, 98304
s_nop 0
buffer_load_dwordx4 v4, s[16:19], s35 offen lds
s_waitcnt lgkmcnt(6)
v_mfma_f32_32x32x16_bf16 v[104:119], v[24:27], v[232:235], v[104:119]
ds_read_b64_tr_b16 v[40:41], v11 offset:4096
ds_read_b64_tr_b16 v[42:43], v11 offset:5120
v_exp_f32 v48, v204
v_exp_f32 v49, v205
s_waitcnt lgkmcnt(6)
v_mfma_f32_32x32x16_bf16 v[56:71], v[28:31], v[236:239], v[56:71]
ds_read_b64_tr_b16 v[20:21], v8 offset:8192
ds_read_b64_tr_b16 v[22:23], v8 offset:9216
s_add_u32 s35, s32, 106496
s_add_u32 m0, s30, 106496
s_nop 0
buffer_load_dwordx4 v4, s[16:19], s35 offen lds
v_cvt_pk_bf16_f32 v232, v44, v45
v_add_f32 v53, v44, v45
v_cvt_pk_bf16_f32 v233, v46, v47
v_add_f32 v53, v53, v46
v_add_f32 v53, v53, v47
s_waitcnt lgkmcnt(6)
v_mfma_f32_32x32x16_bf16 v[72:87], v[32:35], v[236:239], v[72:87]
ds_read_b64_tr_b16 v[24:25], v9 offset:8192
ds_read_b64_tr_b16 v[26:27], v9 offset:9216
v_cvt_pk_bf16_f32 v234, v48, v49
v_add_f32 v53, v53, v48
v_add_f32 v53, v53, v49
v_exp_f32 v50, v206
v_exp_f32 v51, v207
s_waitcnt lgkmcnt(6)
v_mfma_f32_32x32x16_bf16 v[88:103], v[36:39], v[236:239], v[88:103]
ds_read_b64_tr_b16 v[28:29], v10 offset:8192
ds_read_b64_tr_b16 v[30:31], v10 offset:9216
s_add_u32 s35, s32, 114688
s_add_u32 m0, s30, 114688
s_nop 0
buffer_load_dwordx4 v4, s[16:19], s35 offen lds
s_waitcnt lgkmcnt(6)
v_mfma_f32_32x32x16_bf16 v[104:119], v[40:43], v[236:239], v[104:119]
ds_read_b64_tr_b16 v[32:33], v11 offset:8192
ds_read_b64_tr_b16 v[34:35], v11 offset:9216
v_cvt_pk_bf16_f32 v235, v50, v51
v_add_f32 v53, v53, v50
v_add_f32 v53, v53, v51
v_exp_f32 v44, v208
v_exp_f32 v45, v209
s_waitcnt lgkmcnt(6)
v_mfma_f32_32x32x16_bf16 v[56:71], v[20:23], v[240:243], v[56:71]
ds_read_b64_tr_b16 v[36:37], v8 offset:12288
ds_read_b64_tr_b16 v[38:39], v8 offset:13312
s_add_u32 s35, s32, 122880
s_add_u32 m0, s30, 122880
s_nop 0
buffer_load_dwordx4 v4, s[16:19], s35 offen lds
v_exp_f32 v46, v210
v_exp_f32 v47, v211
s_waitcnt lgkmcnt(6)
v_mfma_f32_32x32x16_bf16 v[72:87], v[24:27], v[240:243], v[72:87]
ds_read_b64_tr_b16 v[40:41], v9 offset:12288
ds_read_b64_tr_b16 v[42:43], v9 offset:13312
v_cvt_pk_bf16_f32 v236, v44, v45
v_add_f32 v53, v53, v44
v_add_f32 v53, v53, v45
s_waitcnt lgkmcnt(6)
v_mfma_f32_32x32x16_bf16 v[88:103], v[28:31], v[240:243], v[88:103]
ds_read_b64_tr_b16 v[20:21], v10 offset:12288
ds_read_b64_tr_b16 v[22:23], v10 offset:13312
s_and_b32 s43, s2, 3
s_lshl_b32 s43, s43, 5
s_lshr_b32 s44, s2, 3
s_add_u32 s43, s43, s44
s_lshl_b32 s43, s43, 3
s_add_u32 s43, s43, s22
s_mul_i32 s43, s43, 4608
v_min_u32 v248, 35, v0
v_lshlrev_b32 v248, 7, v248
buffer_load_dword v249, v248, s[48:51], s43 offen
v_cvt_pk_bf16_f32 v237, v46, v47
v_add_f32 v53, v53, v46
v_add_f32 v53, v53, v47
v_exp_f32 v48, v212
v_exp_f32 v49, v213
s_waitcnt lgkmcnt(6)
v_mfma_f32_32x32x16_bf16 v[104:119], v[32:35], v[240:243], v[104:119]
ds_read_b64_tr_b16 v[24:25], v11 offset:12288
ds_read_b64_tr_b16 v[26:27], v11 offset:13312
s_waitcnt lgkmcnt(6)
v_mfma_f32_32x32x16_bf16 v[56:71], v[36:39], v[244:247], v[56:71]
ds_read_b128 v[28:31], v12 offset:32768
v_cvt_pk_bf16_f32 v238, v48, v49
v_add_f32 v53, v53, v48
v_add_f32 v53, v53, v49
v_exp_f32 v50, v214
v_exp_f32 v51, v215
s_waitcnt lgkmcnt(5)
v_mfma_f32_32x32x16_bf16 v[72:87], v[40:43], v[244:247], v[72:87]
ds_read_b128 v[32:35], v12 offset:40960
s_waitcnt lgkmcnt(4)
v_mfma_f32_32x32x16_bf16 v[88:103], v[20:23], v[244:247], v[88:103]
ds_read_b128 v[36:39], v13 offset:32768
v_cvt_pk_bf16_f32 v239, v50, v51
v_add_f32 v53, v53, v50
v_add_f32 v53, v53, v51
v_exp_f32 v44, v216
v_exp_f32 v45, v217
s_waitcnt lgkmcnt(3)
v_mfma_f32_32x32x16_bf16 v[104:119], v[24:27], v[244:247], v[104:119]
ds_read_b128 v[40:43], v13 offset:40960
v_exp_f32 v46, v218
v_exp_f32 v47, v219
s_waitcnt lgkmcnt(3)
v_mfma_f32_32x32x16_bf16 v[168:183], v[28:31], v[136:139], v[120:135]
ds_read_b128 v[20:23], v14 offset:32768
v_cvt_pk_bf16_f32 v240, v44, v45
v_add_f32 v53, v53, v44
v_add_f32 v53, v53, v45
s_waitcnt lgkmcnt(3)
v_mfma_f32_32x32x16_bf16 v[184:199], v[32:35], v[136:139], v[120:135]
ds_read_b128 v[24:27], v14 offset:40960
v_cvt_pk_bf16_f32 v241, v46, v47
v_add_f32 v53, v53, v46
v_add_f32 v53, v53, v47
v_exp_f32 v48, v220
v_exp_f32 v49, v221
s_waitcnt lgkmcnt(3)
v_mfma_f32_32x32x16_bf16 v[168:183], v[36:39], v[140:143], v[168:183]
ds_read_b128 v[28:31], v15 offset:32768
s_waitcnt lgkmcnt(3)
v_mfma_f32_32x32x16_bf16 v[184:199], v[40:43], v[140:143], v[184:199]
ds_read_b128 v[32:35], v15 offset:40960
v_cvt_pk_bf16_f32 v242, v48, v49
v_add_f32 v53, v53, v48
v_add_f32 v53, v53, v49
v_exp_f32 v50, v222
v_exp_f32 v51, v223
s_waitcnt lgkmcnt(3)
v_mfma_f32_32x32x16_bf16 v[168:183], v[20:23], v[144:147], v[168:183]
ds_read_b128 v[36:39], v16 offset:32768
s_waitcnt lgkmcnt(3)
v_mfma_f32_32x32x16_bf16 v[184:199], v[24:27], v[144:147], v[184:199]
ds_read_b128 v[40:43], v16 offset:40960
v_cvt_pk_bf16_f32 v243, v50, v51
v_add_f32 v53, v53, v50
v_add_f32 v53, v53, v51
v_exp_f32 v44, v224
v_exp_f32 v45, v225
s_waitcnt lgkmcnt(3)
v_mfma_f32_32x32x16_bf16 v[168:183], v[28:31], v[148:151], v[168:183]
ds_read_b128 v[20:23], v17 offset:32768
v_exp_f32 v46, v226
v_exp_f32 v47, v227
s_waitcnt lgkmcnt(3)
v_mfma_f32_32x32x16_bf16 v[184:199], v[32:35], v[148:151], v[184:199]
ds_read_b128 v[24:27], v17 offset:40960
v_cvt_pk_bf16_f32 v244, v44, v45
v_add_f32 v53, v53, v44
v_add_f32 v53, v53, v45
s_waitcnt lgkmcnt(3)
v_mfma_f32_32x32x16_bf16 v[168:183], v[36:39], v[152:155], v[168:183]
ds_read_b128 v[28:31], v18 offset:32768
v_cvt_pk_bf16_f32 v245, v46, v47
v_add_f32 v53, v53, v46
v_add_f32 v53, v53, v47
v_exp_f32 v48, v228
v_exp_f32 v49, v229
s_waitcnt lgkmcnt(3)
v_mfma_f32_32x32x16_bf16 v[184:199], v[40:43], v[152:155], v[184:199]
ds_read_b128 v[32:35], v18 offset:40960
s_waitcnt lgkmcnt(3)
v_mfma_f32_32x32x16_bf16 v[168:183], v[20:23], v[156:159], v[168:183]
ds_read_b128 v[36:39], v19 offset:32768
v_cvt_pk_bf16_f32 v246, v48, v49
v_add_f32 v53, v53, v48
v_add_f32 v53, v53, v49
v_exp_f32 v50, v230
v_exp_f32 v51, v231
s_waitcnt lgkmcnt(3)
v_mfma_f32_32x32x16_bf16 v[184:199], v[24:27], v[156:159], v[184:199]
ds_read_b128 v[40:43], v19 offset:40960
s_waitcnt lgkmcnt(3)
v_mfma_f32_32x32x16_bf16 v[168:183], v[28:31], v[160:163], v[168:183]
ds_read_b64_tr_b16 v[20:21], v8 offset:16384
ds_read_b64_tr_b16 v[22:23], v8 offset:17408
v_cvt_pk_bf16_f32 v247, v50, v51
v_add_f32 v53, v53, v50
v_add_f32 v53, v53, v51
s_waitcnt lgkmcnt(4)
v_mfma_f32_32x32x16_bf16 v[184:199], v[32:35], v[160:163], v[184:199]
ds_read_b64_tr_b16 v[24:25], v9 offset:16384
ds_read_b64_tr_b16 v[26:27], v9 offset:17408
s_waitcnt lgkmcnt(5)
v_mfma_f32_32x32x16_bf16 v[168:183], v[36:39], v[164:167], v[168:183]
ds_read_b64_tr_b16 v[28:29], v10 offset:16384
ds_read_b64_tr_b16 v[30:31], v10 offset:17408
s_waitcnt lgkmcnt(6)
v_mfma_f32_32x32x16_bf16 v[184:199], v[40:43], v[164:167], v[184:199]
ds_read_b64_tr_b16 v[32:33], v11 offset:16384
ds_read_b64_tr_b16 v[34:35], v11 offset:17408
v_cmp_nle_f32 vcc, v53, s41
s_nop 1
s_cbranch_vccnz L_fb5
L_ret5:
v_add_f32 v52, v52, v53
s_waitcnt lgkmcnt(6)
v_mfma_f32_32x32x16_bf16 v[56:71], v[20:23], v[232:235], v[56:71]
ds_read_b64_tr_b16 v[36:37], v8 offset:20480
ds_read_b64_tr_b16 v[38:39], v8 offset:21504
v_exp_f32 v44, v168
v_exp_f32 v45, v169
s_waitcnt lgkmcnt(6)
v_mfma_f32_32x32x16_bf16 v[72:87], v[24:27], v[232:235], v[72:87]
ds_read_b64_tr_b16 v[40:41], v9 offset:20480
ds_read_b64_tr_b16 v[42:43], v9 offset:21504
v_exp_f32 v46, v170
v_exp_f32 v47, v171
s_waitcnt lgkmcnt(6)
v_mfma_f32_32x32x16_bf16 v[88:103], v[28:31], v[232:235], v[88:103]
ds_read_b64_tr_b16 v[20:21], v10 offset:20480
ds_read_b64_tr_b16 v[22:23], v10 offset:21504
s_waitcnt lgkmcnt(6)
v_mfma_f32_32x32x16_bf16 v[104:119], v[32:35], v[232:235], v[104:119]
ds_read_b64_tr_b16 v[24:25], v11 offset:20480
ds_read_b64_tr_b16 v[26:27], v11 offset:21504
v_exp_f32 v48, v172
v_exp_f32 v49, v173
s_waitcnt lgkmcnt(6)
v_mfma_f32_32x32x16_bf16 v[56:71], v[36:39], v[236:239], v[56:71]
ds_read_b64_tr_b16 v[28:29], v8 offset:24576
ds_read_b64_tr_b16 v[30:31], v8 offset:25600
v_cvt_pk_bf16_f32 v232, v44, v45
v_add_f32 v53, v44, v45
v_cvt_pk_bf16_f32 v233, v46, v47
v_add_f32 v53, v53, v46
v_add_f32 v53, v53, v47
s_waitcnt lgkmcnt(6)
v_mfma_f32_32x32x16_bf16 v[72:87], v[40:43], v[236:239], v[72:87]
ds_read_b64_tr_b16 v[32:33], v9 offset:24576
ds_read_b64_tr_b16 v[34:35], v9 offset:25600
v_cvt_pk_bf16_f32 v234, v48, v49
v_add_f32 v53, v53, v48
v_add_f32 v53, v53, v49
v_exp_f32 v50, v174
v_exp_f32 v51, v175
s_waitcnt lgkmcnt(6)
v_mfma_f32_32x32x16_bf16 v[88:103], v[20:23], v[236:239], v[88:103]
ds_read_b64_tr_b16 v[36:37], v10 offset:24576
ds_read_b64_tr_b16 v[38:39], v10 offset:25600
s_waitcnt lgkmcnt(6)
v_mfma_f32_32x32x16_bf16 v[104:119], v[24:27], v[236:239], v[104:119]
ds_read_b64_tr_b16 v[40:41], v11 offset:24576
ds_read_b64_tr_b16 v[42:43], v11 offset:25600
v_cvt_pk_bf16_f32 v235, v50, v51
v_add_f32 v53, v53, v50
v_add_f32 v53, v53, v51
v_exp_f32 v44, v176
v_exp_f32 v45, v177
s_waitcnt lgkmcnt(6)
v_mfma_f32_32x32x16_bf16 v[56:71], v[28:31], v[240:243], v[56:71]
ds_read_b64_tr_b16 v[20:21], v8 offset:28672
ds_read_b64_tr_b16 v[22:23], v8 offset:29696
v_exp_f32 v46, v178
v_exp_f32 v47, v179
s_waitcnt lgkmcnt(6)
v_mfma_f32_32x32x16_bf16 v[72:87], v[32:35], v[240:243], v[72:87]
ds_read_b64_tr_b16 v[24:25], v9 offset:28672
ds_read_b64_tr_b16 v[26:27], v9 offset:29696
v_cvt_pk_bf16_f32 v236, v44, v45
v_add_f32 v53, v53, v44
v_add_f32 v53, v53, v45
s_waitcnt lgkmcnt(6)
v_mfma_f32_32x32x16_bf16 v[88:103], v[36:39], v[240:243], v[88:103]
ds_read_b64_tr_b16 v[28:29], v10 offset:28672
ds_read_b64_tr_b16 v[30:31], v10 offset:29696
v_cvt_pk_bf16_f32 v237, v46, v47
v_add_f32 v53, v53, v46
v_add_f32 v53, v53, v47
v_exp_f32 v48, v180
v_exp_f32 v49, v181
s_waitcnt lgkmcnt(6)
v_mfma_f32_32x32x16_bf16 v[104:119], v[40:43], v[240:243], v[104:119]
ds_read_b64_tr_b16 v[32:33], v11 offset:28672
ds_read_b64_tr_b16 v[34:35], v11 offset:29696
s_waitcnt lgkmcnt(6)
v_mfma_f32_32x32x16_bf16 v[56:71], v[20:23], v[244:247], v[56:71]
ds_read_b128 v[36:39], v12 offset:49152
v_cvt_pk_bf16_f32 v238, v48, v49
v_add_f32 v53, v53, v48
v_add_f32 v53, v53, v49
v_exp_f32 v50, v182
v_exp_f32 v51, v183
s_waitcnt lgkmcnt(5)
v_mfma_f32_32x32x16_bf16 v[72:87], v[24:27], v[244:247], v[72:87]
ds_read_b128 v[40:43], v12 offset:57344
s_waitcnt lgkmcnt(4)
v_mfma_f32_32x32x16_bf16 v[88:103], v[28:31], v[244:247], v[88:103]
ds_read_b128 v[20:23], v13 offset:49152
v_cvt_pk_bf16_f32 v239, v50, v51
v_add_f32 v53, v53, v50
v_add_f32 v53, v53, v51
v_exp_f32 v44, v184
v_exp_f32 v45, v185
s_waitcnt lgkmcnt(3)
v_mfma_f32_32x32x16_bf16 v[104:119], v[32:35], v[244:247], v[104:119]
ds_read_b128 v[24:27], v13 offset:57344
v_exp_f32 v46, v186
v_exp_f32 v47, v187
s_waitcnt lgkmcnt(3)
v_mfma_f32_32x32x16_bf16 v[200:215], v[36:39], v[136:139], v[120:135]
ds_read_b128 v[28:31], v14 offset:49152
v_cvt_pk_bf16_f32 v240, v44, v45
v_add_f32 v53, v53, v44
v_add_f32 v53, v53, v45
s_waitcnt lgkmcnt(3)
v_mfma_f32_32x32x16_bf16 v[216:231], v[40:43], v[136:139], v[120:135]
ds_read_b128 v[32:35], v14 offset:57344
v_cvt_pk_bf16_f32 v241, v46, v47
v_add_f32 v53, v53, v46
v_add_f32 v53, v53, v47
v_exp_f32 v48, v188
v_exp_f32 v49, v189
s_waitcnt lgkmcnt(3)
v_mfma_f32_32x32x16_bf16 v[200:215], v[20:23], v[140:143], v[200:215]
ds_read_b128 v[36:39], v15 offset:49152
s_waitcnt lgkmcnt(3)
v_mfma_f32_32x32x16_bf16 v[216:231], v[24:27], v[140:143], v[216:231]
ds_read_b128 v[40:43], v15 offset:57344
v_cvt_pk_bf16_f32 v242, v48, v49
v_add_f32 v53, v53, v48
v_add_f32 v53, v53, v49
v_exp_f32 v50, v190
v_exp_f32 v51, v191
s_waitcnt lgkmcnt(3)
v_mfma_f32_32x32x16_bf16 v[200:215], v[28:31], v[144:147], v[200:215]
ds_read_b128 v[20:23], v16 offset:49152
s_waitcnt lgkmcnt(3)
v_mfma_f32_32x32x16_bf16 v[216:231], v[32:35], v[144:147], v[216:231]
ds_read_b128 v[24:27], v16 offset:57344
v_cvt_pk_bf16_f32 v243, v50, v51
v_add_f32 v53, v53, v50
v_add_f32 v53, v53, v51
v_exp_f32 v44, v192
v_exp_f32 v45, v193
s_waitcnt lgkmcnt(3)
v_mfma_f32_32x32x16_bf16 v[200:215], v[36:39], v[148:151], v[200:215]
ds_read_b128 v[28:31], v17 offset:49152
v_exp_f32 v46, v194
v_exp_f32 v47, v195
s_waitcnt lgkmcnt(3)
v_mfma_f32_32x32x16_bf16 v[216:231], v[40:43], v[148:151], v[216:231]
ds_read_b128 v[32:35], v17 offset:57344
v_cvt_pk_bf16_f32 v244, v44, v45
v_add_f32 v53, v53, v44
v_add_f32 v53, v53, v45
s_waitcnt lgkmcnt(3)
v_mfma_f32_32x32x16_bf16 v[200:215], v[20:23], v[152:155], v[200:215]
ds_read_b128 v[36:39], v18 offset:49152
v_cvt_pk_bf16_f32 v245, v46, v47
v_add_f32 v53, v53, v46
v_add_f32 v53, v53, v47
v_exp_f32 v48, v196
v_exp_f32 v49, v197
s_waitcnt lgkmcnt(3)
v_mfma_f32_32x32x16_bf16 v[216:231], v[24:27], v[152:155], v[216:231]
ds_read_b128 v[40:43], v18 offset:57344
s_waitcnt lgkmcnt(3)
v_mfma_f32_32x32x16_bf16 v[200:215], v[28:31], v[156:159], v[200:215]
ds_read_b128 v[20:23], v19 offset:49152
v_cvt_pk_bf16_f32 v246, v48, v49
v_add_f32 v53, v53, v48
v_add_f32 v53, v53, v49
v_exp_f32 v50, v198
v_exp_f32 v51, v199
s_waitcnt lgkmcnt(3)
v_mfma_f32_32x32x16_bf16 v[216:231], v[32:35], v[156:159], v[216:231]
ds_read_b128 v[24:27], v19 offset:57344
s_waitcnt lgkmcnt(3)
v_mfma_f32_32x32x16_bf16 v[200:215], v[36:39], v[160:163], v[200:215]
s_waitcnt vmcnt(1)
s_barrier
ds_read_b64_tr_b16 v[28:29], v8 offset:32768
ds_read_b64_tr_b16 v[30:31], v8 offset:33792
v_cvt_pk_bf16_f32 v247, v50, v51
v_add_f32 v53, v53, v50
v_add_f32 v53, v53, v51
s_waitcnt lgkmcnt(4)
v_mfma_f32_32x32x16_bf16 v[216:231], v[40:43], v[160:163], v[216:231]
ds_read_b64_tr_b16 v[32:33], v9 offset:32768
ds_read_b64_tr_b16 v[34:35], v9 offset:33792
s_waitcnt lgkmcnt(5)
v_mfma_f32_32x32x16_bf16 v[200:215], v[20:23], v[164:167], v[200:215]
ds_read_b64_tr_b16 v[36:37], v10 offset:32768
ds_read_b64_tr_b16 v[38:39], v10 offset:33792
s_waitcnt lgkmcnt(6)
v_mfma_f32_32x32x16_bf16 v[216:231], v[24:27], v[164:167], v[216:231]
ds_read_b64_tr_b16 v[40:41], v11 offset:32768
ds_read_b64_tr_b16 v[42:43], v11 offset:33792
v_cmp_nle_f32 vcc, v53, s41
s_nop 1
s_cbranch_vccnz L_fb6
L_ret6:
v_add_f32 v52, v52, v53
s_waitcnt lgkmcnt(6)
v_mfma_f32_32x32x16_bf16 v[56:71], v[28:31], v[232:235], v[56:71]
ds_read_b64_tr_b16 v[20:21], v8 offset:36864
ds_read_b64_tr_b16 v[22:23], v8 offset:37888
v_exp_f32 v44, v200
v_exp_f32 v45, v201
v_exp_f32 v46, v202
v_exp_f32 v47, v203
s_waitcnt lgkmcnt(6)
v_mfma_f32_32x32x16_bf16 v[72:87], v[32:35], v[232:235], v[72:87]
ds_read_b64_tr_b16 v[24:25], v9 offset:36864
ds_read_b64_tr_b16 v[26:27], v9 offset:37888
v_exp_f32 v48, v204
v_exp_f32 v49, v205
s_waitcnt lgkmcnt(6)
v_mfma_f32_32x32x16_bf16 v[88:103], v[36:39], v[232:235], v[88:103]
ds_read_b64_tr_b16 v[28:29], v10 offset:36864
ds_read_b64_tr_b16 v[30:31], v10 offset:37888
v_exp_f32 v50, v206
v_exp_f32 v51, v207
s_waitcnt lgkmcnt(6)
v_mfma_f32_32x32x16_bf16 v[104:119], v[40:43], v[232:235], v[104:119]
ds_read_b64_tr_b16 v[32:33], v11 offset:36864
ds_read_b64_tr_b16 v[34:35], v11 offset:37888
s_waitcnt lgkmcnt(6)
v_mfma_f32_32x32x16_bf16 v[56:71], v[20:23], v[236:239], v[56:71]
ds_read_b64_tr_b16 v[36:37], v8 offset:40960
ds_read_b64_tr_b16 v[38:39], v8 offset:41984
v_cvt_pk_bf16_f32 v232, v44, v45
v_add_f32 v53, v44, v45
v_cvt_pk_bf16_f32 v233, v46, v47
v_add_f32 v53, v53, v46
v_add_f32 v53, v53, v47
v_cvt_pk_bf16_f32 v234, v48, v49
v_add_f32 v53, v53, v48
v_add_f32 v53, v53, v49
v_cvt_pk_bf16_f32 v235, v50, v51
v_add_f32 v53, v53, v50
v_add_f32 v53, v53, v51
v_exp_f32 v44, v208
v_exp_f32 v45, v209
s_waitcnt lgkmcnt(6)
v_mfma_f32_32x32x16_bf16 v[72:87], v[24:27], v[236:239], v[72:87]
ds_read_b64_tr_b16 v[40:41], v9 offset:40960
ds_read_b64_tr_b16 v[42:43], v9 offset:41984
v_exp_f32 v46, v210
v_exp_f32 v47, v211
s_waitcnt lgkmcnt(6)
v_mfma_f32_32x32x16_bf16 v[88:103], v[28:31], v[236:239], v[88:103]
ds_read_b64_tr_b16 v[20:21], v10 offset:40960
ds_read_b64_tr_b16 v[22:23], v10 offset:41984
v_exp_f32 v48, v212
v_exp_f32 v49, v213
s_waitcnt lgkmcnt(6)
v_mfma_f32_32x32x16_bf16 v[104:119], v[32:35], v[236:239], v[104:119]
ds_read_b64_tr_b16 v[24:25], v11 offset:40960
ds_read_b64_tr_b16 v[26:27], v11 offset:41984
v_exp_f32 v50, v214
v_exp_f32 v51, v215
s_waitcnt lgkmcnt(6)
v_mfma_f32_32x32x16_bf16 v[56:71], v[36:39], v[240:243], v[56:71]
ds_read_b64_tr_b16 v[28:29], v8 offset:45056
ds_read_b64_tr_b16 v[30:31], v8 offset:46080
v_cvt_pk_bf16_f32 v236, v44, v45
v_add_f32 v53, v53, v44
v_add_f32 v53, v53, v45
v_cvt_pk_bf16_f32 v237, v46, v47
v_add_f32 v53, v53, v46
v_add_f32 v53, v53, v47
v_cvt_pk_bf16_f32 v238, v48, v49
v_add_f32 v53, v53, v48
v_add_f32 v53, v53, v49
v_cvt_pk_bf16_f32 v239, v50, v51
v_add_f32 v53, v53, v50
v_add_f32 v53, v53, v51
v_exp_f32 v44, v216
v_exp_f32 v45, v217
s_waitcnt lgkmcnt(6)
v_mfma_f32_32x32x16_bf16 v[72:87], v[40:43], v[240:243], v[72:87]
ds_read_b64_tr_b16 v[32:33], v9 offset:45056
ds_read_b64_tr_b16 v[34:35], v9 offset:46080
v_exp_f32 v46, v218
v_exp_f32 v47, v219
s_waitcnt lgkmcnt(6)
v_mfma_f32_32x32x16_bf16 v[88:103], v[20:23], v[240:243], v[88:103]
ds_read_b64_tr_b16 v[36:37], v10 offset:45056
ds_read_b64_tr_b16 v[38:39], v10 offset:46080
v_exp_f32 v48, v220
v_exp_f32 v49, v221
s_waitcnt lgkmcnt(6)
v_mfma_f32_32x32x16_bf16 v[104:119], v[24:27], v[240:243], v[104:119]
ds_read_b64_tr_b16 v[40:41], v11 offset:45056
ds_read_b64_tr_b16 v[42:43], v11 offset:46080
v_exp_f32 v50, v222
v_exp_f32 v51, v223
s_waitcnt lgkmcnt(6)
v_mfma_f32_32x32x16_bf16 v[56:71], v[28:31], v[244:247], v[56:71]
ds_read_b64_tr_b16 v[20:21], v8 offset:49152
ds_read_b64_tr_b16 v[22:23], v8 offset:50176
v_cvt_pk_bf16_f32 v240, v44, v45
v_add_f32 v53, v53, v44
v_add_f32 v53, v53, v45
v_cvt_pk_bf16_f32 v241, v46, v47
v_add_f32 v53, v53, v46
v_add_f32 v53, v53, v47
v_cvt_pk_bf16_f32 v242, v48, v49
v_add_f32 v53, v53, v48
v_add_f32 v53, v53, v49
v_cvt_pk_bf16_f32 v243, v50, v51
v_add_f32 v53, v53, v50
v_add_f32 v53, v53, v51
v_exp_f32 v44, v224
v_exp_f32 v45, v225
s_waitcnt lgkmcnt(6)
v_mfma_f32_32x32x16_bf16 v[72:87], v[32:35], v[244:247], v[72:87]
ds_read_b64_tr_b16 v[24:25], v8 offset:53248
ds_read_b64_tr_b16 v[26:27], v8 offset:54272
v_exp_f32 v46, v226
v_exp_f32 v47, v227
s_waitcnt lgkmcnt(6)
v_mfma_f32_32x32x16_bf16 v[88:103], v[36:39], v[244:247], v[88:103]
ds_read_b64_tr_b16 v[28:29], v8 offset:57344
ds_read_b64_tr_b16 v[30:31], v8 offset:58368
v_exp_f32 v48, v228
v_exp_f32 v49, v229
v_exp_f32 v50, v230
v_exp_f32 v51, v231
s_waitcnt lgkmcnt(6)
v_mfma_f32_32x32x16_bf16 v[104:119], v[40:43], v[244:247], v[104:119]
ds_read_b64_tr_b16 v[32:33], v8 offset:61440
ds_read_b64_tr_b16 v[34:35], v8 offset:62464
v_cvt_pk_bf16_f32 v244, v44, v45
v_add_f32 v53, v53, v44
v_add_f32 v53, v53, v45
v_cvt_pk_bf16_f32 v245, v46, v47
v_add_f32 v53, v53, v46
v_add_f32 v53, v53, v47
v_cvt_pk_bf16_f32 v246, v48, v49
v_add_f32 v53, v53, v48
v_add_f32 v53, v53, v49
v_cvt_pk_bf16_f32 v247, v50, v51
v_add_f32 v53, v53, v50
v_add_f32 v53, v53, v51
v_cmp_nle_f32 vcc, v53, s41
s_nop 1
s_cbranch_vccnz L_fb7
L_ret7:
v_add_f32 v52, v52, v53
s_waitcnt lgkmcnt(6)
v_mfma_f32_32x32x16_bf16 v[56:71], v[20:23], v[232:235], v[56:71]
ds_read_b64_tr_b16 v[36:37], v9 offset:49152
ds_read_b64_tr_b16 v[38:39], v9 offset:50176
v_mov_b32 v54, v52
s_mov_b32 s36, s34
s_add_u32 s37, s34, 4096
v_permlane32_swap_b32 v52, v54
s_waitcnt lgkmcnt(6)
v_mfma_f32_32x32x16_bf16 v[56:71], v[24:27], v[236:239], v[56:71]
ds_read_b64_tr_b16 v[40:41], v9 offset:53248
ds_read_b64_tr_b16 v[42:43], v9 offset:54272
v_add_f32 v52, v52, v54
v_rcp_f32 v52, v52
s_waitcnt lgkmcnt(6)
v_mfma_f32_32x32x16_bf16 v[56:71], v[28:31], v[240:243], v[56:71]
ds_read_b64_tr_b16 v[20:21], v9 offset:57344
ds_read_b64_tr_b16 v[22:23], v9 offset:58368
s_waitcnt lgkmcnt(6)
v_mfma_f32_32x32x16_bf16 v[56:71], v[32:35], v[244:247], v[56:71]
ds_read_b64_tr_b16 v[24:25], v9 offset:61440
ds_read_b64_tr_b16 v[26:27], v9 offset:62464
s_waitcnt lgkmcnt(6)
v_mfma_f32_32x32x16_bf16 v[72:87], v[36:39], v[232:235], v[72:87]
ds_read_b64_tr_b16 v[28:29], v10 offset:49152
ds_read_b64_tr_b16 v[30:31], v10 offset:50176
s_waitcnt lgkmcnt(6)
v_mfma_f32_32x32x16_bf16 v[72:87], v[40:43], v[236:239], v[72:87]
ds_read_b64_tr_b16 v[32:33], v10 offset:53248
ds_read_b64_tr_b16 v[34:35], v10 offset:54272
s_waitcnt lgkmcnt(6)
v_mfma_f32_32x32x16_bf16 v[72:87], v[20:23], v[240:243], v[72:87]
ds_read_b64_tr_b16 v[36:37], v10 offset:57344
ds_read_b64_tr_b16 v[38:39], v10 offset:58368
v_mul_f32 v56, v56, v52
v_mul_f32 v57, v57, v52
v_cvt_pk_bf16_f32 v168, v56, v57
v_mul_f32 v58, v58, v52
v_mul_f32 v59, v59, v52
v_cvt_pk_bf16_f32 v169, v58, v59
v_mul_f32 v60, v60, v52
v_mul_f32 v61, v61, v52
v_cvt_pk_bf16_f32 v170, v60, v61
v_mul_f32 v62, v62, v52
v_mul_f32 v63, v63, v52
v_cvt_pk_bf16_f32 v171, v62, v63
buffer_store_dwordx4 v[168:171], v7, s[12:15], s36 offen offset:0 sc1
s_waitcnt lgkmcnt(6)
v_mfma_f32_32x32x16_bf16 v[72:87], v[24:27], v[244:247], v[72:87]
ds_read_b64_tr_b16 v[40:41], v10 offset:61440
ds_read_b64_tr_b16 v[42:43], v10 offset:62464
v_mul_f32 v64, v64, v52
v_mul_f32 v65, v65, v52
v_cvt_pk_bf16_f32 v172, v64, v65
v_mul_f32 v66, v66, v52
v_mul_f32 v67, v67, v52
v_cvt_pk_bf16_f32 v173, v66, v67
v_mul_f32 v68, v68, v52
v_mul_f32 v69, v69, v52
v_cvt_pk_bf16_f32 v174, v68, v69
v_mul_f32 v70, v70, v52
v_mul_f32 v71, v71, v52
v_cvt_pk_bf16_f32 v175, v70, v71
buffer_store_dwordx4 v[172:175], v7, s[12:15], s36 offen offset:1024 sc1
s_waitcnt lgkmcnt(6)
v_mfma_f32_32x32x16_bf16 v[88:103], v[28:31], v[232:235], v[88:103]
ds_read_b64_tr_b16 v[20:21], v11 offset:49152
ds_read_b64_tr_b16 v[22:23], v11 offset:50176
s_waitcnt lgkmcnt(6)
v_mfma_f32_32x32x16_bf16 v[88:103], v[32:35], v[236:239], v[88:103]
ds_read_b64_tr_b16 v[24:25], v11 offset:53248
ds_read_b64_tr_b16 v[26:27], v11 offset:54272
s_waitcnt lgkmcnt(6)
v_mfma_f32_32x32x16_bf16 v[88:103], v[36:39], v[240:243], v[88:103]
ds_read_b64_tr_b16 v[28:29], v11 offset:57344
ds_read_b64_tr_b16 v[30:31], v11 offset:58368
v_mul_f32 v72, v72, v52
v_mul_f32 v73, v73, v52
v_cvt_pk_bf16_f32 v176, v72, v73
v_mul_f32 v74, v74, v52
v_mul_f32 v75, v75, v52
v_cvt_pk_bf16_f32 v177, v74, v75
v_mul_f32 v76, v76, v52
v_mul_f32 v77, v77, v52
v_cvt_pk_bf16_f32 v178, v76, v77
v_mul_f32 v78, v78, v52
v_mul_f32 v79, v79, v52
v_cvt_pk_bf16_f32 v179, v78, v79
buffer_store_dwordx4 v[176:179], v7, s[12:15], s36 offen offset:2048 sc1
s_waitcnt lgkmcnt(6)
v_mfma_f32_32x32x16_bf16 v[88:103], v[40:43], v[244:247], v[88:103]
ds_read_b64_tr_b16 v[32:33], v11 offset:61440
ds_read_b64_tr_b16 v[34:35], v11 offset:62464
v_mul_f32 v80, v80, v52
v_mul_f32 v81, v81, v52
v_cvt_pk_bf16_f32 v180, v80, v81
v_mul_f32 v82, v82, v52
v_mul_f32 v83, v83, v52
v_cvt_pk_bf16_f32 v181, v82, v83
v_mul_f32 v84, v84, v52
v_mul_f32 v85, v85, v52
v_cvt_pk_bf16_f32 v182, v84, v85
v_mul_f32 v86, v86, v52
v_mul_f32 v87, v87, v52
v_cvt_pk_bf16_f32 v183, v86, v87
buffer_store_dwordx4 v[180:183], v7, s[12:15], s36 offen offset:3072 sc1
s_waitcnt lgkmcnt(6)
v_mfma_f32_32x32x16_bf16 v[104:119], v[20:23], v[232:235], v[104:119]
s_waitcnt lgkmcnt(4)
v_mfma_f32_32x32x16_bf16 v[104:119], v[24:27], v[236:239], v[104:119]
s_waitcnt lgkmcnt(2)
v_mfma_f32_32x32x16_bf16 v[104:119], v[28:31], v[240:243], v[104:119]
v_mul_f32 v88, v88, v52
v_mul_f32 v89, v89, v52
v_cvt_pk_bf16_f32 v184, v88, v89
v_mul_f32 v90, v90, v52
v_mul_f32 v91, v91, v52
v_cvt_pk_bf16_f32 v185, v90, v91
v_mul_f32 v92, v92, v52
v_mul_f32 v93, v93, v52
v_cvt_pk_bf16_f32 v186, v92, v93
v_mul_f32 v94, v94, v52
v_mul_f32 v95, v95, v52
v_cvt_pk_bf16_f32 v187, v94, v95
buffer_store_dwordx4 v[184:187], v7, s[12:15], s37 offen offset:0 sc1
s_waitcnt lgkmcnt(0)
v_mfma_f32_32x32x16_bf16 v[104:119], v[32:35], v[244:247], v[104:119]
v_mul_f32 v96, v96, v52
v_mul_f32 v97, v97, v52
v_cvt_pk_bf16_f32 v188, v96, v97
v_mul_f32 v98, v98, v52
v_mul_f32 v99, v99, v52
v_cvt_pk_bf16_f32 v189, v98, v99
v_mul_f32 v100, v100, v52
v_mul_f32 v101, v101, v52
v_cvt_pk_bf16_f32 v190, v100, v101
v_mul_f32 v102, v102, v52
v_mul_f32 v103, v103, v52
v_cvt_pk_bf16_f32 v191, v102, v103
buffer_store_dwordx4 v[188:191], v7, s[12:15], s37 offen offset:1024 sc1
v_mul_f32 v104, v104, v52
v_mul_f32 v105, v105, v52
v_cvt_pk_bf16_f32 v192, v104, v105
v_mul_f32 v106, v106, v52
v_mul_f32 v107, v107, v52
v_cvt_pk_bf16_f32 v193, v106, v107
v_mul_f32 v108, v108, v52
v_mul_f32 v109, v109, v52
v_cvt_pk_bf16_f32 v194, v108, v109
v_mul_f32 v110, v110, v52
v_mul_f32 v111, v111, v52
v_cvt_pk_bf16_f32 v195, v110, v111
buffer_store_dwordx4 v[192:195], v7, s[12:15], s37 offen offset:2048 sc1
v_mul_f32 v112, v112, v52
v_mul_f32 v113, v113, v52
v_cvt_pk_bf16_f32 v196, v112, v113
v_mul_f32 v114, v114, v52
v_mul_f32 v115, v115, v52
v_cvt_pk_bf16_f32 v197, v114, v115
v_mul_f32 v116, v116, v52
v_mul_f32 v117, v117, v52
v_cvt_pk_bf16_f32 v198, v116, v117
v_mul_f32 v118, v118, v52
v_mul_f32 v119, v119, v52
v_cvt_pk_bf16_f32 v199, v118, v119
buffer_store_dwordx4 v[196:199], v7, s[12:15], s37 offen offset:3072 sc1
s_waitcnt vmcnt(0)
s_endpgm
L_fb1:
s_nop 7
s_nop 7
v_max3_f32 v54, v200, v201, v202
v_max3_f32 v55, v203, v204, v205
v_max3_f32 v54, v54, v206, v207
v_max3_f32 v55, v55, v208, v209
v_max3_f32 v54, v54, v210, v211
v_max3_f32 v55, v55, v212, v213
v_max3_f32 v54, v54, v214, v215
v_max3_f32 v55, v55, v216, v217
v_max3_f32 v54, v54, v218, v219
v_max3_f32 v55, v55, v220, v221
v_max3_f32 v54, v54, v222, v223
v_max3_f32 v55, v55, v224, v225
v_max3_f32 v54, v54, v226, v227
v_max3_f32 v55, v55, v228, v229
v_max3_f32 v54, v54, v230, v231
v_max_f32 v54, v54, v55
v_mov_b32 v55, v54
s_nop 1
v_permlane32_swap_b32 v54, v55
v_max_f32 v54, v54, v55
v_max_f32 v54, 0, v54
v_sub_f32 v55, 0, v54
v_exp_f32 v55, v55
s_nop 0
v_mul_f32 v52, v52, v55
v_mul_f32 v56, v56, v55
v_mul_f32 v57, v57, v55
v_mul_f32 v58, v58, v55
v_mul_f32 v59, v59, v55
v_mul_f32 v60, v60, v55
v_mul_f32 v61, v61, v55
v_mul_f32 v62, v62, v55
v_mul_f32 v63, v63, v55
v_mul_f32 v64, v64, v55
v_mul_f32 v65, v65, v55
v_mul_f32 v66, v66, v55
v_mul_f32 v67, v67, v55
v_mul_f32 v68, v68, v55
v_mul_f32 v69, v69, v55
v_mul_f32 v70, v70, v55
v_mul_f32 v71, v71, v55
v_mul_f32 v72, v72, v55
v_mul_f32 v73, v73, v55
v_mul_f32 v74, v74, v55
v_mul_f32 v75, v75, v55
v_mul_f32 v76, v76, v55
v_mul_f32 v77, v77, v55
v_mul_f32 v78, v78, v55
v_mul_f32 v79, v79, v55
v_mul_f32 v80, v80, v55
v_mul_f32 v81, v81, v55
v_mul_f32 v82, v82, v55
v_mul_f32 v83, v83, v55
v_mul_f32 v84, v84, v55
v_mul_f32 v85, v85, v55
v_mul_f32 v86, v86, v55
v_mul_f32 v87, v87, v55
v_mul_f32 v88, v88, v55
v_mul_f32 v89, v89, v55
v_mul_f32 v90, v90, v55
v_mul_f32 v91, v91, v55
v_mul_f32 v92, v92, v55
v_mul_f32 v93, v93, v55
v_mul_f32 v94, v94, v55
v_mul_f32 v95, v95, v55
v_mul_f32 v96, v96, v55
v_mul_f32 v97, v97, v55
v_mul_f32 v98, v98, v55
v_mul_f32 v99, v99, v55
v_mul_f32 v100, v100, v55
v_mul_f32 v101, v101, v55
v_mul_f32 v102, v102, v55
v_mul_f32 v103, v103, v55
v_mul_f32 v104, v104, v55
v_mul_f32 v105, v105, v55
v_mul_f32 v106, v106, v55
v_mul_f32 v107, v107, v55
v_mul_f32 v108, v108, v55
v_mul_f32 v109, v109, v55
v_mul_f32 v110, v110, v55
v_mul_f32 v111, v111, v55
v_mul_f32 v112, v112, v55
v_mul_f32 v113, v113, v55
v_mul_f32 v114, v114, v55
v_mul_f32 v115, v115, v55
v_mul_f32 v116, v116, v55
v_mul_f32 v117, v117, v55
v_mul_f32 v118, v118, v55
v_mul_f32 v119, v119, v55
v_sub_f32 v120, v120, v54
v_sub_f32 v121, v121, v54
v_sub_f32 v122, v122, v54
v_sub_f32 v123, v123, v54
v_sub_f32 v124, v124, v54
v_sub_f32 v125, v125, v54
v_sub_f32 v126, v126, v54
v_sub_f32 v127, v127, v54
v_sub_f32 v128, v128, v54
v_sub_f32 v129, v129, v54
v_sub_f32 v130, v130, v54
v_sub_f32 v131, v131, v54
v_sub_f32 v132, v132, v54
v_sub_f32 v133, v133, v54
v_sub_f32 v134, v134, v54
v_sub_f32 v135, v135, v54
v_sub_f32 v168, v168, v54
v_sub_f32 v169, v169, v54
v_sub_f32 v170, v170, v54
v_sub_f32 v171, v171, v54
v_sub_f32 v172, v172, v54
v_sub_f32 v173, v173, v54
v_sub_f32 v174, v174, v54
v_sub_f32 v175, v175, v54
v_sub_f32 v176, v176, v54
v_sub_f32 v177, v177, v54
v_sub_f32 v178, v178, v54
v_sub_f32 v179, v179, v54
v_sub_f32 v180, v180, v54
v_sub_f32 v181, v181, v54
v_sub_f32 v182, v182, v54
v_sub_f32 v183, v183, v54
v_sub_f32 v184, v184, v54
v_sub_f32 v185, v185, v54
v_sub_f32 v186, v186, v54
v_sub_f32 v187, v187, v54
v_sub_f32 v188, v188, v54
v_sub_f32 v189, v189, v54
v_sub_f32 v190, v190, v54
v_sub_f32 v191, v191, v54
v_sub_f32 v192, v192, v54
v_sub_f32 v193, v193, v54
v_sub_f32 v194, v194, v54
v_sub_f32 v195, v195, v54
v_sub_f32 v196, v196, v54
v_sub_f32 v197, v197, v54
v_sub_f32 v198, v198, v54
v_sub_f32 v199, v199, v54
v_sub_f32 v200, v200, v54
v_sub_f32 v201, v201, v54
v_sub_f32 v202, v202, v54
v_sub_f32 v203, v203, v54
v_sub_f32 v204, v204, v54
v_sub_f32 v205, v205, v54
v_sub_f32 v206, v206, v54
v_sub_f32 v207, v207, v54
v_sub_f32 v208, v208, v54
v_sub_f32 v209, v209, v54
v_sub_f32 v210, v210, v54
v_sub_f32 v211, v211, v54
v_sub_f32 v212, v212, v54
v_sub_f32 v213, v213, v54
v_sub_f32 v214, v214, v54
v_sub_f32 v215, v215, v54
v_sub_f32 v216, v216, v54
v_sub_f32 v217, v217, v54
v_sub_f32 v218, v218, v54
v_sub_f32 v219, v219, v54
v_sub_f32 v220, v220, v54
v_sub_f32 v221, v221, v54
v_sub_f32 v222, v222, v54
v_sub_f32 v223, v223, v54
v_sub_f32 v224, v224, v54
v_sub_f32 v225, v225, v54
v_sub_f32 v226, v226, v54
v_sub_f32 v227, v227, v54
v_sub_f32 v228, v228, v54
v_sub_f32 v229, v229, v54
v_sub_f32 v230, v230, v54
v_sub_f32 v231, v231, v54
v_exp_f32 v44, v200
v_exp_f32 v45, v201
s_nop 0
v_cvt_pk_bf16_f32 v232, v44, v45
v_add_f32 v53, v44, v45
v_exp_f32 v46, v202
v_exp_f32 v47, v203
s_nop 0
v_cvt_pk_bf16_f32 v233, v46, v47
v_add_f32 v53, v53, v46
v_add_f32 v53, v53, v47
v_exp_f32 v48, v204
v_exp_f32 v49, v205
s_nop 0
v_cvt_pk_bf16_f32 v234, v48, v49
v_add_f32 v53, v53, v48
v_add_f32 v53, v53, v49
v_exp_f32 v50, v206
v_exp_f32 v51, v207
s_nop 0
v_cvt_pk_bf16_f32 v235, v50, v51
v_add_f32 v53, v53, v50
v_add_f32 v53, v53, v51
v_exp_f32 v44, v208
v_exp_f32 v45, v209
s_nop 0
v_cvt_pk_bf16_f32 v236, v44, v45
v_add_f32 v53, v53, v44
v_add_f32 v53, v53, v45
v_exp_f32 v46, v210
v_exp_f32 v47, v211
s_nop 0
v_cvt_pk_bf16_f32 v237, v46, v47
v_add_f32 v53, v53, v46
v_add_f32 v53, v53, v47
v_exp_f32 v48, v212
v_exp_f32 v49, v213
s_nop 0
v_cvt_pk_bf16_f32 v238, v48, v49
v_add_f32 v53, v53, v48
v_add_f32 v53, v53, v49
v_exp_f32 v50, v214
v_exp_f32 v51, v215
s_nop 0
v_cvt_pk_bf16_f32 v239, v50, v51
v_add_f32 v53, v53, v50
v_add_f32 v53, v53, v51
v_exp_f32 v44, v216
v_exp_f32 v45, v217
s_nop 0
v_cvt_pk_bf16_f32 v240, v44, v45
v_add_f32 v53, v53, v44
v_add_f32 v53, v53, v45
v_exp_f32 v46, v218
v_exp_f32 v47, v219
s_nop 0
v_cvt_pk_bf16_f32 v241, v46, v47
v_add_f32 v53, v53, v46
v_add_f32 v53, v53, v47
v_exp_f32 v48, v220
v_exp_f32 v49, v221
s_nop 0
v_cvt_pk_bf16_f32 v242, v48, v49
v_add_f32 v53, v53, v48
v_add_f32 v53, v53, v49
v_exp_f32 v50, v222
v_exp_f32 v51, v223
s_nop 0
v_cvt_pk_bf16_f32 v243, v50, v51
v_add_f32 v53, v53, v50
v_add_f32 v53, v53, v51
v_exp_f32 v44, v224
v_exp_f32 v45, v225
s_nop 0
v_cvt_pk_bf16_f32 v244, v44, v45
v_add_f32 v53, v53, v44
v_add_f32 v53, v53, v45
v_exp_f32 v46, v226
v_exp_f32 v47, v227
s_nop 0
v_cvt_pk_bf16_f32 v245, v46, v47
v_add_f32 v53, v53, v46
v_add_f32 v53, v53, v47
v_exp_f32 v48, v228
v_exp_f32 v49, v229
s_nop 0
v_cvt_pk_bf16_f32 v246, v48, v49
v_add_f32 v53, v53, v48
v_add_f32 v53, v53, v49
v_exp_f32 v50, v230
v_exp_f32 v51, v231
s_nop 0
v_cvt_pk_bf16_f32 v247, v50, v51
v_add_f32 v53, v53, v50
v_add_f32 v53, v53, v51
s_nop 1
s_branch L_ret1
L_fb2:
s_nop 7
s_nop 7
v_max3_f32 v54, v168, v169, v170
v_max3_f32 v55, v171, v172, v173
v_max3_f32 v54, v54, v174, v175
v_max3_f32 v55, v55, v176, v177
v_max3_f32 v54, v54, v178, v179
v_max3_f32 v55, v55, v180, v181
v_max3_f32 v54, v54, v182, v183
v_max3_f32 v55, v55, v184, v185
v_max3_f32 v54, v54, v186, v187
v_max3_f32 v55, v55, v188, v189
v_max3_f32 v54, v54, v190, v191
v_max3_f32 v55, v55, v192, v193
v_max3_f32 v54, v54, v194, v195
v_max3_f32 v55, v55, v196, v197
v_max3_f32 v54, v54, v198, v199
v_max_f32 v54, v54, v55
v_mov_b32 v55, v54
s_nop 1
v_permlane32_swap_b32 v54, v55
v_max_f32 v54, v54, v55
v_max_f32 v54, 0, v54
v_sub_f32 v55, 0, v54
v_exp_f32 v55, v55
s_nop 0
v_mul_f32 v52, v52, v55
v_mul_f32 v56, v56, v55
v_mul_f32 v57, v57, v55
v_mul_f32 v58, v58, v55
v_mul_f32 v59, v59, v55
v_mul_f32 v60, v60, v55
v_mul_f32 v61, v61, v55
v_mul_f32 v62, v62, v55
v_mul_f32 v63, v63, v55
v_mul_f32 v64, v64, v55
v_mul_f32 v65, v65, v55
v_mul_f32 v66, v66, v55
v_mul_f32 v67, v67, v55
v_mul_f32 v68, v68, v55
v_mul_f32 v69, v69, v55
v_mul_f32 v70, v70, v55
v_mul_f32 v71, v71, v55
v_mul_f32 v72, v72, v55
v_mul_f32 v73, v73, v55
v_mul_f32 v74, v74, v55
v_mul_f32 v75, v75, v55
v_mul_f32 v76, v76, v55
v_mul_f32 v77, v77, v55
v_mul_f32 v78, v78, v55
v_mul_f32 v79, v79, v55
v_mul_f32 v80, v80, v55
v_mul_f32 v81, v81, v55
v_mul_f32 v82, v82, v55
v_mul_f32 v83, v83, v55
v_mul_f32 v84, v84, v55
v_mul_f32 v85, v85, v55
v_mul_f32 v86, v86, v55
v_mul_f32 v87, v87, v55
v_mul_f32 v88, v88, v55
v_mul_f32 v89, v89, v55
v_mul_f32 v90, v90, v55
v_mul_f32 v91, v91, v55
v_mul_f32 v92, v92, v55
v_mul_f32 v93, v93, v55
v_mul_f32 v94, v94, v55
v_mul_f32 v95, v95, v55
v_mul_f32 v96, v96, v55
v_mul_f32 v97, v97, v55
v_mul_f32 v98, v98, v55
v_mul_f32 v99, v99, v55
v_mul_f32 v100, v100, v55
v_mul_f32 v101, v101, v55
v_mul_f32 v102, v102, v55
v_mul_f32 v103, v103, v55
v_mul_f32 v104, v104, v55
v_mul_f32 v105, v105, v55
v_mul_f32 v106, v106, v55
v_mul_f32 v107, v107, v55
v_mul_f32 v108, v108, v55
v_mul_f32 v109, v109, v55
v_mul_f32 v110, v110, v55
v_mul_f32 v111, v111, v55
v_mul_f32 v112, v112, v55
v_mul_f32 v113, v113, v55
v_mul_f32 v114, v114, v55
v_mul_f32 v115, v115, v55
v_mul_f32 v116, v116, v55
v_mul_f32 v117, v117, v55
v_mul_f32 v118, v118, v55
v_mul_f32 v119, v119, v55
v_sub_f32 v120, v120, v54
v_sub_f32 v121, v121, v54
v_sub_f32 v122, v122, v54
v_sub_f32 v123, v123, v54
v_sub_f32 v124, v124, v54
v_sub_f32 v125, v125, v54
v_sub_f32 v126, v126, v54
v_sub_f32 v127, v127, v54
v_sub_f32 v128, v128, v54
v_sub_f32 v129, v129, v54
v_sub_f32 v130, v130, v54
v_sub_f32 v131, v131, v54
v_sub_f32 v132, v132, v54
v_sub_f32 v133, v133, v54
v_sub_f32 v134, v134, v54
v_sub_f32 v135, v135, v54
v_sub_f32 v168, v168, v54
v_sub_f32 v169, v169, v54
v_sub_f32 v170, v170, v54
v_sub_f32 v171, v171, v54
v_sub_f32 v172, v172, v54
v_sub_f32 v173, v173, v54
v_sub_f32 v174, v174, v54
v_sub_f32 v175, v175, v54
v_sub_f32 v176, v176, v54
v_sub_f32 v177, v177, v54
v_sub_f32 v178, v178, v54
v_sub_f32 v179, v179, v54
v_sub_f32 v180, v180, v54
v_sub_f32 v181, v181, v54
v_sub_f32 v182, v182, v54
v_sub_f32 v183, v183, v54
v_sub_f32 v184, v184, v54
v_sub_f32 v185, v185, v54
v_sub_f32 v186, v186, v54
v_sub_f32 v187, v187, v54
v_sub_f32 v188, v188, v54
v_sub_f32 v189, v189, v54
v_sub_f32 v190, v190, v54
v_sub_f32 v191, v191, v54
v_sub_f32 v192, v192, v54
v_sub_f32 v193, v193, v54
v_sub_f32 v194, v194, v54
v_sub_f32 v195, v195, v54
v_sub_f32 v196, v196, v54
v_sub_f32 v197, v197, v54
v_sub_f32 v198, v198, v54
v_sub_f32 v199, v199, v54
v_sub_f32 v200, v200, v54
v_sub_f32 v201, v201, v54
v_sub_f32 v202, v202, v54
v_sub_f32 v203, v203, v54
v_sub_f32 v204, v204, v54
v_sub_f32 v205, v205, v54
v_sub_f32 v206, v206, v54
v_sub_f32 v207, v207, v54
v_sub_f32 v208, v208, v54
v_sub_f32 v209, v209, v54
v_sub_f32 v210, v210, v54
v_sub_f32 v211, v211, v54
v_sub_f32 v212, v212, v54
v_sub_f32 v213, v213, v54
v_sub_f32 v214, v214, v54
v_sub_f32 v215, v215, v54
v_sub_f32 v216, v216, v54
v_sub_f32 v217, v217, v54
v_sub_f32 v218, v218, v54
v_sub_f32 v219, v219, v54
v_sub_f32 v220, v220, v54
v_sub_f32 v221, v221, v54
v_sub_f32 v222, v222, v54
v_sub_f32 v223, v223, v54
v_sub_f32 v224, v224, v54
v_sub_f32 v225, v225, v54
v_sub_f32 v226, v226, v54
v_sub_f32 v227, v227, v54
v_sub_f32 v228, v228, v54
v_sub_f32 v229, v229, v54
v_sub_f32 v230, v230, v54
v_sub_f32 v231, v231, v54
v_exp_f32 v44, v168
v_exp_f32 v45, v169
s_nop 0
v_cvt_pk_bf16_f32 v232, v44, v45
v_add_f32 v53, v44, v45
v_exp_f32 v46, v170
v_exp_f32 v47, v171
s_nop 0
v_cvt_pk_bf16_f32 v233, v46, v47
v_add_f32 v53, v53, v46
v_add_f32 v53, v53, v47
v_exp_f32 v48, v172
v_exp_f32 v49, v173
s_nop 0
v_cvt_pk_bf16_f32 v234, v48, v49
v_add_f32 v53, v53, v48
v_add_f32 v53, v53, v49
v_exp_f32 v50, v174
v_exp_f32 v51, v175
s_nop 0
v_cvt_pk_bf16_f32 v235, v50, v51
v_add_f32 v53, v53, v50
v_add_f32 v53, v53, v51
v_exp_f32 v44, v176
v_exp_f32 v45, v177
s_nop 0
v_cvt_pk_bf16_f32 v236, v44, v45
v_add_f32 v53, v53, v44
v_add_f32 v53, v53, v45
v_exp_f32 v46, v178
v_exp_f32 v47, v179
s_nop 0
v_cvt_pk_bf16_f32 v237, v46, v47
v_add_f32 v53, v53, v46
v_add_f32 v53, v53, v47
v_exp_f32 v48, v180
v_exp_f32 v49, v181
s_nop 0
v_cvt_pk_bf16_f32 v238, v48, v49
v_add_f32 v53, v53, v48
v_add_f32 v53, v53, v49
v_exp_f32 v50, v182
v_exp_f32 v51, v183
s_nop 0
v_cvt_pk_bf16_f32 v239, v50, v51
v_add_f32 v53, v53, v50
v_add_f32 v53, v53, v51
v_exp_f32 v44, v184
v_exp_f32 v45, v185
s_nop 0
v_cvt_pk_bf16_f32 v240, v44, v45
v_add_f32 v53, v53, v44
v_add_f32 v53, v53, v45
v_exp_f32 v46, v186
v_exp_f32 v47, v187
s_nop 0
v_cvt_pk_bf16_f32 v241, v46, v47
v_add_f32 v53, v53, v46
v_add_f32 v53, v53, v47
v_exp_f32 v48, v188
v_exp_f32 v49, v189
s_nop 0
v_cvt_pk_bf16_f32 v242, v48, v49
v_add_f32 v53, v53, v48
v_add_f32 v53, v53, v49
v_exp_f32 v50, v190
v_exp_f32 v51, v191
s_nop 0
v_cvt_pk_bf16_f32 v243, v50, v51
v_add_f32 v53, v53, v50
v_add_f32 v53, v53, v51
v_exp_f32 v44, v192
v_exp_f32 v45, v193
s_nop 0
v_cvt_pk_bf16_f32 v244, v44, v45
v_add_f32 v53, v53, v44
v_add_f32 v53, v53, v45
v_exp_f32 v46, v194
v_exp_f32 v47, v195
s_nop 0
v_cvt_pk_bf16_f32 v245, v46, v47
v_add_f32 v53, v53, v46
v_add_f32 v53, v53, v47
v_exp_f32 v48, v196
v_exp_f32 v49, v197
s_nop 0
v_cvt_pk_bf16_f32 v246, v48, v49
v_add_f32 v53, v53, v48
v_add_f32 v53, v53, v49
v_exp_f32 v50, v198
v_exp_f32 v51, v199
s_nop 0
v_cvt_pk_bf16_f32 v247, v50, v51
v_add_f32 v53, v53, v50
v_add_f32 v53, v53, v51
s_nop 1
s_branch L_ret2
L_fb3:
s_nop 7
s_nop 7
v_max3_f32 v54, v200, v201, v202
v_max3_f32 v55, v203, v204, v205
v_max3_f32 v54, v54, v206, v207
v_max3_f32 v55, v55, v208, v209
v_max3_f32 v54, v54, v210, v211
v_max3_f32 v55, v55, v212, v213
v_max3_f32 v54, v54, v214, v215
v_max3_f32 v55, v55, v216, v217
v_max3_f32 v54, v54, v218, v219
v_max3_f32 v55, v55, v220, v221
v_max3_f32 v54, v54, v222, v223
v_max3_f32 v55, v55, v224, v225
v_max3_f32 v54, v54, v226, v227
v_max3_f32 v55, v55, v228, v229
v_max3_f32 v54, v54, v230, v231
v_max_f32 v54, v54, v55
v_mov_b32 v55, v54
s_nop 1
v_permlane32_swap_b32 v54, v55
v_max_f32 v54, v54, v55
v_max_f32 v54, 0, v54
v_sub_f32 v55, 0, v54
v_exp_f32 v55, v55
s_nop 0
v_mul_f32 v52, v52, v55
v_mul_f32 v56, v56, v55
v_mul_f32 v57, v57, v55
v_mul_f32 v58, v58, v55
v_mul_f32 v59, v59, v55
v_mul_f32 v60, v60, v55
v_mul_f32 v61, v61, v55
v_mul_f32 v62, v62, v55
v_mul_f32 v63, v63, v55
v_mul_f32 v64, v64, v55
v_mul_f32 v65, v65, v55
v_mul_f32 v66, v66, v55
v_mul_f32 v67, v67, v55
v_mul_f32 v68, v68, v55
v_mul_f32 v69, v69, v55
v_mul_f32 v70, v70, v55
v_mul_f32 v71, v71, v55
v_mul_f32 v72, v72, v55
v_mul_f32 v73, v73, v55
v_mul_f32 v74, v74, v55
v_mul_f32 v75, v75, v55
v_mul_f32 v76, v76, v55
v_mul_f32 v77, v77, v55
v_mul_f32 v78, v78, v55
v_mul_f32 v79, v79, v55
v_mul_f32 v80, v80, v55
v_mul_f32 v81, v81, v55
v_mul_f32 v82, v82, v55
v_mul_f32 v83, v83, v55
v_mul_f32 v84, v84, v55
v_mul_f32 v85, v85, v55
v_mul_f32 v86, v86, v55
v_mul_f32 v87, v87, v55
v_mul_f32 v88, v88, v55
v_mul_f32 v89, v89, v55
v_mul_f32 v90, v90, v55
v_mul_f32 v91, v91, v55
v_mul_f32 v92, v92, v55
v_mul_f32 v93, v93, v55
v_mul_f32 v94, v94, v55
v_mul_f32 v95, v95, v55
v_mul_f32 v96, v96, v55
v_mul_f32 v97, v97, v55
v_mul_f32 v98, v98, v55
v_mul_f32 v99, v99, v55
v_mul_f32 v100, v100, v55
v_mul_f32 v101, v101, v55
v_mul_f32 v102, v102, v55
v_mul_f32 v103, v103, v55
v_mul_f32 v104, v104, v55
v_mul_f32 v105, v105, v55
v_mul_f32 v106, v106, v55
v_mul_f32 v107, v107, v55
v_mul_f32 v108, v108, v55
v_mul_f32 v109, v109, v55
v_mul_f32 v110, v110, v55
v_mul_f32 v111, v111, v55
v_mul_f32 v112, v112, v55
v_mul_f32 v113, v113, v55
v_mul_f32 v114, v114, v55
v_mul_f32 v115, v115, v55
v_mul_f32 v116, v116, v55
v_mul_f32 v117, v117, v55
v_mul_f32 v118, v118, v55
v_mul_f32 v119, v119, v55
v_sub_f32 v120, v120, v54
v_sub_f32 v121, v121, v54
v_sub_f32 v122, v122, v54
v_sub_f32 v123, v123, v54
v_sub_f32 v124, v124, v54
v_sub_f32 v125, v125, v54
v_sub_f32 v126, v126, v54
v_sub_f32 v127, v127, v54
v_sub_f32 v128, v128, v54
v_sub_f32 v129, v129, v54
v_sub_f32 v130, v130, v54
v_sub_f32 v131, v131, v54
v_sub_f32 v132, v132, v54
v_sub_f32 v133, v133, v54
v_sub_f32 v134, v134, v54
v_sub_f32 v135, v135, v54
v_sub_f32 v168, v168, v54
v_sub_f32 v169, v169, v54
v_sub_f32 v170, v170, v54
v_sub_f32 v171, v171, v54
v_sub_f32 v172, v172, v54
v_sub_f32 v173, v173, v54
v_sub_f32 v174, v174, v54
v_sub_f32 v175, v175, v54
v_sub_f32 v176, v176, v54
v_sub_f32 v177, v177, v54
v_sub_f32 v178, v178, v54
v_sub_f32 v179, v179, v54
v_sub_f32 v180, v180, v54
v_sub_f32 v181, v181, v54
v_sub_f32 v182, v182, v54
v_sub_f32 v183, v183, v54
v_sub_f32 v184, v184, v54
v_sub_f32 v185, v185, v54
v_sub_f32 v186, v186, v54
v_sub_f32 v187, v187, v54
v_sub_f32 v188, v188, v54
v_sub_f32 v189, v189, v54
v_sub_f32 v190, v190, v54
v_sub_f32 v191, v191, v54
v_sub_f32 v192, v192, v54
v_sub_f32 v193, v193, v54
v_sub_f32 v194, v194, v54
v_sub_f32 v195, v195, v54
v_sub_f32 v196, v196, v54
v_sub_f32 v197, v197, v54
v_sub_f32 v198, v198, v54
v_sub_f32 v199, v199, v54
v_sub_f32 v200, v200, v54
v_sub_f32 v201, v201, v54
v_sub_f32 v202, v202, v54
v_sub_f32 v203, v203, v54
v_sub_f32 v204, v204, v54
v_sub_f32 v205, v205, v54
v_sub_f32 v206, v206, v54
v_sub_f32 v207, v207, v54
v_sub_f32 v208, v208, v54
v_sub_f32 v209, v209, v54
v_sub_f32 v210, v210, v54
v_sub_f32 v211, v211, v54
v_sub_f32 v212, v212, v54
v_sub_f32 v213, v213, v54
v_sub_f32 v214, v214, v54
v_sub_f32 v215, v215, v54
v_sub_f32 v216, v216, v54
v_sub_f32 v217, v217, v54
v_sub_f32 v218, v218, v54
v_sub_f32 v219, v219, v54
v_sub_f32 v220, v220, v54
v_sub_f32 v221, v221, v54
v_sub_f32 v222, v222, v54
v_sub_f32 v223, v223, v54
v_sub_f32 v224, v224, v54
v_sub_f32 v225, v225, v54
v_sub_f32 v226, v226, v54
v_sub_f32 v227, v227, v54
v_sub_f32 v228, v228, v54
v_sub_f32 v229, v229, v54
v_sub_f32 v230, v230, v54
v_sub_f32 v231, v231, v54
v_exp_f32 v44, v200
v_exp_f32 v45, v201
s_nop 0
v_cvt_pk_bf16_f32 v232, v44, v45
v_add_f32 v53, v44, v45
v_exp_f32 v46, v202
v_exp_f32 v47, v203
s_nop 0
v_cvt_pk_bf16_f32 v233, v46, v47
v_add_f32 v53, v53, v46
v_add_f32 v53, v53, v47
v_exp_f32 v48, v204
v_exp_f32 v49, v205
s_nop 0
v_cvt_pk_bf16_f32 v234, v48, v49
v_add_f32 v53, v53, v48
v_add_f32 v53, v53, v49
v_exp_f32 v50, v206
v_exp_f32 v51, v207
s_nop 0
v_cvt_pk_bf16_f32 v235, v50, v51
v_add_f32 v53, v53, v50
v_add_f32 v53, v53, v51
v_exp_f32 v44, v208
v_exp_f32 v45, v209
s_nop 0
v_cvt_pk_bf16_f32 v236, v44, v45
v_add_f32 v53, v53, v44
v_add_f32 v53, v53, v45
v_exp_f32 v46, v210
v_exp_f32 v47, v211
s_nop 0
v_cvt_pk_bf16_f32 v237, v46, v47
v_add_f32 v53, v53, v46
v_add_f32 v53, v53, v47
v_exp_f32 v48, v212
v_exp_f32 v49, v213
s_nop 0
v_cvt_pk_bf16_f32 v238, v48, v49
v_add_f32 v53, v53, v48
v_add_f32 v53, v53, v49
v_exp_f32 v50, v214
v_exp_f32 v51, v215
s_nop 0
v_cvt_pk_bf16_f32 v239, v50, v51
v_add_f32 v53, v53, v50
v_add_f32 v53, v53, v51
v_exp_f32 v44, v216
v_exp_f32 v45, v217
s_nop 0
v_cvt_pk_bf16_f32 v240, v44, v45
v_add_f32 v53, v53, v44
v_add_f32 v53, v53, v45
v_exp_f32 v46, v218
v_exp_f32 v47, v219
s_nop 0
v_cvt_pk_bf16_f32 v241, v46, v47
v_add_f32 v53, v53, v46
v_add_f32 v53, v53, v47
v_exp_f32 v48, v220
v_exp_f32 v49, v221
s_nop 0
v_cvt_pk_bf16_f32 v242, v48, v49
v_add_f32 v53, v53, v48
v_add_f32 v53, v53, v49
v_exp_f32 v50, v222
v_exp_f32 v51, v223
s_nop 0
v_cvt_pk_bf16_f32 v243, v50, v51
v_add_f32 v53, v53, v50
v_add_f32 v53, v53, v51
v_exp_f32 v44, v224
v_exp_f32 v45, v225
s_nop 0
v_cvt_pk_bf16_f32 v244, v44, v45
v_add_f32 v53, v53, v44
v_add_f32 v53, v53, v45
v_exp_f32 v46, v226
v_exp_f32 v47, v227
s_nop 0
v_cvt_pk_bf16_f32 v245, v46, v47
v_add_f32 v53, v53, v46
v_add_f32 v53, v53, v47
v_exp_f32 v48, v228
v_exp_f32 v49, v229
s_nop 0
v_cvt_pk_bf16_f32 v246, v48, v49
v_add_f32 v53, v53, v48
v_add_f32 v53, v53, v49
v_exp_f32 v50, v230
v_exp_f32 v51, v231
s_nop 0
v_cvt_pk_bf16_f32 v247, v50, v51
v_add_f32 v53, v53, v50
v_add_f32 v53, v53, v51
s_nop 1
s_branch L_ret3
L_fb4:
s_nop 7
s_nop 7
v_max3_f32 v54, v168, v169, v170
v_max3_f32 v55, v171, v172, v173
v_max3_f32 v54, v54, v174, v175
v_max3_f32 v55, v55, v176, v177
v_max3_f32 v54, v54, v178, v179
v_max3_f32 v55, v55, v180, v181
v_max3_f32 v54, v54, v182, v183
v_max3_f32 v55, v55, v184, v185
v_max3_f32 v54, v54, v186, v187
v_max3_f32 v55, v55, v188, v189
v_max3_f32 v54, v54, v190, v191
v_max3_f32 v55, v55, v192, v193
v_max3_f32 v54, v54, v194, v195
v_max3_f32 v55, v55, v196, v197
v_max3_f32 v54, v54, v198, v199
v_max_f32 v54, v54, v55
v_mov_b32 v55, v54
s_nop 1
v_permlane32_swap_b32 v54, v55
v_max_f32 v54, v54, v55
v_max_f32 v54, 0, v54
v_sub_f32 v55, 0, v54
v_exp_f32 v55, v55
s_nop 0
v_mul_f32 v52, v52, v55
v_mul_f32 v56, v56, v55
v_mul_f32 v57, v57, v55
v_mul_f32 v58, v58, v55
v_mul_f32 v59, v59, v55
v_mul_f32 v60, v60, v55
v_mul_f32 v61, v61, v55
v_mul_f32 v62, v62, v55
v_mul_f32 v63, v63, v55
v_mul_f32 v64, v64, v55
v_mul_f32 v65, v65, v55
v_mul_f32 v66, v66, v55
v_mul_f32 v67, v67, v55
v_mul_f32 v68, v68, v55
v_mul_f32 v69, v69, v55
v_mul_f32 v70, v70, v55
v_mul_f32 v71, v71, v55
v_mul_f32 v72, v72, v55
v_mul_f32 v73, v73, v55
v_mul_f32 v74, v74, v55
v_mul_f32 v75, v75, v55
v_mul_f32 v76, v76, v55
v_mul_f32 v77, v77, v55
v_mul_f32 v78, v78, v55
v_mul_f32 v79, v79, v55
v_mul_f32 v80, v80, v55
v_mul_f32 v81, v81, v55
v_mul_f32 v82, v82, v55
v_mul_f32 v83, v83, v55
v_mul_f32 v84, v84, v55
v_mul_f32 v85, v85, v55
v_mul_f32 v86, v86, v55
v_mul_f32 v87, v87, v55
v_mul_f32 v88, v88, v55
v_mul_f32 v89, v89, v55
v_mul_f32 v90, v90, v55
v_mul_f32 v91, v91, v55
v_mul_f32 v92, v92, v55
v_mul_f32 v93, v93, v55
v_mul_f32 v94, v94, v55
v_mul_f32 v95, v95, v55
v_mul_f32 v96, v96, v55
v_mul_f32 v97, v97, v55
v_mul_f32 v98, v98, v55
v_mul_f32 v99, v99, v55
v_mul_f32 v100, v100, v55
v_mul_f32 v101, v101, v55
v_mul_f32 v102, v102, v55
v_mul_f32 v103, v103, v55
v_mul_f32 v104, v104, v55
v_mul_f32 v105, v105, v55
v_mul_f32 v106, v106, v55
v_mul_f32 v107, v107, v55
v_mul_f32 v108, v108, v55
v_mul_f32 v109, v109, v55
v_mul_f32 v110, v110, v55
v_mul_f32 v111, v111, v55
v_mul_f32 v112, v112, v55
v_mul_f32 v113, v113, v55
v_mul_f32 v114, v114, v55
v_mul_f32 v115, v115, v55
v_mul_f32 v116, v116, v55
v_mul_f32 v117, v117, v55
v_mul_f32 v118, v118, v55
v_mul_f32 v119, v119, v55
v_sub_f32 v120, v120, v54
v_sub_f32 v121, v121, v54
v_sub_f32 v122, v122, v54
v_sub_f32 v123, v123, v54
v_sub_f32 v124, v124, v54
v_sub_f32 v125, v125, v54
v_sub_f32 v126, v126, v54
v_sub_f32 v127, v127, v54
v_sub_f32 v128, v128, v54
v_sub_f32 v129, v129, v54
v_sub_f32 v130, v130, v54
v_sub_f32 v131, v131, v54
v_sub_f32 v132, v132, v54
v_sub_f32 v133, v133, v54
v_sub_f32 v134, v134, v54
v_sub_f32 v135, v135, v54
v_sub_f32 v168, v168, v54
v_sub_f32 v169, v169, v54
v_sub_f32 v170, v170, v54
v_sub_f32 v171, v171, v54
v_sub_f32 v172, v172, v54
v_sub_f32 v173, v173, v54
v_sub_f32 v174, v174, v54
v_sub_f32 v175, v175, v54
v_sub_f32 v176, v176, v54
v_sub_f32 v177, v177, v54
v_sub_f32 v178, v178, v54
v_sub_f32 v179, v179, v54
v_sub_f32 v180, v180, v54
v_sub_f32 v181, v181, v54
v_sub_f32 v182, v182, v54
v_sub_f32 v183, v183, v54
v_sub_f32 v184, v184, v54
v_sub_f32 v185, v185, v54
v_sub_f32 v186, v186, v54
v_sub_f32 v187, v187, v54
v_sub_f32 v188, v188, v54
v_sub_f32 v189, v189, v54
v_sub_f32 v190, v190, v54
v_sub_f32 v191, v191, v54
v_sub_f32 v192, v192, v54
v_sub_f32 v193, v193, v54
v_sub_f32 v194, v194, v54
v_sub_f32 v195, v195, v54
v_sub_f32 v196, v196, v54
v_sub_f32 v197, v197, v54
v_sub_f32 v198, v198, v54
v_sub_f32 v199, v199, v54
v_sub_f32 v200, v200, v54
v_sub_f32 v201, v201, v54
v_sub_f32 v202, v202, v54
v_sub_f32 v203, v203, v54
v_sub_f32 v204, v204, v54
v_sub_f32 v205, v205, v54
v_sub_f32 v206, v206, v54
v_sub_f32 v207, v207, v54
v_sub_f32 v208, v208, v54
v_sub_f32 v209, v209, v54
v_sub_f32 v210, v210, v54
v_sub_f32 v211, v211, v54
v_sub_f32 v212, v212, v54
v_sub_f32 v213, v213, v54
v_sub_f32 v214, v214, v54
v_sub_f32 v215, v215, v54
v_sub_f32 v216, v216, v54
v_sub_f32 v217, v217, v54
v_sub_f32 v218, v218, v54
v_sub_f32 v219, v219, v54
v_sub_f32 v220, v220, v54
v_sub_f32 v221, v221, v54
v_sub_f32 v222, v222, v54
v_sub_f32 v223, v223, v54
v_sub_f32 v224, v224, v54
v_sub_f32 v225, v225, v54
v_sub_f32 v226, v226, v54
v_sub_f32 v227, v227, v54
v_sub_f32 v228, v228, v54
v_sub_f32 v229, v229, v54
v_sub_f32 v230, v230, v54
v_sub_f32 v231, v231, v54
v_exp_f32 v44, v168
v_exp_f32 v45, v169
s_nop 0
v_cvt_pk_bf16_f32 v232, v44, v45
v_add_f32 v53, v44, v45
v_exp_f32 v46, v170
v_exp_f32 v47, v171
s_nop 0
v_cvt_pk_bf16_f32 v233, v46, v47
v_add_f32 v53, v53, v46
v_add_f32 v53, v53, v47
v_exp_f32 v48, v172
v_exp_f32 v49, v173
s_nop 0
v_cvt_pk_bf16_f32 v234, v48, v49
v_add_f32 v53, v53, v48
v_add_f32 v53, v53, v49
v_exp_f32 v50, v174
v_exp_f32 v51, v175
s_nop 0
v_cvt_pk_bf16_f32 v235, v50, v51
v_add_f32 v53, v53, v50
v_add_f32 v53, v53, v51
v_exp_f32 v44, v176
v_exp_f32 v45, v177
s_nop 0
v_cvt_pk_bf16_f32 v236, v44, v45
v_add_f32 v53, v53, v44
v_add_f32 v53, v53, v45
v_exp_f32 v46, v178
v_exp_f32 v47, v179
s_nop 0
v_cvt_pk_bf16_f32 v237, v46, v47
v_add_f32 v53, v53, v46
v_add_f32 v53, v53, v47
v_exp_f32 v48, v180
v_exp_f32 v49, v181
s_nop 0
v_cvt_pk_bf16_f32 v238, v48, v49
v_add_f32 v53, v53, v48
v_add_f32 v53, v53, v49
v_exp_f32 v50, v182
v_exp_f32 v51, v183
s_nop 0
v_cvt_pk_bf16_f32 v239, v50, v51
v_add_f32 v53, v53, v50
v_add_f32 v53, v53, v51
v_exp_f32 v44, v184
v_exp_f32 v45, v185
s_nop 0
v_cvt_pk_bf16_f32 v240, v44, v45
v_add_f32 v53, v53, v44
v_add_f32 v53, v53, v45
v_exp_f32 v46, v186
v_exp_f32 v47, v187
s_nop 0
v_cvt_pk_bf16_f32 v241, v46, v47
v_add_f32 v53, v53, v46
v_add_f32 v53, v53, v47
v_exp_f32 v48, v188
v_exp_f32 v49, v189
s_nop 0
v_cvt_pk_bf16_f32 v242, v48, v49
v_add_f32 v53, v53, v48
v_add_f32 v53, v53, v49
v_exp_f32 v50, v190
v_exp_f32 v51, v191
s_nop 0
v_cvt_pk_bf16_f32 v243, v50, v51
v_add_f32 v53, v53, v50
v_add_f32 v53, v53, v51
v_exp_f32 v44, v192
v_exp_f32 v45, v193
s_nop 0
v_cvt_pk_bf16_f32 v244, v44, v45
v_add_f32 v53, v53, v44
v_add_f32 v53, v53, v45
v_exp_f32 v46, v194
v_exp_f32 v47, v195
s_nop 0
v_cvt_pk_bf16_f32 v245, v46, v47
v_add_f32 v53, v53, v46
v_add_f32 v53, v53, v47
v_exp_f32 v48, v196
v_exp_f32 v49, v197
s_nop 0
v_cvt_pk_bf16_f32 v246, v48, v49
v_add_f32 v53, v53, v48
v_add_f32 v53, v53, v49
v_exp_f32 v50, v198
v_exp_f32 v51, v199
s_nop 0
v_cvt_pk_bf16_f32 v247, v50, v51
v_add_f32 v53, v53, v50
v_add_f32 v53, v53, v51
s_nop 1
s_branch L_ret4
L_fb5:
s_nop 7
s_nop 7
v_max3_f32 v54, v200, v201, v202
v_max3_f32 v55, v203, v204, v205
v_max3_f32 v54, v54, v206, v207
v_max3_f32 v55, v55, v208, v209
v_max3_f32 v54, v54, v210, v211
v_max3_f32 v55, v55, v212, v213
v_max3_f32 v54, v54, v214, v215
v_max3_f32 v55, v55, v216, v217
v_max3_f32 v54, v54, v218, v219
v_max3_f32 v55, v55, v220, v221
v_max3_f32 v54, v54, v222, v223
v_max3_f32 v55, v55, v224, v225
v_max3_f32 v54, v54, v226, v227
v_max3_f32 v55, v55, v228, v229
v_max3_f32 v54, v54, v230, v231
v_max_f32 v54, v54, v55
v_mov_b32 v55, v54
s_nop 1
v_permlane32_swap_b32 v54, v55
v_max_f32 v54, v54, v55
v_max_f32 v54, 0, v54
v_sub_f32 v55, 0, v54
v_exp_f32 v55, v55
s_nop 0
v_mul_f32 v52, v52, v55
v_mul_f32 v56, v56, v55
v_mul_f32 v57, v57, v55
v_mul_f32 v58, v58, v55
v_mul_f32 v59, v59, v55
v_mul_f32 v60, v60, v55
v_mul_f32 v61, v61, v55
v_mul_f32 v62, v62, v55
v_mul_f32 v63, v63, v55
v_mul_f32 v64, v64, v55
v_mul_f32 v65, v65, v55
v_mul_f32 v66, v66, v55
v_mul_f32 v67, v67, v55
v_mul_f32 v68, v68, v55
v_mul_f32 v69, v69, v55
v_mul_f32 v70, v70, v55
v_mul_f32 v71, v71, v55
v_mul_f32 v72, v72, v55
v_mul_f32 v73, v73, v55
v_mul_f32 v74, v74, v55
v_mul_f32 v75, v75, v55
v_mul_f32 v76, v76, v55
v_mul_f32 v77, v77, v55
v_mul_f32 v78, v78, v55
v_mul_f32 v79, v79, v55
v_mul_f32 v80, v80, v55
v_mul_f32 v81, v81, v55
v_mul_f32 v82, v82, v55
v_mul_f32 v83, v83, v55
v_mul_f32 v84, v84, v55
v_mul_f32 v85, v85, v55
v_mul_f32 v86, v86, v55
v_mul_f32 v87, v87, v55
v_mul_f32 v88, v88, v55
v_mul_f32 v89, v89, v55
v_mul_f32 v90, v90, v55
v_mul_f32 v91, v91, v55
v_mul_f32 v92, v92, v55
v_mul_f32 v93, v93, v55
v_mul_f32 v94, v94, v55
v_mul_f32 v95, v95, v55
v_mul_f32 v96, v96, v55
v_mul_f32 v97, v97, v55
v_mul_f32 v98, v98, v55
v_mul_f32 v99, v99, v55
v_mul_f32 v100, v100, v55
v_mul_f32 v101, v101, v55
v_mul_f32 v102, v102, v55
v_mul_f32 v103, v103, v55
v_mul_f32 v104, v104, v55
v_mul_f32 v105, v105, v55
v_mul_f32 v106, v106, v55
v_mul_f32 v107, v107, v55
v_mul_f32 v108, v108, v55
v_mul_f32 v109, v109, v55
v_mul_f32 v110, v110, v55
v_mul_f32 v111, v111, v55
v_mul_f32 v112, v112, v55
v_mul_f32 v113, v113, v55
v_mul_f32 v114, v114, v55
v_mul_f32 v115, v115, v55
v_mul_f32 v116, v116, v55
v_mul_f32 v117, v117, v55
v_mul_f32 v118, v118, v55
v_mul_f32 v119, v119, v55
v_sub_f32 v120, v120, v54
v_sub_f32 v121, v121, v54
v_sub_f32 v122, v122, v54
v_sub_f32 v123, v123, v54
v_sub_f32 v124, v124, v54
v_sub_f32 v125, v125, v54
v_sub_f32 v126, v126, v54
v_sub_f32 v127, v127, v54
v_sub_f32 v128, v128, v54
v_sub_f32 v129, v129, v54
v_sub_f32 v130, v130, v54
v_sub_f32 v131, v131, v54
v_sub_f32 v132, v132, v54
v_sub_f32 v133, v133, v54
v_sub_f32 v134, v134, v54
v_sub_f32 v135, v135, v54
v_sub_f32 v168, v168, v54
v_sub_f32 v169, v169, v54
v_sub_f32 v170, v170, v54
v_sub_f32 v171, v171, v54
v_sub_f32 v172, v172, v54
v_sub_f32 v173, v173, v54
v_sub_f32 v174, v174, v54
v_sub_f32 v175, v175, v54
v_sub_f32 v176, v176, v54
v_sub_f32 v177, v177, v54
v_sub_f32 v178, v178, v54
v_sub_f32 v179, v179, v54
v_sub_f32 v180, v180, v54
v_sub_f32 v181, v181, v54
v_sub_f32 v182, v182, v54
v_sub_f32 v183, v183, v54
v_sub_f32 v184, v184, v54
v_sub_f32 v185, v185, v54
v_sub_f32 v186, v186, v54
v_sub_f32 v187, v187, v54
v_sub_f32 v188, v188, v54
v_sub_f32 v189, v189, v54
v_sub_f32 v190, v190, v54
v_sub_f32 v191, v191, v54
v_sub_f32 v192, v192, v54
v_sub_f32 v193, v193, v54
v_sub_f32 v194, v194, v54
v_sub_f32 v195, v195, v54
v_sub_f32 v196, v196, v54
v_sub_f32 v197, v197, v54
v_sub_f32 v198, v198, v54
v_sub_f32 v199, v199, v54
v_sub_f32 v200, v200, v54
v_sub_f32 v201, v201, v54
v_sub_f32 v202, v202, v54
v_sub_f32 v203, v203, v54
v_sub_f32 v204, v204, v54
v_sub_f32 v205, v205, v54
v_sub_f32 v206, v206, v54
v_sub_f32 v207, v207, v54
v_sub_f32 v208, v208, v54
v_sub_f32 v209, v209, v54
v_sub_f32 v210, v210, v54
v_sub_f32 v211, v211, v54
v_sub_f32 v212, v212, v54
v_sub_f32 v213, v213, v54
v_sub_f32 v214, v214, v54
v_sub_f32 v215, v215, v54
v_sub_f32 v216, v216, v54
v_sub_f32 v217, v217, v54
v_sub_f32 v218, v218, v54
v_sub_f32 v219, v219, v54
v_sub_f32 v220, v220, v54
v_sub_f32 v221, v221, v54
v_sub_f32 v222, v222, v54
v_sub_f32 v223, v223, v54
v_sub_f32 v224, v224, v54
v_sub_f32 v225, v225, v54
v_sub_f32 v226, v226, v54
v_sub_f32 v227, v227, v54
v_sub_f32 v228, v228, v54
v_sub_f32 v229, v229, v54
v_sub_f32 v230, v230, v54
v_sub_f32 v231, v231, v54
v_exp_f32 v44, v200
v_exp_f32 v45, v201
s_nop 0
v_cvt_pk_bf16_f32 v232, v44, v45
v_add_f32 v53, v44, v45
v_exp_f32 v46, v202
v_exp_f32 v47, v203
s_nop 0
v_cvt_pk_bf16_f32 v233, v46, v47
v_add_f32 v53, v53, v46
v_add_f32 v53, v53, v47
v_exp_f32 v48, v204
v_exp_f32 v49, v205
s_nop 0
v_cvt_pk_bf16_f32 v234, v48, v49
v_add_f32 v53, v53, v48
v_add_f32 v53, v53, v49
v_exp_f32 v50, v206
v_exp_f32 v51, v207
s_nop 0
v_cvt_pk_bf16_f32 v235, v50, v51
v_add_f32 v53, v53, v50
v_add_f32 v53, v53, v51
v_exp_f32 v44, v208
v_exp_f32 v45, v209
s_nop 0
v_cvt_pk_bf16_f32 v236, v44, v45
v_add_f32 v53, v53, v44
v_add_f32 v53, v53, v45
v_exp_f32 v46, v210
v_exp_f32 v47, v211
s_nop 0
v_cvt_pk_bf16_f32 v237, v46, v47
v_add_f32 v53, v53, v46
v_add_f32 v53, v53, v47
v_exp_f32 v48, v212
v_exp_f32 v49, v213
s_nop 0
v_cvt_pk_bf16_f32 v238, v48, v49
v_add_f32 v53, v53, v48
v_add_f32 v53, v53, v49
v_exp_f32 v50, v214
v_exp_f32 v51, v215
s_nop 0
v_cvt_pk_bf16_f32 v239, v50, v51
v_add_f32 v53, v53, v50
v_add_f32 v53, v53, v51
v_exp_f32 v44, v216
v_exp_f32 v45, v217
s_nop 0
v_cvt_pk_bf16_f32 v240, v44, v45
v_add_f32 v53, v53, v44
v_add_f32 v53, v53, v45
v_exp_f32 v46, v218
v_exp_f32 v47, v219
s_nop 0
v_cvt_pk_bf16_f32 v241, v46, v47
v_add_f32 v53, v53, v46
v_add_f32 v53, v53, v47
v_exp_f32 v48, v220
v_exp_f32 v49, v221
s_nop 0
v_cvt_pk_bf16_f32 v242, v48, v49
v_add_f32 v53, v53, v48
v_add_f32 v53, v53, v49
v_exp_f32 v50, v222
v_exp_f32 v51, v223
s_nop 0
v_cvt_pk_bf16_f32 v243, v50, v51
v_add_f32 v53, v53, v50
v_add_f32 v53, v53, v51
v_exp_f32 v44, v224
v_exp_f32 v45, v225
s_nop 0
v_cvt_pk_bf16_f32 v244, v44, v45
v_add_f32 v53, v53, v44
v_add_f32 v53, v53, v45
v_exp_f32 v46, v226
v_exp_f32 v47, v227
s_nop 0
v_cvt_pk_bf16_f32 v245, v46, v47
v_add_f32 v53, v53, v46
v_add_f32 v53, v53, v47
v_exp_f32 v48, v228
v_exp_f32 v49, v229
s_nop 0
v_cvt_pk_bf16_f32 v246, v48, v49
v_add_f32 v53, v53, v48
v_add_f32 v53, v53, v49
v_exp_f32 v50, v230
v_exp_f32 v51, v231
s_nop 0
v_cvt_pk_bf16_f32 v247, v50, v51
v_add_f32 v53, v53, v50
v_add_f32 v53, v53, v51
s_nop 1
s_branch L_ret5
L_fb6:
s_nop 7
s_nop 7
v_max3_f32 v54, v168, v169, v170
v_max3_f32 v55, v171, v172, v173
v_max3_f32 v54, v54, v174, v175
v_max3_f32 v55, v55, v176, v177
v_max3_f32 v54, v54, v178, v179
v_max3_f32 v55, v55, v180, v181
v_max3_f32 v54, v54, v182, v183
v_max3_f32 v55, v55, v184, v185
v_max3_f32 v54, v54, v186, v187
v_max3_f32 v55, v55, v188, v189
v_max3_f32 v54, v54, v190, v191
v_max3_f32 v55, v55, v192, v193
v_max3_f32 v54, v54, v194, v195
v_max3_f32 v55, v55, v196, v197
v_max3_f32 v54, v54, v198, v199
v_max_f32 v54, v54, v55
v_mov_b32 v55, v54
s_nop 1
v_permlane32_swap_b32 v54, v55
v_max_f32 v54, v54, v55
v_max_f32 v54, 0, v54
v_sub_f32 v55, 0, v54
v_exp_f32 v55, v55
s_nop 0
v_mul_f32 v52, v52, v55
v_mul_f32 v56, v56, v55
v_mul_f32 v57, v57, v55
v_mul_f32 v58, v58, v55
v_mul_f32 v59, v59, v55
v_mul_f32 v60, v60, v55
v_mul_f32 v61, v61, v55
v_mul_f32 v62, v62, v55
v_mul_f32 v63, v63, v55
v_mul_f32 v64, v64, v55
v_mul_f32 v65, v65, v55
v_mul_f32 v66, v66, v55
v_mul_f32 v67, v67, v55
v_mul_f32 v68, v68, v55
v_mul_f32 v69, v69, v55
v_mul_f32 v70, v70, v55
v_mul_f32 v71, v71, v55
v_mul_f32 v72, v72, v55
v_mul_f32 v73, v73, v55
v_mul_f32 v74, v74, v55
v_mul_f32 v75, v75, v55
v_mul_f32 v76, v76, v55
v_mul_f32 v77, v77, v55
v_mul_f32 v78, v78, v55
v_mul_f32 v79, v79, v55
v_mul_f32 v80, v80, v55
v_mul_f32 v81, v81, v55
v_mul_f32 v82, v82, v55
v_mul_f32 v83, v83, v55
v_mul_f32 v84, v84, v55
v_mul_f32 v85, v85, v55
v_mul_f32 v86, v86, v55
v_mul_f32 v87, v87, v55
v_mul_f32 v88, v88, v55
v_mul_f32 v89, v89, v55
v_mul_f32 v90, v90, v55
v_mul_f32 v91, v91, v55
v_mul_f32 v92, v92, v55
v_mul_f32 v93, v93, v55
v_mul_f32 v94, v94, v55
v_mul_f32 v95, v95, v55
v_mul_f32 v96, v96, v55
v_mul_f32 v97, v97, v55
v_mul_f32 v98, v98, v55
v_mul_f32 v99, v99, v55
v_mul_f32 v100, v100, v55
v_mul_f32 v101, v101, v55
v_mul_f32 v102, v102, v55
v_mul_f32 v103, v103, v55
v_mul_f32 v104, v104, v55
v_mul_f32 v105, v105, v55
v_mul_f32 v106, v106, v55
v_mul_f32 v107, v107, v55
v_mul_f32 v108, v108, v55
v_mul_f32 v109, v109, v55
v_mul_f32 v110, v110, v55
v_mul_f32 v111, v111, v55
v_mul_f32 v112, v112, v55
v_mul_f32 v113, v113, v55
v_mul_f32 v114, v114, v55
v_mul_f32 v115, v115, v55
v_mul_f32 v116, v116, v55
v_mul_f32 v117, v117, v55
v_mul_f32 v118, v118, v55
v_mul_f32 v119, v119, v55
v_sub_f32 v120, v120, v54
v_sub_f32 v121, v121, v54
v_sub_f32 v122, v122, v54
v_sub_f32 v123, v123, v54
v_sub_f32 v124, v124, v54
v_sub_f32 v125, v125, v54
v_sub_f32 v126, v126, v54
v_sub_f32 v127, v127, v54
v_sub_f32 v128, v128, v54
v_sub_f32 v129, v129, v54
v_sub_f32 v130, v130, v54
v_sub_f32 v131, v131, v54
v_sub_f32 v132, v132, v54
v_sub_f32 v133, v133, v54
v_sub_f32 v134, v134, v54
v_sub_f32 v135, v135, v54
v_sub_f32 v168, v168, v54
v_sub_f32 v169, v169, v54
v_sub_f32 v170, v170, v54
v_sub_f32 v171, v171, v54
v_sub_f32 v172, v172, v54
v_sub_f32 v173, v173, v54
v_sub_f32 v174, v174, v54
v_sub_f32 v175, v175, v54
v_sub_f32 v176, v176, v54
v_sub_f32 v177, v177, v54
v_sub_f32 v178, v178, v54
v_sub_f32 v179, v179, v54
v_sub_f32 v180, v180, v54
v_sub_f32 v181, v181, v54
v_sub_f32 v182, v182, v54
v_sub_f32 v183, v183, v54
v_sub_f32 v184, v184, v54
v_sub_f32 v185, v185, v54
v_sub_f32 v186, v186, v54
v_sub_f32 v187, v187, v54
v_sub_f32 v188, v188, v54
v_sub_f32 v189, v189, v54
v_sub_f32 v190, v190, v54
v_sub_f32 v191, v191, v54
v_sub_f32 v192, v192, v54
v_sub_f32 v193, v193, v54
v_sub_f32 v194, v194, v54
v_sub_f32 v195, v195, v54
v_sub_f32 v196, v196, v54
v_sub_f32 v197, v197, v54
v_sub_f32 v198, v198, v54
v_sub_f32 v199, v199, v54
v_sub_f32 v200, v200, v54
v_sub_f32 v201, v201, v54
v_sub_f32 v202, v202, v54
v_sub_f32 v203, v203, v54
v_sub_f32 v204, v204, v54
v_sub_f32 v205, v205, v54
v_sub_f32 v206, v206, v54
v_sub_f32 v207, v207, v54
v_sub_f32 v208, v208, v54
v_sub_f32 v209, v209, v54
v_sub_f32 v210, v210, v54
v_sub_f32 v211, v211, v54
v_sub_f32 v212, v212, v54
v_sub_f32 v213, v213, v54
v_sub_f32 v214, v214, v54
v_sub_f32 v215, v215, v54
v_sub_f32 v216, v216, v54
v_sub_f32 v217, v217, v54
v_sub_f32 v218, v218, v54
v_sub_f32 v219, v219, v54
v_sub_f32 v220, v220, v54
v_sub_f32 v221, v221, v54
v_sub_f32 v222, v222, v54
v_sub_f32 v223, v223, v54
v_sub_f32 v224, v224, v54
v_sub_f32 v225, v225, v54
v_sub_f32 v226, v226, v54
v_sub_f32 v227, v227, v54
v_sub_f32 v228, v228, v54
v_sub_f32 v229, v229, v54
v_sub_f32 v230, v230, v54
v_sub_f32 v231, v231, v54
v_exp_f32 v44, v168
v_exp_f32 v45, v169
s_nop 0
v_cvt_pk_bf16_f32 v232, v44, v45
v_add_f32 v53, v44, v45
v_exp_f32 v46, v170
v_exp_f32 v47, v171
s_nop 0
v_cvt_pk_bf16_f32 v233, v46, v47
v_add_f32 v53, v53, v46
v_add_f32 v53, v53, v47
v_exp_f32 v48, v172
v_exp_f32 v49, v173
s_nop 0
v_cvt_pk_bf16_f32 v234, v48, v49
v_add_f32 v53, v53, v48
v_add_f32 v53, v53, v49
v_exp_f32 v50, v174
v_exp_f32 v51, v175
s_nop 0
v_cvt_pk_bf16_f32 v235, v50, v51
v_add_f32 v53, v53, v50
v_add_f32 v53, v53, v51
v_exp_f32 v44, v176
v_exp_f32 v45, v177
s_nop 0
v_cvt_pk_bf16_f32 v236, v44, v45
v_add_f32 v53, v53, v44
v_add_f32 v53, v53, v45
v_exp_f32 v46, v178
v_exp_f32 v47, v179
s_nop 0
v_cvt_pk_bf16_f32 v237, v46, v47
v_add_f32 v53, v53, v46
v_add_f32 v53, v53, v47
v_exp_f32 v48, v180
v_exp_f32 v49, v181
s_nop 0
v_cvt_pk_bf16_f32 v238, v48, v49
v_add_f32 v53, v53, v48
v_add_f32 v53, v53, v49
v_exp_f32 v50, v182
v_exp_f32 v51, v183
s_nop 0
v_cvt_pk_bf16_f32 v239, v50, v51
v_add_f32 v53, v53, v50
v_add_f32 v53, v53, v51
v_exp_f32 v44, v184
v_exp_f32 v45, v185
s_nop 0
v_cvt_pk_bf16_f32 v240, v44, v45
v_add_f32 v53, v53, v44
v_add_f32 v53, v53, v45
v_exp_f32 v46, v186
v_exp_f32 v47, v187
s_nop 0
v_cvt_pk_bf16_f32 v241, v46, v47
v_add_f32 v53, v53, v46
v_add_f32 v53, v53, v47
v_exp_f32 v48, v188
v_exp_f32 v49, v189
s_nop 0
v_cvt_pk_bf16_f32 v242, v48, v49
v_add_f32 v53, v53, v48
v_add_f32 v53, v53, v49
v_exp_f32 v50, v190
v_exp_f32 v51, v191
s_nop 0
v_cvt_pk_bf16_f32 v243, v50, v51
v_add_f32 v53, v53, v50
v_add_f32 v53, v53, v51
v_exp_f32 v44, v192
v_exp_f32 v45, v193
s_nop 0
v_cvt_pk_bf16_f32 v244, v44, v45
v_add_f32 v53, v53, v44
v_add_f32 v53, v53, v45
v_exp_f32 v46, v194
v_exp_f32 v47, v195
s_nop 0
v_cvt_pk_bf16_f32 v245, v46, v47
v_add_f32 v53, v53, v46
v_add_f32 v53, v53, v47
v_exp_f32 v48, v196
v_exp_f32 v49, v197
s_nop 0
v_cvt_pk_bf16_f32 v246, v48, v49
v_add_f32 v53, v53, v48
v_add_f32 v53, v53, v49
v_exp_f32 v50, v198
v_exp_f32 v51, v199
s_nop 0
v_cvt_pk_bf16_f32 v247, v50, v51
v_add_f32 v53, v53, v50
v_add_f32 v53, v53, v51
s_nop 1
s_branch L_ret6
L_fb7:
s_nop 7
s_nop 7
v_max3_f32 v54, v200, v201, v202
v_max3_f32 v55, v203, v204, v205
v_max3_f32 v54, v54, v206, v207
v_max3_f32 v55, v55, v208, v209
v_max3_f32 v54, v54, v210, v211
v_max3_f32 v55, v55, v212, v213
v_max3_f32 v54, v54, v214, v215
v_max3_f32 v55, v55, v216, v217
v_max3_f32 v54, v54, v218, v219
v_max3_f32 v55, v55, v220, v221
v_max3_f32 v54, v54, v222, v223
v_max3_f32 v55, v55, v224, v225
v_max3_f32 v54, v54, v226, v227
v_max3_f32 v55, v55, v228, v229
v_max3_f32 v54, v54, v230, v231
v_max_f32 v54, v54, v55
v_mov_b32 v55, v54
s_nop 1
v_permlane32_swap_b32 v54, v55
v_max_f32 v54, v54, v55
v_max_f32 v54, 0, v54
v_sub_f32 v55, 0, v54
v_exp_f32 v55, v55
s_nop 0
v_mul_f32 v52, v52, v55
v_mul_f32 v56, v56, v55
v_mul_f32 v57, v57, v55
v_mul_f32 v58, v58, v55
v_mul_f32 v59, v59, v55
v_mul_f32 v60, v60, v55
v_mul_f32 v61, v61, v55
v_mul_f32 v62, v62, v55
v_mul_f32 v63, v63, v55
v_mul_f32 v64, v64, v55
v_mul_f32 v65, v65, v55
v_mul_f32 v66, v66, v55
v_mul_f32 v67, v67, v55
v_mul_f32 v68, v68, v55
v_mul_f32 v69, v69, v55
v_mul_f32 v70, v70, v55
v_mul_f32 v71, v71, v55
v_mul_f32 v72, v72, v55
v_mul_f32 v73, v73, v55
v_mul_f32 v74, v74, v55
v_mul_f32 v75, v75, v55
v_mul_f32 v76, v76, v55
v_mul_f32 v77, v77, v55
v_mul_f32 v78, v78, v55
v_mul_f32 v79, v79, v55
v_mul_f32 v80, v80, v55
v_mul_f32 v81, v81, v55
v_mul_f32 v82, v82, v55
v_mul_f32 v83, v83, v55
v_mul_f32 v84, v84, v55
v_mul_f32 v85, v85, v55
v_mul_f32 v86, v86, v55
v_mul_f32 v87, v87, v55
v_mul_f32 v88, v88, v55
v_mul_f32 v89, v89, v55
v_mul_f32 v90, v90, v55
v_mul_f32 v91, v91, v55
v_mul_f32 v92, v92, v55
v_mul_f32 v93, v93, v55
v_mul_f32 v94, v94, v55
v_mul_f32 v95, v95, v55
v_mul_f32 v96, v96, v55
v_mul_f32 v97, v97, v55
v_mul_f32 v98, v98, v55
v_mul_f32 v99, v99, v55
v_mul_f32 v100, v100, v55
v_mul_f32 v101, v101, v55
v_mul_f32 v102, v102, v55
v_mul_f32 v103, v103, v55
v_mul_f32 v104, v104, v55
v_mul_f32 v105, v105, v55
v_mul_f32 v106, v106, v55
v_mul_f32 v107, v107, v55
v_mul_f32 v108, v108, v55
v_mul_f32 v109, v109, v55
v_mul_f32 v110, v110, v55
v_mul_f32 v111, v111, v55
v_mul_f32 v112, v112, v55
v_mul_f32 v113, v113, v55
v_mul_f32 v114, v114, v55
v_mul_f32 v115, v115, v55
v_mul_f32 v116, v116, v55
v_mul_f32 v117, v117, v55
v_mul_f32 v118, v118, v55
v_mul_f32 v119, v119, v55
v_sub_f32 v120, v120, v54
v_sub_f32 v121, v121, v54
v_sub_f32 v122, v122, v54
v_sub_f32 v123, v123, v54
v_sub_f32 v124, v124, v54
v_sub_f32 v125, v125, v54
v_sub_f32 v126, v126, v54
v_sub_f32 v127, v127, v54
v_sub_f32 v128, v128, v54
v_sub_f32 v129, v129, v54
v_sub_f32 v130, v130, v54
v_sub_f32 v131, v131, v54
v_sub_f32 v132, v132, v54
v_sub_f32 v133, v133, v54
v_sub_f32 v134, v134, v54
v_sub_f32 v135, v135, v54
v_sub_f32 v168, v168, v54
v_sub_f32 v169, v169, v54
v_sub_f32 v170, v170, v54
v_sub_f32 v171, v171, v54
v_sub_f32 v172, v172, v54
v_sub_f32 v173, v173, v54
v_sub_f32 v174, v174, v54
v_sub_f32 v175, v175, v54
v_sub_f32 v176, v176, v54
v_sub_f32 v177, v177, v54
v_sub_f32 v178, v178, v54
v_sub_f32 v179, v179, v54
v_sub_f32 v180, v180, v54
v_sub_f32 v181, v181, v54
v_sub_f32 v182, v182, v54
v_sub_f32 v183, v183, v54
v_sub_f32 v184, v184, v54
v_sub_f32 v185, v185, v54
v_sub_f32 v186, v186, v54
v_sub_f32 v187, v187, v54
v_sub_f32 v188, v188, v54
v_sub_f32 v189, v189, v54
v_sub_f32 v190, v190, v54
v_sub_f32 v191, v191, v54
v_sub_f32 v192, v192, v54
v_sub_f32 v193, v193, v54
v_sub_f32 v194, v194, v54
v_sub_f32 v195, v195, v54
v_sub_f32 v196, v196, v54
v_sub_f32 v197, v197, v54
v_sub_f32 v198, v198, v54
v_sub_f32 v199, v199, v54
v_sub_f32 v200, v200, v54
v_sub_f32 v201, v201, v54
v_sub_f32 v202, v202, v54
v_sub_f32 v203, v203, v54
v_sub_f32 v204, v204, v54
v_sub_f32 v205, v205, v54
v_sub_f32 v206, v206, v54
v_sub_f32 v207, v207, v54
v_sub_f32 v208, v208, v54
v_sub_f32 v209, v209, v54
v_sub_f32 v210, v210, v54
v_sub_f32 v211, v211, v54
v_sub_f32 v212, v212, v54
v_sub_f32 v213, v213, v54
v_sub_f32 v214, v214, v54
v_sub_f32 v215, v215, v54
v_sub_f32 v216, v216, v54
v_sub_f32 v217, v217, v54
v_sub_f32 v218, v218, v54
v_sub_f32 v219, v219, v54
v_sub_f32 v220, v220, v54
v_sub_f32 v221, v221, v54
v_sub_f32 v222, v222, v54
v_sub_f32 v223, v223, v54
v_sub_f32 v224, v224, v54
v_sub_f32 v225, v225, v54
v_sub_f32 v226, v226, v54
v_sub_f32 v227, v227, v54
v_sub_f32 v228, v228, v54
v_sub_f32 v229, v229, v54
v_sub_f32 v230, v230, v54
v_sub_f32 v231, v231, v54
v_exp_f32 v44, v200
v_exp_f32 v45, v201
s_nop 0
v_cvt_pk_bf16_f32 v232, v44, v45
v_add_f32 v53, v44, v45
v_exp_f32 v46, v202
v_exp_f32 v47, v203
s_nop 0
v_cvt_pk_bf16_f32 v233, v46, v47
v_add_f32 v53, v53, v46
v_add_f32 v53, v53, v47
v_exp_f32 v48, v204
v_exp_f32 v49, v205
s_nop 0
v_cvt_pk_bf16_f32 v234, v48, v49
v_add_f32 v53, v53, v48
v_add_f32 v53, v53, v49
v_exp_f32 v50, v206
v_exp_f32 v51, v207
s_nop 0
v_cvt_pk_bf16_f32 v235, v50, v51
v_add_f32 v53, v53, v50
v_add_f32 v53, v53, v51
v_exp_f32 v44, v208
v_exp_f32 v45, v209
s_nop 0
v_cvt_pk_bf16_f32 v236, v44, v45
v_add_f32 v53, v53, v44
v_add_f32 v53, v53, v45
v_exp_f32 v46, v210
v_exp_f32 v47, v211
s_nop 0
v_cvt_pk_bf16_f32 v237, v46, v47
v_add_f32 v53, v53, v46
v_add_f32 v53, v53, v47
v_exp_f32 v48, v212
v_exp_f32 v49, v213
s_nop 0
v_cvt_pk_bf16_f32 v238, v48, v49
v_add_f32 v53, v53, v48
v_add_f32 v53, v53, v49
v_exp_f32 v50, v214
v_exp_f32 v51, v215
s_nop 0
v_cvt_pk_bf16_f32 v239, v50, v51
v_add_f32 v53, v53, v50
v_add_f32 v53, v53, v51
v_exp_f32 v44, v216
v_exp_f32 v45, v217
s_nop 0
v_cvt_pk_bf16_f32 v240, v44, v45
v_add_f32 v53, v53, v44
v_add_f32 v53, v53, v45
v_exp_f32 v46, v218
v_exp_f32 v47, v219
s_nop 0
v_cvt_pk_bf16_f32 v241, v46, v47
v_add_f32 v53, v53, v46
v_add_f32 v53, v53, v47
v_exp_f32 v48, v220
v_exp_f32 v49, v221
s_nop 0
v_cvt_pk_bf16_f32 v242, v48, v49
v_add_f32 v53, v53, v48
v_add_f32 v53, v53, v49
v_exp_f32 v50, v222
v_exp_f32 v51, v223
s_nop 0
v_cvt_pk_bf16_f32 v243, v50, v51
v_add_f32 v53, v53, v50
v_add_f32 v53, v53, v51
v_exp_f32 v44, v224
v_exp_f32 v45, v225
s_nop 0
v_cvt_pk_bf16_f32 v244, v44, v45
v_add_f32 v53, v53, v44
v_add_f32 v53, v53, v45
v_exp_f32 v46, v226
v_exp_f32 v47, v227
s_nop 0
v_cvt_pk_bf16_f32 v245, v46, v47
v_add_f32 v53, v53, v46
v_add_f32 v53, v53, v47
v_exp_f32 v48, v228
v_exp_f32 v49, v229
s_nop 0
v_cvt_pk_bf16_f32 v246, v48, v49
v_add_f32 v53, v53, v48
v_add_f32 v53, v53, v49
v_exp_f32 v50, v230
v_exp_f32 v51, v231
s_nop 0
v_cvt_pk_bf16_f32 v247, v50, v51
v_add_f32 v53, v53, v50
v_add_f32 v53, v53, v51
s_nop 1
s_branch L_ret7
L_k1_kernel_end:
s_endpgm
.globl k2_kernel
.p2align 8
.type k2_kernel,@function
k2_kernel:
s_cmp_ge_u32 s2, 256
s_cbranch_scc1 L_k2_kernel_end
s_load_dwordx2 s[4:5], s[0:1], 32
s_mov_b32 s6, 0x480000
s_mov_b32 s7, 0x00020000
s_load_dwordx2 s[12:13], s[0:1], 104
s_mov_b32 s14, 0x10000000
s_mov_b32 s15, 0x00020000
s_and_b32 s16, s2, 3
s_bfe_u32 s17, s2, 0x10002
s_lshr_b32 s18, s2, 3
s_and_b32 s19, s18, 3
s_lshr_b32 s18, s18, 2
s_lshl_b32 s17, s17, 3
s_add_u32 s17, s17, s18
v_lshrrev_b32 v1, 6, v0
v_and_b32 v2, 63, v0
v_readfirstlane_b32 s20, v1
s_lshl_b32 s21, s17, 2
s_nop 0
s_cmp_lt_u32 s20, 4
s_cbranch_scc1 L_k2_kernel_cons
s_and_b32 s20, s20, 3
s_add_u32 s21, s21, s20
s_lshl_b32 s30, s20, 10
s_lshl_b32 s29, s20, 12
s_mul_i32 s31, s16, 1179648
s_mul_i32 s22, s19, 288
s_add_u32 s31, s31, s22
s_mul_i32 s32, s21, 262144
s_mul_i32 s22, s16, 65536
s_add_u32 s32, s32, s22
s_add_u32 s32, s32, 20971520
s_add_u32 s37, s31, 1179648
s_add_u32 s38, s32, 65536
s_mul_i32 s34, s19, 294912
s_add_u32 s34, s34, s31
s_mul_i32 s35, s19, 16384
s_add_u32 s35, s35, s32
v_and_b32 v3, 255, v0
v_lshlrev_b32 v19, 4, v2
v_add_u32 v4, 0, v3
v_min_u32 v4, 1151, v4
v_mul_u32_u24 v5, 3641, v4
v_lshrrev_b32 v5, 16, v5
v_mul_u32_u24 v6, 18, v5
v_sub_u32 v6, v4, v6
v_and_b32 v7, 0x73, v5
v_and_b32 v8, 4, v5
v_lshl_or_b32 v7, v8, 1, v7
v_and_b32 v8, 8, v5
v_lshrrev_b32 v8, 1, v8
v_or_b32 v7, v7, v8
v_mul_u32_u24 v7, 1152, v7
v_lshl_add_u32 v10, v6, 4, v7
v_add_u32 v4, 256, v3
v_min_u32 v4, 1151, v4
v_mul_u32_u24 v5, 3641, v4
v_lshrrev_b32 v5, 16, v5
v_mul_u32_u24 v6, 18, v5
v_sub_u32 v6, v4, v6
v_and_b32 v7, 0x73, v5
v_and_b32 v8, 4, v5
v_lshl_or_b32 v7, v8, 1, v7
v_and_b32 v8, 8, v5
v_lshrrev_b32 v8, 1, v8
v_or_b32 v7, v7, v8
v_mul_u32_u24 v7, 1152, v7
v_lshl_add_u32 v11, v6, 4, v7
v_add_u32 v4, 512, v3
v_min_u32 v4, 1151, v4
v_mul_u32_u24 v5, 3641, v4
v_lshrrev_b32 v5, 16, v5
v_mul_u32_u24 v6, 18, v5
v_sub_u32 v6, v4, v6
v_and_b32 v7, 0x73, v5
v_and_b32 v8, 4, v5
v_lshl_or_b32 v7, v8, 1, v7
v_and_b32 v8, 8, v5
v_lshrrev_b32 v8, 1, v8
v_or_b32 v7, v7, v8
v_mul_u32_u24 v7, 1152, v7
v_lshl_add_u32 v12, v6, 4, v7
v_add_u32 v4, 768, v3
v_min_u32 v4, 1151, v4
v_mul_u32_u24 v5, 3641, v4
v_lshrrev_b32 v5, 16, v5
v_mul_u32_u24 v6, 18, v5
v_sub_u32 v6, v4, v6
v_and_b32 v7, 0x73, v5
v_and_b32 v8, 4, v5
v_lshl_or_b32 v7, v8, 1, v7
v_and_b32 v8, 8, v5
v_lshrrev_b32 v8, 1, v8
v_or_b32 v7, v7, v8
v_mul_u32_u24 v7, 1152, v7
v_lshl_add_u32 v13, v6, 4, v7
v_add_u32 v4, 1024, v3
v_min_u32 v4, 1151, v4
v_mul_u32_u24 v5, 3641, v4
v_lshrrev_b32 v5, 16, v5
v_mul_u32_u24 v6, 18, v5
v_sub_u32 v6, v4, v6
v_and_b32 v7, 0x73, v5
v_and_b32 v8, 4, v5
v_lshl_or_b32 v7, v8, 1, v7
v_and_b32 v8, 8, v5
v_lshrrev_b32 v8, 1, v8
v_or_b32 v7, v7, v8
v_mul_u32_u24 v7, 1152, v7
v_lshl_add_u32 v14, v6, 4, v7
s_waitcnt lgkmcnt(0)
s_add_u32 m0, s30, 0
s_nop 0
buffer_load_dwordx4 v10, s[4:7], s34 offen lds
s_add_u32 m0, s30, 4096
s_nop 0
buffer_load_dwordx4 v11, s[4:7], s34 offen lds
s_add_u32 m0, s30, 8192
s_nop 0
buffer_load_dwordx4 v12, s[4:7], s34 offen lds
s_add_u32 m0, s30, 12288
s_nop 0
buffer_load_dwordx4 v13, s[4:7], s34 offen lds
s_add_u32 m0, s30, 16384
s_nop 0
buffer_load_dwordx4 v14, s[4:7], s34 offen lds
s_add_u32 m0, s29, 20480
s_nop 0
buffer_load_dwordx4 v19, s[12:15], s35 offen offset:0 lds
buffer_load_dwordx4 v19, s[12:15], s35 offen offset:1024 lds
buffer_load_dwordx4 v19, s[12:15], s35 offen offset:2048 lds
buffer_load_dwordx4 v19, s[12:15], s35 offen offset:3072 lds
s_add_u32 s34, s34, 73728
s_cmp_eq_u32 s34, s37
s_cselect_b32 s34, s31, s34
s_add_u32 s35, s35, 4096
s_cmp_eq_u32 s35, s38
s_cselect_b32 s35, s32, s35
s_add_u32 m0, s30, 36864
s_nop 0
buffer_load_dwordx4 v10, s[4:7], s34 offen lds
s_add_u32 m0, s30, 40960
s_nop 0
buffer_load_dwordx4 v11, s[4:7], s34 offen lds
s_add_u32 m0, s30, 45056
s_nop 0
buffer_load_dwordx4 v12, s[4:7], s34 offen lds
s_add_u32 m0, s30, 49152
s_nop 0
buffer_load_dwordx4 v13, s[4:7], s34 offen lds
s_add_u32 m0, s30, 53248
s_nop 0
buffer_load_dwordx4 v14, s[4:7], s34 offen lds
s_add_u32 m0, s29, 57344
s_nop 0
buffer_load_dwordx4 v19, s[12:15], s35 offen offset:0 lds
buffer_load_dwordx4 v19, s[12:15], s35 offen offset:1024 lds
buffer_load_dwordx4 v19, s[12:15], s35 offen offset:2048 lds
buffer_load_dwordx4 v19, s[12:15], s35 offen offset:3072 lds
s_waitcnt vmcnt(9)
s_barrier
s_add_u32 s34, s34, 73728
s_cmp_eq_u32 s34, s37
s_cselect_b32 s34, s31, s34
s_add_u32 s35, s35, 4096
s_cmp_eq_u32 s35, s38
s_cselect_b32 s35, s32, s35
s_add_u32 m0, s30, 73728
s_nop 0
buffer_load_dwordx4 v10, s[4:7], s34 offen lds
s_add_u32 m0, s30, 77824
s_nop 0
buffer_load_dwordx4 v11, s[4:7], s34 offen lds
s_add_u32 m0, s30, 81920
s_nop 0
buffer_load_dwordx4 v12, s[4:7], s34 offen lds
s_add_u32 m0, s30, 86016
s_nop 0
buffer_load_dwordx4 v13, s[4:7], s34 offen lds
s_add_u32 m0, s30, 90112
s_nop 0
buffer_load_dwordx4 v14, s[4:7], s34 offen lds
s_add_u32 m0, s29, 94208
s_nop 0
buffer_load_dwordx4 v19, s[12:15], s35 offen offset:0 lds
buffer_load_dwordx4 v19, s[12:15], s35 offen offset:1024 lds
buffer_load_dwordx4 v19, s[12:15], s35 offen offset:2048 lds
buffer_load_dwordx4 v19, s[12:15], s35 offen offset:3072 lds
s_add_u32 s34, s34, 73728
s_cmp_eq_u32 s34, s37
s_cselect_b32 s34, s31, s34
s_add_u32 s35, s35, 4096
s_cmp_eq_u32 s35, s38
s_cselect_b32 s35, s32, s35
s_add_u32 m0, s30, 110592
s_nop 0
buffer_load_dwordx4 v10, s[4:7], s34 offen lds
s_add_u32 m0, s30, 114688
s_nop 0
buffer_load_dwordx4 v11, s[4:7], s34 offen lds
s_add_u32 m0, s30, 118784
s_nop 0
buffer_load_dwordx4 v12, s[4:7], s34 offen lds
s_add_u32 m0, s30, 122880
s_nop 0
buffer_load_dwordx4 v13, s[4:7], s34 offen lds
s_add_u32 m0, s30, 126976
s_nop 0
buffer_load_dwordx4 v14, s[4:7], s34 offen lds
s_add_u32 m0, s29, 131072
s_nop 0
buffer_load_dwordx4 v19, s[12:15], s35 offen offset:0 lds
buffer_load_dwordx4 v19, s[12:15], s35 offen offset:1024 lds
buffer_load_dwordx4 v19, s[12:15], s35 offen offset:2048 lds
buffer_load_dwordx4 v19, s[12:15], s35 offen offset:3072 lds
s_waitcnt vmcnt(18)
s_barrier
s_add_u32 s34, s34, 73728
s_cmp_eq_u32 s34, s37
s_cselect_b32 s34, s31, s34
s_add_u32 s35, s35, 4096
s_cmp_eq_u32 s35, s38
s_cselect_b32 s35, s32, s35
s_add_u32 m0, s30, 0
s_nop 0
buffer_load_dwordx4 v10, s[4:7], s34 offen lds
s_add_u32 m0, s30, 4096
s_nop 0
buffer_load_dwordx4 v11, s[4:7], s34 offen lds
s_add_u32 m0, s30, 8192
s_nop 0
buffer_load_dwordx4 v12, s[4:7], s34 offen lds
s_add_u32 m0, s30, 12288
s_nop 0
buffer_load_dwordx4 v13, s[4:7], s34 offen lds
s_add_u32 m0, s30, 16384
s_nop 0
buffer_load_dwordx4 v14, s[4:7], s34 offen lds
s_add_u32 m0, s29, 20480
s_nop 0
buffer_load_dwordx4 v19, s[12:15], s35 offen offset:0 lds
buffer_load_dwordx4 v19, s[12:15], s35 offen offset:1024 lds
buffer_load_dwordx4 v19, s[12:15], s35 offen offset:2048 lds
buffer_load_dwordx4 v19, s[12:15], s35 offen offset:3072 lds
s_waitcnt vmcnt(18)
s_barrier
s_add_u32 s34, s34, 73728
s_cmp_eq_u32 s34, s37
s_cselect_b32 s34, s31, s34
s_add_u32 s35, s35, 4096
s_cmp_eq_u32 s35, s38
s_cselect_b32 s35, s32, s35
s_add_u32 m0, s30, 36864
s_nop 0
buffer_load_dwordx4 v10, s[4:7], s34 offen lds
s_add_u32 m0, s30, 40960
s_nop 0
buffer_load_dwordx4 v11, s[4:7], s34 offen lds
s_add_u32 m0, s30, 45056
s_nop 0
buffer_load_dwordx4 v12, s[4:7], s34 offen lds
s_add_u32 m0, s30, 49152
s_nop 0
buffer_load_dwordx4 v13, s[4:7], s34 offen lds
s_add_u32 m0, s30, 53248
s_nop 0
buffer_load_dwordx4 v14, s[4:7], s34 offen lds
s_add_u32 m0, s29, 57344
s_nop 0
buffer_load_dwordx4 v19, s[12:15], s35 offen offset:0 lds
buffer_load_dwordx4 v19, s[12:15], s35 offen offset:1024 lds
buffer_load_dwordx4 v19, s[12:15], s35 offen offset:2048 lds
buffer_load_dwordx4 v19, s[12:15], s35 offen offset:3072 lds
s_waitcnt vmcnt(18)
s_barrier
s_add_u32 s34, s34, 73728
s_cmp_eq_u32 s34, s37
s_cselect_b32 s34, s31, s34
s_add_u32 s35, s35, 4096
s_cmp_eq_u32 s35, s38
s_cselect_b32 s35, s32, s35
s_add_u32 m0, s30, 73728
s_nop 0
buffer_load_dwordx4 v10, s[4:7], s34 offen lds
s_add_u32 m0, s30, 77824
s_nop 0
buffer_load_dwordx4 v11, s[4:7], s34 offen lds
s_add_u32 m0, s30, 81920
s_nop 0
buffer_load_dwordx4 v12, s[4:7], s34 offen lds
s_add_u32 m0, s30, 86016
s_nop 0
buffer_load_dwordx4 v13, s[4:7], s34 offen lds
s_add_u32 m0, s30, 90112
s_nop 0
buffer_load_dwordx4 v14, s[4:7], s34 offen lds
s_add_u32 m0, s29, 94208
s_nop 0
buffer_load_dwordx4 v19, s[12:15], s35 offen offset:0 lds
buffer_load_dwordx4 v19, s[12:15], s35 offen offset:1024 lds
buffer_load_dwordx4 v19, s[12:15], s35 offen offset:2048 lds
buffer_load_dwordx4 v19, s[12:15], s35 offen offset:3072 lds
s_waitcnt vmcnt(18)
s_barrier
s_add_u32 s34, s34, 73728
s_cmp_eq_u32 s34, s37
s_cselect_b32 s34, s31, s34
s_add_u32 s35, s35, 4096
s_cmp_eq_u32 s35, s38
s_cselect_b32 s35, s32, s35
s_add_u32 m0, s30, 110592
s_nop 0
buffer_load_dwordx4 v10, s[4:7], s34 offen lds
s_add_u32 m0, s30, 114688
s_nop 0
buffer_load_dwordx4 v11, s[4:7], s34 offen lds
s_add_u32 m0, s30, 118784
s_nop 0
buffer_load_dwordx4 v12, s[4:7], s34 offen lds
s_add_u32 m0, s30, 122880
s_nop 0
buffer_load_dwordx4 v13, s[4:7], s34 offen lds
s_add_u32 m0, s30, 126976
s_nop 0
buffer_load_dwordx4 v14, s[4:7], s34 offen lds
s_add_u32 m0, s29, 131072
s_nop 0
buffer_load_dwordx4 v19, s[12:15], s35 offen offset:0 lds
buffer_load_dwordx4 v19, s[12:15], s35 offen offset:1024 lds
buffer_load_dwordx4 v19, s[12:15], s35 offen offset:2048 lds
buffer_load_dwordx4 v19, s[12:15], s35 offen offset:3072 lds
s_waitcnt vmcnt(18)
s_barrier
s_add_u32 s34, s34, 73728
s_cmp_eq_u32 s34, s37
s_cselect_b32 s34, s31, s34
s_add_u32 s35, s35, 4096
s_cmp_eq_u32 s35, s38
s_cselect_b32 s35, s32, s35
s_add_u32 m0, s30, 0
s_nop 0
buffer_load_dwordx4 v10, s[4:7], s34 offen lds
s_add_u32 m0, s30, 4096
s_nop 0
buffer_load_dwordx4 v11, s[4:7], s34 offen lds
s_add_u32 m0, s30, 8192
s_nop 0
buffer_load_dwordx4 v12, s[4:7], s34 offen lds
s_add_u32 m0, s30, 12288
s_nop 0
buffer_load_dwordx4 v13, s[4:7], s34 offen lds
s_add_u32 m0, s30, 16384
s_nop 0
buffer_load_dwordx4 v14, s[4:7], s34 offen lds
s_add_u32 m0, s29, 20480
s_nop 0
buffer_load_dwordx4 v19, s[12:15], s35 offen offset:0 lds
buffer_load_dwordx4 v19, s[12:15], s35 offen offset:1024 lds
buffer_load_dwordx4 v19, s[12:15], s35 offen offset:2048 lds
buffer_load_dwordx4 v19, s[12:15], s35 offen offset:3072 lds
s_waitcnt vmcnt(18)
s_barrier
s_add_u32 s34, s34, 73728
s_cmp_eq_u32 s34, s37
s_cselect_b32 s34, s31, s34
s_add_u32 s35, s35, 4096
s_cmp_eq_u32 s35, s38
s_cselect_b32 s35, s32, s35
s_add_u32 m0, s30, 36864
s_nop 0
buffer_load_dwordx4 v10, s[4:7], s34 offen lds
s_add_u32 m0, s30, 40960
s_nop 0
buffer_load_dwordx4 v11, s[4:7], s34 offen lds
s_add_u32 m0, s30, 45056
s_nop 0
buffer_load_dwordx4 v12, s[4:7], s34 offen lds
s_add_u32 m0, s30, 49152
s_nop 0
buffer_load_dwordx4 v13, s[4:7], s34 offen lds
s_add_u32 m0, s30, 53248
s_nop 0
buffer_load_dwordx4 v14, s[4:7], s34 offen lds
s_add_u32 m0, s29, 57344
s_nop 0
buffer_load_dwordx4 v19, s[12:15], s35 offen offset:0 lds
buffer_load_dwordx4 v19, s[12:15], s35 offen offset:1024 lds
buffer_load_dwordx4 v19, s[12:15], s35 offen offset:2048 lds
buffer_load_dwordx4 v19, s[12:15], s35 offen offset:3072 lds
s_waitcnt vmcnt(18)
s_barrier
s_add_u32 s34, s34, 73728
s_cmp_eq_u32 s34, s37
s_cselect_b32 s34, s31, s34
s_add_u32 s35, s35, 4096
s_cmp_eq_u32 s35, s38
s_cselect_b32 s35, s32, s35
s_add_u32 m0, s30, 73728
s_nop 0
buffer_load_dwordx4 v10, s[4:7], s34 offen lds
s_add_u32 m0, s30, 77824
s_nop 0
buffer_load_dwordx4 v11, s[4:7], s34 offen lds
s_add_u32 m0, s30, 81920
s_nop 0
buffer_load_dwordx4 v12, s[4:7], s34 offen lds
s_add_u32 m0, s30, 86016
s_nop 0
buffer_load_dwordx4 v13, s[4:7], s34 offen lds
s_add_u32 m0, s30, 90112
s_nop 0
buffer_load_dwordx4 v14, s[4:7], s34 offen lds
s_add_u32 m0, s29, 94208
s_nop 0
buffer_load_dwordx4 v19, s[12:15], s35 offen offset:0 lds
buffer_load_dwordx4 v19, s[12:15], s35 offen offset:1024 lds
buffer_load_dwordx4 v19, s[12:15], s35 offen offset:2048 lds
buffer_load_dwordx4 v19, s[12:15], s35 offen offset:3072 lds
s_waitcnt vmcnt(18)
s_barrier
s_add_u32 s34, s34, 73728
s_cmp_eq_u32 s34, s37
s_cselect_b32 s34, s31, s34
s_add_u32 s35, s35, 4096
s_cmp_eq_u32 s35, s38
s_cselect_b32 s35, s32, s35
s_add_u32 m0, s30, 110592
s_nop 0
buffer_load_dwordx4 v10, s[4:7], s34 offen lds
s_add_u32 m0, s30, 114688
s_nop 0
buffer_load_dwordx4 v11, s[4:7], s34 offen lds
s_add_u32 m0, s30, 118784
s_nop 0
buffer_load_dwordx4 v12, s[4:7], s34 offen lds
s_add_u32 m0, s30, 122880
s_nop 0
buffer_load_dwordx4 v13, s[4:7], s34 offen lds
s_add_u32 m0, s30, 126976
s_nop 0
buffer_load_dwordx4 v14, s[4:7], s34 offen lds
s_add_u32 m0, s29, 131072
s_nop 0
buffer_load_dwordx4 v19, s[12:15], s35 offen offset:0 lds
buffer_load_dwordx4 v19, s[12:15], s35 offen offset:1024 lds
buffer_load_dwordx4 v19, s[12:15], s35 offen offset:2048 lds
buffer_load_dwordx4 v19, s[12:15], s35 offen offset:3072 lds
s_waitcnt vmcnt(18)
s_barrier
s_add_u32 s34, s34, 73728
s_cmp_eq_u32 s34, s37
s_cselect_b32 s34, s31, s34
s_add_u32 s35, s35, 4096
s_cmp_eq_u32 s35, s38
s_cselect_b32 s35, s32, s35
s_add_u32 m0, s30, 0
s_nop 0
buffer_load_dwordx4 v10, s[4:7], s34 offen lds
s_add_u32 m0, s30, 4096
s_nop 0
buffer_load_dwordx4 v11, s[4:7], s34 offen lds
s_add_u32 m0, s30, 8192
s_nop 0
buffer_load_dwordx4 v12, s[4:7], s34 offen lds
s_add_u32 m0, s30, 12288
s_nop 0
buffer_load_dwordx4 v13, s[4:7], s34 offen lds
s_add_u32 m0, s30, 16384
s_nop 0
buffer_load_dwordx4 v14, s[4:7], s34 offen lds
s_add_u32 m0, s29, 20480
s_nop 0
buffer_load_dwordx4 v19, s[12:15], s35 offen offset:0 lds
buffer_load_dwordx4 v19, s[12:15], s35 offen offset:1024 lds
buffer_load_dwordx4 v19, s[12:15], s35 offen offset:2048 lds
buffer_load_dwordx4 v19, s[12:15], s35 offen offset:3072 lds
s_waitcnt vmcnt(18)
s_barrier
s_add_u32 s34, s34, 73728
s_cmp_eq_u32 s34, s37
s_cselect_b32 s34, s31, s34
s_add_u32 s35, s35, 4096
s_cmp_eq_u32 s35, s38
s_cselect_b32 s35, s32, s35
s_add_u32 m0, s30, 36864
s_nop 0
buffer_load_dwordx4 v10, s[4:7], s34 offen lds
s_add_u32 m0, s30, 40960
s_nop 0
buffer_load_dwordx4 v11, s[4:7], s34 offen lds
s_add_u32 m0, s30, 45056
s_nop 0
buffer_load_dwordx4 v12, s[4:7], s34 offen lds
s_add_u32 m0, s30, 49152
s_nop 0
buffer_load_dwordx4 v13, s[4:7], s34 offen lds
s_add_u32 m0, s30, 53248
s_nop 0
buffer_load_dwordx4 v14, s[4:7], s34 offen lds
s_add_u32 m0, s29, 57344
s_nop 0
buffer_load_dwordx4 v19, s[12:15], s35 offen offset:0 lds
buffer_load_dwordx4 v19, s[12:15], s35 offen offset:1024 lds
buffer_load_dwordx4 v19, s[12:15], s35 offen offset:2048 lds
buffer_load_dwordx4 v19, s[12:15], s35 offen offset:3072 lds
s_waitcnt vmcnt(18)
s_barrier
s_add_u32 s34, s34, 73728
s_cmp_eq_u32 s34, s37
s_cselect_b32 s34, s31, s34
s_add_u32 s35, s35, 4096
s_cmp_eq_u32 s35, s38
s_cselect_b32 s35, s32, s35
s_add_u32 m0, s30, 73728
s_nop 0
buffer_load_dwordx4 v10, s[4:7], s34 offen lds
s_add_u32 m0, s30, 77824
s_nop 0
buffer_load_dwordx4 v11, s[4:7], s34 offen lds
s_add_u32 m0, s30, 81920
s_nop 0
buffer_load_dwordx4 v12, s[4:7], s34 offen lds
s_add_u32 m0, s30, 86016
s_nop 0
buffer_load_dwordx4 v13, s[4:7], s34 offen lds
s_add_u32 m0, s30, 90112
s_nop 0
buffer_load_dwordx4 v14, s[4:7], s34 offen lds
s_add_u32 m0, s29, 94208
s_nop 0
buffer_load_dwordx4 v19, s[12:15], s35 offen offset:0 lds
buffer_load_dwordx4 v19, s[12:15], s35 offen offset:1024 lds
buffer_load_dwordx4 v19, s[12:15], s35 offen offset:2048 lds
buffer_load_dwordx4 v19, s[12:15], s35 offen offset:3072 lds
s_waitcnt vmcnt(18)
s_barrier
s_add_u32 s34, s34, 73728
s_cmp_eq_u32 s34, s37
s_cselect_b32 s34, s31, s34
s_add_u32 s35, s35, 4096
s_cmp_eq_u32 s35, s38
s_cselect_b32 s35, s32, s35
s_add_u32 m0, s30, 110592
s_nop 0
buffer_load_dwordx4 v10, s[4:7], s34 offen lds
s_add_u32 m0, s30, 114688
s_nop 0
buffer_load_dwordx4 v11, s[4:7], s34 offen lds
s_add_u32 m0, s30, 118784
s_nop 0
buffer_load_dwordx4 v12, s[4:7], s34 offen lds
s_add_u32 m0, s30, 122880
s_nop 0
buffer_load_dwordx4 v13, s[4:7], s34 offen lds
s_add_u32 m0, s30, 126976
s_nop 0
buffer_load_dwordx4 v14, s[4:7], s34 offen lds
s_add_u32 m0, s29, 131072
s_nop 0
buffer_load_dwordx4 v19, s[12:15], s35 offen offset:0 lds
buffer_load_dwordx4 v19, s[12:15], s35 offen offset:1024 lds
buffer_load_dwordx4 v19, s[12:15], s35 offen offset:2048 lds
buffer_load_dwordx4 v19, s[12:15], s35 offen offset:3072 lds
s_waitcnt vmcnt(18)
s_barrier
s_waitcnt vmcnt(9)
s_barrier
s_waitcnt vmcnt(0)
s_barrier
s_waitcnt vmcnt(0)
s_endpgm
L_k2_kernel_cons:
s_add_u32 s21, s21, s20
s_mul_i32 s33, s21, 36864
s_mul_i32 s22, s19, 9216
s_add_u32 s33, s33, s22
s_mul_i32 s22, s16, 2359296
s_add_u32 s33, s33, s22
s_add_u32 s33, s33, 8388608
v_lshrrev_b32 v4, 4, v2
v_and_b32 v5, 15, v2
v_lshlrev_b32 v5, 4, v5
v_lshl_add_u32 v19, v4, 9, v5
v_lshl_add_u32 v19, v1, 12, v19
v_add_u32 v25, 20480, v19
v_add_u32 v26, 94208, v19
v_lshrrev_b32 v6, 1, v4
v_lshl_add_u32 v24, v6, 9, v5
v_and_b32 v7, 1, v4
v_lshl_add_u32 v24, v7, 3, v24
v_bfe_u32 v8, v2, 2, 2
v_lshl_add_u32 v8, v7, 2, v8
v_lshl_add_u32 v8, v6, 4, v8
v_mul_u32_u24 v8, 288, v8
v_and_b32 v9, 3, v2
v_lshl_add_u32 v20, v9, 3, v8
v_add_u32 v21, 73728, v20
s_waitcnt lgkmcnt(0)
s_load_dwordx2 s[24:25], s[0:1], 48
s_load_dwordx2 s[28:29], s[0:1], 56
s_mov_b32 s26, 576*9216
s_mov_b32 s27, 0x00020000
v_mul_u32_u24 v10, 57, v2
v_lshrrev_b32 v10, 9, v10
v_mul_u32_u24 v11, 9, v10
v_sub_u32 v11, v2, v11
v_min_u32 v12, 1, v10
v_mul_u32_u24 v10, 9216, v10
v_lshl_add_u32 v10, v11, 7, v10
v_add_u32 v12, 7, v12
v_mul_u32_u24 v12, 9216, v12
v_lshl_add_u32 v12, v11, 7, v12
s_and_b32 s40, s2, 7
s_mul_i32 s40, s40, 1152
s_lshr_b32 s41, s2, 3
s_lshl_b32 s41, s41, 1
s_and_b32 s42, s20, 1
s_add_u32 s41, s41, s42
s_mul_i32 s41, s41, 9*9216
s_add_u32 s40, s40, s41
s_waitcnt lgkmcnt(0)
s_cmp_lt_u32 s20, 2
s_cselect_b32 s24, s24, s28
s_cselect_b32 s25, s25, s29
s_barrier
ds_read_b128 v[176:179], v25 offset:0
ds_read_b128 v[180:183], v25 offset:256
ds_read_b64_tr_b16 v[32:33], v20 offset:0
ds_read_b64_tr_b16 v[34:35], v20 offset:2304
ds_read_b64_tr_b16 v[36:37], v20 offset:32
ds_read_b64_tr_b16 v[38:39], v20 offset:2336
ds_read_b64_tr_b16 v[40:41], v20 offset:64
ds_read_b64_tr_b16 v[42:43], v20 offset:2368
ds_read_b64_tr_b16 v[44:45], v20 offset:96
ds_read_b64_tr_b16 v[46:47], v20 offset:2400
ds_read_b64_tr_b16 v[48:49], v20 offset:128
ds_read_b64_tr_b16 v[50:51], v20 offset:2432
ds_read_b64_tr_b16 v[52:53], v20 offset:160
ds_read_b64_tr_b16 v[54:55], v20 offset:2464
ds_read_b64_tr_b16 v[56:57], v20 offset:192
ds_read_b64_tr_b16 v[58:59], v20 offset:2496
ds_read_b64_tr_b16 v[60:61], v20 offset:224
ds_read_b64_tr_b16 v[62:63], v20 offset:2528
ds_read_b64_tr_b16 v[64:65], v20 offset:256
ds_read_b64_tr_b16 v[66:67], v20 offset:2560
s_waitcnt lgkmcnt(15)
v_mfma_f32_16x16x32_bf16 v[104:107], v[32:35], v[176:179], 0
ds_read_b128 v[184:187], v25 offset:2048
ds_read_b128 v[188:191], v25 offset:2304
v_mfma_f32_16x16x32_bf16 v[140:143], v[32:35], v[180:183], 0
ds_read_b64_tr_b16 v[68:69], v20 offset:9216
ds_read_b64_tr_b16 v[70:71], v20 offset:11520
s_waitcnt lgkmcnt(15)
v_mfma_f32_16x16x32_bf16 v[108:111], v[36:39], v[176:179], 0
ds_read_b64_tr_b16 v[72:73], v20 offset:9248
ds_read_b64_tr_b16 v[74:75], v20 offset:11552
v_mfma_f32_16x16x32_bf16 v[144:147], v[36:39], v[180:183], 0
ds_read_b64_tr_b16 v[76:77], v20 offset:9280
ds_read_b64_tr_b16 v[78:79], v20 offset:11584
v_mfma_f32_16x16x32_bf16 v[112:115], v[40:43], v[176:179], 0
ds_read_b64_tr_b16 v[80:81], v20 offset:9312
ds_read_b64_tr_b16 v[82:83], v20 offset:11616
v_mfma_f32_16x16x32_bf16 v[148:151], v[40:43], v[180:183], 0
ds_read_b64_tr_b16 v[84:85], v20 offset:9344
ds_read_b64_tr_b16 v[86:87], v20 offset:11648
s_waitcnt lgkmcnt(15)
v_mfma_f32_16x16x32_bf16 v[116:119], v[44:47], v[176:179], 0
ds_read_b64_tr_b16 v[88:89], v20 offset:9376
ds_read_b64_tr_b16 v[90:91], v20 offset:11680
v_mfma_f32_16x16x32_bf16 v[152:155], v[44:47], v[180:183], 0
ds_read_b64_tr_b16 v[92:93], v20 offset:9408
ds_read_b64_tr_b16 v[94:95], v20 offset:11712
v_mfma_f32_16x16x32_bf16 v[120:123], v[48:51], v[176:179], 0
ds_read_b64_tr_b16 v[96:97], v20 offset:9440
ds_read_b64_tr_b16 v[98:99], v20 offset:11744
v_mfma_f32_16x16x32_bf16 v[156:159], v[48:51], v[180:183], 0
ds_read_b64_tr_b16 v[100:101], v20 offset:9472
ds_read_b64_tr_b16 v[102:103], v20 offset:11776
v_mfma_f32_16x16x32_bf16 v[124:127], v[52:55], v[176:179], 0
v_mfma_f32_16x16x32_bf16 v[160:163], v[52:55], v[180:183], 0
v_mfma_f32_16x16x32_bf16 v[128:131], v[56:59], v[176:179], 0
v_mfma_f32_16x16x32_bf16 v[164:167], v[56:59], v[180:183], 0
s_waitcnt lgkmcnt(15)
v_mfma_f32_16x16x32_bf16 v[132:135], v[60:63], v[176:179], 0
v_mfma_f32_16x16x32_bf16 v[168:171], v[60:63], v[180:183], 0
v_mfma_f32_16x16x32_bf16 v[136:139], v[64:67], v[176:179], 0
v_mfma_f32_16x16x32_bf16 v[172:175], v[64:67], v[180:183], 0
s_barrier
v_mfma_f32_16x16x32_bf16 v[104:107], v[68:71], v[184:187], v[104:107]
ds_read_b128 v[176:179], v25 offset:36864
ds_read_b128 v[180:183], v25 offset:37120
v_mfma_f32_16x16x32_bf16 v[140:143], v[68:71], v[188:191], v[140:143]
ds_read_b64_tr_b16 v[32:33], v20 offset:36864
ds_read_b64_tr_b16 v[34:35], v20 offset:39168
s_waitcnt lgkmcnt(15)
v_mfma_f32_16x16x32_bf16 v[108:111], v[72:75], v[184:187], v[108:111]
ds_read_b64_tr_b16 v[36:37], v20 offset:36896
ds_read_b64_tr_b16 v[38:39], v20 offset:39200
v_mfma_f32_16x16x32_bf16 v[144:147], v[72:75], v[188:191], v[144:147]
ds_read_b64_tr_b16 v[40:41], v20 offset:36928
ds_read_b64_tr_b16 v[42:43], v20 offset:39232
v_mfma_f32_16x16x32_bf16 v[112:115], v[76:79], v[184:187], v[112:115]
ds_read_b64_tr_b16 v[44:45], v20 offset:36960
ds_read_b64_tr_b16 v[46:47], v20 offset:39264
v_mfma_f32_16x16x32_bf16 v[148:151], v[76:79], v[188:191], v[148:151]
ds_read_b64_tr_b16 v[48:49], v20 offset:36992
ds_read_b64_tr_b16 v[50:51], v20 offset:39296
s_waitcnt lgkmcnt(15)
v_mfma_f32_16x16x32_bf16 v[116:119], v[80:83], v[184:187], v[116:119]
ds_read_b64_tr_b16 v[52:53], v20 offset:37024
ds_read_b64_tr_b16 v[54:55], v20 offset:39328
v_mfma_f32_16x16x32_bf16 v[152:155], v[80:83], v[188:191], v[152:155]
ds_read_b64_tr_b16 v[56:57], v20 offset:37056
ds_read_b64_tr_b16 v[58:59], v20 offset:39360
v_mfma_f32_16x16x32_bf16 v[120:123], v[84:87], v[184:187], v[120:123]
ds_read_b64_tr_b16 v[60:61], v20 offset:37088
ds_read_b64_tr_b16 v[62:63], v20 offset:39392
v_mfma_f32_16x16x32_bf16 v[156:159], v[84:87], v[188:191], v[156:159]
ds_read_b64_tr_b16 v[64:65], v20 offset:37120
ds_read_b64_tr_b16 v[66:67], v20 offset:39424
v_mfma_f32_16x16x32_bf16 v[124:127], v[88:91], v[184:187], v[124:127]
v_mfma_f32_16x16x32_bf16 v[160:163], v[88:91], v[188:191], v[160:163]
v_mfma_f32_16x16x32_bf16 v[128:131], v[92:95], v[184:187], v[128:131]
v_mfma_f32_16x16x32_bf16 v[164:167], v[92:95], v[188:191], v[164:167]
s_waitcnt lgkmcnt(15)
v_mfma_f32_16x16x32_bf16 v[132:135], v[96:99], v[184:187], v[132:135]
v_mfma_f32_16x16x32_bf16 v[168:171], v[96:99], v[188:191], v[168:171]
v_mfma_f32_16x16x32_bf16 v[136:139], v[100:103], v[184:187], v[136:139]
v_mfma_f32_16x16x32_bf16 v[172:175], v[100:103], v[188:191], v[172:175]
v_mfma_f32_16x16x32_bf16 v[104:107], v[32:35], v[176:179], v[104:107]
ds_read_b128 v[184:187], v25 offset:38912
ds_read_b128 v[188:191], v25 offset:39168
v_mfma_f32_16x16x32_bf16 v[140:143], v[32:35], v[180:183], v[140:143]
ds_read_b64_tr_b16 v[68:69], v20 offset:46080
ds_read_b64_tr_b16 v[70:71], v20 offset:48384
s_waitcnt lgkmcnt(15)
v_mfma_f32_16x16x32_bf16 v[108:111], v[36:39], v[176:179], v[108:111]
ds_read_b64_tr_b16 v[72:73], v20 offset:46112
ds_read_b64_tr_b16 v[74:75], v20 offset:48416
v_mfma_f32_16x16x32_bf16 v[144:147], v[36:39], v[180:183], v[144:147]
ds_read_b64_tr_b16 v[76:77], v20 offset:46144
ds_read_b64_tr_b16 v[78:79], v20 offset:48448
v_mfma_f32_16x16x32_bf16 v[112:115], v[40:43], v[176:179], v[112:115]
ds_read_b64_tr_b16 v[80:81], v20 offset:46176
ds_read_b64_tr_b16 v[82:83], v20 offset:48480
v_mfma_f32_16x16x32_bf16 v[148:151], v[40:43], v[180:183], v[148:151]
ds_read_b64_tr_b16 v[84:85], v20 offset:46208
ds_read_b64_tr_b16 v[86:87], v20 offset:48512
s_waitcnt lgkmcnt(15)
v_mfma_f32_16x16x32_bf16 v[116:119], v[44:47], v[176:179], v[116:119]
ds_read_b64_tr_b16 v[88:89], v20 offset:46240
ds_read_b64_tr_b16 v[90:91], v20 offset:48544
v_mfma_f32_16x16x32_bf16 v[152:155], v[44:47], v[180:183], v[152:155]
ds_read_b64_tr_b16 v[92:93], v20 offset:46272
ds_read_b64_tr_b16 v[94:95], v20 offset:48576
v_mfma_f32_16x16x32_bf16 v[120:123], v[48:51], v[176:179], v[120:123]
ds_read_b64_tr_b16 v[96:97], v20 offset:46304
ds_read_b64_tr_b16 v[98:99], v20 offset:48608
v_mfma_f32_16x16x32_bf16 v[156:159], v[48:51], v[180:183], v[156:159]
ds_read_b64_tr_b16 v[100:101], v20 offset:46336
ds_read_b64_tr_b16 v[102:103], v20 offset:48640
v_mfma_f32_16x16x32_bf16 v[124:127], v[52:55], v[176:179], v[124:127]
v_mfma_f32_16x16x32_bf16 v[160:163], v[52:55], v[180:183], v[160:163]
v_mfma_f32_16x16x32_bf16 v[128:131], v[56:59], v[176:179], v[128:131]
v_mfma_f32_16x16x32_bf16 v[164:167], v[56:59], v[180:183], v[164:167]
s_waitcnt lgkmcnt(15)
v_mfma_f32_16x16x32_bf16 v[132:135], v[60:63], v[176:179], v[132:135]
v_mfma_f32_16x16x32_bf16 v[168:171], v[60:63], v[180:183], v[168:171]
v_mfma_f32_16x16x32_bf16 v[136:139], v[64:67], v[176:179], v[136:139]
v_mfma_f32_16x16x32_bf16 v[172:175], v[64:67], v[180:183], v[172:175]
s_barrier
v_mfma_f32_16x16x32_bf16 v[104:107], v[68:71], v[184:187], v[104:107]
ds_read_b128 v[176:179], v26 offset:0
ds_read_b128 v[180:183], v26 offset:256
v_mfma_f32_16x16x32_bf16 v[140:143], v[68:71], v[188:191], v[140:143]
ds_read_b64_tr_b16 v[32:33], v21 offset:0
ds_read_b64_tr_b16 v[34:35], v21 offset:2304
s_waitcnt lgkmcnt(15)
v_mfma_f32_16x16x32_bf16 v[108:111], v[72:75], v[184:187], v[108:111]
ds_read_b64_tr_b16 v[36:37], v21 offset:32
ds_read_b64_tr_b16 v[38:39], v21 offset:2336
v_mfma_f32_16x16x32_bf16 v[144:147], v[72:75], v[188:191], v[144:147]
ds_read_b64_tr_b16 v[40:41], v21 offset:64
ds_read_b64_tr_b16 v[42:43], v21 offset:2368
v_mfma_f32_16x16x32_bf16 v[112:115], v[76:79], v[184:187], v[112:115]
ds_read_b64_tr_b16 v[44:45], v21 offset:96
ds_read_b64_tr_b16 v[46:47], v21 offset:2400
v_mfma_f32_16x16x32_bf16 v[148:151], v[76:79], v[188:191], v[148:151]
ds_read_b64_tr_b16 v[48:49], v21 offset:128
ds_read_b64_tr_b16 v[50:51], v21 offset:2432
s_waitcnt lgkmcnt(15)
v_mfma_f32_16x16x32_bf16 v[116:119], v[80:83], v[184:187], v[116:119]
ds_read_b64_tr_b16 v[52:53], v21 offset:160
ds_read_b64_tr_b16 v[54:55], v21 offset:2464
v_mfma_f32_16x16x32_bf16 v[152:155], v[80:83], v[188:191], v[152:155]
ds_read_b64_tr_b16 v[56:57], v21 offset:192
ds_read_b64_tr_b16 v[58:59], v21 offset:2496
v_mfma_f32_16x16x32_bf16 v[120:123], v[84:87], v[184:187], v[120:123]
ds_read_b64_tr_b16 v[60:61], v21 offset:224
ds_read_b64_tr_b16 v[62:63], v21 offset:2528
v_mfma_f32_16x16x32_bf16 v[156:159], v[84:87], v[188:191], v[156:159]
ds_read_b64_tr_b16 v[64:65], v21 offset:256
ds_read_b64_tr_b16 v[66:67], v21 offset:2560
v_mfma_f32_16x16x32_bf16 v[124:127], v[88:91], v[184:187], v[124:127]
v_mfma_f32_16x16x32_bf16 v[160:163], v[88:91], v[188:191], v[160:163]
v_mfma_f32_16x16x32_bf16 v[128:131], v[92:95], v[184:187], v[128:131]
v_mfma_f32_16x16x32_bf16 v[164:167], v[92:95], v[188:191], v[164:167]
s_waitcnt lgkmcnt(15)
v_mfma_f32_16x16x32_bf16 v[132:135], v[96:99], v[184:187], v[132:135]
v_mfma_f32_16x16x32_bf16 v[168:171], v[96:99], v[188:191], v[168:171]
v_mfma_f32_16x16x32_bf16 v[136:139], v[100:103], v[184:187], v[136:139]
v_mfma_f32_16x16x32_bf16 v[172:175], v[100:103], v[188:191], v[172:175]
v_mfma_f32_16x16x32_bf16 v[104:107], v[32:35], v[176:179], v[104:107]
ds_read_b128 v[184:187], v26 offset:2048
ds_read_b128 v[188:191], v26 offset:2304
v_mfma_f32_16x16x32_bf16 v[140:143], v[32:35], v[180:183], v[140:143]
ds_read_b64_tr_b16 v[68:69], v21 offset:9216
ds_read_b64_tr_b16 v[70:71], v21 offset:11520
s_waitcnt lgkmcnt(15)
v_mfma_f32_16x16x32_bf16 v[108:111], v[36:39], v[176:179], v[108:111]
ds_read_b64_tr_b16 v[72:73], v21 offset:9248
ds_read_b64_tr_b16 v[74:75], v21 offset:11552
v_mfma_f32_16x16x32_bf16 v[144:147], v[36:39], v[180:183], v[144:147]
ds_read_b64_tr_b16 v[76:77], v21 offset:9280
ds_read_b64_tr_b16 v[78:79], v21 offset:11584
v_mfma_f32_16x16x32_bf16 v[112:115], v[40:43], v[176:179], v[112:115]
ds_read_b64_tr_b16 v[80:81], v21 offset:9312
ds_read_b64_tr_b16 v[82:83], v21 offset:11616
v_mfma_f32_16x16x32_bf16 v[148:151], v[40:43], v[180:183], v[148:151]
ds_read_b64_tr_b16 v[84:85], v21 offset:9344
ds_read_b64_tr_b16 v[86:87], v21 offset:11648
s_waitcnt lgkmcnt(15)
v_mfma_f32_16x16x32_bf16 v[116:119], v[44:47], v[176:179], v[116:119]
ds_read_b64_tr_b16 v[88:89], v21 offset:9376
ds_read_b64_tr_b16 v[90:91], v21 offset:11680
v_mfma_f32_16x16x32_bf16 v[152:155], v[44:47], v[180:183], v[152:155]
ds_read_b64_tr_b16 v[92:93], v21 offset:9408
ds_read_b64_tr_b16 v[94:95], v21 offset:11712
v_mfma_f32_16x16x32_bf16 v[120:123], v[48:51], v[176:179], v[120:123]
ds_read_b64_tr_b16 v[96:97], v21 offset:9440
ds_read_b64_tr_b16 v[98:99], v21 offset:11744
v_mfma_f32_16x16x32_bf16 v[156:159], v[48:51], v[180:183], v[156:159]
ds_read_b64_tr_b16 v[100:101], v21 offset:9472
ds_read_b64_tr_b16 v[102:103], v21 offset:11776
v_mfma_f32_16x16x32_bf16 v[124:127], v[52:55], v[176:179], v[124:127]
v_mfma_f32_16x16x32_bf16 v[160:163], v[52:55], v[180:183], v[160:163]
v_mfma_f32_16x16x32_bf16 v[128:131], v[56:59], v[176:179], v[128:131]
v_mfma_f32_16x16x32_bf16 v[164:167], v[56:59], v[180:183], v[164:167]
s_waitcnt lgkmcnt(15)
v_mfma_f32_16x16x32_bf16 v[132:135], v[60:63], v[176:179], v[132:135]
v_mfma_f32_16x16x32_bf16 v[168:171], v[60:63], v[180:183], v[168:171]
v_mfma_f32_16x16x32_bf16 v[136:139], v[64:67], v[176:179], v[136:139]
v_mfma_f32_16x16x32_bf16 v[172:175], v[64:67], v[180:183], v[172:175]
s_barrier
v_mfma_f32_16x16x32_bf16 v[104:107], v[68:71], v[184:187], v[104:107]
ds_read_b128 v[176:179], v26 offset:36864
ds_read_b128 v[180:183], v26 offset:37120
v_mfma_f32_16x16x32_bf16 v[140:143], v[68:71], v[188:191], v[140:143]
ds_read_b64_tr_b16 v[32:33], v21 offset:36864
ds_read_b64_tr_b16 v[34:35], v21 offset:39168
s_waitcnt lgkmcnt(15)
v_mfma_f32_16x16x32_bf16 v[108:111], v[72:75], v[184:187], v[108:111]
ds_read_b64_tr_b16 v[36:37], v21 offset:36896
ds_read_b64_tr_b16 v[38:39], v21 offset:39200
v_mfma_f32_16x16x32_bf16 v[144:147], v[72:75], v[188:191], v[144:147]
ds_read_b64_tr_b16 v[40:41], v21 offset:36928
ds_read_b64_tr_b16 v[42:43], v21 offset:39232
v_mfma_f32_16x16x32_bf16 v[112:115], v[76:79], v[184:187], v[112:115]
ds_read_b64_tr_b16 v[44:45], v21 offset:36960
ds_read_b64_tr_b16 v[46:47], v21 offset:39264
v_mfma_f32_16x16x32_bf16 v[148:151], v[76:79], v[188:191], v[148:151]
ds_read_b64_tr_b16 v[48:49], v21 offset:36992
ds_read_b64_tr_b16 v[50:51], v21 offset:39296
s_waitcnt lgkmcnt(15)
v_mfma_f32_16x16x32_bf16 v[116:119], v[80:83], v[184:187], v[116:119]
ds_read_b64_tr_b16 v[52:53], v21 offset:37024
ds_read_b64_tr_b16 v[54:55], v21 offset:39328
v_mfma_f32_16x16x32_bf16 v[152:155], v[80:83], v[188:191], v[152:155]
ds_read_b64_tr_b16 v[56:57], v21 offset:37056
ds_read_b64_tr_b16 v[58:59], v21 offset:39360
v_mfma_f32_16x16x32_bf16 v[120:123], v[84:87], v[184:187], v[120:123]
ds_read_b64_tr_b16 v[60:61], v21 offset:37088
ds_read_b64_tr_b16 v[62:63], v21 offset:39392
v_mfma_f32_16x16x32_bf16 v[156:159], v[84:87], v[188:191], v[156:159]
ds_read_b64_tr_b16 v[64:65], v21 offset:37120
ds_read_b64_tr_b16 v[66:67], v21 offset:39424
v_mfma_f32_16x16x32_bf16 v[124:127], v[88:91], v[184:187], v[124:127]
v_mfma_f32_16x16x32_bf16 v[160:163], v[88:91], v[188:191], v[160:163]
v_mfma_f32_16x16x32_bf16 v[128:131], v[92:95], v[184:187], v[128:131]
v_mfma_f32_16x16x32_bf16 v[164:167], v[92:95], v[188:191], v[164:167]
s_waitcnt lgkmcnt(15)
v_mfma_f32_16x16x32_bf16 v[132:135], v[96:99], v[184:187], v[132:135]
v_mfma_f32_16x16x32_bf16 v[168:171], v[96:99], v[188:191], v[168:171]
v_mfma_f32_16x16x32_bf16 v[136:139], v[100:103], v[184:187], v[136:139]
v_mfma_f32_16x16x32_bf16 v[172:175], v[100:103], v[188:191], v[172:175]
v_mfma_f32_16x16x32_bf16 v[104:107], v[32:35], v[176:179], v[104:107]
ds_read_b128 v[184:187], v26 offset:38912
ds_read_b128 v[188:191], v26 offset:39168
v_mfma_f32_16x16x32_bf16 v[140:143], v[32:35], v[180:183], v[140:143]
ds_read_b64_tr_b16 v[68:69], v21 offset:46080
ds_read_b64_tr_b16 v[70:71], v21 offset:48384
s_waitcnt lgkmcnt(15)
v_mfma_f32_16x16x32_bf16 v[108:111], v[36:39], v[176:179], v[108:111]
ds_read_b64_tr_b16 v[72:73], v21 offset:46112
ds_read_b64_tr_b16 v[74:75], v21 offset:48416
v_mfma_f32_16x16x32_bf16 v[144:147], v[36:39], v[180:183], v[144:147]
ds_read_b64_tr_b16 v[76:77], v21 offset:46144
ds_read_b64_tr_b16 v[78:79], v21 offset:48448
v_mfma_f32_16x16x32_bf16 v[112:115], v[40:43], v[176:179], v[112:115]
ds_read_b64_tr_b16 v[80:81], v21 offset:46176
ds_read_b64_tr_b16 v[82:83], v21 offset:48480
v_mfma_f32_16x16x32_bf16 v[148:151], v[40:43], v[180:183], v[148:151]
ds_read_b64_tr_b16 v[84:85], v21 offset:46208
ds_read_b64_tr_b16 v[86:87], v21 offset:48512
s_waitcnt lgkmcnt(15)
v_mfma_f32_16x16x32_bf16 v[116:119], v[44:47], v[176:179], v[116:119]
ds_read_b64_tr_b16 v[88:89], v21 offset:46240
ds_read_b64_tr_b16 v[90:91], v21 offset:48544
v_mfma_f32_16x16x32_bf16 v[152:155], v[44:47], v[180:183], v[152:155]
ds_read_b64_tr_b16 v[92:93], v21 offset:46272
ds_read_b64_tr_b16 v[94:95], v21 offset:48576
v_mfma_f32_16x16x32_bf16 v[120:123], v[48:51], v[176:179], v[120:123]
ds_read_b64_tr_b16 v[96:97], v21 offset:46304
ds_read_b64_tr_b16 v[98:99], v21 offset:48608
v_mfma_f32_16x16x32_bf16 v[156:159], v[48:51], v[180:183], v[156:159]
ds_read_b64_tr_b16 v[100:101], v21 offset:46336
ds_read_b64_tr_b16 v[102:103], v21 offset:48640
v_mfma_f32_16x16x32_bf16 v[124:127], v[52:55], v[176:179], v[124:127]
v_mfma_f32_16x16x32_bf16 v[160:163], v[52:55], v[180:183], v[160:163]
v_mfma_f32_16x16x32_bf16 v[128:131], v[56:59], v[176:179], v[128:131]
v_mfma_f32_16x16x32_bf16 v[164:167], v[56:59], v[180:183], v[164:167]
s_waitcnt lgkmcnt(15)
v_mfma_f32_16x16x32_bf16 v[132:135], v[60:63], v[176:179], v[132:135]
v_mfma_f32_16x16x32_bf16 v[168:171], v[60:63], v[180:183], v[168:171]
v_mfma_f32_16x16x32_bf16 v[136:139], v[64:67], v[176:179], v[136:139]
v_mfma_f32_16x16x32_bf16 v[172:175], v[64:67], v[180:183], v[172:175]
s_barrier
v_mfma_f32_16x16x32_bf16 v[104:107], v[68:71], v[184:187], v[104:107]
ds_read_b128 v[176:179], v25 offset:0
ds_read_b128 v[180:183], v25 offset:256
v_mfma_f32_16x16x32_bf16 v[140:143], v[68:71], v[188:191], v[140:143]
ds_read_b64_tr_b16 v[32:33], v20 offset:0
ds_read_b64_tr_b16 v[34:35], v20 offset:2304
s_waitcnt lgkmcnt(15)
v_mfma_f32_16x16x32_bf16 v[108:111], v[72:75], v[184:187], v[108:111]
ds_read_b64_tr_b16 v[36:37], v20 offset:32
ds_read_b64_tr_b16 v[38:39], v20 offset:2336
v_mfma_f32_16x16x32_bf16 v[144:147], v[72:75], v[188:191], v[144:147]
ds_read_b64_tr_b16 v[40:41], v20 offset:64
ds_read_b64_tr_b16 v[42:43], v20 offset:2368
v_mfma_f32_16x16x32_bf16 v[112:115], v[76:79], v[184:187], v[112:115]
ds_read_b64_tr_b16 v[44:45], v20 offset:96
ds_read_b64_tr_b16 v[46:47], v20 offset:2400
v_mfma_f32_16x16x32_bf16 v[148:151], v[76:79], v[188:191], v[148:151]
ds_read_b64_tr_b16 v[48:49], v20 offset:128
ds_read_b64_tr_b16 v[50:51], v20 offset:2432
s_waitcnt lgkmcnt(15)
v_mfma_f32_16x16x32_bf16 v[116:119], v[80:83], v[184:187], v[116:119]
ds_read_b64_tr_b16 v[52:53], v20 offset:160
ds_read_b64_tr_b16 v[54:55], v20 offset:2464
v_mfma_f32_16x16x32_bf16 v[152:155], v[80:83], v[188:191], v[152:155]
ds_read_b64_tr_b16 v[56:57], v20 offset:192
ds_read_b64_tr_b16 v[58:59], v20 offset:2496
v_mfma_f32_16x16x32_bf16 v[120:123], v[84:87], v[184:187], v[120:123]
ds_read_b64_tr_b16 v[60:61], v20 offset:224
ds_read_b64_tr_b16 v[62:63], v20 offset:2528
v_mfma_f32_16x16x32_bf16 v[156:159], v[84:87], v[188:191], v[156:159]
ds_read_b64_tr_b16 v[64:65], v20 offset:256
ds_read_b64_tr_b16 v[66:67], v20 offset:2560
v_mfma_f32_16x16x32_bf16 v[124:127], v[88:91], v[184:187], v[124:127]
v_mfma_f32_16x16x32_bf16 v[160:163], v[88:91], v[188:191], v[160:163]
v_mfma_f32_16x16x32_bf16 v[128:131], v[92:95], v[184:187], v[128:131]
v_mfma_f32_16x16x32_bf16 v[164:167], v[92:95], v[188:191], v[164:167]
s_waitcnt lgkmcnt(15)
v_mfma_f32_16x16x32_bf16 v[132:135], v[96:99], v[184:187], v[132:135]
v_mfma_f32_16x16x32_bf16 v[168:171], v[96:99], v[188:191], v[168:171]
v_mfma_f32_16x16x32_bf16 v[136:139], v[100:103], v[184:187], v[136:139]
v_mfma_f32_16x16x32_bf16 v[172:175], v[100:103], v[188:191], v[172:175]
v_mfma_f32_16x16x32_bf16 v[104:107], v[32:35], v[176:179], v[104:107]
ds_read_b128 v[184:187], v25 offset:2048
ds_read_b128 v[188:191], v25 offset:2304
v_mfma_f32_16x16x32_bf16 v[140:143], v[32:35], v[180:183], v[140:143]
ds_read_b64_tr_b16 v[68:69], v20 offset:9216
ds_read_b64_tr_b16 v[70:71], v20 offset:11520
s_waitcnt lgkmcnt(15)
v_mfma_f32_16x16x32_bf16 v[108:111], v[36:39], v[176:179], v[108:111]
ds_read_b64_tr_b16 v[72:73], v20 offset:9248
ds_read_b64_tr_b16 v[74:75], v20 offset:11552
v_mfma_f32_16x16x32_bf16 v[144:147], v[36:39], v[180:183], v[144:147]
ds_read_b64_tr_b16 v[76:77], v20 offset:9280
ds_read_b64_tr_b16 v[78:79], v20 offset:11584
v_mfma_f32_16x16x32_bf16 v[112:115], v[40:43], v[176:179], v[112:115]
ds_read_b64_tr_b16 v[80:81], v20 offset:9312
ds_read_b64_tr_b16 v[82:83], v20 offset:11616
v_mfma_f32_16x16x32_bf16 v[148:151], v[40:43], v[180:183], v[148:151]
ds_read_b64_tr_b16 v[84:85], v20 offset:9344
ds_read_b64_tr_b16 v[86:87], v20 offset:11648
s_waitcnt lgkmcnt(15)
v_mfma_f32_16x16x32_bf16 v[116:119], v[44:47], v[176:179], v[116:119]
ds_read_b64_tr_b16 v[88:89], v20 offset:9376
ds_read_b64_tr_b16 v[90:91], v20 offset:11680
v_mfma_f32_16x16x32_bf16 v[152:155], v[44:47], v[180:183], v[152:155]
ds_read_b64_tr_b16 v[92:93], v20 offset:9408
ds_read_b64_tr_b16 v[94:95], v20 offset:11712
v_mfma_f32_16x16x32_bf16 v[120:123], v[48:51], v[176:179], v[120:123]
ds_read_b64_tr_b16 v[96:97], v20 offset:9440
ds_read_b64_tr_b16 v[98:99], v20 offset:11744
v_mfma_f32_16x16x32_bf16 v[156:159], v[48:51], v[180:183], v[156:159]
ds_read_b64_tr_b16 v[100:101], v20 offset:9472
ds_read_b64_tr_b16 v[102:103], v20 offset:11776
v_mfma_f32_16x16x32_bf16 v[124:127], v[52:55], v[176:179], v[124:127]
v_mfma_f32_16x16x32_bf16 v[160:163], v[52:55], v[180:183], v[160:163]
v_mfma_f32_16x16x32_bf16 v[128:131], v[56:59], v[176:179], v[128:131]
v_mfma_f32_16x16x32_bf16 v[164:167], v[56:59], v[180:183], v[164:167]
s_waitcnt lgkmcnt(15)
v_mfma_f32_16x16x32_bf16 v[132:135], v[60:63], v[176:179], v[132:135]
v_mfma_f32_16x16x32_bf16 v[168:171], v[60:63], v[180:183], v[168:171]
v_mfma_f32_16x16x32_bf16 v[136:139], v[64:67], v[176:179], v[136:139]
v_mfma_f32_16x16x32_bf16 v[172:175], v[64:67], v[180:183], v[172:175]
s_barrier
v_mfma_f32_16x16x32_bf16 v[104:107], v[68:71], v[184:187], v[104:107]
ds_read_b128 v[176:179], v25 offset:36864
ds_read_b128 v[180:183], v25 offset:37120
v_mfma_f32_16x16x32_bf16 v[140:143], v[68:71], v[188:191], v[140:143]
ds_read_b64_tr_b16 v[32:33], v20 offset:36864
ds_read_b64_tr_b16 v[34:35], v20 offset:39168
s_waitcnt lgkmcnt(15)
v_mfma_f32_16x16x32_bf16 v[108:111], v[72:75], v[184:187], v[108:111]
ds_read_b64_tr_b16 v[36:37], v20 offset:36896
ds_read_b64_tr_b16 v[38:39], v20 offset:39200
v_mfma_f32_16x16x32_bf16 v[144:147], v[72:75], v[188:191], v[144:147]
ds_read_b64_tr_b16 v[40:41], v20 offset:36928
ds_read_b64_tr_b16 v[42:43], v20 offset:39232
v_mfma_f32_16x16x32_bf16 v[112:115], v[76:79], v[184:187], v[112:115]
ds_read_b64_tr_b16 v[44:45], v20 offset:36960
ds_read_b64_tr_b16 v[46:47], v20 offset:39264
v_mfma_f32_16x16x32_bf16 v[148:151], v[76:79], v[188:191], v[148:151]
ds_read_b64_tr_b16 v[48:49], v20 offset:36992
ds_read_b64_tr_b16 v[50:51], v20 offset:39296
s_waitcnt lgkmcnt(15)
v_mfma_f32_16x16x32_bf16 v[116:119], v[80:83], v[184:187], v[116:119]
ds_read_b64_tr_b16 v[52:53], v20 offset:37024
ds_read_b64_tr_b16 v[54:55], v20 offset:39328
v_mfma_f32_16x16x32_bf16 v[152:155], v[80:83], v[188:191], v[152:155]
ds_read_b64_tr_b16 v[56:57], v20 offset:37056
ds_read_b64_tr_b16 v[58:59], v20 offset:39360
v_mfma_f32_16x16x32_bf16 v[120:123], v[84:87], v[184:187], v[120:123]
ds_read_b64_tr_b16 v[60:61], v20 offset:37088
ds_read_b64_tr_b16 v[62:63], v20 offset:39392
v_mfma_f32_16x16x32_bf16 v[156:159], v[84:87], v[188:191], v[156:159]
ds_read_b64_tr_b16 v[64:65], v20 offset:37120
ds_read_b64_tr_b16 v[66:67], v20 offset:39424
v_mfma_f32_16x16x32_bf16 v[124:127], v[88:91], v[184:187], v[124:127]
v_mfma_f32_16x16x32_bf16 v[160:163], v[88:91], v[188:191], v[160:163]
v_mfma_f32_16x16x32_bf16 v[128:131], v[92:95], v[184:187], v[128:131]
v_mfma_f32_16x16x32_bf16 v[164:167], v[92:95], v[188:191], v[164:167]
s_waitcnt lgkmcnt(15)
v_mfma_f32_16x16x32_bf16 v[132:135], v[96:99], v[184:187], v[132:135]
v_mfma_f32_16x16x32_bf16 v[168:171], v[96:99], v[188:191], v[168:171]
v_mfma_f32_16x16x32_bf16 v[136:139], v[100:103], v[184:187], v[136:139]
v_mfma_f32_16x16x32_bf16 v[172:175], v[100:103], v[188:191], v[172:175]
v_mfma_f32_16x16x32_bf16 v[104:107], v[32:35], v[176:179], v[104:107]
ds_read_b128 v[184:187], v25 offset:38912
ds_read_b128 v[188:191], v25 offset:39168
v_mfma_f32_16x16x32_bf16 v[140:143], v[32:35], v[180:183], v[140:143]
ds_read_b64_tr_b16 v[68:69], v20 offset:46080
ds_read_b64_tr_b16 v[70:71], v20 offset:48384
s_waitcnt lgkmcnt(15)
v_mfma_f32_16x16x32_bf16 v[108:111], v[36:39], v[176:179], v[108:111]
ds_read_b64_tr_b16 v[72:73], v20 offset:46112
ds_read_b64_tr_b16 v[74:75], v20 offset:48416
v_mfma_f32_16x16x32_bf16 v[144:147], v[36:39], v[180:183], v[144:147]
ds_read_b64_tr_b16 v[76:77], v20 offset:46144
ds_read_b64_tr_b16 v[78:79], v20 offset:48448
v_mfma_f32_16x16x32_bf16 v[112:115], v[40:43], v[176:179], v[112:115]
ds_read_b64_tr_b16 v[80:81], v20 offset:46176
ds_read_b64_tr_b16 v[82:83], v20 offset:48480
v_mfma_f32_16x16x32_bf16 v[148:151], v[40:43], v[180:183], v[148:151]
ds_read_b64_tr_b16 v[84:85], v20 offset:46208
ds_read_b64_tr_b16 v[86:87], v20 offset:48512
s_waitcnt lgkmcnt(15)
v_mfma_f32_16x16x32_bf16 v[116:119], v[44:47], v[176:179], v[116:119]
ds_read_b64_tr_b16 v[88:89], v20 offset:46240
ds_read_b64_tr_b16 v[90:91], v20 offset:48544
v_mfma_f32_16x16x32_bf16 v[152:155], v[44:47], v[180:183], v[152:155]
ds_read_b64_tr_b16 v[92:93], v20 offset:46272
ds_read_b64_tr_b16 v[94:95], v20 offset:48576
v_mfma_f32_16x16x32_bf16 v[120:123], v[48:51], v[176:179], v[120:123]
ds_read_b64_tr_b16 v[96:97], v20 offset:46304
ds_read_b64_tr_b16 v[98:99], v20 offset:48608
v_mfma_f32_16x16x32_bf16 v[156:159], v[48:51], v[180:183], v[156:159]
ds_read_b64_tr_b16 v[100:101], v20 offset:46336
ds_read_b64_tr_b16 v[102:103], v20 offset:48640
v_mfma_f32_16x16x32_bf16 v[124:127], v[52:55], v[176:179], v[124:127]
v_mfma_f32_16x16x32_bf16 v[160:163], v[52:55], v[180:183], v[160:163]
v_mfma_f32_16x16x32_bf16 v[128:131], v[56:59], v[176:179], v[128:131]
v_mfma_f32_16x16x32_bf16 v[164:167], v[56:59], v[180:183], v[164:167]
s_waitcnt lgkmcnt(15)
v_mfma_f32_16x16x32_bf16 v[132:135], v[60:63], v[176:179], v[132:135]
v_mfma_f32_16x16x32_bf16 v[168:171], v[60:63], v[180:183], v[168:171]
v_mfma_f32_16x16x32_bf16 v[136:139], v[64:67], v[176:179], v[136:139]
v_mfma_f32_16x16x32_bf16 v[172:175], v[64:67], v[180:183], v[172:175]
s_barrier
v_mfma_f32_16x16x32_bf16 v[104:107], v[68:71], v[184:187], v[104:107]
ds_read_b128 v[176:179], v26 offset:0
ds_read_b128 v[180:183], v26 offset:256
v_mfma_f32_16x16x32_bf16 v[140:143], v[68:71], v[188:191], v[140:143]
ds_read_b64_tr_b16 v[32:33], v21 offset:0
ds_read_b64_tr_b16 v[34:35], v21 offset:2304
s_waitcnt lgkmcnt(15)
v_mfma_f32_16x16x32_bf16 v[108:111], v[72:75], v[184:187], v[108:111]
ds_read_b64_tr_b16 v[36:37], v21 offset:32
ds_read_b64_tr_b16 v[38:39], v21 offset:2336
v_mfma_f32_16x16x32_bf16 v[144:147], v[72:75], v[188:191], v[144:147]
ds_read_b64_tr_b16 v[40:41], v21 offset:64
ds_read_b64_tr_b16 v[42:43], v21 offset:2368
v_mfma_f32_16x16x32_bf16 v[112:115], v[76:79], v[184:187], v[112:115]
ds_read_b64_tr_b16 v[44:45], v21 offset:96
ds_read_b64_tr_b16 v[46:47], v21 offset:2400
v_mfma_f32_16x16x32_bf16 v[148:151], v[76:79], v[188:191], v[148:151]
ds_read_b64_tr_b16 v[48:49], v21 offset:128
ds_read_b64_tr_b16 v[50:51], v21 offset:2432
s_waitcnt lgkmcnt(15)
v_mfma_f32_16x16x32_bf16 v[116:119], v[80:83], v[184:187], v[116:119]
ds_read_b64_tr_b16 v[52:53], v21 offset:160
ds_read_b64_tr_b16 v[54:55], v21 offset:2464
v_mfma_f32_16x16x32_bf16 v[152:155], v[80:83], v[188:191], v[152:155]
ds_read_b64_tr_b16 v[56:57], v21 offset:192
ds_read_b64_tr_b16 v[58:59], v21 offset:2496
v_mfma_f32_16x16x32_bf16 v[120:123], v[84:87], v[184:187], v[120:123]
ds_read_b64_tr_b16 v[60:61], v21 offset:224
ds_read_b64_tr_b16 v[62:63], v21 offset:2528
v_mfma_f32_16x16x32_bf16 v[156:159], v[84:87], v[188:191], v[156:159]
ds_read_b64_tr_b16 v[64:65], v21 offset:256
ds_read_b64_tr_b16 v[66:67], v21 offset:2560
v_mfma_f32_16x16x32_bf16 v[124:127], v[88:91], v[184:187], v[124:127]
v_mfma_f32_16x16x32_bf16 v[160:163], v[88:91], v[188:191], v[160:163]
v_mfma_f32_16x16x32_bf16 v[128:131], v[92:95], v[184:187], v[128:131]
v_mfma_f32_16x16x32_bf16 v[164:167], v[92:95], v[188:191], v[164:167]
s_waitcnt lgkmcnt(15)
v_mfma_f32_16x16x32_bf16 v[132:135], v[96:99], v[184:187], v[132:135]
v_mfma_f32_16x16x32_bf16 v[168:171], v[96:99], v[188:191], v[168:171]
v_mfma_f32_16x16x32_bf16 v[136:139], v[100:103], v[184:187], v[136:139]
v_mfma_f32_16x16x32_bf16 v[172:175], v[100:103], v[188:191], v[172:175]
v_mfma_f32_16x16x32_bf16 v[104:107], v[32:35], v[176:179], v[104:107]
ds_read_b128 v[184:187], v26 offset:2048
ds_read_b128 v[188:191], v26 offset:2304
v_mfma_f32_16x16x32_bf16 v[140:143], v[32:35], v[180:183], v[140:143]
ds_read_b64_tr_b16 v[68:69], v21 offset:9216
ds_read_b64_tr_b16 v[70:71], v21 offset:11520
s_waitcnt lgkmcnt(15)
v_mfma_f32_16x16x32_bf16 v[108:111], v[36:39], v[176:179], v[108:111]
ds_read_b64_tr_b16 v[72:73], v21 offset:9248
ds_read_b64_tr_b16 v[74:75], v21 offset:11552
v_mfma_f32_16x16x32_bf16 v[144:147], v[36:39], v[180:183], v[144:147]
ds_read_b64_tr_b16 v[76:77], v21 offset:9280
ds_read_b64_tr_b16 v[78:79], v21 offset:11584
v_mfma_f32_16x16x32_bf16 v[112:115], v[40:43], v[176:179], v[112:115]
ds_read_b64_tr_b16 v[80:81], v21 offset:9312
ds_read_b64_tr_b16 v[82:83], v21 offset:11616
v_mfma_f32_16x16x32_bf16 v[148:151], v[40:43], v[180:183], v[148:151]
ds_read_b64_tr_b16 v[84:85], v21 offset:9344
ds_read_b64_tr_b16 v[86:87], v21 offset:11648
s_waitcnt lgkmcnt(15)
v_mfma_f32_16x16x32_bf16 v[116:119], v[44:47], v[176:179], v[116:119]
ds_read_b64_tr_b16 v[88:89], v21 offset:9376
ds_read_b64_tr_b16 v[90:91], v21 offset:11680
v_mfma_f32_16x16x32_bf16 v[152:155], v[44:47], v[180:183], v[152:155]
ds_read_b64_tr_b16 v[92:93], v21 offset:9408
ds_read_b64_tr_b16 v[94:95], v21 offset:11712
v_mfma_f32_16x16x32_bf16 v[120:123], v[48:51], v[176:179], v[120:123]
ds_read_b64_tr_b16 v[96:97], v21 offset:9440
ds_read_b64_tr_b16 v[98:99], v21 offset:11744
v_mfma_f32_16x16x32_bf16 v[156:159], v[48:51], v[180:183], v[156:159]
ds_read_b64_tr_b16 v[100:101], v21 offset:9472
ds_read_b64_tr_b16 v[102:103], v21 offset:11776
v_mfma_f32_16x16x32_bf16 v[124:127], v[52:55], v[176:179], v[124:127]
v_mfma_f32_16x16x32_bf16 v[160:163], v[52:55], v[180:183], v[160:163]
v_mfma_f32_16x16x32_bf16 v[128:131], v[56:59], v[176:179], v[128:131]
v_mfma_f32_16x16x32_bf16 v[164:167], v[56:59], v[180:183], v[164:167]
s_waitcnt lgkmcnt(15)
v_mfma_f32_16x16x32_bf16 v[132:135], v[60:63], v[176:179], v[132:135]
v_mfma_f32_16x16x32_bf16 v[168:171], v[60:63], v[180:183], v[168:171]
v_mfma_f32_16x16x32_bf16 v[136:139], v[64:67], v[176:179], v[136:139]
v_mfma_f32_16x16x32_bf16 v[172:175], v[64:67], v[180:183], v[172:175]
s_barrier
v_mfma_f32_16x16x32_bf16 v[104:107], v[68:71], v[184:187], v[104:107]
ds_read_b128 v[176:179], v26 offset:36864
ds_read_b128 v[180:183], v26 offset:37120
v_mfma_f32_16x16x32_bf16 v[140:143], v[68:71], v[188:191], v[140:143]
ds_read_b64_tr_b16 v[32:33], v21 offset:36864
ds_read_b64_tr_b16 v[34:35], v21 offset:39168
s_waitcnt lgkmcnt(15)
v_mfma_f32_16x16x32_bf16 v[108:111], v[72:75], v[184:187], v[108:111]
ds_read_b64_tr_b16 v[36:37], v21 offset:36896
ds_read_b64_tr_b16 v[38:39], v21 offset:39200
v_mfma_f32_16x16x32_bf16 v[144:147], v[72:75], v[188:191], v[144:147]
ds_read_b64_tr_b16 v[40:41], v21 offset:36928
ds_read_b64_tr_b16 v[42:43], v21 offset:39232
v_mfma_f32_16x16x32_bf16 v[112:115], v[76:79], v[184:187], v[112:115]
ds_read_b64_tr_b16 v[44:45], v21 offset:36960
ds_read_b64_tr_b16 v[46:47], v21 offset:39264
v_mfma_f32_16x16x32_bf16 v[148:151], v[76:79], v[188:191], v[148:151]
ds_read_b64_tr_b16 v[48:49], v21 offset:36992
ds_read_b64_tr_b16 v[50:51], v21 offset:39296
s_waitcnt lgkmcnt(15)
v_mfma_f32_16x16x32_bf16 v[116:119], v[80:83], v[184:187], v[116:119]
ds_read_b64_tr_b16 v[52:53], v21 offset:37024
ds_read_b64_tr_b16 v[54:55], v21 offset:39328
v_mfma_f32_16x16x32_bf16 v[152:155], v[80:83], v[188:191], v[152:155]
ds_read_b64_tr_b16 v[56:57], v21 offset:37056
ds_read_b64_tr_b16 v[58:59], v21 offset:39360
v_mfma_f32_16x16x32_bf16 v[120:123], v[84:87], v[184:187], v[120:123]
ds_read_b64_tr_b16 v[60:61], v21 offset:37088
ds_read_b64_tr_b16 v[62:63], v21 offset:39392
v_mfma_f32_16x16x32_bf16 v[156:159], v[84:87], v[188:191], v[156:159]
ds_read_b64_tr_b16 v[64:65], v21 offset:37120
ds_read_b64_tr_b16 v[66:67], v21 offset:39424
v_mfma_f32_16x16x32_bf16 v[124:127], v[88:91], v[184:187], v[124:127]
v_mfma_f32_16x16x32_bf16 v[160:163], v[88:91], v[188:191], v[160:163]
v_mfma_f32_16x16x32_bf16 v[128:131], v[92:95], v[184:187], v[128:131]
v_mfma_f32_16x16x32_bf16 v[164:167], v[92:95], v[188:191], v[164:167]
s_waitcnt lgkmcnt(15)
v_mfma_f32_16x16x32_bf16 v[132:135], v[96:99], v[184:187], v[132:135]
v_mfma_f32_16x16x32_bf16 v[168:171], v[96:99], v[188:191], v[168:171]
v_mfma_f32_16x16x32_bf16 v[136:139], v[100:103], v[184:187], v[136:139]
v_mfma_f32_16x16x32_bf16 v[172:175], v[100:103], v[188:191], v[172:175]
v_mfma_f32_16x16x32_bf16 v[104:107], v[32:35], v[176:179], v[104:107]
ds_read_b128 v[184:187], v26 offset:38912
ds_read_b128 v[188:191], v26 offset:39168
v_mfma_f32_16x16x32_bf16 v[140:143], v[32:35], v[180:183], v[140:143]
ds_read_b64_tr_b16 v[68:69], v21 offset:46080
ds_read_b64_tr_b16 v[70:71], v21 offset:48384
s_waitcnt lgkmcnt(15)
v_mfma_f32_16x16x32_bf16 v[108:111], v[36:39], v[176:179], v[108:111]
ds_read_b64_tr_b16 v[72:73], v21 offset:46112
ds_read_b64_tr_b16 v[74:75], v21 offset:48416
v_mfma_f32_16x16x32_bf16 v[144:147], v[36:39], v[180:183], v[144:147]
ds_read_b64_tr_b16 v[76:77], v21 offset:46144
ds_read_b64_tr_b16 v[78:79], v21 offset:48448
v_mfma_f32_16x16x32_bf16 v[112:115], v[40:43], v[176:179], v[112:115]
ds_read_b64_tr_b16 v[80:81], v21 offset:46176
ds_read_b64_tr_b16 v[82:83], v21 offset:48480
v_mfma_f32_16x16x32_bf16 v[148:151], v[40:43], v[180:183], v[148:151]
ds_read_b64_tr_b16 v[84:85], v21 offset:46208
ds_read_b64_tr_b16 v[86:87], v21 offset:48512
s_waitcnt lgkmcnt(15)
v_mfma_f32_16x16x32_bf16 v[116:119], v[44:47], v[176:179], v[116:119]
ds_read_b64_tr_b16 v[88:89], v21 offset:46240
ds_read_b64_tr_b16 v[90:91], v21 offset:48544
v_mfma_f32_16x16x32_bf16 v[152:155], v[44:47], v[180:183], v[152:155]
ds_read_b64_tr_b16 v[92:93], v21 offset:46272
ds_read_b64_tr_b16 v[94:95], v21 offset:48576
v_mfma_f32_16x16x32_bf16 v[120:123], v[48:51], v[176:179], v[120:123]
ds_read_b64_tr_b16 v[96:97], v21 offset:46304
ds_read_b64_tr_b16 v[98:99], v21 offset:48608
v_mfma_f32_16x16x32_bf16 v[156:159], v[48:51], v[180:183], v[156:159]
ds_read_b64_tr_b16 v[100:101], v21 offset:46336
ds_read_b64_tr_b16 v[102:103], v21 offset:48640
v_mfma_f32_16x16x32_bf16 v[124:127], v[52:55], v[176:179], v[124:127]
v_mfma_f32_16x16x32_bf16 v[160:163], v[52:55], v[180:183], v[160:163]
v_mfma_f32_16x16x32_bf16 v[128:131], v[56:59], v[176:179], v[128:131]
v_mfma_f32_16x16x32_bf16 v[164:167], v[56:59], v[180:183], v[164:167]
s_waitcnt lgkmcnt(15)
v_mfma_f32_16x16x32_bf16 v[132:135], v[60:63], v[176:179], v[132:135]
v_mfma_f32_16x16x32_bf16 v[168:171], v[60:63], v[180:183], v[168:171]
v_mfma_f32_16x16x32_bf16 v[136:139], v[64:67], v[176:179], v[136:139]
v_mfma_f32_16x16x32_bf16 v[172:175], v[64:67], v[180:183], v[172:175]
s_barrier
v_mfma_f32_16x16x32_bf16 v[104:107], v[68:71], v[184:187], v[104:107]
ds_read_b128 v[176:179], v25 offset:0
ds_read_b128 v[180:183], v25 offset:256
v_mfma_f32_16x16x32_bf16 v[140:143], v[68:71], v[188:191], v[140:143]
ds_read_b64_tr_b16 v[32:33], v20 offset:0
ds_read_b64_tr_b16 v[34:35], v20 offset:2304
s_waitcnt lgkmcnt(15)
v_mfma_f32_16x16x32_bf16 v[108:111], v[72:75], v[184:187], v[108:111]
ds_read_b64_tr_b16 v[36:37], v20 offset:32
ds_read_b64_tr_b16 v[38:39], v20 offset:2336
v_mfma_f32_16x16x32_bf16 v[144:147], v[72:75], v[188:191], v[144:147]
ds_read_b64_tr_b16 v[40:41], v20 offset:64
ds_read_b64_tr_b16 v[42:43], v20 offset:2368
v_mfma_f32_16x16x32_bf16 v[112:115], v[76:79], v[184:187], v[112:115]
ds_read_b64_tr_b16 v[44:45], v20 offset:96
ds_read_b64_tr_b16 v[46:47], v20 offset:2400
v_mfma_f32_16x16x32_bf16 v[148:151], v[76:79], v[188:191], v[148:151]
ds_read_b64_tr_b16 v[48:49], v20 offset:128
ds_read_b64_tr_b16 v[50:51], v20 offset:2432
s_waitcnt lgkmcnt(15)
v_mfma_f32_16x16x32_bf16 v[116:119], v[80:83], v[184:187], v[116:119]
ds_read_b64_tr_b16 v[52:53], v20 offset:160
ds_read_b64_tr_b16 v[54:55], v20 offset:2464
v_mfma_f32_16x16x32_bf16 v[152:155], v[80:83], v[188:191], v[152:155]
ds_read_b64_tr_b16 v[56:57], v20 offset:192
ds_read_b64_tr_b16 v[58:59], v20 offset:2496
v_mfma_f32_16x16x32_bf16 v[120:123], v[84:87], v[184:187], v[120:123]
ds_read_b64_tr_b16 v[60:61], v20 offset:224
ds_read_b64_tr_b16 v[62:63], v20 offset:2528
v_mfma_f32_16x16x32_bf16 v[156:159], v[84:87], v[188:191], v[156:159]
ds_read_b64_tr_b16 v[64:65], v20 offset:256
ds_read_b64_tr_b16 v[66:67], v20 offset:2560
v_mfma_f32_16x16x32_bf16 v[124:127], v[88:91], v[184:187], v[124:127]
v_mfma_f32_16x16x32_bf16 v[160:163], v[88:91], v[188:191], v[160:163]
v_mfma_f32_16x16x32_bf16 v[128:131], v[92:95], v[184:187], v[128:131]
v_mfma_f32_16x16x32_bf16 v[164:167], v[92:95], v[188:191], v[164:167]
s_waitcnt lgkmcnt(15)
v_mfma_f32_16x16x32_bf16 v[132:135], v[96:99], v[184:187], v[132:135]
v_mfma_f32_16x16x32_bf16 v[168:171], v[96:99], v[188:191], v[168:171]
v_mfma_f32_16x16x32_bf16 v[136:139], v[100:103], v[184:187], v[136:139]
v_mfma_f32_16x16x32_bf16 v[172:175], v[100:103], v[188:191], v[172:175]
v_mfma_f32_16x16x32_bf16 v[104:107], v[32:35], v[176:179], v[104:107]
ds_read_b128 v[184:187], v25 offset:2048
ds_read_b128 v[188:191], v25 offset:2304
v_mfma_f32_16x16x32_bf16 v[140:143], v[32:35], v[180:183], v[140:143]
ds_read_b64_tr_b16 v[68:69], v20 offset:9216
ds_read_b64_tr_b16 v[70:71], v20 offset:11520
s_waitcnt lgkmcnt(15)
v_mfma_f32_16x16x32_bf16 v[108:111], v[36:39], v[176:179], v[108:111]
ds_read_b64_tr_b16 v[72:73], v20 offset:9248
ds_read_b64_tr_b16 v[74:75], v20 offset:11552
v_mfma_f32_16x16x32_bf16 v[144:147], v[36:39], v[180:183], v[144:147]
ds_read_b64_tr_b16 v[76:77], v20 offset:9280
ds_read_b64_tr_b16 v[78:79], v20 offset:11584
v_mfma_f32_16x16x32_bf16 v[112:115], v[40:43], v[176:179], v[112:115]
ds_read_b64_tr_b16 v[80:81], v20 offset:9312
ds_read_b64_tr_b16 v[82:83], v20 offset:11616
v_mfma_f32_16x16x32_bf16 v[148:151], v[40:43], v[180:183], v[148:151]
ds_read_b64_tr_b16 v[84:85], v20 offset:9344
ds_read_b64_tr_b16 v[86:87], v20 offset:11648
s_waitcnt lgkmcnt(15)
v_mfma_f32_16x16x32_bf16 v[116:119], v[44:47], v[176:179], v[116:119]
ds_read_b64_tr_b16 v[88:89], v20 offset:9376
ds_read_b64_tr_b16 v[90:91], v20 offset:11680
v_mfma_f32_16x16x32_bf16 v[152:155], v[44:47], v[180:183], v[152:155]
ds_read_b64_tr_b16 v[92:93], v20 offset:9408
ds_read_b64_tr_b16 v[94:95], v20 offset:11712
v_mfma_f32_16x16x32_bf16 v[120:123], v[48:51], v[176:179], v[120:123]
ds_read_b64_tr_b16 v[96:97], v20 offset:9440
ds_read_b64_tr_b16 v[98:99], v20 offset:11744
v_mfma_f32_16x16x32_bf16 v[156:159], v[48:51], v[180:183], v[156:159]
ds_read_b64_tr_b16 v[100:101], v20 offset:9472
ds_read_b64_tr_b16 v[102:103], v20 offset:11776
v_mfma_f32_16x16x32_bf16 v[124:127], v[52:55], v[176:179], v[124:127]
v_mfma_f32_16x16x32_bf16 v[160:163], v[52:55], v[180:183], v[160:163]
v_mfma_f32_16x16x32_bf16 v[128:131], v[56:59], v[176:179], v[128:131]
v_mfma_f32_16x16x32_bf16 v[164:167], v[56:59], v[180:183], v[164:167]
s_waitcnt lgkmcnt(15)
v_mfma_f32_16x16x32_bf16 v[132:135], v[60:63], v[176:179], v[132:135]
v_mfma_f32_16x16x32_bf16 v[168:171], v[60:63], v[180:183], v[168:171]
v_mfma_f32_16x16x32_bf16 v[136:139], v[64:67], v[176:179], v[136:139]
v_mfma_f32_16x16x32_bf16 v[172:175], v[64:67], v[180:183], v[172:175]
s_barrier
v_mfma_f32_16x16x32_bf16 v[104:107], v[68:71], v[184:187], v[104:107]
ds_read_b128 v[176:179], v25 offset:36864
ds_read_b128 v[180:183], v25 offset:37120
v_mfma_f32_16x16x32_bf16 v[140:143], v[68:71], v[188:191], v[140:143]
ds_read_b64_tr_b16 v[32:33], v20 offset:36864
ds_read_b64_tr_b16 v[34:35], v20 offset:39168
s_waitcnt lgkmcnt(15)
v_mfma_f32_16x16x32_bf16 v[108:111], v[72:75], v[184:187], v[108:111]
ds_read_b64_tr_b16 v[36:37], v20 offset:36896
ds_read_b64_tr_b16 v[38:39], v20 offset:39200
v_mfma_f32_16x16x32_bf16 v[144:147], v[72:75], v[188:191], v[144:147]
ds_read_b64_tr_b16 v[40:41], v20 offset:36928
ds_read_b64_tr_b16 v[42:43], v20 offset:39232
v_mfma_f32_16x16x32_bf16 v[112:115], v[76:79], v[184:187], v[112:115]
ds_read_b64_tr_b16 v[44:45], v20 offset:36960
ds_read_b64_tr_b16 v[46:47], v20 offset:39264
v_mfma_f32_16x16x32_bf16 v[148:151], v[76:79], v[188:191], v[148:151]
ds_read_b64_tr_b16 v[48:49], v20 offset:36992
ds_read_b64_tr_b16 v[50:51], v20 offset:39296
s_waitcnt lgkmcnt(15)
v_mfma_f32_16x16x32_bf16 v[116:119], v[80:83], v[184:187], v[116:119]
ds_read_b64_tr_b16 v[52:53], v20 offset:37024
ds_read_b64_tr_b16 v[54:55], v20 offset:39328
v_mfma_f32_16x16x32_bf16 v[152:155], v[80:83], v[188:191], v[152:155]
ds_read_b64_tr_b16 v[56:57], v20 offset:37056
ds_read_b64_tr_b16 v[58:59], v20 offset:39360
v_mfma_f32_16x16x32_bf16 v[120:123], v[84:87], v[184:187], v[120:123]
ds_read_b64_tr_b16 v[60:61], v20 offset:37088
ds_read_b64_tr_b16 v[62:63], v20 offset:39392
v_mfma_f32_16x16x32_bf16 v[156:159], v[84:87], v[188:191], v[156:159]
ds_read_b64_tr_b16 v[64:65], v20 offset:37120
ds_read_b64_tr_b16 v[66:67], v20 offset:39424
v_mfma_f32_16x16x32_bf16 v[124:127], v[88:91], v[184:187], v[124:127]
v_mfma_f32_16x16x32_bf16 v[160:163], v[88:91], v[188:191], v[160:163]
v_mfma_f32_16x16x32_bf16 v[128:131], v[92:95], v[184:187], v[128:131]
v_mfma_f32_16x16x32_bf16 v[164:167], v[92:95], v[188:191], v[164:167]
s_waitcnt lgkmcnt(15)
v_mfma_f32_16x16x32_bf16 v[132:135], v[96:99], v[184:187], v[132:135]
v_mfma_f32_16x16x32_bf16 v[168:171], v[96:99], v[188:191], v[168:171]
v_mfma_f32_16x16x32_bf16 v[136:139], v[100:103], v[184:187], v[136:139]
v_mfma_f32_16x16x32_bf16 v[172:175], v[100:103], v[188:191], v[172:175]
v_mfma_f32_16x16x32_bf16 v[104:107], v[32:35], v[176:179], v[104:107]
ds_read_b128 v[184:187], v25 offset:38912
ds_read_b128 v[188:191], v25 offset:39168
v_mfma_f32_16x16x32_bf16 v[140:143], v[32:35], v[180:183], v[140:143]
ds_read_b64_tr_b16 v[68:69], v20 offset:46080
ds_read_b64_tr_b16 v[70:71], v20 offset:48384
s_waitcnt lgkmcnt(15)
v_mfma_f32_16x16x32_bf16 v[108:111], v[36:39], v[176:179], v[108:111]
ds_read_b64_tr_b16 v[72:73], v20 offset:46112
ds_read_b64_tr_b16 v[74:75], v20 offset:48416
v_mfma_f32_16x16x32_bf16 v[144:147], v[36:39], v[180:183], v[144:147]
ds_read_b64_tr_b16 v[76:77], v20 offset:46144
ds_read_b64_tr_b16 v[78:79], v20 offset:48448
v_mfma_f32_16x16x32_bf16 v[112:115], v[40:43], v[176:179], v[112:115]
ds_read_b64_tr_b16 v[80:81], v20 offset:46176
ds_read_b64_tr_b16 v[82:83], v20 offset:48480
v_mfma_f32_16x16x32_bf16 v[148:151], v[40:43], v[180:183], v[148:151]
ds_read_b64_tr_b16 v[84:85], v20 offset:46208
ds_read_b64_tr_b16 v[86:87], v20 offset:48512
s_waitcnt lgkmcnt(15)
v_mfma_f32_16x16x32_bf16 v[116:119], v[44:47], v[176:179], v[116:119]
ds_read_b64_tr_b16 v[88:89], v20 offset:46240
ds_read_b64_tr_b16 v[90:91], v20 offset:48544
v_mfma_f32_16x16x32_bf16 v[152:155], v[44:47], v[180:183], v[152:155]
ds_read_b64_tr_b16 v[92:93], v20 offset:46272
ds_read_b64_tr_b16 v[94:95], v20 offset:48576
v_mfma_f32_16x16x32_bf16 v[120:123], v[48:51], v[176:179], v[120:123]
ds_read_b64_tr_b16 v[96:97], v20 offset:46304
ds_read_b64_tr_b16 v[98:99], v20 offset:48608
v_mfma_f32_16x16x32_bf16 v[156:159], v[48:51], v[180:183], v[156:159]
ds_read_b64_tr_b16 v[100:101], v20 offset:46336
ds_read_b64_tr_b16 v[102:103], v20 offset:48640
v_mfma_f32_16x16x32_bf16 v[124:127], v[52:55], v[176:179], v[124:127]
v_mfma_f32_16x16x32_bf16 v[160:163], v[52:55], v[180:183], v[160:163]
v_mfma_f32_16x16x32_bf16 v[128:131], v[56:59], v[176:179], v[128:131]
v_mfma_f32_16x16x32_bf16 v[164:167], v[56:59], v[180:183], v[164:167]
s_waitcnt lgkmcnt(15)
v_mfma_f32_16x16x32_bf16 v[132:135], v[60:63], v[176:179], v[132:135]
v_mfma_f32_16x16x32_bf16 v[168:171], v[60:63], v[180:183], v[168:171]
v_mfma_f32_16x16x32_bf16 v[136:139], v[64:67], v[176:179], v[136:139]
v_mfma_f32_16x16x32_bf16 v[172:175], v[64:67], v[180:183], v[172:175]
s_barrier
v_mfma_f32_16x16x32_bf16 v[104:107], v[68:71], v[184:187], v[104:107]
ds_read_b128 v[176:179], v26 offset:0
ds_read_b128 v[180:183], v26 offset:256
v_mfma_f32_16x16x32_bf16 v[140:143], v[68:71], v[188:191], v[140:143]
ds_read_b64_tr_b16 v[32:33], v21 offset:0
ds_read_b64_tr_b16 v[34:35], v21 offset:2304
s_waitcnt lgkmcnt(15)
v_mfma_f32_16x16x32_bf16 v[108:111], v[72:75], v[184:187], v[108:111]
ds_read_b64_tr_b16 v[36:37], v21 offset:32
ds_read_b64_tr_b16 v[38:39], v21 offset:2336
v_mfma_f32_16x16x32_bf16 v[144:147], v[72:75], v[188:191], v[144:147]
ds_read_b64_tr_b16 v[40:41], v21 offset:64
ds_read_b64_tr_b16 v[42:43], v21 offset:2368
v_mfma_f32_16x16x32_bf16 v[112:115], v[76:79], v[184:187], v[112:115]
ds_read_b64_tr_b16 v[44:45], v21 offset:96
ds_read_b64_tr_b16 v[46:47], v21 offset:2400
v_mfma_f32_16x16x32_bf16 v[148:151], v[76:79], v[188:191], v[148:151]
ds_read_b64_tr_b16 v[48:49], v21 offset:128
ds_read_b64_tr_b16 v[50:51], v21 offset:2432
s_waitcnt lgkmcnt(15)
v_mfma_f32_16x16x32_bf16 v[116:119], v[80:83], v[184:187], v[116:119]
ds_read_b64_tr_b16 v[52:53], v21 offset:160
ds_read_b64_tr_b16 v[54:55], v21 offset:2464
v_mfma_f32_16x16x32_bf16 v[152:155], v[80:83], v[188:191], v[152:155]
ds_read_b64_tr_b16 v[56:57], v21 offset:192
ds_read_b64_tr_b16 v[58:59], v21 offset:2496
v_mfma_f32_16x16x32_bf16 v[120:123], v[84:87], v[184:187], v[120:123]
ds_read_b64_tr_b16 v[60:61], v21 offset:224
ds_read_b64_tr_b16 v[62:63], v21 offset:2528
v_mfma_f32_16x16x32_bf16 v[156:159], v[84:87], v[188:191], v[156:159]
ds_read_b64_tr_b16 v[64:65], v21 offset:256
ds_read_b64_tr_b16 v[66:67], v21 offset:2560
v_mfma_f32_16x16x32_bf16 v[124:127], v[88:91], v[184:187], v[124:127]
v_mfma_f32_16x16x32_bf16 v[160:163], v[88:91], v[188:191], v[160:163]
v_mfma_f32_16x16x32_bf16 v[128:131], v[92:95], v[184:187], v[128:131]
v_mfma_f32_16x16x32_bf16 v[164:167], v[92:95], v[188:191], v[164:167]
s_waitcnt lgkmcnt(15)
v_mfma_f32_16x16x32_bf16 v[132:135], v[96:99], v[184:187], v[132:135]
v_mfma_f32_16x16x32_bf16 v[168:171], v[96:99], v[188:191], v[168:171]
v_mfma_f32_16x16x32_bf16 v[136:139], v[100:103], v[184:187], v[136:139]
v_mfma_f32_16x16x32_bf16 v[172:175], v[100:103], v[188:191], v[172:175]
v_mfma_f32_16x16x32_bf16 v[104:107], v[32:35], v[176:179], v[104:107]
ds_read_b128 v[184:187], v26 offset:2048
ds_read_b128 v[188:191], v26 offset:2304
v_mfma_f32_16x16x32_bf16 v[140:143], v[32:35], v[180:183], v[140:143]
ds_read_b64_tr_b16 v[68:69], v21 offset:9216
ds_read_b64_tr_b16 v[70:71], v21 offset:11520
s_waitcnt lgkmcnt(15)
v_mfma_f32_16x16x32_bf16 v[108:111], v[36:39], v[176:179], v[108:111]
ds_read_b64_tr_b16 v[72:73], v21 offset:9248
ds_read_b64_tr_b16 v[74:75], v21 offset:11552
v_mfma_f32_16x16x32_bf16 v[144:147], v[36:39], v[180:183], v[144:147]
ds_read_b64_tr_b16 v[76:77], v21 offset:9280
ds_read_b64_tr_b16 v[78:79], v21 offset:11584
v_mfma_f32_16x16x32_bf16 v[112:115], v[40:43], v[176:179], v[112:115]
ds_read_b64_tr_b16 v[80:81], v21 offset:9312
ds_read_b64_tr_b16 v[82:83], v21 offset:11616
v_mfma_f32_16x16x32_bf16 v[148:151], v[40:43], v[180:183], v[148:151]
ds_read_b64_tr_b16 v[84:85], v21 offset:9344
ds_read_b64_tr_b16 v[86:87], v21 offset:11648
s_waitcnt lgkmcnt(15)
v_mfma_f32_16x16x32_bf16 v[116:119], v[44:47], v[176:179], v[116:119]
ds_read_b64_tr_b16 v[88:89], v21 offset:9376
ds_read_b64_tr_b16 v[90:91], v21 offset:11680
v_mfma_f32_16x16x32_bf16 v[152:155], v[44:47], v[180:183], v[152:155]
ds_read_b64_tr_b16 v[92:93], v21 offset:9408
ds_read_b64_tr_b16 v[94:95], v21 offset:11712
v_mfma_f32_16x16x32_bf16 v[120:123], v[48:51], v[176:179], v[120:123]
ds_read_b64_tr_b16 v[96:97], v21 offset:9440
ds_read_b64_tr_b16 v[98:99], v21 offset:11744
v_mfma_f32_16x16x32_bf16 v[156:159], v[48:51], v[180:183], v[156:159]
ds_read_b64_tr_b16 v[100:101], v21 offset:9472
ds_read_b64_tr_b16 v[102:103], v21 offset:11776
v_mfma_f32_16x16x32_bf16 v[124:127], v[52:55], v[176:179], v[124:127]
v_mfma_f32_16x16x32_bf16 v[160:163], v[52:55], v[180:183], v[160:163]
v_mfma_f32_16x16x32_bf16 v[128:131], v[56:59], v[176:179], v[128:131]
v_mfma_f32_16x16x32_bf16 v[164:167], v[56:59], v[180:183], v[164:167]
s_waitcnt lgkmcnt(15)
v_mfma_f32_16x16x32_bf16 v[132:135], v[60:63], v[176:179], v[132:135]
v_mfma_f32_16x16x32_bf16 v[168:171], v[60:63], v[180:183], v[168:171]
v_mfma_f32_16x16x32_bf16 v[136:139], v[64:67], v[176:179], v[136:139]
v_mfma_f32_16x16x32_bf16 v[172:175], v[64:67], v[180:183], v[172:175]
s_barrier
v_mfma_f32_16x16x32_bf16 v[104:107], v[68:71], v[184:187], v[104:107]
ds_read_b128 v[176:179], v26 offset:36864
ds_read_b128 v[180:183], v26 offset:37120
v_mfma_f32_16x16x32_bf16 v[140:143], v[68:71], v[188:191], v[140:143]
ds_read_b64_tr_b16 v[32:33], v21 offset:36864
ds_read_b64_tr_b16 v[34:35], v21 offset:39168
s_waitcnt lgkmcnt(15)
v_mfma_f32_16x16x32_bf16 v[108:111], v[72:75], v[184:187], v[108:111]
ds_read_b64_tr_b16 v[36:37], v21 offset:36896
ds_read_b64_tr_b16 v[38:39], v21 offset:39200
v_mfma_f32_16x16x32_bf16 v[144:147], v[72:75], v[188:191], v[144:147]
ds_read_b64_tr_b16 v[40:41], v21 offset:36928
ds_read_b64_tr_b16 v[42:43], v21 offset:39232
v_mfma_f32_16x16x32_bf16 v[112:115], v[76:79], v[184:187], v[112:115]
ds_read_b64_tr_b16 v[44:45], v21 offset:36960
ds_read_b64_tr_b16 v[46:47], v21 offset:39264
v_mfma_f32_16x16x32_bf16 v[148:151], v[76:79], v[188:191], v[148:151]
ds_read_b64_tr_b16 v[48:49], v21 offset:36992
ds_read_b64_tr_b16 v[50:51], v21 offset:39296
s_waitcnt lgkmcnt(15)
v_mfma_f32_16x16x32_bf16 v[116:119], v[80:83], v[184:187], v[116:119]
ds_read_b64_tr_b16 v[52:53], v21 offset:37024
ds_read_b64_tr_b16 v[54:55], v21 offset:39328
v_mfma_f32_16x16x32_bf16 v[152:155], v[80:83], v[188:191], v[152:155]
ds_read_b64_tr_b16 v[56:57], v21 offset:37056
ds_read_b64_tr_b16 v[58:59], v21 offset:39360
v_mfma_f32_16x16x32_bf16 v[120:123], v[84:87], v[184:187], v[120:123]
ds_read_b64_tr_b16 v[60:61], v21 offset:37088
ds_read_b64_tr_b16 v[62:63], v21 offset:39392
v_mfma_f32_16x16x32_bf16 v[156:159], v[84:87], v[188:191], v[156:159]
ds_read_b64_tr_b16 v[64:65], v21 offset:37120
ds_read_b64_tr_b16 v[66:67], v21 offset:39424
v_mfma_f32_16x16x32_bf16 v[124:127], v[88:91], v[184:187], v[124:127]
v_mfma_f32_16x16x32_bf16 v[160:163], v[88:91], v[188:191], v[160:163]
v_mfma_f32_16x16x32_bf16 v[128:131], v[92:95], v[184:187], v[128:131]
v_mfma_f32_16x16x32_bf16 v[164:167], v[92:95], v[188:191], v[164:167]
s_waitcnt lgkmcnt(15)
v_mfma_f32_16x16x32_bf16 v[132:135], v[96:99], v[184:187], v[132:135]
v_mfma_f32_16x16x32_bf16 v[168:171], v[96:99], v[188:191], v[168:171]
v_mfma_f32_16x16x32_bf16 v[136:139], v[100:103], v[184:187], v[136:139]
v_mfma_f32_16x16x32_bf16 v[172:175], v[100:103], v[188:191], v[172:175]
v_mfma_f32_16x16x32_bf16 v[104:107], v[32:35], v[176:179], v[104:107]
ds_read_b128 v[184:187], v26 offset:38912
ds_read_b128 v[188:191], v26 offset:39168
v_mfma_f32_16x16x32_bf16 v[140:143], v[32:35], v[180:183], v[140:143]
ds_read_b64_tr_b16 v[68:69], v21 offset:46080
ds_read_b64_tr_b16 v[70:71], v21 offset:48384
s_waitcnt lgkmcnt(15)
v_mfma_f32_16x16x32_bf16 v[108:111], v[36:39], v[176:179], v[108:111]
ds_read_b64_tr_b16 v[72:73], v21 offset:46112
ds_read_b64_tr_b16 v[74:75], v21 offset:48416
v_mfma_f32_16x16x32_bf16 v[144:147], v[36:39], v[180:183], v[144:147]
ds_read_b64_tr_b16 v[76:77], v21 offset:46144
ds_read_b64_tr_b16 v[78:79], v21 offset:48448
v_mfma_f32_16x16x32_bf16 v[112:115], v[40:43], v[176:179], v[112:115]
ds_read_b64_tr_b16 v[80:81], v21 offset:46176
ds_read_b64_tr_b16 v[82:83], v21 offset:48480
v_mfma_f32_16x16x32_bf16 v[148:151], v[40:43], v[180:183], v[148:151]
ds_read_b64_tr_b16 v[84:85], v21 offset:46208
ds_read_b64_tr_b16 v[86:87], v21 offset:48512
s_waitcnt lgkmcnt(15)
v_mfma_f32_16x16x32_bf16 v[116:119], v[44:47], v[176:179], v[116:119]
ds_read_b64_tr_b16 v[88:89], v21 offset:46240
ds_read_b64_tr_b16 v[90:91], v21 offset:48544
v_mfma_f32_16x16x32_bf16 v[152:155], v[44:47], v[180:183], v[152:155]
ds_read_b64_tr_b16 v[92:93], v21 offset:46272
ds_read_b64_tr_b16 v[94:95], v21 offset:48576
v_mfma_f32_16x16x32_bf16 v[120:123], v[48:51], v[176:179], v[120:123]
ds_read_b64_tr_b16 v[96:97], v21 offset:46304
ds_read_b64_tr_b16 v[98:99], v21 offset:48608
v_mfma_f32_16x16x32_bf16 v[156:159], v[48:51], v[180:183], v[156:159]
ds_read_b64_tr_b16 v[100:101], v21 offset:46336
ds_read_b64_tr_b16 v[102:103], v21 offset:48640
v_mfma_f32_16x16x32_bf16 v[124:127], v[52:55], v[176:179], v[124:127]
v_mfma_f32_16x16x32_bf16 v[160:163], v[52:55], v[180:183], v[160:163]
v_mfma_f32_16x16x32_bf16 v[128:131], v[56:59], v[176:179], v[128:131]
v_mfma_f32_16x16x32_bf16 v[164:167], v[56:59], v[180:183], v[164:167]
s_waitcnt lgkmcnt(15)
v_mfma_f32_16x16x32_bf16 v[132:135], v[60:63], v[176:179], v[132:135]
v_mfma_f32_16x16x32_bf16 v[168:171], v[60:63], v[180:183], v[168:171]
v_mfma_f32_16x16x32_bf16 v[136:139], v[64:67], v[176:179], v[136:139]
v_mfma_f32_16x16x32_bf16 v[172:175], v[64:67], v[180:183], v[172:175]
s_barrier
v_mfma_f32_16x16x32_bf16 v[104:107], v[68:71], v[184:187], v[104:107]
ds_read_b128 v[176:179], v25 offset:0
ds_read_b128 v[180:183], v25 offset:256
v_mfma_f32_16x16x32_bf16 v[140:143], v[68:71], v[188:191], v[140:143]
ds_read_b64_tr_b16 v[32:33], v20 offset:0
ds_read_b64_tr_b16 v[34:35], v20 offset:2304
s_waitcnt lgkmcnt(15)
v_mfma_f32_16x16x32_bf16 v[108:111], v[72:75], v[184:187], v[108:111]
ds_read_b64_tr_b16 v[36:37], v20 offset:32
ds_read_b64_tr_b16 v[38:39], v20 offset:2336
v_mfma_f32_16x16x32_bf16 v[144:147], v[72:75], v[188:191], v[144:147]
ds_read_b64_tr_b16 v[40:41], v20 offset:64
ds_read_b64_tr_b16 v[42:43], v20 offset:2368
v_mfma_f32_16x16x32_bf16 v[112:115], v[76:79], v[184:187], v[112:115]
ds_read_b64_tr_b16 v[44:45], v20 offset:96
ds_read_b64_tr_b16 v[46:47], v20 offset:2400
v_mfma_f32_16x16x32_bf16 v[148:151], v[76:79], v[188:191], v[148:151]
ds_read_b64_tr_b16 v[48:49], v20 offset:128
ds_read_b64_tr_b16 v[50:51], v20 offset:2432
s_waitcnt lgkmcnt(15)
v_mfma_f32_16x16x32_bf16 v[116:119], v[80:83], v[184:187], v[116:119]
ds_read_b64_tr_b16 v[52:53], v20 offset:160
ds_read_b64_tr_b16 v[54:55], v20 offset:2464
v_mfma_f32_16x16x32_bf16 v[152:155], v[80:83], v[188:191], v[152:155]
ds_read_b64_tr_b16 v[56:57], v20 offset:192
ds_read_b64_tr_b16 v[58:59], v20 offset:2496
v_mfma_f32_16x16x32_bf16 v[120:123], v[84:87], v[184:187], v[120:123]
ds_read_b64_tr_b16 v[60:61], v20 offset:224
ds_read_b64_tr_b16 v[62:63], v20 offset:2528
v_mfma_f32_16x16x32_bf16 v[156:159], v[84:87], v[188:191], v[156:159]
ds_read_b64_tr_b16 v[64:65], v20 offset:256
ds_read_b64_tr_b16 v[66:67], v20 offset:2560
v_mfma_f32_16x16x32_bf16 v[124:127], v[88:91], v[184:187], v[124:127]
v_mfma_f32_16x16x32_bf16 v[160:163], v[88:91], v[188:191], v[160:163]
v_mfma_f32_16x16x32_bf16 v[128:131], v[92:95], v[184:187], v[128:131]
v_mfma_f32_16x16x32_bf16 v[164:167], v[92:95], v[188:191], v[164:167]
s_waitcnt lgkmcnt(15)
v_mfma_f32_16x16x32_bf16 v[132:135], v[96:99], v[184:187], v[132:135]
v_mfma_f32_16x16x32_bf16 v[168:171], v[96:99], v[188:191], v[168:171]
v_mfma_f32_16x16x32_bf16 v[136:139], v[100:103], v[184:187], v[136:139]
v_mfma_f32_16x16x32_bf16 v[172:175], v[100:103], v[188:191], v[172:175]
v_mfma_f32_16x16x32_bf16 v[104:107], v[32:35], v[176:179], v[104:107]
ds_read_b128 v[184:187], v25 offset:2048
ds_read_b128 v[188:191], v25 offset:2304
v_mfma_f32_16x16x32_bf16 v[140:143], v[32:35], v[180:183], v[140:143]
ds_read_b64_tr_b16 v[68:69], v20 offset:9216
ds_read_b64_tr_b16 v[70:71], v20 offset:11520
s_waitcnt lgkmcnt(15)
v_mfma_f32_16x16x32_bf16 v[108:111], v[36:39], v[176:179], v[108:111]
ds_read_b64_tr_b16 v[72:73], v20 offset:9248
ds_read_b64_tr_b16 v[74:75], v20 offset:11552
v_mfma_f32_16x16x32_bf16 v[144:147], v[36:39], v[180:183], v[144:147]
ds_read_b64_tr_b16 v[76:77], v20 offset:9280
ds_read_b64_tr_b16 v[78:79], v20 offset:11584
v_mfma_f32_16x16x32_bf16 v[112:115], v[40:43], v[176:179], v[112:115]
ds_read_b64_tr_b16 v[80:81], v20 offset:9312
ds_read_b64_tr_b16 v[82:83], v20 offset:11616
v_mfma_f32_16x16x32_bf16 v[148:151], v[40:43], v[180:183], v[148:151]
ds_read_b64_tr_b16 v[84:85], v20 offset:9344
ds_read_b64_tr_b16 v[86:87], v20 offset:11648
s_waitcnt lgkmcnt(15)
v_mfma_f32_16x16x32_bf16 v[116:119], v[44:47], v[176:179], v[116:119]
ds_read_b64_tr_b16 v[88:89], v20 offset:9376
ds_read_b64_tr_b16 v[90:91], v20 offset:11680
v_mfma_f32_16x16x32_bf16 v[152:155], v[44:47], v[180:183], v[152:155]
ds_read_b64_tr_b16 v[92:93], v20 offset:9408
ds_read_b64_tr_b16 v[94:95], v20 offset:11712
v_mfma_f32_16x16x32_bf16 v[120:123], v[48:51], v[176:179], v[120:123]
ds_read_b64_tr_b16 v[96:97], v20 offset:9440
ds_read_b64_tr_b16 v[98:99], v20 offset:11744
v_mfma_f32_16x16x32_bf16 v[156:159], v[48:51], v[180:183], v[156:159]
ds_read_b64_tr_b16 v[100:101], v20 offset:9472
ds_read_b64_tr_b16 v[102:103], v20 offset:11776
v_mfma_f32_16x16x32_bf16 v[124:127], v[52:55], v[176:179], v[124:127]
v_mfma_f32_16x16x32_bf16 v[160:163], v[52:55], v[180:183], v[160:163]
v_mfma_f32_16x16x32_bf16 v[128:131], v[56:59], v[176:179], v[128:131]
v_mfma_f32_16x16x32_bf16 v[164:167], v[56:59], v[180:183], v[164:167]
s_waitcnt lgkmcnt(15)
v_mfma_f32_16x16x32_bf16 v[132:135], v[60:63], v[176:179], v[132:135]
v_mfma_f32_16x16x32_bf16 v[168:171], v[60:63], v[180:183], v[168:171]
v_mfma_f32_16x16x32_bf16 v[136:139], v[64:67], v[176:179], v[136:139]
v_mfma_f32_16x16x32_bf16 v[172:175], v[64:67], v[180:183], v[172:175]
s_barrier
v_mfma_f32_16x16x32_bf16 v[104:107], v[68:71], v[184:187], v[104:107]
ds_read_b128 v[176:179], v25 offset:36864
ds_read_b128 v[180:183], v25 offset:37120
v_mfma_f32_16x16x32_bf16 v[140:143], v[68:71], v[188:191], v[140:143]
ds_read_b64_tr_b16 v[32:33], v20 offset:36864
ds_read_b64_tr_b16 v[34:35], v20 offset:39168
s_waitcnt lgkmcnt(15)
v_mfma_f32_16x16x32_bf16 v[108:111], v[72:75], v[184:187], v[108:111]
ds_read_b64_tr_b16 v[36:37], v20 offset:36896
ds_read_b64_tr_b16 v[38:39], v20 offset:39200
v_mfma_f32_16x16x32_bf16 v[144:147], v[72:75], v[188:191], v[144:147]
ds_read_b64_tr_b16 v[40:41], v20 offset:36928
ds_read_b64_tr_b16 v[42:43], v20 offset:39232
v_mfma_f32_16x16x32_bf16 v[112:115], v[76:79], v[184:187], v[112:115]
ds_read_b64_tr_b16 v[44:45], v20 offset:36960
ds_read_b64_tr_b16 v[46:47], v20 offset:39264
v_mfma_f32_16x16x32_bf16 v[148:151], v[76:79], v[188:191], v[148:151]
ds_read_b64_tr_b16 v[48:49], v20 offset:36992
ds_read_b64_tr_b16 v[50:51], v20 offset:39296
s_waitcnt lgkmcnt(15)
v_mfma_f32_16x16x32_bf16 v[116:119], v[80:83], v[184:187], v[116:119]
ds_read_b64_tr_b16 v[52:53], v20 offset:37024
ds_read_b64_tr_b16 v[54:55], v20 offset:39328
v_mfma_f32_16x16x32_bf16 v[152:155], v[80:83], v[188:191], v[152:155]
ds_read_b64_tr_b16 v[56:57], v20 offset:37056
ds_read_b64_tr_b16 v[58:59], v20 offset:39360
v_mfma_f32_16x16x32_bf16 v[120:123], v[84:87], v[184:187], v[120:123]
ds_read_b64_tr_b16 v[60:61], v20 offset:37088
ds_read_b64_tr_b16 v[62:63], v20 offset:39392
v_mfma_f32_16x16x32_bf16 v[156:159], v[84:87], v[188:191], v[156:159]
ds_read_b64_tr_b16 v[64:65], v20 offset:37120
ds_read_b64_tr_b16 v[66:67], v20 offset:39424
v_mfma_f32_16x16x32_bf16 v[124:127], v[88:91], v[184:187], v[124:127]
v_mfma_f32_16x16x32_bf16 v[160:163], v[88:91], v[188:191], v[160:163]
v_mfma_f32_16x16x32_bf16 v[128:131], v[92:95], v[184:187], v[128:131]
v_mfma_f32_16x16x32_bf16 v[164:167], v[92:95], v[188:191], v[164:167]
s_waitcnt lgkmcnt(15)
v_mfma_f32_16x16x32_bf16 v[132:135], v[96:99], v[184:187], v[132:135]
v_mfma_f32_16x16x32_bf16 v[168:171], v[96:99], v[188:191], v[168:171]
v_mfma_f32_16x16x32_bf16 v[136:139], v[100:103], v[184:187], v[136:139]
v_mfma_f32_16x16x32_bf16 v[172:175], v[100:103], v[188:191], v[172:175]
v_mfma_f32_16x16x32_bf16 v[104:107], v[32:35], v[176:179], v[104:107]
ds_read_b128 v[184:187], v25 offset:38912
ds_read_b128 v[188:191], v25 offset:39168
v_mfma_f32_16x16x32_bf16 v[140:143], v[32:35], v[180:183], v[140:143]
ds_read_b64_tr_b16 v[68:69], v20 offset:46080
ds_read_b64_tr_b16 v[70:71], v20 offset:48384
s_waitcnt lgkmcnt(15)
v_mfma_f32_16x16x32_bf16 v[108:111], v[36:39], v[176:179], v[108:111]
ds_read_b64_tr_b16 v[72:73], v20 offset:46112
ds_read_b64_tr_b16 v[74:75], v20 offset:48416
v_mfma_f32_16x16x32_bf16 v[144:147], v[36:39], v[180:183], v[144:147]
ds_read_b64_tr_b16 v[76:77], v20 offset:46144
ds_read_b64_tr_b16 v[78:79], v20 offset:48448
v_mfma_f32_16x16x32_bf16 v[112:115], v[40:43], v[176:179], v[112:115]
ds_read_b64_tr_b16 v[80:81], v20 offset:46176
ds_read_b64_tr_b16 v[82:83], v20 offset:48480
v_mfma_f32_16x16x32_bf16 v[148:151], v[40:43], v[180:183], v[148:151]
ds_read_b64_tr_b16 v[84:85], v20 offset:46208
ds_read_b64_tr_b16 v[86:87], v20 offset:48512
s_waitcnt lgkmcnt(15)
v_mfma_f32_16x16x32_bf16 v[116:119], v[44:47], v[176:179], v[116:119]
ds_read_b64_tr_b16 v[88:89], v20 offset:46240
ds_read_b64_tr_b16 v[90:91], v20 offset:48544
v_mfma_f32_16x16x32_bf16 v[152:155], v[44:47], v[180:183], v[152:155]
ds_read_b64_tr_b16 v[92:93], v20 offset:46272
ds_read_b64_tr_b16 v[94:95], v20 offset:48576
v_mfma_f32_16x16x32_bf16 v[120:123], v[48:51], v[176:179], v[120:123]
ds_read_b64_tr_b16 v[96:97], v20 offset:46304
ds_read_b64_tr_b16 v[98:99], v20 offset:48608
v_mfma_f32_16x16x32_bf16 v[156:159], v[48:51], v[180:183], v[156:159]
ds_read_b64_tr_b16 v[100:101], v20 offset:46336
ds_read_b64_tr_b16 v[102:103], v20 offset:48640
v_mfma_f32_16x16x32_bf16 v[124:127], v[52:55], v[176:179], v[124:127]
v_mfma_f32_16x16x32_bf16 v[160:163], v[52:55], v[180:183], v[160:163]
v_mfma_f32_16x16x32_bf16 v[128:131], v[56:59], v[176:179], v[128:131]
v_mfma_f32_16x16x32_bf16 v[164:167], v[56:59], v[180:183], v[164:167]
s_waitcnt lgkmcnt(15)
v_mfma_f32_16x16x32_bf16 v[132:135], v[60:63], v[176:179], v[132:135]
v_mfma_f32_16x16x32_bf16 v[168:171], v[60:63], v[180:183], v[168:171]
v_mfma_f32_16x16x32_bf16 v[136:139], v[64:67], v[176:179], v[136:139]
v_mfma_f32_16x16x32_bf16 v[172:175], v[64:67], v[180:183], v[172:175]
s_barrier
v_mfma_f32_16x16x32_bf16 v[104:107], v[68:71], v[184:187], v[104:107]
ds_read_b128 v[176:179], v26 offset:0
ds_read_b128 v[180:183], v26 offset:256
v_mfma_f32_16x16x32_bf16 v[140:143], v[68:71], v[188:191], v[140:143]
ds_read_b64_tr_b16 v[32:33], v21 offset:0
ds_read_b64_tr_b16 v[34:35], v21 offset:2304
s_waitcnt lgkmcnt(15)
v_mfma_f32_16x16x32_bf16 v[108:111], v[72:75], v[184:187], v[108:111]
ds_read_b64_tr_b16 v[36:37], v21 offset:32
ds_read_b64_tr_b16 v[38:39], v21 offset:2336
v_mfma_f32_16x16x32_bf16 v[144:147], v[72:75], v[188:191], v[144:147]
ds_read_b64_tr_b16 v[40:41], v21 offset:64
ds_read_b64_tr_b16 v[42:43], v21 offset:2368
v_mfma_f32_16x16x32_bf16 v[112:115], v[76:79], v[184:187], v[112:115]
ds_read_b64_tr_b16 v[44:45], v21 offset:96
ds_read_b64_tr_b16 v[46:47], v21 offset:2400
v_mfma_f32_16x16x32_bf16 v[148:151], v[76:79], v[188:191], v[148:151]
ds_read_b64_tr_b16 v[48:49], v21 offset:128
ds_read_b64_tr_b16 v[50:51], v21 offset:2432
s_waitcnt lgkmcnt(15)
v_mfma_f32_16x16x32_bf16 v[116:119], v[80:83], v[184:187], v[116:119]
ds_read_b64_tr_b16 v[52:53], v21 offset:160
ds_read_b64_tr_b16 v[54:55], v21 offset:2464
v_mfma_f32_16x16x32_bf16 v[152:155], v[80:83], v[188:191], v[152:155]
ds_read_b64_tr_b16 v[56:57], v21 offset:192
ds_read_b64_tr_b16 v[58:59], v21 offset:2496
v_mfma_f32_16x16x32_bf16 v[120:123], v[84:87], v[184:187], v[120:123]
ds_read_b64_tr_b16 v[60:61], v21 offset:224
ds_read_b64_tr_b16 v[62:63], v21 offset:2528
v_mfma_f32_16x16x32_bf16 v[156:159], v[84:87], v[188:191], v[156:159]
ds_read_b64_tr_b16 v[64:65], v21 offset:256
ds_read_b64_tr_b16 v[66:67], v21 offset:2560
v_mfma_f32_16x16x32_bf16 v[124:127], v[88:91], v[184:187], v[124:127]
v_mfma_f32_16x16x32_bf16 v[160:163], v[88:91], v[188:191], v[160:163]
v_mfma_f32_16x16x32_bf16 v[128:131], v[92:95], v[184:187], v[128:131]
v_mfma_f32_16x16x32_bf16 v[164:167], v[92:95], v[188:191], v[164:167]
s_waitcnt lgkmcnt(15)
v_mfma_f32_16x16x32_bf16 v[132:135], v[96:99], v[184:187], v[132:135]
v_mfma_f32_16x16x32_bf16 v[168:171], v[96:99], v[188:191], v[168:171]
v_mfma_f32_16x16x32_bf16 v[136:139], v[100:103], v[184:187], v[136:139]
v_mfma_f32_16x16x32_bf16 v[172:175], v[100:103], v[188:191], v[172:175]
v_mfma_f32_16x16x32_bf16 v[104:107], v[32:35], v[176:179], v[104:107]
ds_read_b128 v[184:187], v26 offset:2048
ds_read_b128 v[188:191], v26 offset:2304
v_mfma_f32_16x16x32_bf16 v[140:143], v[32:35], v[180:183], v[140:143]
ds_read_b64_tr_b16 v[68:69], v21 offset:9216
ds_read_b64_tr_b16 v[70:71], v21 offset:11520
s_waitcnt lgkmcnt(15)
v_mfma_f32_16x16x32_bf16 v[108:111], v[36:39], v[176:179], v[108:111]
ds_read_b64_tr_b16 v[72:73], v21 offset:9248
ds_read_b64_tr_b16 v[74:75], v21 offset:11552
v_mfma_f32_16x16x32_bf16 v[144:147], v[36:39], v[180:183], v[144:147]
ds_read_b64_tr_b16 v[76:77], v21 offset:9280
ds_read_b64_tr_b16 v[78:79], v21 offset:11584
v_mfma_f32_16x16x32_bf16 v[112:115], v[40:43], v[176:179], v[112:115]
ds_read_b64_tr_b16 v[80:81], v21 offset:9312
ds_read_b64_tr_b16 v[82:83], v21 offset:11616
v_mfma_f32_16x16x32_bf16 v[148:151], v[40:43], v[180:183], v[148:151]
ds_read_b64_tr_b16 v[84:85], v21 offset:9344
ds_read_b64_tr_b16 v[86:87], v21 offset:11648
s_waitcnt lgkmcnt(15)
v_mfma_f32_16x16x32_bf16 v[116:119], v[44:47], v[176:179], v[116:119]
ds_read_b64_tr_b16 v[88:89], v21 offset:9376
ds_read_b64_tr_b16 v[90:91], v21 offset:11680
v_mfma_f32_16x16x32_bf16 v[152:155], v[44:47], v[180:183], v[152:155]
ds_read_b64_tr_b16 v[92:93], v21 offset:9408
ds_read_b64_tr_b16 v[94:95], v21 offset:11712
v_mfma_f32_16x16x32_bf16 v[120:123], v[48:51], v[176:179], v[120:123]
ds_read_b64_tr_b16 v[96:97], v21 offset:9440
ds_read_b64_tr_b16 v[98:99], v21 offset:11744
v_mfma_f32_16x16x32_bf16 v[156:159], v[48:51], v[180:183], v[156:159]
ds_read_b64_tr_b16 v[100:101], v21 offset:9472
ds_read_b64_tr_b16 v[102:103], v21 offset:11776
v_mfma_f32_16x16x32_bf16 v[124:127], v[52:55], v[176:179], v[124:127]
v_mfma_f32_16x16x32_bf16 v[160:163], v[52:55], v[180:183], v[160:163]
v_mfma_f32_16x16x32_bf16 v[128:131], v[56:59], v[176:179], v[128:131]
v_mfma_f32_16x16x32_bf16 v[164:167], v[56:59], v[180:183], v[164:167]
s_waitcnt lgkmcnt(15)
v_mfma_f32_16x16x32_bf16 v[132:135], v[60:63], v[176:179], v[132:135]
v_mfma_f32_16x16x32_bf16 v[168:171], v[60:63], v[180:183], v[168:171]
v_mfma_f32_16x16x32_bf16 v[136:139], v[64:67], v[176:179], v[136:139]
v_mfma_f32_16x16x32_bf16 v[172:175], v[64:67], v[180:183], v[172:175]
s_barrier
v_mfma_f32_16x16x32_bf16 v[104:107], v[68:71], v[184:187], v[104:107]
ds_read_b128 v[176:179], v26 offset:36864
ds_read_b128 v[180:183], v26 offset:37120
v_mfma_f32_16x16x32_bf16 v[140:143], v[68:71], v[188:191], v[140:143]
ds_read_b64_tr_b16 v[32:33], v21 offset:36864
ds_read_b64_tr_b16 v[34:35], v21 offset:39168
s_waitcnt lgkmcnt(15)
v_mfma_f32_16x16x32_bf16 v[108:111], v[72:75], v[184:187], v[108:111]
ds_read_b64_tr_b16 v[36:37], v21 offset:36896
ds_read_b64_tr_b16 v[38:39], v21 offset:39200
v_mfma_f32_16x16x32_bf16 v[144:147], v[72:75], v[188:191], v[144:147]
ds_read_b64_tr_b16 v[40:41], v21 offset:36928
ds_read_b64_tr_b16 v[42:43], v21 offset:39232
v_mfma_f32_16x16x32_bf16 v[112:115], v[76:79], v[184:187], v[112:115]
ds_read_b64_tr_b16 v[44:45], v21 offset:36960
ds_read_b64_tr_b16 v[46:47], v21 offset:39264
v_mfma_f32_16x16x32_bf16 v[148:151], v[76:79], v[188:191], v[148:151]
ds_read_b64_tr_b16 v[48:49], v21 offset:36992
ds_read_b64_tr_b16 v[50:51], v21 offset:39296
s_waitcnt lgkmcnt(15)
v_mfma_f32_16x16x32_bf16 v[116:119], v[80:83], v[184:187], v[116:119]
ds_read_b64_tr_b16 v[52:53], v21 offset:37024
ds_read_b64_tr_b16 v[54:55], v21 offset:39328
v_mfma_f32_16x16x32_bf16 v[152:155], v[80:83], v[188:191], v[152:155]
ds_read_b64_tr_b16 v[56:57], v21 offset:37056
ds_read_b64_tr_b16 v[58:59], v21 offset:39360
v_mfma_f32_16x16x32_bf16 v[120:123], v[84:87], v[184:187], v[120:123]
ds_read_b64_tr_b16 v[60:61], v21 offset:37088
ds_read_b64_tr_b16 v[62:63], v21 offset:39392
v_mfma_f32_16x16x32_bf16 v[156:159], v[84:87], v[188:191], v[156:159]
ds_read_b64_tr_b16 v[64:65], v21 offset:37120
ds_read_b64_tr_b16 v[66:67], v21 offset:39424
v_mfma_f32_16x16x32_bf16 v[124:127], v[88:91], v[184:187], v[124:127]
v_mfma_f32_16x16x32_bf16 v[160:163], v[88:91], v[188:191], v[160:163]
v_mfma_f32_16x16x32_bf16 v[128:131], v[92:95], v[184:187], v[128:131]
v_mfma_f32_16x16x32_bf16 v[164:167], v[92:95], v[188:191], v[164:167]
s_waitcnt lgkmcnt(15)
v_mfma_f32_16x16x32_bf16 v[132:135], v[96:99], v[184:187], v[132:135]
v_mfma_f32_16x16x32_bf16 v[168:171], v[96:99], v[188:191], v[168:171]
v_mfma_f32_16x16x32_bf16 v[136:139], v[100:103], v[184:187], v[136:139]
v_mfma_f32_16x16x32_bf16 v[172:175], v[100:103], v[188:191], v[172:175]
v_mfma_f32_16x16x32_bf16 v[104:107], v[32:35], v[176:179], v[104:107]
ds_read_b128 v[184:187], v26 offset:38912
ds_read_b128 v[188:191], v26 offset:39168
v_mfma_f32_16x16x32_bf16 v[140:143], v[32:35], v[180:183], v[140:143]
ds_read_b64_tr_b16 v[68:69], v21 offset:46080
ds_read_b64_tr_b16 v[70:71], v21 offset:48384
s_waitcnt lgkmcnt(15)
v_mfma_f32_16x16x32_bf16 v[108:111], v[36:39], v[176:179], v[108:111]
ds_read_b64_tr_b16 v[72:73], v21 offset:46112
ds_read_b64_tr_b16 v[74:75], v21 offset:48416
v_mfma_f32_16x16x32_bf16 v[144:147], v[36:39], v[180:183], v[144:147]
ds_read_b64_tr_b16 v[76:77], v21 offset:46144
ds_read_b64_tr_b16 v[78:79], v21 offset:48448
v_mfma_f32_16x16x32_bf16 v[112:115], v[40:43], v[176:179], v[112:115]
ds_read_b64_tr_b16 v[80:81], v21 offset:46176
ds_read_b64_tr_b16 v[82:83], v21 offset:48480
v_mfma_f32_16x16x32_bf16 v[148:151], v[40:43], v[180:183], v[148:151]
ds_read_b64_tr_b16 v[84:85], v21 offset:46208
ds_read_b64_tr_b16 v[86:87], v21 offset:48512
s_waitcnt lgkmcnt(15)
v_mfma_f32_16x16x32_bf16 v[116:119], v[44:47], v[176:179], v[116:119]
ds_read_b64_tr_b16 v[88:89], v21 offset:46240
ds_read_b64_tr_b16 v[90:91], v21 offset:48544
v_mfma_f32_16x16x32_bf16 v[152:155], v[44:47], v[180:183], v[152:155]
ds_read_b64_tr_b16 v[92:93], v21 offset:46272
ds_read_b64_tr_b16 v[94:95], v21 offset:48576
v_mfma_f32_16x16x32_bf16 v[120:123], v[48:51], v[176:179], v[120:123]
ds_read_b64_tr_b16 v[96:97], v21 offset:46304
ds_read_b64_tr_b16 v[98:99], v21 offset:48608
v_mfma_f32_16x16x32_bf16 v[156:159], v[48:51], v[180:183], v[156:159]
ds_read_b64_tr_b16 v[100:101], v21 offset:46336
ds_read_b64_tr_b16 v[102:103], v21 offset:48640
v_mfma_f32_16x16x32_bf16 v[124:127], v[52:55], v[176:179], v[124:127]
v_mfma_f32_16x16x32_bf16 v[160:163], v[52:55], v[180:183], v[160:163]
v_mfma_f32_16x16x32_bf16 v[128:131], v[56:59], v[176:179], v[128:131]
v_mfma_f32_16x16x32_bf16 v[164:167], v[56:59], v[180:183], v[164:167]
s_waitcnt lgkmcnt(15)
v_mfma_f32_16x16x32_bf16 v[132:135], v[60:63], v[176:179], v[132:135]
v_mfma_f32_16x16x32_bf16 v[168:171], v[60:63], v[180:183], v[168:171]
v_mfma_f32_16x16x32_bf16 v[136:139], v[64:67], v[176:179], v[136:139]
v_mfma_f32_16x16x32_bf16 v[172:175], v[64:67], v[180:183], v[172:175]
v_mfma_f32_16x16x32_bf16 v[104:107], v[68:71], v[184:187], v[104:107]
v_mfma_f32_16x16x32_bf16 v[140:143], v[68:71], v[188:191], v[140:143]
s_waitcnt lgkmcnt(14)
v_mfma_f32_16x16x32_bf16 v[108:111], v[72:75], v[184:187], v[108:111]
v_mfma_f32_16x16x32_bf16 v[144:147], v[72:75], v[188:191], v[144:147]
s_waitcnt lgkmcnt(12)
v_mfma_f32_16x16x32_bf16 v[112:115], v[76:79], v[184:187], v[112:115]
v_mfma_f32_16x16x32_bf16 v[148:151], v[76:79], v[188:191], v[148:151]
s_waitcnt lgkmcnt(10)
v_mfma_f32_16x16x32_bf16 v[116:119], v[80:83], v[184:187], v[116:119]
v_mfma_f32_16x16x32_bf16 v[152:155], v[80:83], v[188:191], v[152:155]
s_waitcnt lgkmcnt(8)
v_mfma_f32_16x16x32_bf16 v[120:123], v[84:87], v[184:187], v[120:123]
v_mfma_f32_16x16x32_bf16 v[156:159], v[84:87], v[188:191], v[156:159]
s_waitcnt lgkmcnt(6)
v_mfma_f32_16x16x32_bf16 v[124:127], v[88:91], v[184:187], v[124:127]
v_mfma_f32_16x16x32_bf16 v[160:163], v[88:91], v[188:191], v[160:163]
s_waitcnt lgkmcnt(4)
v_mfma_f32_16x16x32_bf16 v[128:131], v[92:95], v[184:187], v[128:131]
v_mfma_f32_16x16x32_bf16 v[164:167], v[92:95], v[188:191], v[164:167]
s_waitcnt lgkmcnt(2)
v_mfma_f32_16x16x32_bf16 v[132:135], v[96:99], v[184:187], v[132:135]
v_mfma_f32_16x16x32_bf16 v[168:171], v[96:99], v[188:191], v[168:171]
s_waitcnt lgkmcnt(0)
v_mfma_f32_16x16x32_bf16 v[136:139], v[100:103], v[184:187], v[136:139]
v_mfma_f32_16x16x32_bf16 v[172:175], v[100:103], v[188:191], v[172:175]
v_lshrrev_b32 v24, 5, v2
v_lshlrev_b32 v24, 9, v24
v_and_b32 v26, 31, v2
v_lshl_add_u32 v24, v26, 4, v24
v_cvt_pk_bf16_f32 v32, v104, v105
v_cvt_pk_bf16_f32 v33, v106, v107
v_cvt_pk_bf16_f32 v34, v140, v141
v_cvt_pk_bf16_f32 v35, v142, v143
v_cvt_pk_bf16_f32 v36, v108, v109
v_cvt_pk_bf16_f32 v37, v110, v111
v_cvt_pk_bf16_f32 v38, v144, v145
v_cvt_pk_bf16_f32 v39, v146, v147
s_add_u32 s36, s33, 0
v_permlane16_swap_b32 v32, v34
v_permlane16_swap_b32 v33, v35
buffer_store_dwordx4 v[32:35], v24, s[12:15], s36 offen offset:0 sc1
v_cvt_pk_bf16_f32 v40, v112, v113
v_cvt_pk_bf16_f32 v41, v114, v115
v_cvt_pk_bf16_f32 v42, v148, v149
v_cvt_pk_bf16_f32 v43, v150, v151
v_permlane16_swap_b32 v36, v38
v_permlane16_swap_b32 v37, v39
buffer_store_dwordx4 v[36:39], v24, s[12:15], s36 offen offset:1024 sc1
v_cvt_pk_bf16_f32 v44, v116, v117
v_cvt_pk_bf16_f32 v45, v118, v119
v_cvt_pk_bf16_f32 v46, v152, v153
v_cvt_pk_bf16_f32 v47, v154, v155
v_permlane16_swap_b32 v40, v42
v_permlane16_swap_b32 v41, v43
buffer_store_dwordx4 v[40:43], v24, s[12:15], s36 offen offset:2048 sc1
v_cvt_pk_bf16_f32 v48, v120, v121
v_cvt_pk_bf16_f32 v49, v122, v123
v_cvt_pk_bf16_f32 v50, v156, v157
v_cvt_pk_bf16_f32 v51, v158, v159
v_permlane16_swap_b32 v44, v46
v_permlane16_swap_b32 v45, v47
buffer_store_dwordx4 v[44:47], v24, s[12:15], s36 offen offset:3072 sc1
v_cvt_pk_bf16_f32 v52, v124, v125
v_cvt_pk_bf16_f32 v53, v126, v127
v_cvt_pk_bf16_f32 v54, v160, v161
v_cvt_pk_bf16_f32 v55, v162, v163
s_add_u32 s36, s33, 4096
v_permlane16_swap_b32 v48, v50
v_permlane16_swap_b32 v49, v51
buffer_store_dwordx4 v[48:51], v24, s[12:15], s36 offen offset:0 sc1
v_cvt_pk_bf16_f32 v56, v128, v129
v_cvt_pk_bf16_f32 v57, v130, v131
v_cvt_pk_bf16_f32 v58, v164, v165
v_cvt_pk_bf16_f32 v59, v166, v167
v_permlane16_swap_b32 v52, v54
v_permlane16_swap_b32 v53, v55
buffer_store_dwordx4 v[52:55], v24, s[12:15], s36 offen offset:1024 sc1
v_cvt_pk_bf16_f32 v60, v132, v133
v_cvt_pk_bf16_f32 v61, v134, v135
v_cvt_pk_bf16_f32 v62, v168, v169
v_cvt_pk_bf16_f32 v63, v170, v171
v_permlane16_swap_b32 v56, v58
v_permlane16_swap_b32 v57, v59
buffer_store_dwordx4 v[56:59], v24, s[12:15], s36 offen offset:2048 sc1
v_cvt_pk_bf16_f32 v64, v136, v137
v_cvt_pk_bf16_f32 v65, v138, v139
v_cvt_pk_bf16_f32 v66, v172, v173
v_cvt_pk_bf16_f32 v67, v174, v175
v_permlane16_swap_b32 v60, v62
v_permlane16_swap_b32 v61, v63
buffer_store_dwordx4 v[60:63], v24, s[12:15], s36 offen offset:3072 sc1
s_add_u32 s36, s33, 8192
v_permlane16_swap_b32 v64, v66
v_permlane16_swap_b32 v65, v67
buffer_store_dwordx4 v[64:67], v24, s[12:15], s36 offen offset:0 sc1
s_waitcnt vmcnt(0)
L_k2_kernel_end:
s_endpgm
.globl r1_kernel
.p2align 8
.type r1_kernel,@function
r1_kernel:
s_cmp_ge_u32 s2, 256
s_cbranch_scc1 L_r1_kernel_end
s_load_dwordx2 s[4:5], s[0:1], 0
s_mov_b32 s6, 0x240000
s_mov_b32 s7, 0x00020000
s_load_dwordx2 s[12:13], s[0:1], 104
s_mov_b32 s14, 0x10000000
s_mov_b32 s15, 0x00020000
s_load_dwordx2 s[24:25], s[0:1], 48
s_mov_b32 s26, 0x510000
s_mov_b32 s27, 0x00020000
s_load_dwordx2 s[28:29], s[0:1], 56
s_mov_b32 s30, 0x510000
s_mov_b32 s31, 0x00020000
v_lshrrev_b32 v1, 3, v0
v_and_b32 v2, 7, v0
s_lshl_b32 s16, s2, 3
v_add_u32 v3, s16, v2
v_mul_u32_u24 v4, 1152, v3
v_lshl_add_u32 v4, v1, 4, v4
s_lshr_b32 s17, s2, 2
s_mul_i32 s17, s17, 72*512
v_and_b32 v5, 31, v3
v_lshlrev_b32 v5, 4, v5
v_lshl_add_u32 v5, v1, 9, v5
v_add_u32 v5, s17, v5
v_lshlrev_b32 v6, 5, v1
s_waitcnt lgkmcnt(0)
buffer_load_dwordx4 v[8:11], v4, s[4:7], 0 offen
s_mov_b32 s20, 8388608
buffer_load_dwordx4 v[12:15], v5, s[12:15], s20 offen
s_mov_b32 s20, 10747904
buffer_load_dwordx4 v[16:19], v5, s[12:15], s20 offen
s_mov_b32 s20, 13107200
buffer_load_dwordx4 v[20:23], v5, s[12:15], s20 offen
s_mov_b32 s20, 15466496
buffer_load_dwordx4 v[24:27], v5, s[12:15], s20 offen
s_movk_i32 s18, 4608
buffer_load_dwordx4 v[32:35], v6, s[12:15], s18 offen
buffer_load_dwordx4 v[36:39], v6, s[12:15], s18 offen offset:16
s_movk_i32 s18, 9216
buffer_load_dwordx4 v[40:43], v6, s[12:15], s18 offen
buffer_load_dwordx4 v[44:47], v6, s[12:15], s18 offen offset:16
s_movk_i32 s18, 6912
buffer_load_dwordx4 v[48:51], v6, s[12:15], s18 offen
buffer_load_dwordx4 v[52:55], v6, s[12:15], s18 offen offset:16
s_waitcnt vmcnt(10)
v_lshlrev_b32 v56, 16, v8
v_and_b32 v57, 0xffff0000, v8
v_lshlrev_b32 v58, 16, v9
v_and_b32 v59, 0xffff0000, v9
v_lshlrev_b32 v60, 16, v10
v_and_b32 v61, 0xffff0000, v10
v_lshlrev_b32 v62, 16, v11
v_and_b32 v63, 0xffff0000, v11
s_waitcnt vmcnt(9)
v_lshlrev_b32 v64, 16, v12
v_and_b32 v65, 0xffff0000, v12
v_lshlrev_b32 v66, 16, v13
v_and_b32 v67, 0xffff0000, v13
v_lshlrev_b32 v68, 16, v14
v_and_b32 v69, 0xffff0000, v14
v_lshlrev_b32 v70, 16, v15
v_and_b32 v71, 0xffff0000, v15
s_waitcnt vmcnt(8)
v_lshlrev_b32 v72, 16, v16
v_and_b32 v73, 0xffff0000, v16
v_lshlrev_b32 v74, 16, v17
v_and_b32 v75, 0xffff0000, v17
v_lshlrev_b32 v76, 16, v18
v_and_b32 v77, 0xffff0000, v18
v_lshlrev_b32 v78, 16, v19
v_and_b32 v79, 0xffff0000, v19
v_add_f32 v64, v64, v72
v_add_f32 v65, v65, v73
v_add_f32 v66, v66, v74
v_add_f32 v67, v67, v75
v_add_f32 v68, v68, v76
v_add_f32 v69, v69, v77
v_add_f32 v70, v70, v78
v_add_f32 v71, v71, v79
s_waitcnt vmcnt(7)
v_lshlrev_b32 v72, 16, v20
v_and_b32 v73, 0xffff0000, v20
v_lshlrev_b32 v74, 16, v21
v_and_b32 v75, 0xffff0000, v21
v_lshlrev_b32 v76, 16, v22
v_and_b32 v77, 0xffff0000, v22
v_lshlrev_b32 v78, 16, v23
v_and_b32 v79, 0xffff0000, v23
v_add_f32 v64, v64, v72
v_add_f32 v65, v65, v73
v_add_f32 v66, v66, v74
v_add_f32 v67, v67, v75
v_add_f32 v68, v68, v76
v_add_f32 v69, v69, v77
v_add_f32 v70, v70, v78
v_add_f32 v71, v71, v79
s_waitcnt vmcnt(6)
v_lshlrev_b32 v72, 16, v24
v_and_b32 v73, 0xffff0000, v24
v_lshlrev_b32 v74, 16, v25
v_and_b32 v75, 0xffff0000, v25
v_lshlrev_b32 v76, 16, v26
v_and_b32 v77, 0xffff0000, v26
v_lshlrev_b32 v78, 16, v27
v_and_b32 v79, 0xffff0000, v27
v_add_f32 v64, v64, v72
v_add_f32 v65, v65, v73
v_add_f32 v66, v66, v74
v_add_f32 v67, v67, v75
v_add_f32 v68, v68, v76
v_add_f32 v69, v69, v77
v_add_f32 v70, v70, v78
v_add_f32 v71, v71, v79
s_waitcnt vmcnt(0)
v_fmac_f32 v56, v64, v32
v_fmac_f32 v57, v65, v33
v_fmac_f32 v58, v66, v34
v_fmac_f32 v59, v67, v35
v_fmac_f32 v60, v68, v36
v_fmac_f32 v61, v69, v37
v_fmac_f32 v62, v70, v38
v_fmac_f32 v63, v71, v39
v_cvt_pk_bf16_f32 v8, v56, v57
v_cvt_pk_bf16_f32 v9, v58, v59
v_cvt_pk_bf16_f32 v10, v60, v61
v_cvt_pk_bf16_f32 v11, v62, v63
s_mov_b32 s19, 2621440
buffer_store_dwordx4 v[8:11], v5, s[12:15], s19 offen sc1
v_lshlrev_b32 v56, 16, v8
v_and_b32 v57, 0xffff0000, v8
v_lshlrev_b32 v58, 16, v9
v_and_b32 v59, 0xffff0000, v9
v_lshlrev_b32 v60, 16, v10
v_and_b32 v61, 0xffff0000, v10
v_lshlrev_b32 v62, 16, v11
v_and_b32 v63, 0xffff0000, v11
v_add_f32 v80, v56, v57
v_mul_f32 v81, v56, v56
v_fmac_f32 v81, v57, v57
v_add_f32 v80, v80, v58
v_fmac_f32 v81, v58, v58
v_add_f32 v80, v80, v59
v_fmac_f32 v81, v59, v59
v_add_f32 v80, v80, v60
v_fmac_f32 v81, v60, v60
v_add_f32 v80, v80, v61
v_fmac_f32 v81, v61, v61
v_add_f32 v80, v80, v62
v_fmac_f32 v81, v62, v62
v_add_f32 v80, v80, v63
v_fmac_f32 v81, v63, v63
s_nop 0
v_add_f32_dpp v80, v80, v80 row_ror:8 row_mask:0xf bank_mask:0xf
v_mov_b32 v82, v80
s_nop 1
v_permlane16_swap_b32 v80, v82
v_add_f32 v80, v80, v82
v_mov_b32 v82, v80
s_nop 1
v_permlane32_swap_b32 v80, v82
v_add_f32 v80, v80, v82
v_add_f32_dpp v81, v81, v81 row_ror:8 row_mask:0xf bank_mask:0xf
v_mov_b32 v83, v81
s_nop 1
v_permlane16_swap_b32 v81, v83
v_add_f32 v81, v81, v83
v_mov_b32 v83, v81
s_nop 1
v_permlane32_swap_b32 v81, v83
v_add_f32 v81, v81, v83
v_lshrrev_b32 v84, 6, v0
v_lshlrev_b32 v84, 3, v84
v_lshl_add_u32 v84, v2, 7, v84
v_lshlrev_b32 v85, 7, v2
ds_write_b64 v84, v[80:81]
s_waitcnt lgkmcnt(0)
s_barrier
ds_read_b64 v[88:89], v85 offset:0
ds_read_b64 v[90:91], v85 offset:8
ds_read_b64 v[92:93], v85 offset:16
ds_read_b64 v[94:95], v85 offset:24
ds_read_b64 v[96:97], v85 offset:32
ds_read_b64 v[98:99], v85 offset:40
ds_read_b64 v[100:101], v85 offset:48
ds_read_b64 v[102:103], v85 offset:56
ds_read_b64 v[104:105], v85 offset:64
v_add_f32 v40, 1.0, v40
v_add_f32 v41, 1.0, v41
v_add_f32 v42, 1.0, v42
v_add_f32 v43, 1.0, v43
v_add_f32 v44, 1.0, v44
v_add_f32 v45, 1.0, v45
v_add_f32 v46, 1.0, v46
v_add_f32 v47, 1.0, v47
v_cvt_pk_bf16_f32 v12, v40, v41
v_cvt_pk_bf16_f32 v13, v42, v43
v_cvt_pk_bf16_f32 v14, v44, v45
v_cvt_pk_bf16_f32 v15, v46, v47
v_lshlrev_b32 v40, 16, v12
v_and_b32 v41, 0xffff0000, v12
v_lshlrev_b32 v42, 16, v13
v_and_b32 v43, 0xffff0000, v13
v_lshlrev_b32 v44, 16, v14
v_and_b32 v45, 0xffff0000, v14
v_lshlrev_b32 v46, 16, v15
v_and_b32 v47, 0xffff0000, v15
s_waitcnt lgkmcnt(0)
v_add_f32 v88, v88, v90
v_add_f32 v89, v89, v91
v_add_f32 v88, v88, v92
v_add_f32 v89, v89, v93
v_add_f32 v88, v88, v94
v_add_f32 v89, v89, v95
v_add_f32 v88, v88, v96
v_add_f32 v89, v89, v97
v_add_f32 v88, v88, v98
v_add_f32 v89, v89, v99
v_add_f32 v88, v88, v100
v_add_f32 v89, v89, v101
v_add_f32 v88, v88, v102
v_add_f32 v89, v89, v103
v_add_f32 v88, v88, v104
v_add_f32 v89, v89, v105
v_mul_f32 v88, 0x3ae38e39, v88
v_mul_f32 v89, 0x3ae38e39, v89
v_fma_f32 v89, -v88, v88, v89
v_max_f32 v89, 0, v89
v_add_f32 v89, 0x3727c5ac, v89
v_rsq_f32 v89, v89
v_sub_f32 v56, v56, v88
v_mul_f32 v40, v40, v89
v_fma_f32 v56, v56, v40, v48
v_sub_f32 v57, v57, v88
v_mul_f32 v41, v41, v89
v_fma_f32 v57, v57, v41, v49
v_sub_f32 v58, v58, v88
v_mul_f32 v42, v42, v89
v_fma_f32 v58, v58, v42, v50
v_sub_f32 v59, v59, v88
v_mul_f32 v43, v43, v89
v_fma_f32 v59, v59, v43, v51
v_sub_f32 v60, v60, v88
v_mul_f32 v44, v44, v89
v_fma_f32 v60, v60, v44, v52
v_sub_f32 v61, v61, v88
v_mul_f32 v45, v45, v89
v_fma_f32 v61, v61, v45, v53
v_sub_f32 v62, v62, v88
v_mul_f32 v46, v46, v89
v_fma_f32 v62, v62, v46, v54
v_sub_f32 v63, v63, v88
v_mul_f32 v47, v47, v89
v_fma_f32 v63, v63, v47, v55
v_cvt_pk_bf16_f32 v16, v56, v57
v_cvt_pk_bf16_f32 v17, v58, v59
v_cvt_pk_bf16_f32 v18, v60, v61
v_cvt_pk_bf16_f32 v19, v62, v63
s_mov_b32 s19, 5242880
buffer_store_dwordx4 v[16:19], v5, s[12:15], s19 offen sc1
s_waitcnt vmcnt(0)
L_r1_kernel_end:
s_endpgm
.globl k3_kernel
.p2align 8
.type k3_kernel,@function
k3_kernel:
s_cmp_ge_u32 s2, 256
s_cbranch_scc1 L_k3_kernel_end
s_load_dwordx2 s[4:5], s[0:1], 48
s_mov_b32 s6, 0x510000
s_mov_b32 s7, 0x00020000
s_load_dwordx2 s[8:9], s[0:1], 56
s_load_dwordx2 s[12:13], s[0:1], 104
s_mov_b32 s14, 0x10000000
s_mov_b32 s15, 0x00020000
s_load_dwordx2 s[48:49], s[0:1], 64
s_mov_b32 s50, 0x510000
s_mov_b32 s51, 0x00020000
s_load_dwordx2 s[52:53], s[0:1], 0
s_mov_b32 s54, 0x240000
s_mov_b32 s55, 0x00020000
s_load_dwordx2 s[56:57], s[0:1], 96
s_mov_b32 s58, 0x100
s_mov_b32 s59, 0x00020000
s_mov_b32 s3, s2
s_and_b32 s20, s3, 7
s_bfe_u32 s21, s3, 0x20003
s_lshr_b32 s23, s3, 5
v_lshrrev_b32 v1, 6, v0
v_and_b32 v0, 63, v0
v_readfirstlane_b32 s22, v1
s_lshl_b32 s23, s23, 3
s_nop 0
s_add_u32 s23, s23, s22
s_and_b32 s24, s22, 3
s_lshr_b32 s25, s22, 2
s_mul_i32 s30, s25, 12416
s_lshl_b32 s26, s24, 10
s_add_u32 s30, s30, s26
s_mul_i32 s31, s20, 1152
s_lshl_b32 s26, s21, 5
s_add_u32 s32, s31, s26
s_add_u32 s32, s32, 1024
s_lshl_b32 s26, s21, 8
s_add_u32 s31, s31, s26
s_mul_i32 s26, s24, 73728
s_add_u32 s31, s31, s26
s_and_b32 s26, s24, 1
s_mul_i32 s26, s26, 73728
s_add_u32 s32, s32, s26
s_mul_i32 s33, s23, 36864
s_add_u32 s33, s33, 5242880
s_mul_i32 s34, s23, 294912
s_mul_i32 s26, s20, 36864
s_add_u32 s34, s34, s26
s_add_u32 s34, s34, 41943040
s_lshl_b32 s26, s21, 10
s_add_u32 s37, s34, s26
s_add_u32 s37, s37, 32768
s_lshl_b32 s26, s21, 13
s_add_u32 s34, s34, s26
s_mov_b32 s40, 0xbdd2d3e8
v_lshlrev_b32 v6, 4, v0
v_lshrrev_b32 v1, 4, v0
v_bfe_u32 v2, v0, 1, 3
v_and_b32 v3, 1, v0
v_mul_u32_u24 v4, 9216, v2
v_lshl_add_u32 v4, v3, 4, v4
v_mul_u32_u24 v5, 147456, v1
v_add_u32 v5, v5, v4
v_lshl_add_u32 v4, v1, 5, v4
s_waitcnt lgkmcnt(0)
s_cmp_eq_u32 s25, 0
s_cselect_b32 s4, s4, s8
s_cselect_b32 s5, s5, s9
s_lshr_b32 s26, s3, 5
s_add_u32 s26, s26, s21
s_mul_i32 s27, s26, 43
s_lshr_b32 s27, s27, 7
s_mul_i32 s27, s27, 3
s_sub_u32 s26, s26, s27
s_lshl_b32 s27, s26, 1
s_mul_i32 s28, s26, 3
s_lshr_b32 s29, s24, 1
s_add_u32 s28, s28, s29
s_add_u32 s29, s27, 0
s_sub_u32 s39, s29, 6
s_cmp_ge_u32 s29, 6
s_cselect_b32 s29, s39, s29
s_mul_i32 s39, s29, 884736
s_add_u32 s60, s31, s39
s_mul_i32 s39, s29, 6144
s_add_u32 s66, s33, s39
s_add_u32 s29, s27, 1
s_sub_u32 s39, s29, 6
s_cmp_ge_u32 s29, 6
s_cselect_b32 s29, s39, s29
s_mul_i32 s39, s29, 884736
s_add_u32 s61, s31, s39
s_mul_i32 s39, s29, 6144
s_add_u32 s67, s33, s39
s_add_u32 s29, s27, 2
s_sub_u32 s39, s29, 6
s_cmp_ge_u32 s29, 6
s_cselect_b32 s29, s39, s29
s_mul_i32 s39, s29, 884736
s_add_u32 s62, s31, s39
s_mul_i32 s39, s29, 6144
s_add_u32 s68, s33, s39
s_add_u32 s29, s27, 3
s_sub_u32 s39, s29, 6
s_cmp_ge_u32 s29, 6
s_cselect_b32 s29, s39, s29
s_mul_i32 s39, s29, 884736
s_add_u32 s63, s31, s39
s_mul_i32 s39, s29, 6144
s_add_u32 s69, s33, s39
s_add_u32 s29, s27, 4
s_sub_u32 s39, s29, 6
s_cmp_ge_u32 s29, 6
s_cselect_b32 s29, s39, s29
s_mul_i32 s39, s29, 884736
s_add_u32 s64, s31, s39
s_mul_i32 s39, s29, 6144
s_add_u32 s70, s33, s39
s_add_u32 s29, s27, 5
s_sub_u32 s39, s29, 6
s_cmp_ge_u32 s29, 6
s_cselect_b32 s29, s39, s29
s_mul_i32 s39, s29, 884736
s_add_u32 s65, s31, s39
s_mul_i32 s39, s29, 6144
s_add_u32 s71, s33, s39
s_add_u32 s29, s28, 0
s_sub_u32 s39, s29, 9
s_cmp_ge_u32 s29, 9
s_cselect_b32 s29, s39, s29
s_mul_i32 s39, s29, 589824
s_add_u32 s72, s32, s39
s_add_u32 s29, s28, 2
s_sub_u32 s39, s29, 9
s_cmp_ge_u32 s29, 9
s_cselect_b32 s29, s39, s29
s_mul_i32 s39, s29, 589824
s_add_u32 s73, s32, s39
s_add_u32 s29, s28, 4
s_sub_u32 s39, s29, 9
s_cmp_ge_u32 s29, 9
s_cselect_b32 s29, s39, s29
s_mul_i32 s39, s29, 589824
s_add_u32 s74, s32, s39
s_add_u32 s29, s28, 5
s_sub_u32 s39, s29, 9
s_cmp_ge_u32 s29, 9
s_cselect_b32 s29, s39, s29
s_mul_i32 s39, s29, 589824
s_add_u32 s75, s32, s39
s_add_u32 s29, s28, 7
s_sub_u32 s39, s29, 9
s_cmp_ge_u32 s29, 9
s_cselect_b32 s29, s39, s29
s_mul_i32 s39, s29, 589824
s_add_u32 s76, s32, s39
s_lshr_b32 s47, s2, 5
s_lshl_b32 s77, s47, 8
s_and_b32 s45, s2, 31
s_lshl_b32 s45, s45, 3
s_add_u32 s77, s77, s45
s_lshl_b32 s47, s47, 4
v_mov_b32 v10, 0xc0135761
v_and_b32 v3, 1, v0
v_lshrrev_b32 v1, 5, v0
v_lshlrev_b32 v1, 10, v1
v_bfe_u32 v2, v0, 2, 2
v_lshl_add_u32 v1, v2, 5, v1
v_lshl_add_u32 v1, v3, 4, v1
v_bfe_u32 v2, v0, 1, 1
v_lshl_add_u32 v1, v2, 3, v1
v_bfe_u32 v2, v0, 4, 1
v_mul_u32_u24 v2, 12416, v2
v_add_u32 v1, v1, v2
v_add_u32 v2, 49664, v1
v_add_u32 v3, 99328, v1
s_add_u32 s35, s60, 0
s_add_u32 m0, s30, 0
s_nop 0
buffer_load_dwordx4 v4, s[4:7], s35 offen lds
s_add_u32 s35, s60, 294912
s_add_u32 m0, s30, 4096
s_nop 0
buffer_load_dwordx4 v4, s[4:7], s35 offen lds
s_add_u32 s35, s60, 589824
s_add_u32 m0, s30, 8192
s_nop 0
buffer_load_dwordx4 v4, s[4:7], s35 offen lds
s_add_u32 s36, s66, 0
buffer_load_dwordx4 v[112:115], v6, s[12:15], s36 offen offset:0
buffer_load_dwordx4 v[116:119], v6, s[12:15], s36 offen offset:1024
buffer_load_dwordx4 v[120:123], v6, s[12:15], s36 offen offset:2048
buffer_load_dwordx4 v[124:127], v6, s[12:15], s36 offen offset:3072
s_add_u32 s36, s66, 4096
buffer_load_dwordx4 v[128:131], v6, s[12:15], s36 offen offset:0
buffer_load_dwordx4 v[132:135], v6, s[12:15], s36 offen offset:1024
s_waitcnt vmcnt(6)
s_barrier
ds_read_b64_tr_b16 v[12:13], v1 offset:0
ds_read_b64_tr_b16 v[14:15], v1 offset:128
ds_read_b64_tr_b16 v[16:17], v1 offset:2048
ds_read_b64_tr_b16 v[18:19], v1 offset:2176
ds_read_b64_tr_b16 v[20:21], v1 offset:4096
ds_read_b64_tr_b16 v[22:23], v1 offset:4224
ds_read_b64_tr_b16 v[24:25], v1 offset:6144
ds_read_b64_tr_b16 v[26:27], v1 offset:6272
ds_read_b64_tr_b16 v[28:29], v1 offset:8192
ds_read_b64_tr_b16 v[30:31], v1 offset:8320
ds_read_b64_tr_b16 v[32:33], v1 offset:10240
ds_read_b64_tr_b16 v[34:35], v1 offset:10368
ds_read_b64_tr_b16 v[36:37], v1 offset:256
ds_read_b64_tr_b16 v[38:39], v1 offset:384
s_waitcnt vmcnt(5)
s_waitcnt lgkmcnt(12)
v_mfma_f32_32x32x16_bf16 v[48:63], v[12:15], v[112:115], 0
ds_read_b64_tr_b16 v[40:41], v1 offset:2304
ds_read_b64_tr_b16 v[42:43], v1 offset:2432
s_add_u32 s35, s61, 0
s_add_u32 m0, s30, 24832
s_nop 0
buffer_load_dwordx4 v4, s[4:7], s35 offen lds
s_waitcnt vmcnt(5)
s_waitcnt lgkmcnt(12)
v_mfma_f32_32x32x16_bf16 v[48:63], v[16:19], v[116:119], v[48:63]
ds_read_b64_tr_b16 v[44:45], v1 offset:4352
ds_read_b64_tr_b16 v[46:47], v1 offset:4480
s_waitcnt vmcnt(4)
s_waitcnt lgkmcnt(12)
v_mfma_f32_32x32x16_bf16 v[48:63], v[20:23], v[120:123], v[48:63]
ds_read_b64_tr_b16 v[12:13], v1 offset:6400
ds_read_b64_tr_b16 v[14:15], v1 offset:6528
s_add_u32 s35, s61, 294912
s_add_u32 m0, s30, 28928
s_nop 0
buffer_load_dwordx4 v4, s[4:7], s35 offen lds
s_waitcnt vmcnt(4)
s_waitcnt lgkmcnt(12)
v_mfma_f32_32x32x16_bf16 v[48:63], v[24:27], v[124:127], v[48:63]
ds_read_b64_tr_b16 v[16:17], v1 offset:8448
ds_read_b64_tr_b16 v[18:19], v1 offset:8576
s_waitcnt vmcnt(3)
s_waitcnt lgkmcnt(12)
v_mfma_f32_32x32x16_bf16 v[48:63], v[28:31], v[128:131], v[48:63]
ds_read_b64_tr_b16 v[20:21], v1 offset:10496
ds_read_b64_tr_b16 v[22:23], v1 offset:10624
s_add_u32 s35, s61, 589824
s_add_u32 m0, s30, 33024
s_nop 0
buffer_load_dwordx4 v4, s[4:7], s35 offen lds
s_waitcnt vmcnt(3)
s_waitcnt lgkmcnt(12)
v_mfma_f32_32x32x16_bf16 v[48:63], v[32:35], v[132:135], v[48:63]
ds_read_b64_tr_b16 v[24:25], v1 offset:512
ds_read_b64_tr_b16 v[26:27], v1 offset:640
s_waitcnt lgkmcnt(12)
v_mfma_f32_32x32x16_bf16 v[64:79], v[36:39], v[112:115], 0
ds_read_b64_tr_b16 v[28:29], v1 offset:2560
ds_read_b64_tr_b16 v[30:31], v1 offset:2688
s_add_u32 s36, s67, 0
buffer_load_dwordx4 v[136:139], v6, s[12:15], s36 offen offset:0
s_waitcnt lgkmcnt(12)
v_mfma_f32_32x32x16_bf16 v[64:79], v[40:43], v[116:119], v[64:79]
ds_read_b64_tr_b16 v[32:33], v1 offset:4608
ds_read_b64_tr_b16 v[34:35], v1 offset:4736
s_waitcnt lgkmcnt(12)
v_mfma_f32_32x32x16_bf16 v[64:79], v[44:47], v[120:123], v[64:79]
ds_read_b64_tr_b16 v[36:37], v1 offset:6656
ds_read_b64_tr_b16 v[38:39], v1 offset:6784
buffer_load_dwordx4 v[140:143], v6, s[12:15], s36 offen offset:1024
s_waitcnt lgkmcnt(12)
v_mfma_f32_32x32x16_bf16 v[64:79], v[12:15], v[124:127], v[64:79]
ds_read_b64_tr_b16 v[40:41], v1 offset:8704
ds_read_b64_tr_b16 v[42:43], v1 offset:8832
s_waitcnt lgkmcnt(12)
v_mfma_f32_32x32x16_bf16 v[64:79], v[16:19], v[128:131], v[64:79]
ds_read_b64_tr_b16 v[44:45], v1 offset:10752
ds_read_b64_tr_b16 v[46:47], v1 offset:10880
buffer_load_dwordx4 v[144:147], v6, s[12:15], s36 offen offset:2048
s_waitcnt lgkmcnt(12)
v_mfma_f32_32x32x16_bf16 v[64:79], v[20:23], v[132:135], v[64:79]
ds_read_b64_tr_b16 v[12:13], v1 offset:768
ds_read_b64_tr_b16 v[14:15], v1 offset:896
s_waitcnt lgkmcnt(12)
v_mfma_f32_32x32x16_bf16 v[80:95], v[24:27], v[112:115], 0
ds_read_b64_tr_b16 v[16:17], v1 offset:2816
ds_read_b64_tr_b16 v[18:19], v1 offset:2944
buffer_load_dwordx4 v[148:151], v6, s[12:15], s36 offen offset:3072
s_waitcnt lgkmcnt(12)
v_mfma_f32_32x32x16_bf16 v[80:95], v[28:31], v[116:119], v[80:95]
ds_read_b64_tr_b16 v[20:21], v1 offset:4864
ds_read_b64_tr_b16 v[22:23], v1 offset:4992
s_waitcnt lgkmcnt(12)
v_mfma_f32_32x32x16_bf16 v[80:95], v[32:35], v[120:123], v[80:95]
ds_read_b64_tr_b16 v[24:25], v1 offset:6912
ds_read_b64_tr_b16 v[26:27], v1 offset:7040
s_add_u32 s36, s67, 4096
buffer_load_dwordx4 v[152:155], v6, s[12:15], s36 offen offset:0
s_waitcnt lgkmcnt(12)
v_mfma_f32_32x32x16_bf16 v[80:95], v[36:39], v[124:127], v[80:95]
ds_read_b64_tr_b16 v[28:29], v1 offset:8960
ds_read_b64_tr_b16 v[30:31], v1 offset:9088
s_waitcnt lgkmcnt(12)
v_mfma_f32_32x32x16_bf16 v[80:95], v[40:43], v[128:131], v[80:95]
ds_read_b64_tr_b16 v[32:33], v1 offset:11008
ds_read_b64_tr_b16 v[34:35], v1 offset:11136
buffer_load_dwordx4 v[156:159], v6, s[12:15], s36 offen offset:1024
s_waitcnt lgkmcnt(12)
v_mfma_f32_32x32x16_bf16 v[80:95], v[44:47], v[132:135], v[80:95]
s_waitcnt vmcnt(6)
s_barrier
ds_read_b64_tr_b16 v[36:37], v1 offset:24832
ds_read_b64_tr_b16 v[38:39], v1 offset:24960
s_waitcnt lgkmcnt(12)
v_mfma_f32_32x32x16_bf16 v[96:111], v[12:15], v[112:115], 0
ds_read_b64_tr_b16 v[40:41], v1 offset:26880
ds_read_b64_tr_b16 v[42:43], v1 offset:27008
s_add_u32 s35, s62, 0
s_add_u32 m0, s30, 49664
s_nop 0
buffer_load_dwordx4 v4, s[4:7], s35 offen lds
s_waitcnt lgkmcnt(12)
v_mfma_f32_32x32x16_bf16 v[96:111], v[16:19], v[116:119], v[96:111]
ds_read_b64_tr_b16 v[44:45], v1 offset:28928
ds_read_b64_tr_b16 v[46:47], v1 offset:29056
s_waitcnt lgkmcnt(12)
v_mfma_f32_32x32x16_bf16 v[96:111], v[20:23], v[120:123], v[96:111]
ds_read_b64_tr_b16 v[12:13], v1 offset:30976
ds_read_b64_tr_b16 v[14:15], v1 offset:31104
s_add_u32 s35, s62, 294912
s_add_u32 m0, s30, 53760
s_nop 0
buffer_load_dwordx4 v4, s[4:7], s35 offen lds
s_waitcnt lgkmcnt(12)
v_mfma_f32_32x32x16_bf16 v[96:111], v[24:27], v[124:127], v[96:111]
ds_read_b64_tr_b16 v[16:17], v1 offset:33024
ds_read_b64_tr_b16 v[18:19], v1 offset:33152
s_waitcnt lgkmcnt(12)
v_mfma_f32_32x32x16_bf16 v[96:111], v[28:31], v[128:131], v[96:111]
ds_read_b64_tr_b16 v[20:21], v1 offset:35072
ds_read_b64_tr_b16 v[22:23], v1 offset:35200
s_add_u32 s35, s62, 589824
s_add_u32 m0, s30, 57856
s_nop 0
buffer_load_dwordx4 v4, s[4:7], s35 offen lds
s_waitcnt lgkmcnt(12)
v_mfma_f32_32x32x16_bf16 v[96:111], v[32:35], v[132:135], v[96:111]
ds_read_b64_tr_b16 v[24:25], v1 offset:25088
ds_read_b64_tr_b16 v[26:27], v1 offset:25216
s_waitcnt vmcnt(8)
s_waitcnt lgkmcnt(12)
v_mfma_f32_32x32x16_bf16 v[48:63], v[36:39], v[136:139], v[48:63]
ds_read_b64_tr_b16 v[28:29], v1 offset:27136
ds_read_b64_tr_b16 v[30:31], v1 offset:27264
s_add_u32 s36, s68, 0
buffer_load_dwordx4 v[160:163], v6, s[12:15], s36 offen offset:0
s_waitcnt vmcnt(8)
s_waitcnt lgkmcnt(12)
v_mfma_f32_32x32x16_bf16 v[48:63], v[40:43], v[140:143], v[48:63]
ds_read_b64_tr_b16 v[32:33], v1 offset:29184
ds_read_b64_tr_b16 v[34:35], v1 offset:29312
s_waitcnt vmcnt(7)
s_waitcnt lgkmcnt(12)
v_mfma_f32_32x32x16_bf16 v[48:63], v[44:47], v[144:147], v[48:63]
ds_read_b64_tr_b16 v[36:37], v1 offset:31232
ds_read_b64_tr_b16 v[38:39], v1 offset:31360
buffer_load_dwordx4 v[164:167], v6, s[12:15], s36 offen offset:1024
s_waitcnt vmcnt(7)
s_waitcnt lgkmcnt(12)
v_mfma_f32_32x32x16_bf16 v[48:63], v[12:15], v[148:151], v[48:63]
ds_read_b64_tr_b16 v[40:41], v1 offset:33280
ds_read_b64_tr_b16 v[42:43], v1 offset:33408
s_waitcnt vmcnt(6)
s_waitcnt lgkmcnt(12)
v_mfma_f32_32x32x16_bf16 v[48:63], v[16:19], v[152:155], v[48:63]
ds_read_b64_tr_b16 v[44:45], v1 offset:35328
ds_read_b64_tr_b16 v[46:47], v1 offset:35456
buffer_load_dwordx4 v[168:171], v6, s[12:15], s36 offen offset:2048
s_waitcnt vmcnt(6)
s_waitcnt lgkmcnt(12)
v_mfma_f32_32x32x16_bf16 v[48:63], v[20:23], v[156:159], v[48:63]
ds_read_b64_tr_b16 v[12:13], v1 offset:25344
ds_read_b64_tr_b16 v[14:15], v1 offset:25472
s_waitcnt lgkmcnt(12)
v_mfma_f32_32x32x16_bf16 v[64:79], v[24:27], v[136:139], v[64:79]
ds_read_b64_tr_b16 v[16:17], v1 offset:27392
ds_read_b64_tr_b16 v[18:19], v1 offset:27520
buffer_load_dwordx4 v[172:175], v6, s[12:15], s36 offen offset:3072
s_waitcnt lgkmcnt(12)
v_mfma_f32_32x32x16_bf16 v[64:79], v[28:31], v[140:143], v[64:79]
ds_read_b64_tr_b16 v[20:21], v1 offset:29440
ds_read_b64_tr_b16 v[22:23], v1 offset:29568
s_waitcnt lgkmcnt(12)
v_mfma_f32_32x32x16_bf16 v[64:79], v[32:35], v[144:147], v[64:79]
ds_read_b64_tr_b16 v[24:25], v1 offset:31488
ds_read_b64_tr_b16 v[26:27], v1 offset:31616
s_add_u32 s36, s68, 4096
buffer_load_dwordx4 v[176:179], v6, s[12:15], s36 offen offset:0
s_waitcnt lgkmcnt(12)
v_mfma_f32_32x32x16_bf16 v[64:79], v[36:39], v[148:151], v[64:79]
ds_read_b64_tr_b16 v[28:29], v1 offset:33536
ds_read_b64_tr_b16 v[30:31], v1 offset:33664
s_waitcnt lgkmcnt(12)
v_mfma_f32_32x32x16_bf16 v[64:79], v[40:43], v[152:155], v[64:79]
ds_read_b64_tr_b16 v[32:33], v1 offset:35584
ds_read_b64_tr_b16 v[34:35], v1 offset:35712
buffer_load_dwordx4 v[180:183], v6, s[12:15], s36 offen offset:1024
s_waitcnt lgkmcnt(12)
v_mfma_f32_32x32x16_bf16 v[64:79], v[44:47], v[156:159], v[64:79]
ds_read_b64_tr_b16 v[36:37], v1 offset:25600
ds_read_b64_tr_b16 v[38:39], v1 offset:25728
s_waitcnt lgkmcnt(12)
v_mfma_f32_32x32x16_bf16 v[80:95], v[12:15], v[136:139], v[80:95]
ds_read_b64_tr_b16 v[40:41], v1 offset:27648
ds_read_b64_tr_b16 v[42:43], v1 offset:27776
s_add_u32 s35, s63, 0
s_add_u32 m0, s30, 74496
s_nop 0
buffer_load_dwordx4 v4, s[4:7], s35 offen lds
s_waitcnt lgkmcnt(12)
v_mfma_f32_32x32x16_bf16 v[80:95], v[16:19], v[140:143], v[80:95]
ds_read_b64_tr_b16 v[44:45], v1 offset:29696
ds_read_b64_tr_b16 v[46:47], v1 offset:29824
s_waitcnt lgkmcnt(12)
v_mfma_f32_32x32x16_bf16 v[80:95], v[20:23], v[144:147], v[80:95]
ds_read_b64_tr_b16 v[12:13], v1 offset:31744
ds_read_b64_tr_b16 v[14:15], v1 offset:31872
s_add_u32 s35, s63, 294912
s_add_u32 m0, s30, 78592
s_nop 0
buffer_load_dwordx4 v4, s[4:7], s35 offen lds
s_waitcnt lgkmcnt(12)
v_mfma_f32_32x32x16_bf16 v[80:95], v[24:27], v[148:151], v[80:95]
ds_read_b64_tr_b16 v[16:17], v1 offset:33792
ds_read_b64_tr_b16 v[18:19], v1 offset:33920
s_waitcnt lgkmcnt(12)
v_mfma_f32_32x32x16_bf16 v[80:95], v[28:31], v[152:155], v[80:95]
ds_read_b64_tr_b16 v[20:21], v1 offset:35840
ds_read_b64_tr_b16 v[22:23], v1 offset:35968
s_add_u32 s35, s63, 589824
s_add_u32 m0, s30, 82688
s_nop 0
buffer_load_dwordx4 v4, s[4:7], s35 offen lds
s_waitcnt lgkmcnt(12)
v_mfma_f32_32x32x16_bf16 v[80:95], v[32:35], v[156:159], v[80:95]
s_waitcnt vmcnt(9)
s_barrier
ds_read_b64_tr_b16 v[24:25], v2 offset:0
ds_read_b64_tr_b16 v[26:27], v2 offset:128
s_waitcnt lgkmcnt(12)
v_mfma_f32_32x32x16_bf16 v[96:111], v[36:39], v[136:139], v[96:111]
ds_read_b64_tr_b16 v[28:29], v2 offset:2048
ds_read_b64_tr_b16 v[30:31], v2 offset:2176
s_add_u32 s36, s69, 0
buffer_load_dwordx4 v[184:187], v6, s[12:15], s36 offen offset:0
s_waitcnt lgkmcnt(12)
v_mfma_f32_32x32x16_bf16 v[96:111], v[40:43], v[140:143], v[96:111]
ds_read_b64_tr_b16 v[32:33], v2 offset:4096
ds_read_b64_tr_b16 v[34:35], v2 offset:4224
s_waitcnt lgkmcnt(12)
v_mfma_f32_32x32x16_bf16 v[96:111], v[44:47], v[144:147], v[96:111]
ds_read_b64_tr_b16 v[36:37], v2 offset:6144
ds_read_b64_tr_b16 v[38:39], v2 offset:6272
buffer_load_dwordx4 v[188:191], v6, s[12:15], s36 offen offset:1024
s_waitcnt lgkmcnt(12)
v_mfma_f32_32x32x16_bf16 v[96:111], v[12:15], v[148:151], v[96:111]
ds_read_b64_tr_b16 v[40:41], v2 offset:8192
ds_read_b64_tr_b16 v[42:43], v2 offset:8320
s_waitcnt lgkmcnt(12)
v_mfma_f32_32x32x16_bf16 v[96:111], v[16:19], v[152:155], v[96:111]
ds_read_b64_tr_b16 v[44:45], v2 offset:10240
ds_read_b64_tr_b16 v[46:47], v2 offset:10368
buffer_load_dwordx4 v[192:195], v6, s[12:15], s36 offen offset:2048
s_waitcnt lgkmcnt(12)
v_mfma_f32_32x32x16_bf16 v[96:111], v[20:23], v[156:159], v[96:111]
ds_read_b64_tr_b16 v[12:13], v2 offset:256
ds_read_b64_tr_b16 v[14:15], v2 offset:384
s_waitcnt vmcnt(11)
s_waitcnt lgkmcnt(12)
v_mfma_f32_32x32x16_bf16 v[48:63], v[24:27], v[160:163], v[48:63]
ds_read_b64_tr_b16 v[16:17], v2 offset:2304
ds_read_b64_tr_b16 v[18:19], v2 offset:2432
buffer_load_dwordx4 v[196:199], v6, s[12:15], s36 offen offset:3072
s_waitcnt vmcnt(11)
s_waitcnt lgkmcnt(12)
v_mfma_f32_32x32x16_bf16 v[48:63], v[28:31], v[164:167], v[48:63]
ds_read_b64_tr_b16 v[20:21], v2 offset:4352
ds_read_b64_tr_b16 v[22:23], v2 offset:4480
s_waitcnt vmcnt(10)
s_waitcnt lgkmcnt(12)
v_mfma_f32_32x32x16_bf16 v[48:63], v[32:35], v[168:171], v[48:63]
ds_read_b64_tr_b16 v[24:25], v2 offset:6400
ds_read_b64_tr_b16 v[26:27], v2 offset:6528
s_add_u32 s36, s69, 4096
buffer_load_dwordx4 v[200:203], v6, s[12:15], s36 offen offset:0
s_waitcnt vmcnt(10)
s_waitcnt lgkmcnt(12)
v_mfma_f32_32x32x16_bf16 v[48:63], v[36:39], v[172:175], v[48:63]
ds_read_b64_tr_b16 v[28:29], v2 offset:8448
ds_read_b64_tr_b16 v[30:31], v2 offset:8576
s_waitcnt vmcnt(9)
s_waitcnt lgkmcnt(12)
v_mfma_f32_32x32x16_bf16 v[48:63], v[40:43], v[176:179], v[48:63]
ds_read_b64_tr_b16 v[32:33], v2 offset:10496
ds_read_b64_tr_b16 v[34:35], v2 offset:10624
buffer_load_dwordx4 v[204:207], v6, s[12:15], s36 offen offset:1024
s_waitcnt vmcnt(9)
s_waitcnt lgkmcnt(12)
v_mfma_f32_32x32x16_bf16 v[48:63], v[44:47], v[180:183], v[48:63]
ds_read_b64_tr_b16 v[36:37], v2 offset:512
ds_read_b64_tr_b16 v[38:39], v2 offset:640
s_waitcnt lgkmcnt(12)
v_mfma_f32_32x32x16_bf16 v[64:79], v[12:15], v[160:163], v[64:79]
ds_read_b64_tr_b16 v[40:41], v2 offset:2560
ds_read_b64_tr_b16 v[42:43], v2 offset:2688
s_add_u32 s35, s64, 0
s_add_u32 m0, s30, 99328
s_nop 0
buffer_load_dwordx4 v4, s[4:7], s35 offen lds
s_waitcnt lgkmcnt(12)
v_mfma_f32_32x32x16_bf16 v[64:79], v[16:19], v[164:167], v[64:79]
ds_read_b64_tr_b16 v[44:45], v2 offset:4608
ds_read_b64_tr_b16 v[46:47], v2 offset:4736
s_waitcnt lgkmcnt(12)
v_mfma_f32_32x32x16_bf16 v[64:79], v[20:23], v[168:171], v[64:79]
ds_read_b64_tr_b16 v[12:13], v2 offset:6656
ds_read_b64_tr_b16 v[14:15], v2 offset:6784
s_add_u32 s35, s64, 294912
s_add_u32 m0, s30, 103424
s_nop 0
buffer_load_dwordx4 v4, s[4:7], s35 offen lds
s_waitcnt lgkmcnt(12)
v_mfma_f32_32x32x16_bf16 v[64:79], v[24:27], v[172:175], v[64:79]
ds_read_b64_tr_b16 v[16:17], v2 offset:8704
ds_read_b64_tr_b16 v[18:19], v2 offset:8832
s_waitcnt lgkmcnt(12)
v_mfma_f32_32x32x16_bf16 v[64:79], v[28:31], v[176:179], v[64:79]
ds_read_b64_tr_b16 v[20:21], v2 offset:10752
ds_read_b64_tr_b16 v[22:23], v2 offset:10880
s_add_u32 s35, s64, 589824
s_add_u32 m0, s30, 107520
s_nop 0
buffer_load_dwordx4 v4, s[4:7], s35 offen lds
s_waitcnt lgkmcnt(12)
v_mfma_f32_32x32x16_bf16 v[64:79], v[32:35], v[180:183], v[64:79]
s_waitcnt vmcnt(9)
s_barrier
ds_read_b64_tr_b16 v[24:25], v2 offset:24832
ds_read_b64_tr_b16 v[26:27], v2 offset:24960
s_waitcnt lgkmcnt(12)
v_mfma_f32_32x32x16_bf16 v[80:95], v[36:39], v[160:163], v[80:95]
ds_read_b64_tr_b16 v[28:29], v2 offset:26880
ds_read_b64_tr_b16 v[30:31], v2 offset:27008
s_add_u32 s36, s70, 0
buffer_load_dwordx4 v[208:211], v6, s[12:15], s36 offen offset:0
s_waitcnt lgkmcnt(12)
v_mfma_f32_32x32x16_bf16 v[80:95], v[40:43], v[164:167], v[80:95]
ds_read_b64_tr_b16 v[32:33], v2 offset:28928
ds_read_b64_tr_b16 v[34:35], v2 offset:29056
s_waitcnt lgkmcnt(12)
v_mfma_f32_32x32x16_bf16 v[80:95], v[44:47], v[168:171], v[80:95]
ds_read_b64_tr_b16 v[36:37], v2 offset:30976
ds_read_b64_tr_b16 v[38:39], v2 offset:31104
buffer_load_dwordx4 v[212:215], v6, s[12:15], s36 offen offset:1024
s_waitcnt lgkmcnt(12)
v_mfma_f32_32x32x16_bf16 v[80:95], v[12:15], v[172:175], v[80:95]
ds_read_b64_tr_b16 v[40:41], v2 offset:33024
ds_read_b64_tr_b16 v[42:43], v2 offset:33152
s_waitcnt lgkmcnt(12)
v_mfma_f32_32x32x16_bf16 v[80:95], v[16:19], v[176:179], v[80:95]
ds_read_b64_tr_b16 v[44:45], v2 offset:35072
ds_read_b64_tr_b16 v[46:47], v2 offset:35200
buffer_load_dwordx4 v[216:219], v6, s[12:15], s36 offen offset:2048
s_waitcnt lgkmcnt(12)
v_mfma_f32_32x32x16_bf16 v[80:95], v[20:23], v[180:183], v[80:95]
ds_read_b64_tr_b16 v[12:13], v2 offset:768
ds_read_b64_tr_b16 v[14:15], v2 offset:896
s_waitcnt vmcnt(11)
s_waitcnt lgkmcnt(12)
v_mfma_f32_32x32x16_bf16 v[48:63], v[24:27], v[184:187], v[48:63]
ds_read_b64_tr_b16 v[16:17], v2 offset:2816
ds_read_b64_tr_b16 v[18:19], v2 offset:2944
buffer_load_dwordx4 v[220:223], v6, s[12:15], s36 offen offset:3072
s_waitcnt vmcnt(11)
s_waitcnt lgkmcnt(12)
v_mfma_f32_32x32x16_bf16 v[48:63], v[28:31], v[188:191], v[48:63]
ds_read_b64_tr_b16 v[20:21], v2 offset:4864
ds_read_b64_tr_b16 v[22:23], v2 offset:4992
s_waitcnt vmcnt(10)
s_waitcnt lgkmcnt(12)
v_mfma_f32_32x32x16_bf16 v[48:63], v[32:35], v[192:195], v[48:63]
ds_read_b64_tr_b16 v[24:25], v2 offset:6912
ds_read_b64_tr_b16 v[26:27], v2 offset:7040
s_add_u32 s36, s70, 4096
buffer_load_dwordx4 v[224:227], v6, s[12:15], s36 offen offset:0
s_waitcnt vmcnt(10)
s_waitcnt lgkmcnt(12)
v_mfma_f32_32x32x16_bf16 v[48:63], v[36:39], v[196:199], v[48:63]
ds_read_b64_tr_b16 v[28:29], v2 offset:8960
ds_read_b64_tr_b16 v[30:31], v2 offset:9088
s_waitcnt vmcnt(9)
s_waitcnt lgkmcnt(12)
v_mfma_f32_32x32x16_bf16 v[48:63], v[40:43], v[200:203], v[48:63]
ds_read_b64_tr_b16 v[32:33], v2 offset:11008
ds_read_b64_tr_b16 v[34:35], v2 offset:11136
buffer_load_dwordx4 v[228:231], v6, s[12:15], s36 offen offset:1024
s_waitcnt vmcnt(9)
s_waitcnt lgkmcnt(12)
v_mfma_f32_32x32x16_bf16 v[48:63], v[44:47], v[204:207], v[48:63]
ds_read_b64_tr_b16 v[36:37], v2 offset:25088
ds_read_b64_tr_b16 v[38:39], v2 offset:25216
s_waitcnt lgkmcnt(12)
v_mfma_f32_32x32x16_bf16 v[96:111], v[12:15], v[160:163], v[96:111]
ds_read_b64_tr_b16 v[40:41], v2 offset:27136
ds_read_b64_tr_b16 v[42:43], v2 offset:27264
s_add_u32 s35, s65, 0
s_add_u32 m0, s30, 124160
s_nop 0
buffer_load_dwordx4 v4, s[4:7], s35 offen lds
s_waitcnt lgkmcnt(12)
v_mfma_f32_32x32x16_bf16 v[96:111], v[16:19], v[164:167], v[96:111]
ds_read_b64_tr_b16 v[44:45], v2 offset:29184
ds_read_b64_tr_b16 v[46:47], v2 offset:29312
s_waitcnt lgkmcnt(12)
v_mfma_f32_32x32x16_bf16 v[96:111], v[20:23], v[168:171], v[96:111]
ds_read_b64_tr_b16 v[12:13], v2 offset:31232
ds_read_b64_tr_b16 v[14:15], v2 offset:31360
s_add_u32 s35, s65, 294912
s_add_u32 m0, s30, 128256
s_nop 0
buffer_load_dwordx4 v4, s[4:7], s35 offen lds
s_waitcnt lgkmcnt(12)
v_mfma_f32_32x32x16_bf16 v[96:111], v[24:27], v[172:175], v[96:111]
ds_read_b64_tr_b16 v[16:17], v2 offset:33280
ds_read_b64_tr_b16 v[18:19], v2 offset:33408
s_waitcnt lgkmcnt(12)
v_mfma_f32_32x32x16_bf16 v[96:111], v[28:31], v[176:179], v[96:111]
ds_read_b64_tr_b16 v[20:21], v2 offset:35328
ds_read_b64_tr_b16 v[22:23], v2 offset:35456
s_add_u32 s35, s65, 589824
s_add_u32 m0, s30, 132352
s_nop 0
buffer_load_dwordx4 v4, s[4:7], s35 offen lds
s_waitcnt lgkmcnt(12)
v_mfma_f32_32x32x16_bf16 v[96:111], v[32:35], v[180:183], v[96:111]
s_waitcnt vmcnt(9)
s_barrier
ds_read_b64_tr_b16 v[24:25], v3 offset:0
ds_read_b64_tr_b16 v[26:27], v3 offset:128
s_waitcnt lgkmcnt(12)
v_mfma_f32_32x32x16_bf16 v[64:79], v[36:39], v[184:187], v[64:79]
ds_read_b64_tr_b16 v[28:29], v3 offset:2048
ds_read_b64_tr_b16 v[30:31], v3 offset:2176
s_add_u32 s36, s71, 0
buffer_load_dwordx4 v[232:235], v6, s[12:15], s36 offen offset:0
s_waitcnt lgkmcnt(12)
v_mfma_f32_32x32x16_bf16 v[64:79], v[40:43], v[188:191], v[64:79]
ds_read_b64_tr_b16 v[32:33], v3 offset:4096
ds_read_b64_tr_b16 v[34:35], v3 offset:4224
s_waitcnt lgkmcnt(12)
v_mfma_f32_32x32x16_bf16 v[64:79], v[44:47], v[192:195], v[64:79]
ds_read_b64_tr_b16 v[36:37], v3 offset:6144
ds_read_b64_tr_b16 v[38:39], v3 offset:6272
buffer_load_dwordx4 v[236:239], v6, s[12:15], s36 offen offset:1024
s_waitcnt lgkmcnt(12)
v_mfma_f32_32x32x16_bf16 v[64:79], v[12:15], v[196:199], v[64:79]
ds_read_b64_tr_b16 v[40:41], v3 offset:8192
ds_read_b64_tr_b16 v[42:43], v3 offset:8320
s_waitcnt lgkmcnt(12)
v_mfma_f32_32x32x16_bf16 v[64:79], v[16:19], v[200:203], v[64:79]
ds_read_b64_tr_b16 v[44:45], v3 offset:10240
ds_read_b64_tr_b16 v[46:47], v3 offset:10368
buffer_load_dwordx4 v[240:243], v6, s[12:15], s36 offen offset:2048
s_waitcnt lgkmcnt(12)
v_mfma_f32_32x32x16_bf16 v[64:79], v[20:23], v[204:207], v[64:79]
ds_read_b64_tr_b16 v[12:13], v2 offset:25344
ds_read_b64_tr_b16 v[14:15], v2 offset:25472
s_waitcnt vmcnt(11)
s_waitcnt lgkmcnt(12)
v_mfma_f32_32x32x16_bf16 v[48:63], v[24:27], v[208:211], v[48:63]
ds_read_b64_tr_b16 v[16:17], v2 offset:27392
ds_read_b64_tr_b16 v[18:19], v2 offset:27520
buffer_load_dwordx4 v[244:247], v6, s[12:15], s36 offen offset:3072
s_waitcnt vmcnt(11)
s_waitcnt lgkmcnt(12)
v_mfma_f32_32x32x16_bf16 v[48:63], v[28:31], v[212:215], v[48:63]
ds_read_b64_tr_b16 v[20:21], v2 offset:29440
ds_read_b64_tr_b16 v[22:23], v2 offset:29568
s_waitcnt vmcnt(10)
s_waitcnt lgkmcnt(12)
v_mfma_f32_32x32x16_bf16 v[48:63], v[32:35], v[216:219], v[48:63]
ds_read_b64_tr_b16 v[24:25], v2 offset:31488
ds_read_b64_tr_b16 v[26:27], v2 offset:31616
s_add_u32 s36, s71, 4096
buffer_load_dwordx4 v[248:251], v6, s[12:15], s36 offen offset:0
s_waitcnt vmcnt(10)
s_waitcnt lgkmcnt(12)
v_mfma_f32_32x32x16_bf16 v[48:63], v[36:39], v[220:223], v[48:63]
ds_read_b64_tr_b16 v[28:29], v2 offset:33536
ds_read_b64_tr_b16 v[30:31], v2 offset:33664
s_waitcnt vmcnt(9)
s_waitcnt lgkmcnt(12)
v_mfma_f32_32x32x16_bf16 v[48:63], v[40:43], v[224:227], v[48:63]
ds_read_b64_tr_b16 v[32:33], v2 offset:35584
ds_read_b64_tr_b16 v[34:35], v2 offset:35712
buffer_load_dwordx4 v[252:255], v6, s[12:15], s36 offen offset:1024
s_waitcnt vmcnt(9)
s_waitcnt lgkmcnt(12)
v_mfma_f32_32x32x16_bf16 v[48:63], v[44:47], v[228:231], v[48:63]
ds_read_b64_tr_b16 v[36:37], v3 offset:256
ds_read_b64_tr_b16 v[38:39], v3 offset:384
s_waitcnt lgkmcnt(12)
v_mfma_f32_32x32x16_bf16 v[80:95], v[12:15], v[184:187], v[80:95]
ds_read_b64_tr_b16 v[40:41], v3 offset:2304
ds_read_b64_tr_b16 v[42:43], v3 offset:2432
s_add_u32 s35, s60, 128
s_add_u32 m0, s30, 0
s_nop 0
buffer_load_dwordx4 v4, s[4:7], s35 offen lds
s_waitcnt lgkmcnt(12)
v_mfma_f32_32x32x16_bf16 v[80:95], v[16:19], v[188:191], v[80:95]
ds_read_b64_tr_b16 v[44:45], v3 offset:4352
ds_read_b64_tr_b16 v[46:47], v3 offset:4480
s_waitcnt lgkmcnt(12)
v_mfma_f32_32x32x16_bf16 v[80:95], v[20:23], v[192:195], v[80:95]
ds_read_b64_tr_b16 v[12:13], v3 offset:6400
ds_read_b64_tr_b16 v[14:15], v3 offset:6528
s_add_u32 s35, s60, 295040
s_add_u32 m0, s30, 4096
s_nop 0
buffer_load_dwordx4 v4, s[4:7], s35 offen lds
s_waitcnt lgkmcnt(12)
v_mfma_f32_32x32x16_bf16 v[80:95], v[24:27], v[196:199], v[80:95]
ds_read_b64_tr_b16 v[16:17], v3 offset:8448
ds_read_b64_tr_b16 v[18:19], v3 offset:8576
s_waitcnt lgkmcnt(12)
v_mfma_f32_32x32x16_bf16 v[80:95], v[28:31], v[200:203], v[80:95]
ds_read_b64_tr_b16 v[20:21], v3 offset:10496
ds_read_b64_tr_b16 v[22:23], v3 offset:10624
s_add_u32 s35, s60, 589952
s_add_u32 m0, s30, 8192
s_nop 0
buffer_load_dwordx4 v4, s[4:7], s35 offen lds
s_waitcnt lgkmcnt(12)
v_mfma_f32_32x32x16_bf16 v[80:95], v[32:35], v[204:207], v[80:95]
ds_read_b64_tr_b16 v[24:25], v2 offset:25600
ds_read_b64_tr_b16 v[26:27], v2 offset:25728
s_waitcnt lgkmcnt(12)
v_mfma_f32_32x32x16_bf16 v[64:79], v[36:39], v[208:211], v[64:79]
ds_read_b64_tr_b16 v[28:29], v2 offset:27648
ds_read_b64_tr_b16 v[30:31], v2 offset:27776
s_waitcnt lgkmcnt(12)
v_mfma_f32_32x32x16_bf16 v[64:79], v[40:43], v[212:215], v[64:79]
ds_read_b64_tr_b16 v[32:33], v2 offset:29696
ds_read_b64_tr_b16 v[34:35], v2 offset:29824
s_waitcnt lgkmcnt(12)
v_mfma_f32_32x32x16_bf16 v[64:79], v[44:47], v[216:219], v[64:79]
ds_read_b64_tr_b16 v[36:37], v2 offset:31744
ds_read_b64_tr_b16 v[38:39], v2 offset:31872
s_waitcnt lgkmcnt(12)
v_mfma_f32_32x32x16_bf16 v[64:79], v[12:15], v[220:223], v[64:79]
ds_read_b64_tr_b16 v[40:41], v2 offset:33792
ds_read_b64_tr_b16 v[42:43], v2 offset:33920
s_waitcnt lgkmcnt(12)
v_mfma_f32_32x32x16_bf16 v[64:79], v[16:19], v[224:227], v[64:79]
ds_read_b64_tr_b16 v[44:45], v2 offset:35840
ds_read_b64_tr_b16 v[46:47], v2 offset:35968
s_waitcnt lgkmcnt(12)
v_mfma_f32_32x32x16_bf16 v[64:79], v[20:23], v[228:231], v[64:79]
s_waitcnt vmcnt(9)
s_barrier
ds_read_b64_tr_b16 v[12:13], v3 offset:24832
ds_read_b64_tr_b16 v[14:15], v3 offset:24960
s_waitcnt lgkmcnt(12)
v_mfma_f32_32x32x16_bf16 v[96:111], v[24:27], v[184:187], v[96:111]
ds_read_b64_tr_b16 v[16:17], v3 offset:26880
ds_read_b64_tr_b16 v[18:19], v3 offset:27008
s_waitcnt lgkmcnt(12)
v_mfma_f32_32x32x16_bf16 v[96:111], v[28:31], v[188:191], v[96:111]
ds_read_b64_tr_b16 v[20:21], v3 offset:28928
ds_read_b64_tr_b16 v[22:23], v3 offset:29056
s_waitcnt lgkmcnt(12)
v_mfma_f32_32x32x16_bf16 v[96:111], v[32:35], v[192:195], v[96:111]
ds_read_b64_tr_b16 v[24:25], v3 offset:30976
ds_read_b64_tr_b16 v[26:27], v3 offset:31104
s_waitcnt lgkmcnt(12)
v_mfma_f32_32x32x16_bf16 v[96:111], v[36:39], v[196:199], v[96:111]
ds_read_b64_tr_b16 v[28:29], v3 offset:33024
ds_read_b64_tr_b16 v[30:31], v3 offset:33152
s_waitcnt lgkmcnt(12)
v_mfma_f32_32x32x16_bf16 v[96:111], v[40:43], v[200:203], v[96:111]
ds_read_b64_tr_b16 v[32:33], v3 offset:35072
ds_read_b64_tr_b16 v[34:35], v3 offset:35200
s_waitcnt lgkmcnt(12)
v_mfma_f32_32x32x16_bf16 v[96:111], v[44:47], v[204:207], v[96:111]
ds_read_b64_tr_b16 v[36:37], v3 offset:512
ds_read_b64_tr_b16 v[38:39], v3 offset:640
s_waitcnt vmcnt(8)
s_waitcnt lgkmcnt(12)
v_mfma_f32_32x32x16_bf16 v[48:63], v[12:15], v[232:235], v[48:63]
ds_read_b64_tr_b16 v[40:41], v3 offset:2560
ds_read_b64_tr_b16 v[42:43], v3 offset:2688
s_waitcnt vmcnt(7)
s_waitcnt lgkmcnt(12)
v_mfma_f32_32x32x16_bf16 v[48:63], v[16:19], v[236:239], v[48:63]
ds_read_b64_tr_b16 v[44:45], v3 offset:4608
ds_read_b64_tr_b16 v[46:47], v3 offset:4736
s_waitcnt vmcnt(6)
s_waitcnt lgkmcnt(12)
v_mfma_f32_32x32x16_bf16 v[48:63], v[20:23], v[240:243], v[48:63]
ds_read_b64_tr_b16 v[12:13], v3 offset:6656
ds_read_b64_tr_b16 v[14:15], v3 offset:6784
s_add_u32 s35, s61, 128
s_add_u32 m0, s30, 24832
s_nop 0
buffer_load_dwordx4 v4, s[4:7], s35 offen lds
s_waitcnt vmcnt(6)
s_waitcnt lgkmcnt(12)
v_mfma_f32_32x32x16_bf16 v[48:63], v[24:27], v[244:247], v[48:63]
ds_read_b64_tr_b16 v[16:17], v3 offset:8704
ds_read_b64_tr_b16 v[18:19], v3 offset:8832
s_waitcnt vmcnt(5)
s_waitcnt lgkmcnt(12)
v_mfma_f32_32x32x16_bf16 v[48:63], v[28:31], v[248:251], v[48:63]
ds_read_b64_tr_b16 v[20:21], v3 offset:10752
ds_read_b64_tr_b16 v[22:23], v3 offset:10880
s_add_u32 s35, s61, 295040
s_add_u32 m0, s30, 28928
s_nop 0
buffer_load_dwordx4 v4, s[4:7], s35 offen lds
s_waitcnt vmcnt(5)
s_waitcnt lgkmcnt(12)
v_mfma_f32_32x32x16_bf16 v[48:63], v[32:35], v[252:255], v[48:63]
s_barrier
ds_read_b64_tr_b16 v[24:25], v3 offset:25088
ds_read_b64_tr_b16 v[26:27], v3 offset:25216
s_waitcnt lgkmcnt(12)
v_mfma_f32_32x32x16_bf16 v[80:95], v[36:39], v[208:211], v[80:95]
ds_read_b64_tr_b16 v[28:29], v3 offset:27136
ds_read_b64_tr_b16 v[30:31], v3 offset:27264
s_add_u32 s35, s61, 589952
s_add_u32 m0, s30, 33024
s_nop 0
buffer_load_dwordx4 v4, s[4:7], s35 offen lds
s_waitcnt lgkmcnt(12)
v_mfma_f32_32x32x16_bf16 v[80:95], v[40:43], v[212:215], v[80:95]
ds_read_b64_tr_b16 v[32:33], v3 offset:29184
ds_read_b64_tr_b16 v[34:35], v3 offset:29312
s_waitcnt lgkmcnt(12)
v_mfma_f32_32x32x16_bf16 v[80:95], v[44:47], v[216:219], v[80:95]
ds_read_b64_tr_b16 v[36:37], v3 offset:31232
ds_read_b64_tr_b16 v[38:39], v3 offset:31360
v_mul_f32 v0, v48, v48
v_mul_f32 v7, v49, v49
v_fma_f32 v0, v0, s40, v10
v_fma_f32 v7, v7, s40, v10
s_waitcnt lgkmcnt(12)
v_mfma_f32_32x32x16_bf16 v[80:95], v[12:15], v[220:223], v[80:95]
ds_read_b64_tr_b16 v[40:41], v3 offset:33280
ds_read_b64_tr_b16 v[42:43], v3 offset:33408
v_mul_f32 v0, v0, v48
v_mul_f32 v7, v7, v49
v_exp_f32 v0, v0
v_exp_f32 v7, v7
s_waitcnt lgkmcnt(12)
v_mfma_f32_32x32x16_bf16 v[80:95], v[16:19], v[224:227], v[80:95]
ds_read_b64_tr_b16 v[44:45], v3 offset:35328
ds_read_b64_tr_b16 v[46:47], v3 offset:35456
v_mul_f32 v56, v48, v56
v_mul_f32 v57, v49, v57
v_add_f32 v0, 1.0, v0
v_add_f32 v7, 1.0, v7
s_waitcnt lgkmcnt(12)
v_mfma_f32_32x32x16_bf16 v[80:95], v[20:23], v[228:231], v[80:95]
ds_read_b64_tr_b16 v[12:13], v3 offset:768
ds_read_b64_tr_b16 v[14:15], v3 offset:896
v_rcp_f32 v0, v0
v_rcp_f32 v7, v7
v_mul_f32 v8, v50, v50
v_mul_f32 v9, v51, v51
s_waitcnt lgkmcnt(12)
v_mfma_f32_32x32x16_bf16 v[64:79], v[24:27], v[232:235], v[64:79]
ds_read_b64_tr_b16 v[16:17], v3 offset:2816
ds_read_b64_tr_b16 v[18:19], v3 offset:2944
v_mul_f32 v56, v56, v0
v_mul_f32 v57, v57, v7
v_cvt_pk_bf16_f32 v48, v56, v57
v_fma_f32 v8, v8, s40, v10
s_waitcnt lgkmcnt(12)
v_mfma_f32_32x32x16_bf16 v[64:79], v[28:31], v[236:239], v[64:79]
ds_read_b64_tr_b16 v[20:21], v3 offset:4864
ds_read_b64_tr_b16 v[22:23], v3 offset:4992
v_fma_f32 v9, v9, s40, v10
v_mul_f32 v8, v8, v50
v_mul_f32 v9, v9, v51
v_exp_f32 v8, v8
s_waitcnt lgkmcnt(12)
v_mfma_f32_32x32x16_bf16 v[64:79], v[32:35], v[240:243], v[64:79]
ds_read_b64_tr_b16 v[24:25], v3 offset:6912
ds_read_b64_tr_b16 v[26:27], v3 offset:7040
s_add_u32 s35, s62, 128
s_add_u32 m0, s30, 49664
s_nop 0
buffer_load_dwordx4 v4, s[4:7], s35 offen lds
v_exp_f32 v9, v9
v_mul_f32 v58, v50, v58
v_mul_f32 v59, v51, v59
v_add_f32 v8, 1.0, v8
s_waitcnt lgkmcnt(12)
v_mfma_f32_32x32x16_bf16 v[64:79], v[36:39], v[244:247], v[64:79]
ds_read_b64_tr_b16 v[28:29], v3 offset:8960
ds_read_b64_tr_b16 v[30:31], v3 offset:9088
v_add_f32 v9, 1.0, v9
v_rcp_f32 v8, v8
v_rcp_f32 v9, v9
v_mul_f32 v0, v52, v52
s_waitcnt lgkmcnt(12)
v_mfma_f32_32x32x16_bf16 v[64:79], v[40:43], v[248:251], v[64:79]
ds_read_b64_tr_b16 v[32:33], v3 offset:11008
ds_read_b64_tr_b16 v[34:35], v3 offset:11136
s_add_u32 s35, s62, 295040
s_add_u32 m0, s30, 53760
s_nop 0
buffer_load_dwordx4 v4, s[4:7], s35 offen lds
v_mul_f32 v7, v53, v53
v_mul_f32 v58, v58, v8
v_mul_f32 v59, v59, v9
v_cvt_pk_bf16_f32 v49, v58, v59
s_waitcnt lgkmcnt(12)
v_mfma_f32_32x32x16_bf16 v[64:79], v[44:47], v[252:255], v[64:79]
s_waitcnt vmcnt(5)
s_barrier
ds_read_b64_tr_b16 v[36:37], v3 offset:25344
ds_read_b64_tr_b16 v[38:39], v3 offset:25472
v_fma_f32 v0, v0, s40, v10
v_fma_f32 v7, v7, s40, v10
v_mul_f32 v0, v0, v52
v_mul_f32 v7, v7, v53
s_waitcnt lgkmcnt(12)
v_mfma_f32_32x32x16_bf16 v[96:111], v[12:15], v[208:211], v[96:111]
ds_read_b64_tr_b16 v[40:41], v3 offset:27392
ds_read_b64_tr_b16 v[42:43], v3 offset:27520
s_add_u32 s35, s62, 589952
s_add_u32 m0, s30, 57856
s_nop 0
buffer_load_dwordx4 v4, s[4:7], s35 offen lds
v_exp_f32 v0, v0
v_exp_f32 v7, v7
v_mul_f32 v60, v52, v60
v_mul_f32 v61, v53, v61
s_waitcnt lgkmcnt(12)
v_mfma_f32_32x32x16_bf16 v[96:111], v[16:19], v[212:215], v[96:111]
ds_read_b64_tr_b16 v[44:45], v3 offset:29440
ds_read_b64_tr_b16 v[46:47], v3 offset:29568
v_add_f32 v0, 1.0, v0
v_add_f32 v7, 1.0, v7
v_rcp_f32 v0, v0
v_rcp_f32 v7, v7
s_waitcnt lgkmcnt(12)
v_mfma_f32_32x32x16_bf16 v[96:111], v[20:23], v[216:219], v[96:111]
ds_read_b64_tr_b16 v[12:13], v3 offset:31488
ds_read_b64_tr_b16 v[14:15], v3 offset:31616
v_mul_f32 v8, v54, v54
v_mul_f32 v9, v55, v55
v_mul_f32 v60, v60, v0
v_mul_f32 v61, v61, v7
s_waitcnt lgkmcnt(12)
v_mfma_f32_32x32x16_bf16 v[96:111], v[24:27], v[220:223], v[96:111]
ds_read_b64_tr_b16 v[16:17], v3 offset:33536
ds_read_b64_tr_b16 v[18:19], v3 offset:33664
v_cvt_pk_bf16_f32 v50, v60, v61
v_fma_f32 v8, v8, s40, v10
v_fma_f32 v9, v9, s40, v10
v_mul_f32 v8, v8, v54
s_waitcnt lgkmcnt(12)
v_mfma_f32_32x32x16_bf16 v[96:111], v[28:31], v[224:227], v[96:111]
ds_read_b64_tr_b16 v[20:21], v3 offset:35584
ds_read_b64_tr_b16 v[22:23], v3 offset:35712
v_mul_f32 v9, v9, v55
v_exp_f32 v8, v8
v_exp_f32 v9, v9
v_mul_f32 v62, v54, v62
s_waitcnt lgkmcnt(12)
v_mfma_f32_32x32x16_bf16 v[96:111], v[32:35], v[228:231], v[96:111]
ds_read_b64_tr_b16 v[24:25], v1 offset:0
ds_read_b64_tr_b16 v[26:27], v1 offset:128
v_mul_f32 v63, v55, v63
v_add_f32 v8, 1.0, v8
v_add_f32 v9, 1.0, v9
v_rcp_f32 v8, v8
s_waitcnt lgkmcnt(12)
v_mfma_f32_32x32x16_bf16 v[80:95], v[36:39], v[232:235], v[80:95]
ds_read_b64_tr_b16 v[28:29], v1 offset:2048
ds_read_b64_tr_b16 v[30:31], v1 offset:2176
v_rcp_f32 v9, v9
v_mul_f32 v62, v62, v8
v_mul_f32 v63, v63, v9
v_cvt_pk_bf16_f32 v51, v62, v63
s_waitcnt lgkmcnt(12)
v_mfma_f32_32x32x16_bf16 v[80:95], v[40:43], v[236:239], v[80:95]
ds_read_b64_tr_b16 v[32:33], v1 offset:4096
ds_read_b64_tr_b16 v[34:35], v1 offset:4224
s_add_u32 s38, s34, 0
buffer_store_dwordx4 v[48:51], v6, s[12:15], s38 offen sc1
v_mul_f32 v0, v64, v64
v_mul_f32 v7, v65, v65
s_waitcnt lgkmcnt(12)
v_mfma_f32_32x32x16_bf16 v[80:95], v[44:47], v[240:243], v[80:95]
ds_read_b64_tr_b16 v[36:37], v1 offset:6144
ds_read_b64_tr_b16 v[38:39], v1 offset:6272
s_add_u32 s35, s63, 128
s_add_u32 m0, s30, 74496
s_nop 0
buffer_load_dwordx4 v4, s[4:7], s35 offen lds
v_fma_f32 v0, v0, s40, v10
v_fma_f32 v7, v7, s40, v10
v_mul_f32 v0, v0, v64
v_mul_f32 v7, v7, v65
s_waitcnt lgkmcnt(12)
v_mfma_f32_32x32x16_bf16 v[80:95], v[12:15], v[244:247], v[80:95]
ds_read_b64_tr_b16 v[40:41], v1 offset:8192
ds_read_b64_tr_b16 v[42:43], v1 offset:8320
v_exp_f32 v0, v0
v_exp_f32 v7, v7
v_mul_f32 v72, v64, v72
v_mul_f32 v73, v65, v73
s_waitcnt lgkmcnt(12)
v_mfma_f32_32x32x16_bf16 v[80:95], v[16:19], v[248:251], v[80:95]
ds_read_b64_tr_b16 v[44:45], v1 offset:10240
ds_read_b64_tr_b16 v[46:47], v1 offset:10368
s_add_u32 s35, s63, 295040
s_add_u32 m0, s30, 78592
s_nop 0
buffer_load_dwordx4 v4, s[4:7], s35 offen lds
v_add_f32 v0, 1.0, v0
v_add_f32 v7, 1.0, v7
v_rcp_f32 v0, v0
v_rcp_f32 v7, v7
s_waitcnt lgkmcnt(12)
v_mfma_f32_32x32x16_bf16 v[80:95], v[20:23], v[252:255], v[80:95]
s_waitcnt vmcnt(6)
s_barrier
ds_read_b64_tr_b16 v[12:13], v3 offset:25600
ds_read_b64_tr_b16 v[14:15], v3 offset:25728
v_mul_f32 v8, v66, v66
v_mul_f32 v9, v67, v67
v_mul_f32 v72, v72, v0
v_mul_f32 v73, v73, v7
s_waitcnt lgkmcnt(12)
v_mfma_f32_32x32x16_bf16 v[48:63], v[24:27], v[112:115], 0
ds_read_b64_tr_b16 v[16:17], v3 offset:27648
ds_read_b64_tr_b16 v[18:19], v3 offset:27776
s_add_u32 s35, s63, 589952
s_add_u32 m0, s30, 82688
s_nop 0
buffer_load_dwordx4 v4, s[4:7], s35 offen lds
v_cvt_pk_bf16_f32 v64, v72, v73
v_fma_f32 v8, v8, s40, v10
v_fma_f32 v9, v9, s40, v10
v_mul_f32 v8, v8, v66
s_waitcnt lgkmcnt(12)
v_mfma_f32_32x32x16_bf16 v[48:63], v[28:31], v[116:119], v[48:63]
ds_read_b64_tr_b16 v[20:21], v3 offset:29696
ds_read_b64_tr_b16 v[22:23], v3 offset:29824
v_mul_f32 v9, v9, v67
v_exp_f32 v8, v8
v_exp_f32 v9, v9
v_mul_f32 v74, v66, v74
s_waitcnt lgkmcnt(12)
v_mfma_f32_32x32x16_bf16 v[48:63], v[32:35], v[120:123], v[48:63]
ds_read_b64_tr_b16 v[24:25], v3 offset:31744
ds_read_b64_tr_b16 v[26:27], v3 offset:31872
v_mul_f32 v75, v67, v75
v_add_f32 v8, 1.0, v8
v_add_f32 v9, 1.0, v9
v_rcp_f32 v8, v8
s_waitcnt lgkmcnt(12)
v_mfma_f32_32x32x16_bf16 v[48:63], v[36:39], v[124:127], v[48:63]
ds_read_b64_tr_b16 v[28:29], v3 offset:33792
ds_read_b64_tr_b16 v[30:31], v3 offset:33920
v_rcp_f32 v9, v9
v_mul_f32 v0, v68, v68
v_mul_f32 v7, v69, v69
v_mul_f32 v74, v74, v8
s_waitcnt lgkmcnt(12)
v_mfma_f32_32x32x16_bf16 v[48:63], v[40:43], v[128:131], v[48:63]
ds_read_b64_tr_b16 v[32:33], v3 offset:35840
ds_read_b64_tr_b16 v[34:35], v3 offset:35968
v_mul_f32 v75, v75, v9
v_cvt_pk_bf16_f32 v65, v74, v75
v_fma_f32 v0, v0, s40, v10
v_fma_f32 v7, v7, s40, v10
s_waitcnt lgkmcnt(12)
v_mfma_f32_32x32x16_bf16 v[48:63], v[44:47], v[132:135], v[48:63]
ds_read_b64_tr_b16 v[36:37], v1 offset:24832
ds_read_b64_tr_b16 v[38:39], v1 offset:24960
v_mul_f32 v0, v0, v68
v_mul_f32 v7, v7, v69
v_exp_f32 v0, v0
v_exp_f32 v7, v7
s_waitcnt lgkmcnt(12)
v_mfma_f32_32x32x16_bf16 v[96:111], v[12:15], v[232:235], v[96:111]
ds_read_b64_tr_b16 v[40:41], v1 offset:26880
ds_read_b64_tr_b16 v[42:43], v1 offset:27008
v_mul_f32 v76, v68, v76
v_mul_f32 v77, v69, v77
v_add_f32 v0, 1.0, v0
v_add_f32 v7, 1.0, v7
s_waitcnt lgkmcnt(12)
v_mfma_f32_32x32x16_bf16 v[96:111], v[16:19], v[236:239], v[96:111]
ds_read_b64_tr_b16 v[44:45], v1 offset:28928
ds_read_b64_tr_b16 v[46:47], v1 offset:29056
v_rcp_f32 v0, v0
v_rcp_f32 v7, v7
v_mul_f32 v8, v70, v70
v_mul_f32 v9, v71, v71
s_waitcnt lgkmcnt(12)
v_mfma_f32_32x32x16_bf16 v[96:111], v[20:23], v[240:243], v[96:111]
ds_read_b64_tr_b16 v[12:13], v1 offset:30976
ds_read_b64_tr_b16 v[14:15], v1 offset:31104
s_add_u32 s35, s64, 128
s_add_u32 m0, s30, 99328
s_nop 0
buffer_load_dwordx4 v4, s[4:7], s35 offen lds
v_mul_f32 v76, v76, v0
v_mul_f32 v77, v77, v7
v_cvt_pk_bf16_f32 v66, v76, v77
v_fma_f32 v8, v8, s40, v10
s_waitcnt lgkmcnt(12)
v_mfma_f32_32x32x16_bf16 v[96:111], v[24:27], v[244:247], v[96:111]
ds_read_b64_tr_b16 v[16:17], v1 offset:33024
ds_read_b64_tr_b16 v[18:19], v1 offset:33152
v_fma_f32 v9, v9, s40, v10
v_mul_f32 v8, v8, v70
v_mul_f32 v9, v9, v71
v_exp_f32 v8, v8
s_waitcnt lgkmcnt(12)
v_mfma_f32_32x32x16_bf16 v[96:111], v[28:31], v[248:251], v[96:111]
ds_read_b64_tr_b16 v[20:21], v1 offset:35072
ds_read_b64_tr_b16 v[22:23], v1 offset:35200
s_add_u32 s35, s64, 295040
s_add_u32 m0, s30, 103424
s_nop 0
buffer_load_dwordx4 v4, s[4:7], s35 offen lds
v_exp_f32 v9, v9
v_mul_f32 v78, v70, v78
v_mul_f32 v79, v71, v79
v_add_f32 v8, 1.0, v8
s_waitcnt lgkmcnt(12)
v_mfma_f32_32x32x16_bf16 v[96:111], v[32:35], v[252:255], v[96:111]
ds_read_b64_tr_b16 v[24:25], v1 offset:256
ds_read_b64_tr_b16 v[26:27], v1 offset:384
v_add_f32 v9, 1.0, v9
v_rcp_f32 v8, v8
v_rcp_f32 v9, v9
v_mul_f32 v78, v78, v8
s_waitcnt lgkmcnt(12)
v_mfma_f32_32x32x16_bf16 v[48:63], v[36:39], v[136:139], v[48:63]
ds_read_b64_tr_b16 v[28:29], v1 offset:2304
ds_read_b64_tr_b16 v[30:31], v1 offset:2432
s_add_u32 s35, s64, 589952
s_add_u32 m0, s30, 107520
s_nop 0
buffer_load_dwordx4 v4, s[4:7], s35 offen lds
v_mul_f32 v79, v79, v9
v_cvt_pk_bf16_f32 v67, v78, v79
s_add_u32 s38, s34, 1024
buffer_store_dwordx4 v[64:67], v6, s[12:15], s38 offen sc1
s_waitcnt lgkmcnt(12)
v_mfma_f32_32x32x16_bf16 v[48:63], v[40:43], v[140:143], v[48:63]
ds_read_b64_tr_b16 v[32:33], v1 offset:4352
ds_read_b64_tr_b16 v[34:35], v1 offset:4480
v_mul_f32 v0, v80, v80
v_mul_f32 v7, v81, v81
v_fma_f32 v0, v0, s40, v10
v_fma_f32 v7, v7, s40, v10
s_waitcnt lgkmcnt(12)
v_mfma_f32_32x32x16_bf16 v[48:63], v[44:47], v[144:147], v[48:63]
ds_read_b64_tr_b16 v[36:37], v1 offset:6400
ds_read_b64_tr_b16 v[38:39], v1 offset:6528
v_mul_f32 v0, v0, v80
v_mul_f32 v7, v7, v81
v_exp_f32 v0, v0
v_exp_f32 v7, v7
s_waitcnt lgkmcnt(12)
v_mfma_f32_32x32x16_bf16 v[48:63], v[12:15], v[148:151], v[48:63]
ds_read_b64_tr_b16 v[40:41], v1 offset:8448
ds_read_b64_tr_b16 v[42:43], v1 offset:8576
v_mul_f32 v88, v80, v88
v_mul_f32 v89, v81, v89
v_add_f32 v0, 1.0, v0
v_add_f32 v7, 1.0, v7
s_waitcnt lgkmcnt(12)
v_mfma_f32_32x32x16_bf16 v[48:63], v[16:19], v[152:155], v[48:63]
ds_read_b64_tr_b16 v[44:45], v1 offset:10496
ds_read_b64_tr_b16 v[46:47], v1 offset:10624
v_rcp_f32 v0, v0
v_rcp_f32 v7, v7
v_mul_f32 v8, v82, v82
v_mul_f32 v9, v83, v83
s_waitcnt lgkmcnt(12)
v_mfma_f32_32x32x16_bf16 v[48:63], v[20:23], v[156:159], v[48:63]
s_waitcnt vmcnt(8)
s_barrier
ds_read_b64_tr_b16 v[12:13], v2 offset:0
ds_read_b64_tr_b16 v[14:15], v2 offset:128
v_mul_f32 v88, v88, v0
v_mul_f32 v89, v89, v7
v_cvt_pk_bf16_f32 v80, v88, v89
v_fma_f32 v8, v8, s40, v10
s_waitcnt lgkmcnt(12)
v_mfma_f32_32x32x16_bf16 v[64:79], v[24:27], v[112:115], 0
ds_read_b64_tr_b16 v[16:17], v2 offset:2048
ds_read_b64_tr_b16 v[18:19], v2 offset:2176
v_fma_f32 v9, v9, s40, v10
v_mul_f32 v8, v8, v82
v_mul_f32 v9, v9, v83
v_exp_f32 v8, v8
s_waitcnt lgkmcnt(12)
v_mfma_f32_32x32x16_bf16 v[64:79], v[28:31], v[116:119], v[64:79]
ds_read_b64_tr_b16 v[20:21], v2 offset:4096
ds_read_b64_tr_b16 v[22:23], v2 offset:4224
v_exp_f32 v9, v9
v_mul_f32 v90, v82, v90
v_mul_f32 v91, v83, v91
v_add_f32 v8, 1.0, v8
s_waitcnt lgkmcnt(12)
v_mfma_f32_32x32x16_bf16 v[64:79], v[32:35], v[120:123], v[64:79]
ds_read_b64_tr_b16 v[24:25], v2 offset:6144
ds_read_b64_tr_b16 v[26:27], v2 offset:6272
v_add_f32 v9, 1.0, v9
v_rcp_f32 v8, v8
v_rcp_f32 v9, v9
v_mul_f32 v0, v84, v84
s_waitcnt lgkmcnt(12)
v_mfma_f32_32x32x16_bf16 v[64:79], v[36:39], v[124:127], v[64:79]
ds_read_b64_tr_b16 v[28:29], v2 offset:8192
ds_read_b64_tr_b16 v[30:31], v2 offset:8320
v_mul_f32 v7, v85, v85
v_mul_f32 v90, v90, v8
v_mul_f32 v91, v91, v9
v_cvt_pk_bf16_f32 v81, v90, v91
s_waitcnt lgkmcnt(12)
v_mfma_f32_32x32x16_bf16 v[64:79], v[40:43], v[128:131], v[64:79]
ds_read_b64_tr_b16 v[32:33], v2 offset:10240
ds_read_b64_tr_b16 v[34:35], v2 offset:10368
v_fma_f32 v0, v0, s40, v10
v_fma_f32 v7, v7, s40, v10
v_mul_f32 v0, v0, v84
v_mul_f32 v7, v7, v85
s_waitcnt lgkmcnt(12)
v_mfma_f32_32x32x16_bf16 v[64:79], v[44:47], v[132:135], v[64:79]
ds_read_b64_tr_b16 v[36:37], v1 offset:25088
ds_read_b64_tr_b16 v[38:39], v1 offset:25216
v_exp_f32 v0, v0
v_exp_f32 v7, v7
v_mul_f32 v92, v84, v92
v_mul_f32 v93, v85, v93
s_waitcnt lgkmcnt(12)
v_mfma_f32_32x32x16_bf16 v[48:63], v[12:15], v[160:163], v[48:63]
ds_read_b64_tr_b16 v[40:41], v1 offset:27136
ds_read_b64_tr_b16 v[42:43], v1 offset:27264
v_add_f32 v0, 1.0, v0
v_add_f32 v7, 1.0, v7
v_rcp_f32 v0, v0
v_rcp_f32 v7, v7
s_waitcnt lgkmcnt(12)
v_mfma_f32_32x32x16_bf16 v[48:63], v[16:19], v[164:167], v[48:63]
ds_read_b64_tr_b16 v[44:45], v1 offset:29184
ds_read_b64_tr_b16 v[46:47], v1 offset:29312
v_mul_f32 v8, v86, v86
v_mul_f32 v9, v87, v87
v_mul_f32 v92, v92, v0
v_mul_f32 v93, v93, v7
s_waitcnt lgkmcnt(12)
v_mfma_f32_32x32x16_bf16 v[48:63], v[20:23], v[168:171], v[48:63]
ds_read_b64_tr_b16 v[12:13], v1 offset:31232
ds_read_b64_tr_b16 v[14:15], v1 offset:31360
s_add_u32 s35, s65, 128
s_add_u32 m0, s30, 124160
s_nop 0
buffer_load_dwordx4 v4, s[4:7], s35 offen lds
v_cvt_pk_bf16_f32 v82, v92, v93
v_fma_f32 v8, v8, s40, v10
v_fma_f32 v9, v9, s40, v10
v_mul_f32 v8, v8, v86
s_waitcnt lgkmcnt(12)
v_mfma_f32_32x32x16_bf16 v[48:63], v[24:27], v[172:175], v[48:63]
ds_read_b64_tr_b16 v[16:17], v1 offset:33280
ds_read_b64_tr_b16 v[18:19], v1 offset:33408
v_mul_f32 v9, v9, v87
v_exp_f32 v8, v8
v_exp_f32 v9, v9
v_mul_f32 v94, v86, v94
s_waitcnt lgkmcnt(12)
v_mfma_f32_32x32x16_bf16 v[48:63], v[28:31], v[176:179], v[48:63]
ds_read_b64_tr_b16 v[20:21], v1 offset:35328
ds_read_b64_tr_b16 v[22:23], v1 offset:35456
s_add_u32 s35, s65, 295040
s_add_u32 m0, s30, 128256
s_nop 0
buffer_load_dwordx4 v4, s[4:7], s35 offen lds
v_mul_f32 v95, v87, v95
v_add_f32 v8, 1.0, v8
v_add_f32 v9, 1.0, v9
v_rcp_f32 v8, v8
s_waitcnt lgkmcnt(12)
v_mfma_f32_32x32x16_bf16 v[48:63], v[32:35], v[180:183], v[48:63]
ds_read_b64_tr_b16 v[24:25], v1 offset:512
ds_read_b64_tr_b16 v[26:27], v1 offset:640
v_rcp_f32 v9, v9
v_mul_f32 v94, v94, v8
v_mul_f32 v95, v95, v9
v_cvt_pk_bf16_f32 v83, v94, v95
s_waitcnt lgkmcnt(12)
v_mfma_f32_32x32x16_bf16 v[64:79], v[36:39], v[136:139], v[64:79]
ds_read_b64_tr_b16 v[28:29], v1 offset:2560
ds_read_b64_tr_b16 v[30:31], v1 offset:2688
s_add_u32 s35, s65, 589952
s_add_u32 m0, s30, 132352
s_nop 0
buffer_load_dwordx4 v4, s[4:7], s35 offen lds
s_add_u32 s38, s34, 2048
buffer_store_dwordx4 v[80:83], v6, s[12:15], s38 offen sc1
v_mul_f32 v0, v96, v96
v_mul_f32 v7, v97, v97
s_waitcnt lgkmcnt(12)
v_mfma_f32_32x32x16_bf16 v[64:79], v[40:43], v[140:143], v[64:79]
ds_read_b64_tr_b16 v[32:33], v1 offset:4608
ds_read_b64_tr_b16 v[34:35], v1 offset:4736
v_fma_f32 v0, v0, s40, v10
v_fma_f32 v7, v7, s40, v10
v_mul_f32 v0, v0, v96
v_mul_f32 v7, v7, v97
s_waitcnt lgkmcnt(12)
v_mfma_f32_32x32x16_bf16 v[64:79], v[44:47], v[144:147], v[64:79]
ds_read_b64_tr_b16 v[36:37], v1 offset:6656
ds_read_b64_tr_b16 v[38:39], v1 offset:6784
v_exp_f32 v0, v0
v_exp_f32 v7, v7
v_mul_f32 v104, v96, v104
v_mul_f32 v105, v97, v105
s_waitcnt lgkmcnt(12)
v_mfma_f32_32x32x16_bf16 v[64:79], v[12:15], v[148:151], v[64:79]
ds_read_b64_tr_b16 v[40:41], v1 offset:8704
ds_read_b64_tr_b16 v[42:43], v1 offset:8832
v_add_f32 v0, 1.0, v0
v_add_f32 v7, 1.0, v7
v_rcp_f32 v0, v0
v_rcp_f32 v7, v7
s_waitcnt lgkmcnt(12)
v_mfma_f32_32x32x16_bf16 v[64:79], v[16:19], v[152:155], v[64:79]
ds_read_b64_tr_b16 v[44:45], v1 offset:10752
ds_read_b64_tr_b16 v[46:47], v1 offset:10880
v_mul_f32 v8, v98, v98
v_mul_f32 v9, v99, v99
v_mul_f32 v104, v104, v0
v_mul_f32 v105, v105, v7
s_waitcnt lgkmcnt(12)
v_mfma_f32_32x32x16_bf16 v[64:79], v[20:23], v[156:159], v[64:79]
s_waitcnt vmcnt(8)
s_barrier
ds_read_b64_tr_b16 v[12:13], v2 offset:24832
ds_read_b64_tr_b16 v[14:15], v2 offset:24960
v_cvt_pk_bf16_f32 v96, v104, v105
v_fma_f32 v8, v8, s40, v10
v_fma_f32 v9, v9, s40, v10
v_mul_f32 v8, v8, v98
s_waitcnt lgkmcnt(12)
v_mfma_f32_32x32x16_bf16 v[80:95], v[24:27], v[112:115], 0
ds_read_b64_tr_b16 v[16:17], v2 offset:26880
ds_read_b64_tr_b16 v[18:19], v2 offset:27008
v_mul_f32 v9, v9, v99
v_exp_f32 v8, v8
v_exp_f32 v9, v9
v_mul_f32 v106, v98, v106
s_waitcnt lgkmcnt(12)
v_mfma_f32_32x32x16_bf16 v[80:95], v[28:31], v[116:119], v[80:95]
ds_read_b64_tr_b16 v[20:21], v2 offset:28928
ds_read_b64_tr_b16 v[22:23], v2 offset:29056
v_mul_f32 v107, v99, v107
v_add_f32 v8, 1.0, v8
v_add_f32 v9, 1.0, v9
v_rcp_f32 v8, v8
s_waitcnt lgkmcnt(12)
v_mfma_f32_32x32x16_bf16 v[80:95], v[32:35], v[120:123], v[80:95]
ds_read_b64_tr_b16 v[24:25], v2 offset:30976
ds_read_b64_tr_b16 v[26:27], v2 offset:31104
v_rcp_f32 v9, v9
v_mul_f32 v0, v100, v100
v_mul_f32 v7, v101, v101
v_mul_f32 v106, v106, v8
s_waitcnt lgkmcnt(12)
v_mfma_f32_32x32x16_bf16 v[80:95], v[36:39], v[124:127], v[80:95]
ds_read_b64_tr_b16 v[28:29], v2 offset:33024
ds_read_b64_tr_b16 v[30:31], v2 offset:33152
v_mul_f32 v107, v107, v9
v_cvt_pk_bf16_f32 v97, v106, v107
v_fma_f32 v0, v0, s40, v10
v_fma_f32 v7, v7, s40, v10
s_waitcnt lgkmcnt(12)
v_mfma_f32_32x32x16_bf16 v[80:95], v[40:43], v[128:131], v[80:95]
ds_read_b64_tr_b16 v[32:33], v2 offset:35072
ds_read_b64_tr_b16 v[34:35], v2 offset:35200
v_mul_f32 v0, v0, v100
v_mul_f32 v7, v7, v101
v_exp_f32 v0, v0
v_exp_f32 v7, v7
s_waitcnt lgkmcnt(12)
v_mfma_f32_32x32x16_bf16 v[80:95], v[44:47], v[132:135], v[80:95]
ds_read_b64_tr_b16 v[36:37], v2 offset:256
ds_read_b64_tr_b16 v[38:39], v2 offset:384
v_mul_f32 v108, v100, v108
v_mul_f32 v109, v101, v109
v_add_f32 v0, 1.0, v0
v_add_f32 v7, 1.0, v7
s_waitcnt lgkmcnt(12)
v_mfma_f32_32x32x16_bf16 v[48:63], v[12:15], v[184:187], v[48:63]
ds_read_b64_tr_b16 v[40:41], v2 offset:2304
ds_read_b64_tr_b16 v[42:43], v2 offset:2432
v_rcp_f32 v0, v0
v_rcp_f32 v7, v7
v_mul_f32 v8, v102, v102
v_mul_f32 v9, v103, v103
s_waitcnt lgkmcnt(12)
v_mfma_f32_32x32x16_bf16 v[48:63], v[16:19], v[188:191], v[48:63]
ds_read_b64_tr_b16 v[44:45], v2 offset:4352
ds_read_b64_tr_b16 v[46:47], v2 offset:4480
v_mul_f32 v108, v108, v0
v_mul_f32 v109, v109, v7
v_cvt_pk_bf16_f32 v98, v108, v109
v_fma_f32 v8, v8, s40, v10
s_waitcnt lgkmcnt(12)
v_mfma_f32_32x32x16_bf16 v[48:63], v[20:23], v[192:195], v[48:63]
ds_read_b64_tr_b16 v[12:13], v2 offset:6400
ds_read_b64_tr_b16 v[14:15], v2 offset:6528
v_fma_f32 v9, v9, s40, v10
v_mul_f32 v8, v8, v102
v_mul_f32 v9, v9, v103
v_exp_f32 v8, v8
s_waitcnt lgkmcnt(12)
v_mfma_f32_32x32x16_bf16 v[48:63], v[24:27], v[196:199], v[48:63]
ds_read_b64_tr_b16 v[16:17], v2 offset:8448
ds_read_b64_tr_b16 v[18:19], v2 offset:8576
v_exp_f32 v9, v9
v_mul_f32 v110, v102, v110
v_mul_f32 v111, v103, v111
v_add_f32 v8, 1.0, v8
s_waitcnt lgkmcnt(12)
v_mfma_f32_32x32x16_bf16 v[48:63], v[28:31], v[200:203], v[48:63]
ds_read_b64_tr_b16 v[20:21], v2 offset:10496
ds_read_b64_tr_b16 v[22:23], v2 offset:10624
v_add_f32 v9, 1.0, v9
v_rcp_f32 v8, v8
v_rcp_f32 v9, v9
v_mul_f32 v110, v110, v8
s_waitcnt lgkmcnt(12)
v_mfma_f32_32x32x16_bf16 v[48:63], v[32:35], v[204:207], v[48:63]
ds_read_b64_tr_b16 v[24:25], v1 offset:25344
ds_read_b64_tr_b16 v[26:27], v1 offset:25472
v_mul_f32 v111, v111, v9
v_cvt_pk_bf16_f32 v99, v110, v111
s_add_u32 s38, s34, 3072
buffer_store_dwordx4 v[96:99], v6, s[12:15], s38 offen sc1
s_waitcnt lgkmcnt(12)
v_mfma_f32_32x32x16_bf16 v[64:79], v[36:39], v[160:163], v[64:79]
ds_read_b64_tr_b16 v[28:29], v1 offset:27392
ds_read_b64_tr_b16 v[30:31], v1 offset:27520
s_waitcnt lgkmcnt(12)
v_mfma_f32_32x32x16_bf16 v[64:79], v[40:43], v[164:167], v[64:79]
ds_read_b64_tr_b16 v[32:33], v1 offset:29440
ds_read_b64_tr_b16 v[34:35], v1 offset:29568
s_waitcnt lgkmcnt(12)
v_mfma_f32_32x32x16_bf16 v[64:79], v[44:47], v[168:171], v[64:79]
ds_read_b64_tr_b16 v[36:37], v1 offset:31488
ds_read_b64_tr_b16 v[38:39], v1 offset:31616
s_waitcnt lgkmcnt(12)
v_mfma_f32_32x32x16_bf16 v[64:79], v[12:15], v[172:175], v[64:79]
ds_read_b64_tr_b16 v[40:41], v1 offset:33536
ds_read_b64_tr_b16 v[42:43], v1 offset:33664
s_waitcnt lgkmcnt(12)
v_mfma_f32_32x32x16_bf16 v[64:79], v[16:19], v[176:179], v[64:79]
ds_read_b64_tr_b16 v[44:45], v1 offset:35584
ds_read_b64_tr_b16 v[46:47], v1 offset:35712
s_waitcnt lgkmcnt(12)
v_mfma_f32_32x32x16_bf16 v[64:79], v[20:23], v[180:183], v[64:79]
ds_read_b64_tr_b16 v[12:13], v1 offset:768
ds_read_b64_tr_b16 v[14:15], v1 offset:896
s_waitcnt lgkmcnt(12)
v_mfma_f32_32x32x16_bf16 v[80:95], v[24:27], v[136:139], v[80:95]
ds_read_b64_tr_b16 v[16:17], v1 offset:2816
ds_read_b64_tr_b16 v[18:19], v1 offset:2944
s_waitcnt lgkmcnt(12)
v_mfma_f32_32x32x16_bf16 v[80:95], v[28:31], v[140:143], v[80:95]
ds_read_b64_tr_b16 v[20:21], v1 offset:4864
ds_read_b64_tr_b16 v[22:23], v1 offset:4992
s_waitcnt lgkmcnt(12)
v_mfma_f32_32x32x16_bf16 v[80:95], v[32:35], v[144:147], v[80:95]
ds_read_b64_tr_b16 v[24:25], v1 offset:6912
ds_read_b64_tr_b16 v[26:27], v1 offset:7040
s_waitcnt lgkmcnt(12)
v_mfma_f32_32x32x16_bf16 v[80:95], v[36:39], v[148:151], v[80:95]
ds_read_b64_tr_b16 v[28:29], v1 offset:8960
ds_read_b64_tr_b16 v[30:31], v1 offset:9088
s_waitcnt lgkmcnt(12)
v_mfma_f32_32x32x16_bf16 v[80:95], v[40:43], v[152:155], v[80:95]
ds_read_b64_tr_b16 v[32:33], v1 offset:11008
ds_read_b64_tr_b16 v[34:35], v1 offset:11136
s_waitcnt lgkmcnt(12)
v_mfma_f32_32x32x16_bf16 v[80:95], v[44:47], v[156:159], v[80:95]
s_waitcnt vmcnt(6)
s_barrier
ds_read_b64_tr_b16 v[36:37], v3 offset:0
ds_read_b64_tr_b16 v[38:39], v3 offset:128
s_waitcnt lgkmcnt(12)
v_mfma_f32_32x32x16_bf16 v[96:111], v[12:15], v[112:115], 0
ds_read_b64_tr_b16 v[40:41], v3 offset:2048
ds_read_b64_tr_b16 v[42:43], v3 offset:2176
s_waitcnt lgkmcnt(12)
v_mfma_f32_32x32x16_bf16 v[96:111], v[16:19], v[116:119], v[96:111]
ds_read_b64_tr_b16 v[44:45], v3 offset:4096
ds_read_b64_tr_b16 v[46:47], v3 offset:4224
s_waitcnt lgkmcnt(12)
v_mfma_f32_32x32x16_bf16 v[96:111], v[20:23], v[120:123], v[96:111]
ds_read_b64_tr_b16 v[12:13], v3 offset:6144
ds_read_b64_tr_b16 v[14:15], v3 offset:6272
s_waitcnt lgkmcnt(12)
v_mfma_f32_32x32x16_bf16 v[96:111], v[24:27], v[124:127], v[96:111]
ds_read_b64_tr_b16 v[16:17], v3 offset:8192
ds_read_b64_tr_b16 v[18:19], v3 offset:8320
s_waitcnt lgkmcnt(12)
v_mfma_f32_32x32x16_bf16 v[96:111], v[28:31], v[128:131], v[96:111]
ds_read_b64_tr_b16 v[20:21], v3 offset:10240
ds_read_b64_tr_b16 v[22:23], v3 offset:10368
s_waitcnt lgkmcnt(12)
v_mfma_f32_32x32x16_bf16 v[96:111], v[32:35], v[132:135], v[96:111]
ds_read_b64_tr_b16 v[24:25], v2 offset:25088
ds_read_b64_tr_b16 v[26:27], v2 offset:25216
s_waitcnt lgkmcnt(12)
v_mfma_f32_32x32x16_bf16 v[48:63], v[36:39], v[208:211], v[48:63]
ds_read_b64_tr_b16 v[28:29], v2 offset:27136
ds_read_b64_tr_b16 v[30:31], v2 offset:27264
s_waitcnt lgkmcnt(12)
v_mfma_f32_32x32x16_bf16 v[48:63], v[40:43], v[212:215], v[48:63]
ds_read_b64_tr_b16 v[32:33], v2 offset:29184
ds_read_b64_tr_b16 v[34:35], v2 offset:29312
s_waitcnt lgkmcnt(12)
v_mfma_f32_32x32x16_bf16 v[48:63], v[44:47], v[216:219], v[48:63]
ds_read_b64_tr_b16 v[36:37], v2 offset:31232
ds_read_b64_tr_b16 v[38:39], v2 offset:31360
s_mov_b32 s35, s72
s_add_u32 m0, s30, 0
s_nop 0
buffer_load_dwordx4 v5, s[4:7], s35 offen lds
s_waitcnt lgkmcnt(12)
v_mfma_f32_32x32x16_bf16 v[48:63], v[12:15], v[220:223], v[48:63]
ds_read_b64_tr_b16 v[40:41], v2 offset:33280
ds_read_b64_tr_b16 v[42:43], v2 offset:33408
s_waitcnt lgkmcnt(12)
v_mfma_f32_32x32x16_bf16 v[48:63], v[16:19], v[224:227], v[48:63]
ds_read_b64_tr_b16 v[44:45], v2 offset:35328
ds_read_b64_tr_b16 v[46:47], v2 offset:35456
s_mov_b32 s35, s73
s_add_u32 m0, s30, 4096
s_nop 0
buffer_load_dwordx4 v5, s[4:7], s35 offen lds
s_waitcnt lgkmcnt(12)
v_mfma_f32_32x32x16_bf16 v[48:63], v[20:23], v[228:231], v[48:63]
ds_read_b64_tr_b16 v[12:13], v2 offset:512
ds_read_b64_tr_b16 v[14:15], v2 offset:640
s_waitcnt lgkmcnt(12)
v_mfma_f32_32x32x16_bf16 v[64:79], v[24:27], v[184:187], v[64:79]
ds_read_b64_tr_b16 v[16:17], v2 offset:2560
ds_read_b64_tr_b16 v[18:19], v2 offset:2688
s_mov_b32 s35, s74
s_add_u32 m0, s30, 8192
s_nop 0
buffer_load_dwordx4 v5, s[4:7], s35 offen lds
s_waitcnt lgkmcnt(12)
v_mfma_f32_32x32x16_bf16 v[64:79], v[28:31], v[188:191], v[64:79]
ds_read_b64_tr_b16 v[20:21], v2 offset:4608
ds_read_b64_tr_b16 v[22:23], v2 offset:4736
s_waitcnt lgkmcnt(12)
v_mfma_f32_32x32x16_bf16 v[64:79], v[32:35], v[192:195], v[64:79]
ds_read_b64_tr_b16 v[24:25], v2 offset:6656
ds_read_b64_tr_b16 v[26:27], v2 offset:6784
s_waitcnt lgkmcnt(12)
v_mfma_f32_32x32x16_bf16 v[64:79], v[36:39], v[196:199], v[64:79]
ds_read_b64_tr_b16 v[28:29], v2 offset:8704
ds_read_b64_tr_b16 v[30:31], v2 offset:8832
s_waitcnt lgkmcnt(12)
v_mfma_f32_32x32x16_bf16 v[64:79], v[40:43], v[200:203], v[64:79]
ds_read_b64_tr_b16 v[32:33], v2 offset:10752
ds_read_b64_tr_b16 v[34:35], v2 offset:10880
s_waitcnt lgkmcnt(12)
v_mfma_f32_32x32x16_bf16 v[64:79], v[44:47], v[204:207], v[64:79]
ds_read_b64_tr_b16 v[36:37], v1 offset:25600
ds_read_b64_tr_b16 v[38:39], v1 offset:25728
s_waitcnt lgkmcnt(12)
v_mfma_f32_32x32x16_bf16 v[80:95], v[12:15], v[160:163], v[80:95]
ds_read_b64_tr_b16 v[40:41], v1 offset:27648
ds_read_b64_tr_b16 v[42:43], v1 offset:27776
s_waitcnt lgkmcnt(12)
v_mfma_f32_32x32x16_bf16 v[80:95], v[16:19], v[164:167], v[80:95]
ds_read_b64_tr_b16 v[44:45], v1 offset:29696
ds_read_b64_tr_b16 v[46:47], v1 offset:29824
s_waitcnt lgkmcnt(12)
v_mfma_f32_32x32x16_bf16 v[80:95], v[20:23], v[168:171], v[80:95]
ds_read_b64_tr_b16 v[12:13], v1 offset:31744
ds_read_b64_tr_b16 v[14:15], v1 offset:31872
s_waitcnt lgkmcnt(12)
v_mfma_f32_32x32x16_bf16 v[80:95], v[24:27], v[172:175], v[80:95]
ds_read_b64_tr_b16 v[16:17], v1 offset:33792
ds_read_b64_tr_b16 v[18:19], v1 offset:33920
s_waitcnt lgkmcnt(12)
v_mfma_f32_32x32x16_bf16 v[80:95], v[28:31], v[176:179], v[80:95]
ds_read_b64_tr_b16 v[20:21], v1 offset:35840
ds_read_b64_tr_b16 v[22:23], v1 offset:35968
s_waitcnt lgkmcnt(12)
v_mfma_f32_32x32x16_bf16 v[80:95], v[32:35], v[180:183], v[80:95]
s_waitcnt vmcnt(5)
s_barrier
ds_read_b64_tr_b16 v[24:25], v3 offset:24832
ds_read_b64_tr_b16 v[26:27], v3 offset:24960
s_waitcnt lgkmcnt(12)
v_mfma_f32_32x32x16_bf16 v[96:111], v[36:39], v[136:139], v[96:111]
ds_read_b64_tr_b16 v[28:29], v3 offset:26880
ds_read_b64_tr_b16 v[30:31], v3 offset:27008
s_waitcnt lgkmcnt(12)
v_mfma_f32_32x32x16_bf16 v[96:111], v[40:43], v[140:143], v[96:111]
ds_read_b64_tr_b16 v[32:33], v3 offset:28928
ds_read_b64_tr_b16 v[34:35], v3 offset:29056
s_waitcnt lgkmcnt(12)
v_mfma_f32_32x32x16_bf16 v[96:111], v[44:47], v[144:147], v[96:111]
ds_read_b64_tr_b16 v[36:37], v3 offset:30976
ds_read_b64_tr_b16 v[38:39], v3 offset:31104
s_waitcnt lgkmcnt(12)
v_mfma_f32_32x32x16_bf16 v[96:111], v[12:15], v[148:151], v[96:111]
ds_read_b64_tr_b16 v[40:41], v3 offset:33024
ds_read_b64_tr_b16 v[42:43], v3 offset:33152
s_waitcnt lgkmcnt(12)
v_mfma_f32_32x32x16_bf16 v[96:111], v[16:19], v[152:155], v[96:111]
ds_read_b64_tr_b16 v[44:45], v3 offset:35072
ds_read_b64_tr_b16 v[46:47], v3 offset:35200
s_waitcnt lgkmcnt(12)
v_mfma_f32_32x32x16_bf16 v[96:111], v[20:23], v[156:159], v[96:111]
ds_read_b64_tr_b16 v[12:13], v3 offset:256
ds_read_b64_tr_b16 v[14:15], v3 offset:384
s_waitcnt lgkmcnt(12)
v_mfma_f32_32x32x16_bf16 v[48:63], v[24:27], v[232:235], v[48:63]
ds_read_b64_tr_b16 v[16:17], v3 offset:2304
ds_read_b64_tr_b16 v[18:19], v3 offset:2432
s_waitcnt lgkmcnt(12)
v_mfma_f32_32x32x16_bf16 v[48:63], v[28:31], v[236:239], v[48:63]
ds_read_b64_tr_b16 v[20:21], v3 offset:4352
ds_read_b64_tr_b16 v[22:23], v3 offset:4480
s_waitcnt lgkmcnt(12)
v_mfma_f32_32x32x16_bf16 v[48:63], v[32:35], v[240:243], v[48:63]
ds_read_b64_tr_b16 v[24:25], v3 offset:6400
ds_read_b64_tr_b16 v[26:27], v3 offset:6528
s_mov_b32 s35, s75
s_add_u32 m0, s30, 24832
s_nop 0
buffer_load_dwordx4 v5, s[4:7], s35 offen lds
s_waitcnt lgkmcnt(12)
v_mfma_f32_32x32x16_bf16 v[48:63], v[36:39], v[244:247], v[48:63]
ds_read_b64_tr_b16 v[28:29], v3 offset:8448
ds_read_b64_tr_b16 v[30:31], v3 offset:8576
s_waitcnt lgkmcnt(12)
v_mfma_f32_32x32x16_bf16 v[48:63], v[40:43], v[248:251], v[48:63]
ds_read_b64_tr_b16 v[32:33], v3 offset:10496
ds_read_b64_tr_b16 v[34:35], v3 offset:10624
s_mov_b32 s35, s76
s_add_u32 m0, s30, 28928
s_nop 0
buffer_load_dwordx4 v5, s[4:7], s35 offen lds
s_waitcnt lgkmcnt(12)
v_mfma_f32_32x32x16_bf16 v[48:63], v[44:47], v[252:255], v[48:63]
ds_read_b64_tr_b16 v[36:37], v2 offset:25344
ds_read_b64_tr_b16 v[38:39], v2 offset:25472
s_waitcnt lgkmcnt(12)
v_mfma_f32_32x32x16_bf16 v[64:79], v[12:15], v[208:211], v[64:79]
ds_read_b64_tr_b16 v[40:41], v2 offset:27392
ds_read_b64_tr_b16 v[42:43], v2 offset:27520
s_waitcnt lgkmcnt(12)
v_mfma_f32_32x32x16_bf16 v[64:79], v[16:19], v[212:215], v[64:79]
ds_read_b64_tr_b16 v[44:45], v2 offset:29440
ds_read_b64_tr_b16 v[46:47], v2 offset:29568
s_waitcnt lgkmcnt(12)
v_mfma_f32_32x32x16_bf16 v[64:79], v[20:23], v[216:219], v[64:79]
ds_read_b64_tr_b16 v[12:13], v2 offset:31488
ds_read_b64_tr_b16 v[14:15], v2 offset:31616
v_mul_f32 v0, v48, v48
v_mul_f32 v7, v49, v49
v_fma_f32 v0, v0, s40, v10
v_fma_f32 v7, v7, s40, v10
s_waitcnt lgkmcnt(12)
v_mfma_f32_32x32x16_bf16 v[64:79], v[24:27], v[220:223], v[64:79]
ds_read_b64_tr_b16 v[16:17], v2 offset:33536
ds_read_b64_tr_b16 v[18:19], v2 offset:33664
v_mul_f32 v0, v0, v48
v_mul_f32 v7, v7, v49
v_exp_f32 v0, v0
v_exp_f32 v7, v7
s_waitcnt lgkmcnt(12)
v_mfma_f32_32x32x16_bf16 v[64:79], v[28:31], v[224:227], v[64:79]
ds_read_b64_tr_b16 v[20:21], v2 offset:35584
ds_read_b64_tr_b16 v[22:23], v2 offset:35712
v_mul_f32 v56, v48, v56
v_mul_f32 v57, v49, v57
v_add_f32 v0, 1.0, v0
v_add_f32 v7, 1.0, v7
s_waitcnt lgkmcnt(12)
v_mfma_f32_32x32x16_bf16 v[64:79], v[32:35], v[228:231], v[64:79]
ds_read_b64_tr_b16 v[24:25], v2 offset:768
ds_read_b64_tr_b16 v[26:27], v2 offset:896
v_rcp_f32 v0, v0
v_rcp_f32 v7, v7
v_mul_f32 v8, v50, v50
v_mul_f32 v9, v51, v51
s_waitcnt lgkmcnt(12)
v_mfma_f32_32x32x16_bf16 v[80:95], v[36:39], v[184:187], v[80:95]
ds_read_b64_tr_b16 v[28:29], v2 offset:2816
ds_read_b64_tr_b16 v[30:31], v2 offset:2944
v_mul_f32 v56, v56, v0
v_mul_f32 v57, v57, v7
v_cvt_pk_bf16_f32 v48, v56, v57
v_fma_f32 v8, v8, s40, v10
s_waitcnt lgkmcnt(12)
v_mfma_f32_32x32x16_bf16 v[80:95], v[40:43], v[188:191], v[80:95]
ds_read_b64_tr_b16 v[32:33], v2 offset:4864
ds_read_b64_tr_b16 v[34:35], v2 offset:4992
v_fma_f32 v9, v9, s40, v10
v_mul_f32 v8, v8, v50
v_mul_f32 v9, v9, v51
v_exp_f32 v8, v8
s_waitcnt lgkmcnt(12)
v_mfma_f32_32x32x16_bf16 v[80:95], v[44:47], v[192:195], v[80:95]
ds_read_b64_tr_b16 v[36:37], v2 offset:6912
ds_read_b64_tr_b16 v[38:39], v2 offset:7040
v_exp_f32 v9, v9
v_mul_f32 v58, v50, v58
v_mul_f32 v59, v51, v59
v_add_f32 v8, 1.0, v8
s_waitcnt lgkmcnt(12)
v_mfma_f32_32x32x16_bf16 v[80:95], v[12:15], v[196:199], v[80:95]
ds_read_b64_tr_b16 v[40:41], v2 offset:8960
ds_read_b64_tr_b16 v[42:43], v2 offset:9088
v_add_f32 v9, 1.0, v9
v_rcp_f32 v8, v8
v_rcp_f32 v9, v9
v_mul_f32 v0, v52, v52
s_waitcnt lgkmcnt(12)
v_mfma_f32_32x32x16_bf16 v[80:95], v[16:19], v[200:203], v[80:95]
ds_read_b64_tr_b16 v[44:45], v2 offset:11008
ds_read_b64_tr_b16 v[46:47], v2 offset:11136
v_mul_f32 v7, v53, v53
v_mul_f32 v58, v58, v8
v_mul_f32 v59, v59, v9
v_cvt_pk_bf16_f32 v49, v58, v59
s_waitcnt lgkmcnt(12)
v_mfma_f32_32x32x16_bf16 v[80:95], v[20:23], v[204:207], v[80:95]
s_waitcnt vmcnt(2)
s_barrier
ds_read_b64_tr_b16 v[12:13], v3 offset:25088
ds_read_b64_tr_b16 v[14:15], v3 offset:25216
v_fma_f32 v0, v0, s40, v10
v_fma_f32 v7, v7, s40, v10
v_mul_f32 v0, v0, v52
v_mul_f32 v7, v7, v53
s_waitcnt lgkmcnt(12)
v_mfma_f32_32x32x16_bf16 v[96:111], v[24:27], v[160:163], v[96:111]
ds_read_b64_tr_b16 v[16:17], v3 offset:27136
ds_read_b64_tr_b16 v[18:19], v3 offset:27264
v_exp_f32 v0, v0
v_exp_f32 v7, v7
v_mul_f32 v60, v52, v60
v_mul_f32 v61, v53, v61
s_waitcnt lgkmcnt(12)
v_mfma_f32_32x32x16_bf16 v[96:111], v[28:31], v[164:167], v[96:111]
ds_read_b64_tr_b16 v[20:21], v3 offset:29184
ds_read_b64_tr_b16 v[22:23], v3 offset:29312
v_add_f32 v0, 1.0, v0
v_add_f32 v7, 1.0, v7
v_rcp_f32 v0, v0
v_rcp_f32 v7, v7
s_waitcnt lgkmcnt(12)
v_mfma_f32_32x32x16_bf16 v[96:111], v[32:35], v[168:171], v[96:111]
ds_read_b64_tr_b16 v[24:25], v3 offset:31232
ds_read_b64_tr_b16 v[26:27], v3 offset:31360
v_mul_f32 v8, v54, v54
v_mul_f32 v9, v55, v55
v_mul_f32 v60, v60, v0
v_mul_f32 v61, v61, v7
s_waitcnt lgkmcnt(12)
v_mfma_f32_32x32x16_bf16 v[96:111], v[36:39], v[172:175], v[96:111]
ds_read_b64_tr_b16 v[28:29], v3 offset:33280
ds_read_b64_tr_b16 v[30:31], v3 offset:33408
v_cvt_pk_bf16_f32 v50, v60, v61
v_fma_f32 v8, v8, s40, v10
v_fma_f32 v9, v9, s40, v10
v_mul_f32 v8, v8, v54
s_waitcnt lgkmcnt(12)
v_mfma_f32_32x32x16_bf16 v[96:111], v[40:43], v[176:179], v[96:111]
ds_read_b64_tr_b16 v[32:33], v3 offset:35328
ds_read_b64_tr_b16 v[34:35], v3 offset:35456
v_mul_f32 v9, v9, v55
v_exp_f32 v8, v8
v_exp_f32 v9, v9
v_mul_f32 v62, v54, v62
s_waitcnt lgkmcnt(12)
v_mfma_f32_32x32x16_bf16 v[96:111], v[44:47], v[180:183], v[96:111]
ds_read_b64_tr_b16 v[36:37], v3 offset:512
ds_read_b64_tr_b16 v[38:39], v3 offset:640
v_mul_f32 v63, v55, v63
v_add_f32 v8, 1.0, v8
v_add_f32 v9, 1.0, v9
v_rcp_f32 v8, v8
s_waitcnt lgkmcnt(12)
v_mfma_f32_32x32x16_bf16 v[64:79], v[12:15], v[232:235], v[64:79]
ds_read_b64_tr_b16 v[40:41], v3 offset:2560
ds_read_b64_tr_b16 v[42:43], v3 offset:2688
v_rcp_f32 v9, v9
v_mul_f32 v62, v62, v8
v_mul_f32 v63, v63, v9
v_cvt_pk_bf16_f32 v51, v62, v63
s_waitcnt lgkmcnt(12)
v_mfma_f32_32x32x16_bf16 v[64:79], v[16:19], v[236:239], v[64:79]
ds_read_b64_tr_b16 v[44:45], v3 offset:4608
ds_read_b64_tr_b16 v[46:47], v3 offset:4736
s_add_u32 s38, s34, 4096
buffer_store_dwordx4 v[48:51], v6, s[12:15], s38 offen sc1
s_waitcnt lgkmcnt(12)
v_mfma_f32_32x32x16_bf16 v[64:79], v[20:23], v[240:243], v[64:79]
ds_read_b64_tr_b16 v[12:13], v3 offset:6656
ds_read_b64_tr_b16 v[14:15], v3 offset:6784
s_waitcnt lgkmcnt(12)
v_mfma_f32_32x32x16_bf16 v[64:79], v[24:27], v[244:247], v[64:79]
ds_read_b64_tr_b16 v[16:17], v3 offset:8704
ds_read_b64_tr_b16 v[18:19], v3 offset:8832
s_waitcnt lgkmcnt(12)
v_mfma_f32_32x32x16_bf16 v[64:79], v[28:31], v[248:251], v[64:79]
ds_read_b64_tr_b16 v[20:21], v3 offset:10752
ds_read_b64_tr_b16 v[22:23], v3 offset:10880
s_waitcnt lgkmcnt(12)
v_mfma_f32_32x32x16_bf16 v[64:79], v[32:35], v[252:255], v[64:79]
ds_read_b64_tr_b16 v[24:25], v2 offset:25600
ds_read_b64_tr_b16 v[26:27], v2 offset:25728
s_waitcnt lgkmcnt(12)
v_mfma_f32_32x32x16_bf16 v[80:95], v[36:39], v[208:211], v[80:95]
ds_read_b64_tr_b16 v[28:29], v2 offset:27648
ds_read_b64_tr_b16 v[30:31], v2 offset:27776
s_waitcnt lgkmcnt(12)
v_mfma_f32_32x32x16_bf16 v[80:95], v[40:43], v[212:215], v[80:95]
ds_read_b64_tr_b16 v[32:33], v2 offset:29696
ds_read_b64_tr_b16 v[34:35], v2 offset:29824
s_waitcnt lgkmcnt(12)
v_mfma_f32_32x32x16_bf16 v[80:95], v[44:47], v[216:219], v[80:95]
ds_read_b64_tr_b16 v[36:37], v2 offset:31744
ds_read_b64_tr_b16 v[38:39], v2 offset:31872
v_mul_f32 v0, v64, v64
v_mul_f32 v7, v65, v65
v_fma_f32 v0, v0, s40, v10
v_fma_f32 v7, v7, s40, v10
s_waitcnt lgkmcnt(12)
v_mfma_f32_32x32x16_bf16 v[80:95], v[12:15], v[220:223], v[80:95]
ds_read_b64_tr_b16 v[40:41], v2 offset:33792
ds_read_b64_tr_b16 v[42:43], v2 offset:33920
v_mul_f32 v0, v0, v64
v_mul_f32 v7, v7, v65
v_exp_f32 v0, v0
v_exp_f32 v7, v7
s_waitcnt lgkmcnt(12)
v_mfma_f32_32x32x16_bf16 v[80:95], v[16:19], v[224:227], v[80:95]
ds_read_b64_tr_b16 v[44:45], v2 offset:35840
ds_read_b64_tr_b16 v[46:47], v2 offset:35968
v_mul_f32 v72, v64, v72
v_mul_f32 v73, v65, v73
v_add_f32 v0, 1.0, v0
v_add_f32 v7, 1.0, v7
s_waitcnt lgkmcnt(12)
v_mfma_f32_32x32x16_bf16 v[80:95], v[20:23], v[228:231], v[80:95]
ds_read_b64_tr_b16 v[12:13], v1 offset:0
ds_read_b64_tr_b16 v[14:15], v1 offset:128
v_rcp_f32 v0, v0
v_rcp_f32 v7, v7
v_mul_f32 v8, v66, v66
v_mul_f32 v9, v67, v67
s_waitcnt lgkmcnt(12)
v_mfma_f32_32x32x16_bf16 v[96:111], v[24:27], v[184:187], v[96:111]
ds_read_b64_tr_b16 v[16:17], v1 offset:256
ds_read_b64_tr_b16 v[18:19], v1 offset:384
v_mul_f32 v72, v72, v0
v_mul_f32 v73, v73, v7
v_cvt_pk_bf16_f32 v64, v72, v73
v_fma_f32 v8, v8, s40, v10
s_waitcnt lgkmcnt(12)
v_mfma_f32_32x32x16_bf16 v[96:111], v[28:31], v[188:191], v[96:111]
ds_read_b64_tr_b16 v[20:21], v1 offset:512
ds_read_b64_tr_b16 v[22:23], v1 offset:640
v_fma_f32 v9, v9, s40, v10
v_mul_f32 v8, v8, v66
v_mul_f32 v9, v9, v67
v_exp_f32 v8, v8
s_waitcnt lgkmcnt(12)
v_mfma_f32_32x32x16_bf16 v[96:111], v[32:35], v[192:195], v[96:111]
ds_read_b64_tr_b16 v[24:25], v1 offset:768
ds_read_b64_tr_b16 v[26:27], v1 offset:896
v_exp_f32 v9, v9
v_mul_f32 v74, v66, v74
v_mul_f32 v75, v67, v75
v_add_f32 v8, 1.0, v8
s_waitcnt lgkmcnt(12)
v_mfma_f32_32x32x16_bf16 v[96:111], v[36:39], v[196:199], v[96:111]
ds_read_b64_tr_b16 v[28:29], v1 offset:2048
ds_read_b64_tr_b16 v[30:31], v1 offset:2176
v_add_f32 v9, 1.0, v9
v_rcp_f32 v8, v8
v_rcp_f32 v9, v9
v_mul_f32 v0, v68, v68
s_waitcnt lgkmcnt(12)
v_mfma_f32_32x32x16_bf16 v[96:111], v[40:43], v[200:203], v[96:111]
ds_read_b64_tr_b16 v[32:33], v1 offset:2304
ds_read_b64_tr_b16 v[34:35], v1 offset:2432
v_mul_f32 v7, v69, v69
v_mul_f32 v74, v74, v8
v_mul_f32 v75, v75, v9
v_cvt_pk_bf16_f32 v65, v74, v75
s_waitcnt lgkmcnt(12)
v_mfma_f32_32x32x16_bf16 v[96:111], v[44:47], v[204:207], v[96:111]
s_barrier
ds_read_b64_tr_b16 v[36:37], v3 offset:25344
ds_read_b64_tr_b16 v[38:39], v3 offset:25472
v_fma_f32 v0, v0, s40, v10
v_fma_f32 v7, v7, s40, v10
v_mul_f32 v0, v0, v68
v_mul_f32 v7, v7, v69
s_waitcnt lgkmcnt(12)
v_mfma_f32_32x32x16_bf16 v[48:63], v[12:15], v[112:115], 0
ds_read_b64_tr_b16 v[40:41], v3 offset:27392
ds_read_b64_tr_b16 v[42:43], v3 offset:27520
v_exp_f32 v0, v0
v_exp_f32 v7, v7
v_mul_f32 v76, v68, v76
v_mul_f32 v77, v69, v77
s_waitcnt lgkmcnt(12)
v_mfma_f32_32x32x16_bf16 v[48:63], v[16:19], v[116:119], v[48:63]
ds_read_b64_tr_b16 v[44:45], v3 offset:29440
ds_read_b64_tr_b16 v[46:47], v3 offset:29568
v_add_f32 v0, 1.0, v0
v_add_f32 v7, 1.0, v7
v_rcp_f32 v0, v0
v_rcp_f32 v7, v7
s_waitcnt lgkmcnt(12)
v_mfma_f32_32x32x16_bf16 v[48:63], v[20:23], v[120:123], v[48:63]
ds_read_b64_tr_b16 v[12:13], v3 offset:31488
ds_read_b64_tr_b16 v[14:15], v3 offset:31616
v_mul_f32 v8, v70, v70
v_mul_f32 v9, v71, v71
v_mul_f32 v76, v76, v0
v_mul_f32 v77, v77, v7
s_waitcnt lgkmcnt(12)
v_mfma_f32_32x32x16_bf16 v[48:63], v[24:27], v[124:127], v[48:63]
ds_read_b64_tr_b16 v[16:17], v3 offset:33536
ds_read_b64_tr_b16 v[18:19], v3 offset:33664
v_cvt_pk_bf16_f32 v66, v76, v77
v_fma_f32 v8, v8, s40, v10
v_fma_f32 v9, v9, s40, v10
v_mul_f32 v8, v8, v70
s_waitcnt lgkmcnt(12)
v_mfma_f32_32x32x16_bf16 v[48:63], v[28:31], v[128:131], v[48:63]
ds_read_b64_tr_b16 v[20:21], v3 offset:35584
ds_read_b64_tr_b16 v[22:23], v3 offset:35712
v_mul_f32 v9, v9, v71
v_exp_f32 v8, v8
v_exp_f32 v9, v9
v_mul_f32 v78, v70, v78
s_waitcnt lgkmcnt(12)
v_mfma_f32_32x32x16_bf16 v[48:63], v[32:35], v[132:135], v[48:63]
ds_read_b64_tr_b16 v[24:25], v3 offset:768
ds_read_b64_tr_b16 v[26:27], v3 offset:896
v_mul_f32 v79, v71, v79
v_add_f32 v8, 1.0, v8
v_add_f32 v9, 1.0, v9
v_rcp_f32 v8, v8
s_waitcnt lgkmcnt(12)
v_mfma_f32_32x32x16_bf16 v[80:95], v[36:39], v[232:235], v[80:95]
ds_read_b64_tr_b16 v[28:29], v3 offset:2816
ds_read_b64_tr_b16 v[30:31], v3 offset:2944
v_rcp_f32 v9, v9
v_mul_f32 v78, v78, v8
v_mul_f32 v79, v79, v9
v_cvt_pk_bf16_f32 v67, v78, v79
s_waitcnt lgkmcnt(12)
v_mfma_f32_32x32x16_bf16 v[80:95], v[40:43], v[236:239], v[80:95]
ds_read_b64_tr_b16 v[32:33], v3 offset:4864
ds_read_b64_tr_b16 v[34:35], v3 offset:4992
s_add_u32 s38, s34, 5120
buffer_store_dwordx4 v[64:67], v6, s[12:15], s38 offen sc1
s_waitcnt lgkmcnt(12)
v_mfma_f32_32x32x16_bf16 v[80:95], v[44:47], v[240:243], v[80:95]
ds_read_b64_tr_b16 v[36:37], v3 offset:6912
ds_read_b64_tr_b16 v[38:39], v3 offset:7040
s_and_b32 s43, s2, 3
s_lshl_b32 s43, s43, 5
s_lshr_b32 s44, s2, 3
s_add_u32 s43, s43, s44
s_lshl_b32 s43, s43, 3
s_add_u32 s43, s43, s22
s_mul_i32 s43, s43, 5184
v_lshrrev_b32 v11, 4, v6
v_min_u32 v11, 40, v11
v_lshlrev_b32 v11, 7, v11
buffer_load_dword v11, v11, s[48:51], s43 offen
s_waitcnt lgkmcnt(12)
v_mfma_f32_32x32x16_bf16 v[80:95], v[12:15], v[244:247], v[80:95]
ds_read_b64_tr_b16 v[40:41], v3 offset:8960
ds_read_b64_tr_b16 v[42:43], v3 offset:9088
s_waitcnt lgkmcnt(12)
v_mfma_f32_32x32x16_bf16 v[80:95], v[16:19], v[248:251], v[80:95]
ds_read_b64_tr_b16 v[44:45], v3 offset:11008
ds_read_b64_tr_b16 v[46:47], v3 offset:11136
s_waitcnt lgkmcnt(12)
v_mfma_f32_32x32x16_bf16 v[80:95], v[20:23], v[252:255], v[80:95]
ds_read_b64_tr_b16 v[12:13], v1 offset:2560
ds_read_b64_tr_b16 v[14:15], v1 offset:2688
s_waitcnt lgkmcnt(12)
v_mfma_f32_32x32x16_bf16 v[96:111], v[24:27], v[208:211], v[96:111]
ds_read_b64_tr_b16 v[16:17], v1 offset:2816
ds_read_b64_tr_b16 v[18:19], v1 offset:2944
s_waitcnt lgkmcnt(12)
v_mfma_f32_32x32x16_bf16 v[96:111], v[28:31], v[212:215], v[96:111]
ds_read_b64_tr_b16 v[20:21], v1 offset:4096
ds_read_b64_tr_b16 v[22:23], v1 offset:4224
s_waitcnt lgkmcnt(12)
v_mfma_f32_32x32x16_bf16 v[96:111], v[32:35], v[216:219], v[96:111]
ds_read_b64_tr_b16 v[24:25], v1 offset:4352
ds_read_b64_tr_b16 v[26:27], v1 offset:4480
v_mul_f32 v0, v80, v80
v_mul_f32 v7, v81, v81
v_fma_f32 v0, v0, s40, v10
v_fma_f32 v7, v7, s40, v10
s_waitcnt lgkmcnt(12)
v_mfma_f32_32x32x16_bf16 v[96:111], v[36:39], v[220:223], v[96:111]
ds_read_b64_tr_b16 v[28:29], v1 offset:4608
ds_read_b64_tr_b16 v[30:31], v1 offset:4736
v_mul_f32 v0, v0, v80
v_mul_f32 v7, v7, v81
v_exp_f32 v0, v0
v_exp_f32 v7, v7
s_waitcnt lgkmcnt(12)
v_mfma_f32_32x32x16_bf16 v[96:111], v[40:43], v[224:227], v[96:111]
ds_read_b64_tr_b16 v[32:33], v1 offset:4864
ds_read_b64_tr_b16 v[34:35], v1 offset:4992
v_mul_f32 v88, v80, v88
v_mul_f32 v89, v81, v89
v_add_f32 v0, 1.0, v0
v_add_f32 v7, 1.0, v7
s_waitcnt lgkmcnt(12)
v_mfma_f32_32x32x16_bf16 v[96:111], v[44:47], v[228:231], v[96:111]
ds_read_b64_tr_b16 v[36:37], v1 offset:6144
ds_read_b64_tr_b16 v[38:39], v1 offset:6272
v_rcp_f32 v0, v0
v_rcp_f32 v7, v7
v_mul_f32 v8, v82, v82
v_mul_f32 v9, v83, v83
s_waitcnt lgkmcnt(12)
v_mfma_f32_32x32x16_bf16 v[48:63], v[12:15], v[136:139], v[48:63]
ds_read_b64_tr_b16 v[40:41], v1 offset:6400
ds_read_b64_tr_b16 v[42:43], v1 offset:6528
v_mul_f32 v88, v88, v0
v_mul_f32 v89, v89, v7
v_cvt_pk_bf16_f32 v80, v88, v89
v_fma_f32 v8, v8, s40, v10
s_waitcnt lgkmcnt(12)
v_mfma_f32_32x32x16_bf16 v[48:63], v[16:19], v[140:143], v[48:63]
ds_read_b64_tr_b16 v[44:45], v1 offset:6656
ds_read_b64_tr_b16 v[46:47], v1 offset:6784
v_fma_f32 v9, v9, s40, v10
v_mul_f32 v8, v8, v82
v_mul_f32 v9, v9, v83
v_exp_f32 v8, v8
s_waitcnt lgkmcnt(12)
v_mfma_f32_32x32x16_bf16 v[48:63], v[20:23], v[144:147], v[48:63]
ds_read_b64_tr_b16 v[12:13], v1 offset:6912
ds_read_b64_tr_b16 v[14:15], v1 offset:7040
v_exp_f32 v9, v9
v_mul_f32 v90, v82, v90
v_mul_f32 v91, v83, v91
v_add_f32 v8, 1.0, v8
s_waitcnt lgkmcnt(12)
v_mfma_f32_32x32x16_bf16 v[48:63], v[24:27], v[148:151], v[48:63]
ds_read_b64_tr_b16 v[16:17], v1 offset:8192
ds_read_b64_tr_b16 v[18:19], v1 offset:8320
v_add_f32 v9, 1.0, v9
v_rcp_f32 v8, v8
v_rcp_f32 v9, v9
v_mul_f32 v0, v84, v84
s_waitcnt lgkmcnt(12)
v_mfma_f32_32x32x16_bf16 v[48:63], v[28:31], v[152:155], v[48:63]
ds_read_b64_tr_b16 v[20:21], v1 offset:8448
ds_read_b64_tr_b16 v[22:23], v1 offset:8576
v_mul_f32 v7, v85, v85
v_mul_f32 v90, v90, v8
v_mul_f32 v91, v91, v9
v_cvt_pk_bf16_f32 v81, v90, v91
s_waitcnt lgkmcnt(12)
v_mfma_f32_32x32x16_bf16 v[48:63], v[32:35], v[156:159], v[48:63]
s_waitcnt vmcnt(3)
s_barrier
ds_read_b64_tr_b16 v[24:25], v3 offset:25600
ds_read_b64_tr_b16 v[26:27], v3 offset:25728
v_fma_f32 v0, v0, s40, v10
v_fma_f32 v7, v7, s40, v10
v_mul_f32 v0, v0, v84
v_mul_f32 v7, v7, v85
s_waitcnt lgkmcnt(12)
v_mfma_f32_32x32x16_bf16 v[48:63], v[36:39], v[160:163], v[48:63]
ds_read_b64_tr_b16 v[28:29], v3 offset:27648
ds_read_b64_tr_b16 v[30:31], v3 offset:27776
v_exp_f32 v0, v0
v_exp_f32 v7, v7
v_mul_f32 v92, v84, v92
v_mul_f32 v93, v85, v93
s_waitcnt lgkmcnt(12)
v_mfma_f32_32x32x16_bf16 v[48:63], v[40:43], v[164:167], v[48:63]
ds_read_b64_tr_b16 v[32:33], v3 offset:29696
ds_read_b64_tr_b16 v[34:35], v3 offset:29824
v_add_f32 v0, 1.0, v0
v_add_f32 v7, 1.0, v7
v_rcp_f32 v0, v0
v_rcp_f32 v7, v7
s_waitcnt lgkmcnt(12)
v_mfma_f32_32x32x16_bf16 v[48:63], v[44:47], v[168:171], v[48:63]
ds_read_b64_tr_b16 v[36:37], v3 offset:31744
ds_read_b64_tr_b16 v[38:39], v3 offset:31872
v_mul_f32 v8, v86, v86
v_mul_f32 v9, v87, v87
v_mul_f32 v92, v92, v0
v_mul_f32 v93, v93, v7
s_waitcnt lgkmcnt(12)
v_mfma_f32_32x32x16_bf16 v[48:63], v[12:15], v[172:175], v[48:63]
ds_read_b64_tr_b16 v[40:41], v3 offset:33792
ds_read_b64_tr_b16 v[42:43], v3 offset:33920
v_cvt_pk_bf16_f32 v82, v92, v93
v_fma_f32 v8, v8, s40, v10
v_fma_f32 v9, v9, s40, v10
v_mul_f32 v8, v8, v86
s_waitcnt lgkmcnt(12)
v_mfma_f32_32x32x16_bf16 v[48:63], v[16:19], v[176:179], v[48:63]
ds_read_b64_tr_b16 v[44:45], v3 offset:35840
ds_read_b64_tr_b16 v[46:47], v3 offset:35968
v_mul_f32 v9, v9, v87
v_exp_f32 v8, v8
v_exp_f32 v9, v9
v_mul_f32 v94, v86, v94
s_waitcnt lgkmcnt(12)
v_mfma_f32_32x32x16_bf16 v[48:63], v[20:23], v[180:183], v[48:63]
ds_read_b64_tr_b16 v[12:13], v1 offset:8704
ds_read_b64_tr_b16 v[14:15], v1 offset:8832
v_mul_f32 v95, v87, v95
v_add_f32 v8, 1.0, v8
v_add_f32 v9, 1.0, v9
v_rcp_f32 v8, v8
s_waitcnt lgkmcnt(12)
v_mfma_f32_32x32x16_bf16 v[96:111], v[24:27], v[232:235], v[96:111]
ds_read_b64_tr_b16 v[16:17], v1 offset:8960
ds_read_b64_tr_b16 v[18:19], v1 offset:9088
v_rcp_f32 v9, v9
v_mul_f32 v94, v94, v8
v_mul_f32 v95, v95, v9
v_cvt_pk_bf16_f32 v83, v94, v95
s_waitcnt lgkmcnt(12)
v_mfma_f32_32x32x16_bf16 v[96:111], v[28:31], v[236:239], v[96:111]
ds_read_b64_tr_b16 v[20:21], v1 offset:10240
ds_read_b64_tr_b16 v[22:23], v1 offset:10368
s_add_u32 s38, s34, 6144
buffer_store_dwordx4 v[80:83], v6, s[12:15], s38 offen sc1
s_waitcnt lgkmcnt(12)
v_mfma_f32_32x32x16_bf16 v[96:111], v[32:35], v[240:243], v[96:111]
ds_read_b64_tr_b16 v[24:25], v1 offset:10496
ds_read_b64_tr_b16 v[26:27], v1 offset:10624
s_waitcnt lgkmcnt(12)
v_mfma_f32_32x32x16_bf16 v[96:111], v[36:39], v[244:247], v[96:111]
ds_read_b64_tr_b16 v[28:29], v1 offset:10752
ds_read_b64_tr_b16 v[30:31], v1 offset:10880
s_waitcnt lgkmcnt(12)
v_mfma_f32_32x32x16_bf16 v[96:111], v[40:43], v[248:251], v[96:111]
ds_read_b64_tr_b16 v[32:33], v1 offset:11008
ds_read_b64_tr_b16 v[34:35], v1 offset:11136
s_waitcnt lgkmcnt(12)
v_mfma_f32_32x32x16_bf16 v[96:111], v[44:47], v[252:255], v[96:111]
ds_read_b64_tr_b16 v[36:37], v1 offset:26880
ds_read_b64_tr_b16 v[38:39], v1 offset:27008
s_waitcnt lgkmcnt(12)
v_mfma_f32_32x32x16_bf16 v[48:63], v[12:15], v[184:187], v[48:63]
ds_read_b64_tr_b16 v[40:41], v1 offset:27136
ds_read_b64_tr_b16 v[42:43], v1 offset:27264
s_waitcnt lgkmcnt(12)
v_mfma_f32_32x32x16_bf16 v[48:63], v[16:19], v[188:191], v[48:63]
ds_read_b64_tr_b16 v[44:45], v1 offset:27392
ds_read_b64_tr_b16 v[46:47], v1 offset:27520
s_waitcnt lgkmcnt(12)
v_mfma_f32_32x32x16_bf16 v[48:63], v[20:23], v[192:195], v[48:63]
ds_read_b64_tr_b16 v[12:13], v1 offset:27648
ds_read_b64_tr_b16 v[14:15], v1 offset:27776
v_mul_f32 v0, v96, v96
v_mul_f32 v7, v97, v97
v_fma_f32 v0, v0, s40, v10
v_fma_f32 v7, v7, s40, v10
s_waitcnt lgkmcnt(12)
v_mfma_f32_32x32x16_bf16 v[48:63], v[24:27], v[196:199], v[48:63]
ds_read_b64_tr_b16 v[16:17], v1 offset:28928
ds_read_b64_tr_b16 v[18:19], v1 offset:29056
v_mul_f32 v0, v0, v96
v_mul_f32 v7, v7, v97
v_exp_f32 v0, v0
v_exp_f32 v7, v7
s_waitcnt lgkmcnt(12)
v_mfma_f32_32x32x16_bf16 v[48:63], v[28:31], v[200:203], v[48:63]
ds_read_b64_tr_b16 v[20:21], v1 offset:29184
ds_read_b64_tr_b16 v[22:23], v1 offset:29312
v_mul_f32 v104, v96, v104
v_mul_f32 v105, v97, v105
v_add_f32 v0, 1.0, v0
v_add_f32 v7, 1.0, v7
s_waitcnt lgkmcnt(12)
v_mfma_f32_32x32x16_bf16 v[48:63], v[32:35], v[204:207], v[48:63]
ds_read_b64_tr_b16 v[24:25], v1 offset:29440
ds_read_b64_tr_b16 v[26:27], v1 offset:29568
v_rcp_f32 v0, v0
v_rcp_f32 v7, v7
v_mul_f32 v8, v98, v98
v_mul_f32 v9, v99, v99
s_waitcnt lgkmcnt(12)
v_mfma_f32_32x32x16_bf16 v[48:63], v[36:39], v[208:211], v[48:63]
ds_read_b64_tr_b16 v[28:29], v1 offset:29696
ds_read_b64_tr_b16 v[30:31], v1 offset:29824
v_mul_f32 v104, v104, v0
v_mul_f32 v105, v105, v7
v_cvt_pk_bf16_f32 v96, v104, v105
v_fma_f32 v8, v8, s40, v10
s_waitcnt lgkmcnt(12)
v_mfma_f32_32x32x16_bf16 v[48:63], v[40:43], v[212:215], v[48:63]
ds_read_b64_tr_b16 v[32:33], v1 offset:30976
ds_read_b64_tr_b16 v[34:35], v1 offset:31104
v_fma_f32 v9, v9, s40, v10
v_mul_f32 v8, v8, v98
v_mul_f32 v9, v9, v99
v_exp_f32 v8, v8
s_waitcnt lgkmcnt(12)
v_mfma_f32_32x32x16_bf16 v[48:63], v[44:47], v[216:219], v[48:63]
ds_read_b64_tr_b16 v[36:37], v1 offset:31232
ds_read_b64_tr_b16 v[38:39], v1 offset:31360
v_exp_f32 v9, v9
v_mul_f32 v106, v98, v106
v_mul_f32 v107, v99, v107
v_add_f32 v8, 1.0, v8
s_waitcnt lgkmcnt(12)
v_mfma_f32_32x32x16_bf16 v[48:63], v[12:15], v[220:223], v[48:63]
ds_read_b64_tr_b16 v[40:41], v1 offset:31488
ds_read_b64_tr_b16 v[42:43], v1 offset:31616
v_add_f32 v9, 1.0, v9
v_rcp_f32 v8, v8
v_rcp_f32 v9, v9
v_mul_f32 v0, v100, v100
s_waitcnt lgkmcnt(12)
v_mfma_f32_32x32x16_bf16 v[48:63], v[16:19], v[224:227], v[48:63]
ds_read_b64_tr_b16 v[44:45], v1 offset:31744
ds_read_b64_tr_b16 v[46:47], v1 offset:31872
v_mul_f32 v7, v101, v101
v_mul_f32 v106, v106, v8
v_mul_f32 v107, v107, v9
v_cvt_pk_bf16_f32 v97, v106, v107
s_waitcnt lgkmcnt(12)
v_mfma_f32_32x32x16_bf16 v[48:63], v[20:23], v[228:231], v[48:63]
v_fma_f32 v0, v0, s40, v10
v_fma_f32 v7, v7, s40, v10
v_mul_f32 v0, v0, v100
v_mul_f32 v7, v7, v101
s_waitcnt lgkmcnt(10)
v_mfma_f32_32x32x16_bf16 v[48:63], v[24:27], v[232:235], v[48:63]
v_exp_f32 v0, v0
v_exp_f32 v7, v7
v_mul_f32 v108, v100, v108
v_mul_f32 v109, v101, v109
s_waitcnt lgkmcnt(8)
v_mfma_f32_32x32x16_bf16 v[48:63], v[28:31], v[236:239], v[48:63]
v_add_f32 v0, 1.0, v0
v_add_f32 v7, 1.0, v7
v_rcp_f32 v0, v0
v_rcp_f32 v7, v7
s_waitcnt lgkmcnt(6)
v_mfma_f32_32x32x16_bf16 v[48:63], v[32:35], v[240:243], v[48:63]
v_mul_f32 v8, v102, v102
v_mul_f32 v9, v103, v103
v_mul_f32 v108, v108, v0
v_mul_f32 v109, v109, v7
s_waitcnt lgkmcnt(4)
v_mfma_f32_32x32x16_bf16 v[48:63], v[36:39], v[244:247], v[48:63]
v_cvt_pk_bf16_f32 v98, v108, v109
v_fma_f32 v8, v8, s40, v10
v_fma_f32 v9, v9, s40, v10
v_mul_f32 v8, v8, v102
s_waitcnt lgkmcnt(2)
v_mfma_f32_32x32x16_bf16 v[48:63], v[40:43], v[248:251], v[48:63]
v_mul_f32 v9, v9, v103
v_exp_f32 v8, v8
v_exp_f32 v9, v9
v_mul_f32 v110, v102, v110
s_waitcnt lgkmcnt(0)
v_mfma_f32_32x32x16_bf16 v[48:63], v[44:47], v[252:255], v[48:63]
v_mul_f32 v111, v103, v111
v_add_f32 v8, 1.0, v8
v_add_f32 v9, 1.0, v9
v_rcp_f32 v8, v8
v_rcp_f32 v9, v9
v_mul_f32 v110, v110, v8
v_mul_f32 v111, v111, v9
v_cvt_pk_bf16_f32 v99, v110, v111
s_add_u32 s38, s34, 7168
buffer_store_dwordx4 v[96:99], v6, s[12:15], s38 offen sc1
s_nop 1
v_mul_f32 v0, v48, v48
v_mul_f32 v7, v49, v49
v_fma_f32 v0, v0, s40, v10
v_fma_f32 v7, v7, s40, v10
v_mul_f32 v0, v0, v48
v_mul_f32 v7, v7, v49
v_exp_f32 v0, v0
v_exp_f32 v7, v7
v_mul_f32 v56, v48, v56
v_mul_f32 v57, v49, v57
v_add_f32 v0, 1.0, v0
v_add_f32 v7, 1.0, v7
v_rcp_f32 v0, v0
v_rcp_f32 v7, v7
v_mul_f32 v8, v50, v50
v_mul_f32 v9, v51, v51
v_mul_f32 v56, v56, v0
v_mul_f32 v57, v57, v7
v_cvt_pk_bf16_f32 v48, v56, v57
v_fma_f32 v8, v8, s40, v10
v_fma_f32 v9, v9, s40, v10
v_mul_f32 v8, v8, v50
v_mul_f32 v9, v9, v51
v_exp_f32 v8, v8
v_exp_f32 v9, v9
v_mul_f32 v58, v50, v58
v_mul_f32 v59, v51, v59
v_add_f32 v8, 1.0, v8
v_add_f32 v9, 1.0, v9
v_rcp_f32 v8, v8
v_rcp_f32 v9, v9
v_mul_f32 v0, v52, v52
v_mul_f32 v7, v53, v53
v_mul_f32 v58, v58, v8
v_mul_f32 v59, v59, v9
v_cvt_pk_bf16_f32 v49, v58, v59
v_fma_f32 v0, v0, s40, v10
v_fma_f32 v7, v7, s40, v10
v_mul_f32 v0, v0, v52
v_mul_f32 v7, v7, v53
v_exp_f32 v0, v0
v_exp_f32 v7, v7
v_mul_f32 v60, v52, v60
v_mul_f32 v61, v53, v61
v_add_f32 v0, 1.0, v0
v_add_f32 v7, 1.0, v7
v_rcp_f32 v0, v0
v_rcp_f32 v7, v7
v_mul_f32 v8, v54, v54
v_mul_f32 v9, v55, v55
v_mul_f32 v60, v60, v0
v_mul_f32 v61, v61, v7
v_cvt_pk_bf16_f32 v50, v60, v61
v_fma_f32 v8, v8, s40, v10
v_fma_f32 v9, v9, s40, v10
v_mul_f32 v8, v8, v54
v_mul_f32 v9, v9, v55
v_exp_f32 v8, v8
v_exp_f32 v9, v9
v_mul_f32 v62, v54, v62
v_mul_f32 v63, v55, v63
v_add_f32 v8, 1.0, v8
v_add_f32 v9, 1.0, v9
v_rcp_f32 v8, v8
v_rcp_f32 v9, v9
v_mul_f32 v62, v62, v8
v_mul_f32 v63, v63, v9
v_cvt_pk_bf16_f32 v51, v62, v63
buffer_store_dwordx4 v[48:51], v6, s[12:15], s37 offen sc1
s_waitcnt vmcnt(0)
L_k3_kernel_end:
s_endpgm
.globl k4_kernel
.p2align 8
.type k4_kernel,@function
k4_kernel:
s_cmp_ge_u32 s2, 256
s_cbranch_scc1 L_k4_kernel_end
s_load_dwordx2 s[4:5], s[0:1], 64
s_mov_b32 s6, 0x510000
s_mov_b32 s7, 0x00020000
s_load_dwordx2 s[12:13], s[0:1], 104
s_mov_b32 s14, 0x10000000
s_mov_b32 s15, 0x00020000
s_and_b32 s16, s2, 3
s_bfe_u32 s17, s2, 0x10002
s_lshr_b32 s18, s2, 3
s_and_b32 s19, s18, 3
s_lshr_b32 s18, s18, 2
s_lshl_b32 s17, s17, 3
s_add_u32 s17, s17, s18
v_lshrrev_b32 v1, 6, v0
v_and_b32 v2, 63, v0
v_readfirstlane_b32 s20, v1
s_lshl_b32 s21, s17, 2
s_nop 0
s_cmp_lt_u32 s20, 4
s_cbranch_scc1 L_k4_kernel_cons
s_and_b32 s20, s20, 3
s_add_u32 s21, s21, s20
s_lshl_b32 s30, s20, 10
s_lshl_b32 s29, s20, 12
s_mul_i32 s31, s16, 1327104
s_mul_i32 s22, s19, 288
s_add_u32 s31, s31, s22
s_mul_i32 s32, s21, 294912
s_mul_i32 s22, s16, 73728
s_add_u32 s32, s32, s22
s_add_u32 s32, s32, 41943040
s_add_u32 s37, s31, 1327104
s_add_u32 s38, s32, 73728
s_mul_i32 s34, s19, 294912
s_add_u32 s34, s34, s31
s_mul_i32 s35, s19, 16384
s_add_u32 s35, s35, s32
v_and_b32 v3, 255, v0
v_lshlrev_b32 v19, 4, v2
v_add_u32 v4, 0, v3
v_min_u32 v4, 1151, v4
v_mul_u32_u24 v5, 3641, v4
v_lshrrev_b32 v5, 16, v5
v_mul_u32_u24 v6, 18, v5
v_sub_u32 v6, v4, v6
v_and_b32 v7, 0x73, v5
v_and_b32 v8, 4, v5
v_lshl_or_b32 v7, v8, 1, v7
v_and_b32 v8, 8, v5
v_lshrrev_b32 v8, 1, v8
v_or_b32 v7, v7, v8
v_mul_u32_u24 v7, 1152, v7
v_lshl_add_u32 v10, v6, 4, v7
v_add_u32 v4, 256, v3
v_min_u32 v4, 1151, v4
v_mul_u32_u24 v5, 3641, v4
v_lshrrev_b32 v5, 16, v5
v_mul_u32_u24 v6, 18, v5
v_sub_u32 v6, v4, v6
v_and_b32 v7, 0x73, v5
v_and_b32 v8, 4, v5
v_lshl_or_b32 v7, v8, 1, v7
v_and_b32 v8, 8, v5
v_lshrrev_b32 v8, 1, v8
v_or_b32 v7, v7, v8
v_mul_u32_u24 v7, 1152, v7
v_lshl_add_u32 v11, v6, 4, v7
v_add_u32 v4, 512, v3
v_min_u32 v4, 1151, v4
v_mul_u32_u24 v5, 3641, v4
v_lshrrev_b32 v5, 16, v5
v_mul_u32_u24 v6, 18, v5
v_sub_u32 v6, v4, v6
v_and_b32 v7, 0x73, v5
v_and_b32 v8, 4, v5
v_lshl_or_b32 v7, v8, 1, v7
v_and_b32 v8, 8, v5
v_lshrrev_b32 v8, 1, v8
v_or_b32 v7, v7, v8
v_mul_u32_u24 v7, 1152, v7
v_lshl_add_u32 v12, v6, 4, v7
v_add_u32 v4, 768, v3
v_min_u32 v4, 1151, v4
v_mul_u32_u24 v5, 3641, v4
v_lshrrev_b32 v5, 16, v5
v_mul_u32_u24 v6, 18, v5
v_sub_u32 v6, v4, v6
v_and_b32 v7, 0x73, v5
v_and_b32 v8, 4, v5
v_lshl_or_b32 v7, v8, 1, v7
v_and_b32 v8, 8, v5
v_lshrrev_b32 v8, 1, v8
v_or_b32 v7, v7, v8
v_mul_u32_u24 v7, 1152, v7
v_lshl_add_u32 v13, v6, 4, v7
v_add_u32 v4, 1024, v3
v_min_u32 v4, 1151, v4
v_mul_u32_u24 v5, 3641, v4
v_lshrrev_b32 v5, 16, v5
v_mul_u32_u24 v6, 18, v5
v_sub_u32 v6, v4, v6
v_and_b32 v7, 0x73, v5
v_and_b32 v8, 4, v5
v_lshl_or_b32 v7, v8, 1, v7
v_and_b32 v8, 8, v5
v_lshrrev_b32 v8, 1, v8
v_or_b32 v7, v7, v8
v_mul_u32_u24 v7, 1152, v7
v_lshl_add_u32 v14, v6, 4, v7
s_waitcnt lgkmcnt(0)
s_add_u32 m0, s30, 0
s_nop 0
buffer_load_dwordx4 v10, s[4:7], s34 offen lds
s_add_u32 m0, s30, 4096
s_nop 0
buffer_load_dwordx4 v11, s[4:7], s34 offen lds
s_add_u32 m0, s30, 8192
s_nop 0
buffer_load_dwordx4 v12, s[4:7], s34 offen lds
s_add_u32 m0, s30, 12288
s_nop 0
buffer_load_dwordx4 v13, s[4:7], s34 offen lds
s_add_u32 m0, s30, 16384
s_nop 0
buffer_load_dwordx4 v14, s[4:7], s34 offen lds
s_add_u32 m0, s29, 20480
s_nop 0
buffer_load_dwordx4 v19, s[12:15], s35 offen offset:0 lds
buffer_load_dwordx4 v19, s[12:15], s35 offen offset:1024 lds
buffer_load_dwordx4 v19, s[12:15], s35 offen offset:2048 lds
buffer_load_dwordx4 v19, s[12:15], s35 offen offset:3072 lds
s_add_u32 s34, s34, 73728
s_cmp_eq_u32 s34, s37
s_cselect_b32 s34, s31, s34
s_add_u32 s35, s35, 4096
s_cmp_eq_u32 s35, s38
s_cselect_b32 s35, s32, s35
s_add_u32 m0, s30, 36864
s_nop 0
buffer_load_dwordx4 v10, s[4:7], s34 offen lds
s_add_u32 m0, s30, 40960
s_nop 0
buffer_load_dwordx4 v11, s[4:7], s34 offen lds
s_add_u32 m0, s30, 45056
s_nop 0
buffer_load_dwordx4 v12, s[4:7], s34 offen lds
s_add_u32 m0, s30, 49152
s_nop 0
buffer_load_dwordx4 v13, s[4:7], s34 offen lds
s_add_u32 m0, s30, 53248
s_nop 0
buffer_load_dwordx4 v14, s[4:7], s34 offen lds
s_add_u32 m0, s29, 57344
s_nop 0
buffer_load_dwordx4 v19, s[12:15], s35 offen offset:0 lds
buffer_load_dwordx4 v19, s[12:15], s35 offen offset:1024 lds
buffer_load_dwordx4 v19, s[12:15], s35 offen offset:2048 lds
buffer_load_dwordx4 v19, s[12:15], s35 offen offset:3072 lds
s_waitcnt vmcnt(9)
s_barrier
s_add_u32 s34, s34, 73728
s_cmp_eq_u32 s34, s37
s_cselect_b32 s34, s31, s34
s_add_u32 s35, s35, 4096
s_cmp_eq_u32 s35, s38
s_cselect_b32 s35, s32, s35
s_add_u32 m0, s30, 73728
s_nop 0
buffer_load_dwordx4 v10, s[4:7], s34 offen lds
s_add_u32 m0, s30, 77824
s_nop 0
buffer_load_dwordx4 v11, s[4:7], s34 offen lds
s_add_u32 m0, s30, 81920
s_nop 0
buffer_load_dwordx4 v12, s[4:7], s34 offen lds
s_add_u32 m0, s30, 86016
s_nop 0
buffer_load_dwordx4 v13, s[4:7], s34 offen lds
s_add_u32 m0, s30, 90112
s_nop 0
buffer_load_dwordx4 v14, s[4:7], s34 offen lds
s_add_u32 m0, s29, 94208
s_nop 0
buffer_load_dwordx4 v19, s[12:15], s35 offen offset:0 lds
buffer_load_dwordx4 v19, s[12:15], s35 offen offset:1024 lds
buffer_load_dwordx4 v19, s[12:15], s35 offen offset:2048 lds
buffer_load_dwordx4 v19, s[12:15], s35 offen offset:3072 lds
s_add_u32 s34, s34, 73728
s_cmp_eq_u32 s34, s37
s_cselect_b32 s34, s31, s34
s_add_u32 s35, s35, 4096
s_cmp_eq_u32 s35, s38
s_cselect_b32 s35, s32, s35
s_add_u32 m0, s30, 110592
s_nop 0
buffer_load_dwordx4 v10, s[4:7], s34 offen lds
s_add_u32 m0, s30, 114688
s_nop 0
buffer_load_dwordx4 v11, s[4:7], s34 offen lds
s_add_u32 m0, s30, 118784
s_nop 0
buffer_load_dwordx4 v12, s[4:7], s34 offen lds
s_add_u32 m0, s30, 122880
s_nop 0
buffer_load_dwordx4 v13, s[4:7], s34 offen lds
s_add_u32 m0, s30, 126976
s_nop 0
buffer_load_dwordx4 v14, s[4:7], s34 offen lds
s_add_u32 m0, s29, 131072
s_nop 0
buffer_load_dwordx4 v19, s[12:15], s35 offen offset:0 lds
buffer_load_dwordx4 v19, s[12:15], s35 offen offset:1024 lds
buffer_load_dwordx4 v19, s[12:15], s35 offen offset:2048 lds
buffer_load_dwordx4 v19, s[12:15], s35 offen offset:3072 lds
s_waitcnt vmcnt(18)
s_barrier
s_add_u32 s34, s34, 73728
s_cmp_eq_u32 s34, s37
s_cselect_b32 s34, s31, s34
s_add_u32 s35, s35, 4096
s_cmp_eq_u32 s35, s38
s_cselect_b32 s35, s32, s35
s_add_u32 m0, s30, 0
s_nop 0
buffer_load_dwordx4 v10, s[4:7], s34 offen lds
s_add_u32 m0, s30, 4096
s_nop 0
buffer_load_dwordx4 v11, s[4:7], s34 offen lds
s_add_u32 m0, s30, 8192
s_nop 0
buffer_load_dwordx4 v12, s[4:7], s34 offen lds
s_add_u32 m0, s30, 12288
s_nop 0
buffer_load_dwordx4 v13, s[4:7], s34 offen lds
s_add_u32 m0, s30, 16384
s_nop 0
buffer_load_dwordx4 v14, s[4:7], s34 offen lds
s_add_u32 m0, s29, 20480
s_nop 0
buffer_load_dwordx4 v19, s[12:15], s35 offen offset:0 lds
buffer_load_dwordx4 v19, s[12:15], s35 offen offset:1024 lds
buffer_load_dwordx4 v19, s[12:15], s35 offen offset:2048 lds
buffer_load_dwordx4 v19, s[12:15], s35 offen offset:3072 lds
s_waitcnt vmcnt(18)
s_barrier
s_add_u32 s34, s34, 73728
s_cmp_eq_u32 s34, s37
s_cselect_b32 s34, s31, s34
s_add_u32 s35, s35, 4096
s_cmp_eq_u32 s35, s38
s_cselect_b32 s35, s32, s35
s_add_u32 m0, s30, 36864
s_nop 0
buffer_load_dwordx4 v10, s[4:7], s34 offen lds
s_add_u32 m0, s30, 40960
s_nop 0
buffer_load_dwordx4 v11, s[4:7], s34 offen lds
s_add_u32 m0, s30, 45056
s_nop 0
buffer_load_dwordx4 v12, s[4:7], s34 offen lds
s_add_u32 m0, s30, 49152
s_nop 0
buffer_load_dwordx4 v13, s[4:7], s34 offen lds
s_add_u32 m0, s30, 53248
s_nop 0
buffer_load_dwordx4 v14, s[4:7], s34 offen lds
s_add_u32 m0, s29, 57344
s_nop 0
buffer_load_dwordx4 v19, s[12:15], s35 offen offset:0 lds
buffer_load_dwordx4 v19, s[12:15], s35 offen offset:1024 lds
buffer_load_dwordx4 v19, s[12:15], s35 offen offset:2048 lds
buffer_load_dwordx4 v19, s[12:15], s35 offen offset:3072 lds
s_waitcnt vmcnt(18)
s_barrier
s_add_u32 s34, s34, 73728
s_cmp_eq_u32 s34, s37
s_cselect_b32 s34, s31, s34
s_add_u32 s35, s35, 4096
s_cmp_eq_u32 s35, s38
s_cselect_b32 s35, s32, s35
s_add_u32 m0, s30, 73728
s_nop 0
buffer_load_dwordx4 v10, s[4:7], s34 offen lds
s_add_u32 m0, s30, 77824
s_nop 0
buffer_load_dwordx4 v11, s[4:7], s34 offen lds
s_add_u32 m0, s30, 81920
s_nop 0
buffer_load_dwordx4 v12, s[4:7], s34 offen lds
s_add_u32 m0, s30, 86016
s_nop 0
buffer_load_dwordx4 v13, s[4:7], s34 offen lds
s_add_u32 m0, s30, 90112
s_nop 0
buffer_load_dwordx4 v14, s[4:7], s34 offen lds
s_add_u32 m0, s29, 94208
s_nop 0
buffer_load_dwordx4 v19, s[12:15], s35 offen offset:0 lds
buffer_load_dwordx4 v19, s[12:15], s35 offen offset:1024 lds
buffer_load_dwordx4 v19, s[12:15], s35 offen offset:2048 lds
buffer_load_dwordx4 v19, s[12:15], s35 offen offset:3072 lds
s_waitcnt vmcnt(18)
s_barrier
s_add_u32 s34, s34, 73728
s_cmp_eq_u32 s34, s37
s_cselect_b32 s34, s31, s34
s_add_u32 s35, s35, 4096
s_cmp_eq_u32 s35, s38
s_cselect_b32 s35, s32, s35
s_add_u32 m0, s30, 110592
s_nop 0
buffer_load_dwordx4 v10, s[4:7], s34 offen lds
s_add_u32 m0, s30, 114688
s_nop 0
buffer_load_dwordx4 v11, s[4:7], s34 offen lds
s_add_u32 m0, s30, 118784
s_nop 0
buffer_load_dwordx4 v12, s[4:7], s34 offen lds
s_add_u32 m0, s30, 122880
s_nop 0
buffer_load_dwordx4 v13, s[4:7], s34 offen lds
s_add_u32 m0, s30, 126976
s_nop 0
buffer_load_dwordx4 v14, s[4:7], s34 offen lds
s_add_u32 m0, s29, 131072
s_nop 0
buffer_load_dwordx4 v19, s[12:15], s35 offen offset:0 lds
buffer_load_dwordx4 v19, s[12:15], s35 offen offset:1024 lds
buffer_load_dwordx4 v19, s[12:15], s35 offen offset:2048 lds
buffer_load_dwordx4 v19, s[12:15], s35 offen offset:3072 lds
s_waitcnt vmcnt(18)
s_barrier
s_add_u32 s34, s34, 73728
s_cmp_eq_u32 s34, s37
s_cselect_b32 s34, s31, s34
s_add_u32 s35, s35, 4096
s_cmp_eq_u32 s35, s38
s_cselect_b32 s35, s32, s35
s_add_u32 m0, s30, 0
s_nop 0
buffer_load_dwordx4 v10, s[4:7], s34 offen lds
s_add_u32 m0, s30, 4096
s_nop 0
buffer_load_dwordx4 v11, s[4:7], s34 offen lds
s_add_u32 m0, s30, 8192
s_nop 0
buffer_load_dwordx4 v12, s[4:7], s34 offen lds
s_add_u32 m0, s30, 12288
s_nop 0
buffer_load_dwordx4 v13, s[4:7], s34 offen lds
s_add_u32 m0, s30, 16384
s_nop 0
buffer_load_dwordx4 v14, s[4:7], s34 offen lds
s_add_u32 m0, s29, 20480
s_nop 0
buffer_load_dwordx4 v19, s[12:15], s35 offen offset:0 lds
buffer_load_dwordx4 v19, s[12:15], s35 offen offset:1024 lds
buffer_load_dwordx4 v19, s[12:15], s35 offen offset:2048 lds
buffer_load_dwordx4 v19, s[12:15], s35 offen offset:3072 lds
s_waitcnt vmcnt(18)
s_barrier
s_add_u32 s34, s34, 73728
s_cmp_eq_u32 s34, s37
s_cselect_b32 s34, s31, s34
s_add_u32 s35, s35, 4096
s_cmp_eq_u32 s35, s38
s_cselect_b32 s35, s32, s35
s_add_u32 m0, s30, 36864
s_nop 0
buffer_load_dwordx4 v10, s[4:7], s34 offen lds
s_add_u32 m0, s30, 40960
s_nop 0
buffer_load_dwordx4 v11, s[4:7], s34 offen lds
s_add_u32 m0, s30, 45056
s_nop 0
buffer_load_dwordx4 v12, s[4:7], s34 offen lds
s_add_u32 m0, s30, 49152
s_nop 0
buffer_load_dwordx4 v13, s[4:7], s34 offen lds
s_add_u32 m0, s30, 53248
s_nop 0
buffer_load_dwordx4 v14, s[4:7], s34 offen lds
s_add_u32 m0, s29, 57344
s_nop 0
buffer_load_dwordx4 v19, s[12:15], s35 offen offset:0 lds
buffer_load_dwordx4 v19, s[12:15], s35 offen offset:1024 lds
buffer_load_dwordx4 v19, s[12:15], s35 offen offset:2048 lds
buffer_load_dwordx4 v19, s[12:15], s35 offen offset:3072 lds
s_waitcnt vmcnt(18)
s_barrier
s_add_u32 s34, s34, 73728
s_cmp_eq_u32 s34, s37
s_cselect_b32 s34, s31, s34
s_add_u32 s35, s35, 4096
s_cmp_eq_u32 s35, s38
s_cselect_b32 s35, s32, s35
s_add_u32 m0, s30, 73728
s_nop 0
buffer_load_dwordx4 v10, s[4:7], s34 offen lds
s_add_u32 m0, s30, 77824
s_nop 0
buffer_load_dwordx4 v11, s[4:7], s34 offen lds
s_add_u32 m0, s30, 81920
s_nop 0
buffer_load_dwordx4 v12, s[4:7], s34 offen lds
s_add_u32 m0, s30, 86016
s_nop 0
buffer_load_dwordx4 v13, s[4:7], s34 offen lds
s_add_u32 m0, s30, 90112
s_nop 0
buffer_load_dwordx4 v14, s[4:7], s34 offen lds
s_add_u32 m0, s29, 94208
s_nop 0
buffer_load_dwordx4 v19, s[12:15], s35 offen offset:0 lds
buffer_load_dwordx4 v19, s[12:15], s35 offen offset:1024 lds
buffer_load_dwordx4 v19, s[12:15], s35 offen offset:2048 lds
buffer_load_dwordx4 v19, s[12:15], s35 offen offset:3072 lds
s_waitcnt vmcnt(18)
s_barrier
s_add_u32 s34, s34, 73728
s_cmp_eq_u32 s34, s37
s_cselect_b32 s34, s31, s34
s_add_u32 s35, s35, 4096
s_cmp_eq_u32 s35, s38
s_cselect_b32 s35, s32, s35
s_add_u32 m0, s30, 110592
s_nop 0
buffer_load_dwordx4 v10, s[4:7], s34 offen lds
s_add_u32 m0, s30, 114688
s_nop 0
buffer_load_dwordx4 v11, s[4:7], s34 offen lds
s_add_u32 m0, s30, 118784
s_nop 0
buffer_load_dwordx4 v12, s[4:7], s34 offen lds
s_add_u32 m0, s30, 122880
s_nop 0
buffer_load_dwordx4 v13, s[4:7], s34 offen lds
s_add_u32 m0, s30, 126976
s_nop 0
buffer_load_dwordx4 v14, s[4:7], s34 offen lds
s_add_u32 m0, s29, 131072
s_nop 0
buffer_load_dwordx4 v19, s[12:15], s35 offen offset:0 lds
buffer_load_dwordx4 v19, s[12:15], s35 offen offset:1024 lds
buffer_load_dwordx4 v19, s[12:15], s35 offen offset:2048 lds
buffer_load_dwordx4 v19, s[12:15], s35 offen offset:3072 lds
s_waitcnt vmcnt(18)
s_barrier
s_add_u32 s34, s34, 73728
s_cmp_eq_u32 s34, s37
s_cselect_b32 s34, s31, s34
s_add_u32 s35, s35, 4096
s_cmp_eq_u32 s35, s38
s_cselect_b32 s35, s32, s35
s_add_u32 m0, s30, 0
s_nop 0
buffer_load_dwordx4 v10, s[4:7], s34 offen lds
s_add_u32 m0, s30, 4096
s_nop 0
buffer_load_dwordx4 v11, s[4:7], s34 offen lds
s_add_u32 m0, s30, 8192
s_nop 0
buffer_load_dwordx4 v12, s[4:7], s34 offen lds
s_add_u32 m0, s30, 12288
s_nop 0
buffer_load_dwordx4 v13, s[4:7], s34 offen lds
s_add_u32 m0, s30, 16384
s_nop 0
buffer_load_dwordx4 v14, s[4:7], s34 offen lds
s_add_u32 m0, s29, 20480
s_nop 0
buffer_load_dwordx4 v19, s[12:15], s35 offen offset:0 lds
buffer_load_dwordx4 v19, s[12:15], s35 offen offset:1024 lds
buffer_load_dwordx4 v19, s[12:15], s35 offen offset:2048 lds
buffer_load_dwordx4 v19, s[12:15], s35 offen offset:3072 lds
s_waitcnt vmcnt(18)
s_barrier
s_add_u32 s34, s34, 73728
s_cmp_eq_u32 s34, s37
s_cselect_b32 s34, s31, s34
s_add_u32 s35, s35, 4096
s_cmp_eq_u32 s35, s38
s_cselect_b32 s35, s32, s35
s_add_u32 m0, s30, 36864
s_nop 0
buffer_load_dwordx4 v10, s[4:7], s34 offen lds
s_add_u32 m0, s30, 40960
s_nop 0
buffer_load_dwordx4 v11, s[4:7], s34 offen lds
s_add_u32 m0, s30, 45056
s_nop 0
buffer_load_dwordx4 v12, s[4:7], s34 offen lds
s_add_u32 m0, s30, 49152
s_nop 0
buffer_load_dwordx4 v13, s[4:7], s34 offen lds
s_add_u32 m0, s30, 53248
s_nop 0
buffer_load_dwordx4 v14, s[4:7], s34 offen lds
s_add_u32 m0, s29, 57344
s_nop 0
buffer_load_dwordx4 v19, s[12:15], s35 offen offset:0 lds
buffer_load_dwordx4 v19, s[12:15], s35 offen offset:1024 lds
buffer_load_dwordx4 v19, s[12:15], s35 offen offset:2048 lds
buffer_load_dwordx4 v19, s[12:15], s35 offen offset:3072 lds
s_waitcnt vmcnt(18)
s_barrier
s_add_u32 s34, s34, 73728
s_cmp_eq_u32 s34, s37
s_cselect_b32 s34, s31, s34
s_add_u32 s35, s35, 4096
s_cmp_eq_u32 s35, s38
s_cselect_b32 s35, s32, s35
s_add_u32 m0, s30, 73728
s_nop 0
buffer_load_dwordx4 v10, s[4:7], s34 offen lds
s_add_u32 m0, s30, 77824
s_nop 0
buffer_load_dwordx4 v11, s[4:7], s34 offen lds
s_add_u32 m0, s30, 81920
s_nop 0
buffer_load_dwordx4 v12, s[4:7], s34 offen lds
s_add_u32 m0, s30, 86016
s_nop 0
buffer_load_dwordx4 v13, s[4:7], s34 offen lds
s_add_u32 m0, s30, 90112
s_nop 0
buffer_load_dwordx4 v14, s[4:7], s34 offen lds
s_add_u32 m0, s29, 94208
s_nop 0
buffer_load_dwordx4 v19, s[12:15], s35 offen offset:0 lds
buffer_load_dwordx4 v19, s[12:15], s35 offen offset:1024 lds
buffer_load_dwordx4 v19, s[12:15], s35 offen offset:2048 lds
buffer_load_dwordx4 v19, s[12:15], s35 offen offset:3072 lds
s_waitcnt vmcnt(18)
s_barrier
s_add_u32 s34, s34, 73728
s_cmp_eq_u32 s34, s37
s_cselect_b32 s34, s31, s34
s_add_u32 s35, s35, 4096
s_cmp_eq_u32 s35, s38
s_cselect_b32 s35, s32, s35
s_add_u32 m0, s30, 110592
s_nop 0
buffer_load_dwordx4 v10, s[4:7], s34 offen lds
s_add_u32 m0, s30, 114688
s_nop 0
buffer_load_dwordx4 v11, s[4:7], s34 offen lds
s_add_u32 m0, s30, 118784
s_nop 0
buffer_load_dwordx4 v12, s[4:7], s34 offen lds
s_add_u32 m0, s30, 122880
s_nop 0
buffer_load_dwordx4 v13, s[4:7], s34 offen lds
s_add_u32 m0, s30, 126976
s_nop 0
buffer_load_dwordx4 v14, s[4:7], s34 offen lds
s_add_u32 m0, s29, 131072
s_nop 0
buffer_load_dwordx4 v19, s[12:15], s35 offen offset:0 lds
buffer_load_dwordx4 v19, s[12:15], s35 offen offset:1024 lds
buffer_load_dwordx4 v19, s[12:15], s35 offen offset:2048 lds
buffer_load_dwordx4 v19, s[12:15], s35 offen offset:3072 lds
s_waitcnt vmcnt(18)
s_barrier
s_add_u32 s34, s34, 73728
s_cmp_eq_u32 s34, s37
s_cselect_b32 s34, s31, s34
s_add_u32 s35, s35, 4096
s_cmp_eq_u32 s35, s38
s_cselect_b32 s35, s32, s35
s_add_u32 m0, s30, 0
s_nop 0
buffer_load_dwordx4 v10, s[4:7], s34 offen lds
s_add_u32 m0, s30, 4096
s_nop 0
buffer_load_dwordx4 v11, s[4:7], s34 offen lds
s_add_u32 m0, s30, 8192
s_nop 0
buffer_load_dwordx4 v12, s[4:7], s34 offen lds
s_add_u32 m0, s30, 12288
s_nop 0
buffer_load_dwordx4 v13, s[4:7], s34 offen lds
s_add_u32 m0, s30, 16384
s_nop 0
buffer_load_dwordx4 v14, s[4:7], s34 offen lds
s_add_u32 m0, s29, 20480
s_nop 0
buffer_load_dwordx4 v19, s[12:15], s35 offen offset:0 lds
buffer_load_dwordx4 v19, s[12:15], s35 offen offset:1024 lds
buffer_load_dwordx4 v19, s[12:15], s35 offen offset:2048 lds
buffer_load_dwordx4 v19, s[12:15], s35 offen offset:3072 lds
s_waitcnt vmcnt(18)
s_barrier
s_add_u32 s34, s34, 73728
s_cmp_eq_u32 s34, s37
s_cselect_b32 s34, s31, s34
s_add_u32 s35, s35, 4096
s_cmp_eq_u32 s35, s38
s_cselect_b32 s35, s32, s35
s_add_u32 m0, s30, 36864
s_nop 0
buffer_load_dwordx4 v10, s[4:7], s34 offen lds
s_add_u32 m0, s30, 40960
s_nop 0
buffer_load_dwordx4 v11, s[4:7], s34 offen lds
s_add_u32 m0, s30, 45056
s_nop 0
buffer_load_dwordx4 v12, s[4:7], s34 offen lds
s_add_u32 m0, s30, 49152
s_nop 0
buffer_load_dwordx4 v13, s[4:7], s34 offen lds
s_add_u32 m0, s30, 53248
s_nop 0
buffer_load_dwordx4 v14, s[4:7], s34 offen lds
s_add_u32 m0, s29, 57344
s_nop 0
buffer_load_dwordx4 v19, s[12:15], s35 offen offset:0 lds
buffer_load_dwordx4 v19, s[12:15], s35 offen offset:1024 lds
buffer_load_dwordx4 v19, s[12:15], s35 offen offset:2048 lds
buffer_load_dwordx4 v19, s[12:15], s35 offen offset:3072 lds
s_waitcnt vmcnt(18)
s_barrier
s_waitcnt vmcnt(9)
s_barrier
s_waitcnt vmcnt(0)
s_barrier
s_waitcnt vmcnt(0)
s_endpgm
L_k4_kernel_cons:
s_add_u32 s21, s21, s20
s_mul_i32 s33, s21, 36864
s_mul_i32 s22, s19, 9216
s_add_u32 s33, s33, s22
s_mul_i32 s22, s16, 2359296
s_add_u32 s33, s33, s22
s_add_u32 s33, s33, 8388608
v_lshrrev_b32 v4, 4, v2
v_and_b32 v5, 15, v2
v_lshlrev_b32 v5, 4, v5
v_lshl_add_u32 v19, v4, 9, v5
v_lshl_add_u32 v19, v1, 12, v19
v_add_u32 v25, 20480, v19
v_add_u32 v26, 94208, v19
v_lshrrev_b32 v6, 1, v4
v_lshl_add_u32 v24, v6, 9, v5
v_and_b32 v7, 1, v4
v_lshl_add_u32 v24, v7, 3, v24
v_bfe_u32 v8, v2, 2, 2
v_lshl_add_u32 v8, v7, 2, v8
v_lshl_add_u32 v8, v6, 4, v8
v_mul_u32_u24 v8, 288, v8
v_and_b32 v9, 3, v2
v_lshl_add_u32 v20, v9, 3, v8
v_add_u32 v21, 73728, v20
s_waitcnt lgkmcnt(0)
s_barrier
ds_read_b128 v[176:179], v25 offset:0
ds_read_b128 v[180:183], v25 offset:256
ds_read_b64_tr_b16 v[32:33], v20 offset:0
ds_read_b64_tr_b16 v[34:35], v20 offset:2304
ds_read_b64_tr_b16 v[36:37], v20 offset:32
ds_read_b64_tr_b16 v[38:39], v20 offset:2336
ds_read_b64_tr_b16 v[40:41], v20 offset:64
ds_read_b64_tr_b16 v[42:43], v20 offset:2368
ds_read_b64_tr_b16 v[44:45], v20 offset:96
ds_read_b64_tr_b16 v[46:47], v20 offset:2400
ds_read_b64_tr_b16 v[48:49], v20 offset:128
ds_read_b64_tr_b16 v[50:51], v20 offset:2432
ds_read_b64_tr_b16 v[52:53], v20 offset:160
ds_read_b64_tr_b16 v[54:55], v20 offset:2464
ds_read_b64_tr_b16 v[56:57], v20 offset:192
ds_read_b64_tr_b16 v[58:59], v20 offset:2496
ds_read_b64_tr_b16 v[60:61], v20 offset:224
ds_read_b64_tr_b16 v[62:63], v20 offset:2528
ds_read_b64_tr_b16 v[64:65], v20 offset:256
ds_read_b64_tr_b16 v[66:67], v20 offset:2560
s_waitcnt lgkmcnt(15)
v_mfma_f32_16x16x32_bf16 v[104:107], v[32:35], v[176:179], 0
ds_read_b128 v[184:187], v25 offset:2048
ds_read_b128 v[188:191], v25 offset:2304
v_mfma_f32_16x16x32_bf16 v[140:143], v[32:35], v[180:183], 0
ds_read_b64_tr_b16 v[68:69], v20 offset:9216
ds_read_b64_tr_b16 v[70:71], v20 offset:11520
s_waitcnt lgkmcnt(15)
v_mfma_f32_16x16x32_bf16 v[108:111], v[36:39], v[176:179], 0
ds_read_b64_tr_b16 v[72:73], v20 offset:9248
ds_read_b64_tr_b16 v[74:75], v20 offset:11552
v_mfma_f32_16x16x32_bf16 v[144:147], v[36:39], v[180:183], 0
ds_read_b64_tr_b16 v[76:77], v20 offset:9280
ds_read_b64_tr_b16 v[78:79], v20 offset:11584
v_mfma_f32_16x16x32_bf16 v[112:115], v[40:43], v[176:179], 0
ds_read_b64_tr_b16 v[80:81], v20 offset:9312
ds_read_b64_tr_b16 v[82:83], v20 offset:11616
v_mfma_f32_16x16x32_bf16 v[148:151], v[40:43], v[180:183], 0
ds_read_b64_tr_b16 v[84:85], v20 offset:9344
ds_read_b64_tr_b16 v[86:87], v20 offset:11648
s_waitcnt lgkmcnt(15)
v_mfma_f32_16x16x32_bf16 v[116:119], v[44:47], v[176:179], 0
ds_read_b64_tr_b16 v[88:89], v20 offset:9376
ds_read_b64_tr_b16 v[90:91], v20 offset:11680
v_mfma_f32_16x16x32_bf16 v[152:155], v[44:47], v[180:183], 0
ds_read_b64_tr_b16 v[92:93], v20 offset:9408
ds_read_b64_tr_b16 v[94:95], v20 offset:11712
v_mfma_f32_16x16x32_bf16 v[120:123], v[48:51], v[176:179], 0
ds_read_b64_tr_b16 v[96:97], v20 offset:9440
ds_read_b64_tr_b16 v[98:99], v20 offset:11744
v_mfma_f32_16x16x32_bf16 v[156:159], v[48:51], v[180:183], 0
ds_read_b64_tr_b16 v[100:101], v20 offset:9472
ds_read_b64_tr_b16 v[102:103], v20 offset:11776
v_mfma_f32_16x16x32_bf16 v[124:127], v[52:55], v[176:179], 0
v_mfma_f32_16x16x32_bf16 v[160:163], v[52:55], v[180:183], 0
v_mfma_f32_16x16x32_bf16 v[128:131], v[56:59], v[176:179], 0
v_mfma_f32_16x16x32_bf16 v[164:167], v[56:59], v[180:183], 0
s_waitcnt lgkmcnt(15)
v_mfma_f32_16x16x32_bf16 v[132:135], v[60:63], v[176:179], 0
v_mfma_f32_16x16x32_bf16 v[168:171], v[60:63], v[180:183], 0
v_mfma_f32_16x16x32_bf16 v[136:139], v[64:67], v[176:179], 0
v_mfma_f32_16x16x32_bf16 v[172:175], v[64:67], v[180:183], 0
s_barrier
v_mfma_f32_16x16x32_bf16 v[104:107], v[68:71], v[184:187], v[104:107]
ds_read_b128 v[176:179], v25 offset:36864
ds_read_b128 v[180:183], v25 offset:37120
v_mfma_f32_16x16x32_bf16 v[140:143], v[68:71], v[188:191], v[140:143]
ds_read_b64_tr_b16 v[32:33], v20 offset:36864
ds_read_b64_tr_b16 v[34:35], v20 offset:39168
s_waitcnt lgkmcnt(15)
v_mfma_f32_16x16x32_bf16 v[108:111], v[72:75], v[184:187], v[108:111]
ds_read_b64_tr_b16 v[36:37], v20 offset:36896
ds_read_b64_tr_b16 v[38:39], v20 offset:39200
v_mfma_f32_16x16x32_bf16 v[144:147], v[72:75], v[188:191], v[144:147]
ds_read_b64_tr_b16 v[40:41], v20 offset:36928
ds_read_b64_tr_b16 v[42:43], v20 offset:39232
v_mfma_f32_16x16x32_bf16 v[112:115], v[76:79], v[184:187], v[112:115]
ds_read_b64_tr_b16 v[44:45], v20 offset:36960
ds_read_b64_tr_b16 v[46:47], v20 offset:39264
v_mfma_f32_16x16x32_bf16 v[148:151], v[76:79], v[188:191], v[148:151]
ds_read_b64_tr_b16 v[48:49], v20 offset:36992
ds_read_b64_tr_b16 v[50:51], v20 offset:39296
s_waitcnt lgkmcnt(15)
v_mfma_f32_16x16x32_bf16 v[116:119], v[80:83], v[184:187], v[116:119]
ds_read_b64_tr_b16 v[52:53], v20 offset:37024
ds_read_b64_tr_b16 v[54:55], v20 offset:39328
v_mfma_f32_16x16x32_bf16 v[152:155], v[80:83], v[188:191], v[152:155]
ds_read_b64_tr_b16 v[56:57], v20 offset:37056
ds_read_b64_tr_b16 v[58:59], v20 offset:39360
v_mfma_f32_16x16x32_bf16 v[120:123], v[84:87], v[184:187], v[120:123]
ds_read_b64_tr_b16 v[60:61], v20 offset:37088
ds_read_b64_tr_b16 v[62:63], v20 offset:39392
v_mfma_f32_16x16x32_bf16 v[156:159], v[84:87], v[188:191], v[156:159]
ds_read_b64_tr_b16 v[64:65], v20 offset:37120
ds_read_b64_tr_b16 v[66:67], v20 offset:39424
v_mfma_f32_16x16x32_bf16 v[124:127], v[88:91], v[184:187], v[124:127]
v_mfma_f32_16x16x32_bf16 v[160:163], v[88:91], v[188:191], v[160:163]
v_mfma_f32_16x16x32_bf16 v[128:131], v[92:95], v[184:187], v[128:131]
v_mfma_f32_16x16x32_bf16 v[164:167], v[92:95], v[188:191], v[164:167]
s_waitcnt lgkmcnt(15)
v_mfma_f32_16x16x32_bf16 v[132:135], v[96:99], v[184:187], v[132:135]
v_mfma_f32_16x16x32_bf16 v[168:171], v[96:99], v[188:191], v[168:171]
v_mfma_f32_16x16x32_bf16 v[136:139], v[100:103], v[184:187], v[136:139]
v_mfma_f32_16x16x32_bf16 v[172:175], v[100:103], v[188:191], v[172:175]
v_mfma_f32_16x16x32_bf16 v[104:107], v[32:35], v[176:179], v[104:107]
ds_read_b128 v[184:187], v25 offset:38912
ds_read_b128 v[188:191], v25 offset:39168
v_mfma_f32_16x16x32_bf16 v[140:143], v[32:35], v[180:183], v[140:143]
ds_read_b64_tr_b16 v[68:69], v20 offset:46080
ds_read_b64_tr_b16 v[70:71], v20 offset:48384
s_waitcnt lgkmcnt(15)
v_mfma_f32_16x16x32_bf16 v[108:111], v[36:39], v[176:179], v[108:111]
ds_read_b64_tr_b16 v[72:73], v20 offset:46112
ds_read_b64_tr_b16 v[74:75], v20 offset:48416
v_mfma_f32_16x16x32_bf16 v[144:147], v[36:39], v[180:183], v[144:147]
ds_read_b64_tr_b16 v[76:77], v20 offset:46144
ds_read_b64_tr_b16 v[78:79], v20 offset:48448
v_mfma_f32_16x16x32_bf16 v[112:115], v[40:43], v[176:179], v[112:115]
ds_read_b64_tr_b16 v[80:81], v20 offset:46176
ds_read_b64_tr_b16 v[82:83], v20 offset:48480
v_mfma_f32_16x16x32_bf16 v[148:151], v[40:43], v[180:183], v[148:151]
ds_read_b64_tr_b16 v[84:85], v20 offset:46208
ds_read_b64_tr_b16 v[86:87], v20 offset:48512
s_waitcnt lgkmcnt(15)
v_mfma_f32_16x16x32_bf16 v[116:119], v[44:47], v[176:179], v[116:119]
ds_read_b64_tr_b16 v[88:89], v20 offset:46240
ds_read_b64_tr_b16 v[90:91], v20 offset:48544
v_mfma_f32_16x16x32_bf16 v[152:155], v[44:47], v[180:183], v[152:155]
ds_read_b64_tr_b16 v[92:93], v20 offset:46272
ds_read_b64_tr_b16 v[94:95], v20 offset:48576
v_mfma_f32_16x16x32_bf16 v[120:123], v[48:51], v[176:179], v[120:123]
ds_read_b64_tr_b16 v[96:97], v20 offset:46304
ds_read_b64_tr_b16 v[98:99], v20 offset:48608
v_mfma_f32_16x16x32_bf16 v[156:159], v[48:51], v[180:183], v[156:159]
ds_read_b64_tr_b16 v[100:101], v20 offset:46336
ds_read_b64_tr_b16 v[102:103], v20 offset:48640
v_mfma_f32_16x16x32_bf16 v[124:127], v[52:55], v[176:179], v[124:127]
v_mfma_f32_16x16x32_bf16 v[160:163], v[52:55], v[180:183], v[160:163]
v_mfma_f32_16x16x32_bf16 v[128:131], v[56:59], v[176:179], v[128:131]
v_mfma_f32_16x16x32_bf16 v[164:167], v[56:59], v[180:183], v[164:167]
s_waitcnt lgkmcnt(15)
v_mfma_f32_16x16x32_bf16 v[132:135], v[60:63], v[176:179], v[132:135]
v_mfma_f32_16x16x32_bf16 v[168:171], v[60:63], v[180:183], v[168:171]
v_mfma_f32_16x16x32_bf16 v[136:139], v[64:67], v[176:179], v[136:139]
v_mfma_f32_16x16x32_bf16 v[172:175], v[64:67], v[180:183], v[172:175]
s_barrier
v_mfma_f32_16x16x32_bf16 v[104:107], v[68:71], v[184:187], v[104:107]
ds_read_b128 v[176:179], v26 offset:0
ds_read_b128 v[180:183], v26 offset:256
v_mfma_f32_16x16x32_bf16 v[140:143], v[68:71], v[188:191], v[140:143]
ds_read_b64_tr_b16 v[32:33], v21 offset:0
ds_read_b64_tr_b16 v[34:35], v21 offset:2304
s_waitcnt lgkmcnt(15)
v_mfma_f32_16x16x32_bf16 v[108:111], v[72:75], v[184:187], v[108:111]
ds_read_b64_tr_b16 v[36:37], v21 offset:32
ds_read_b64_tr_b16 v[38:39], v21 offset:2336
v_mfma_f32_16x16x32_bf16 v[144:147], v[72:75], v[188:191], v[144:147]
ds_read_b64_tr_b16 v[40:41], v21 offset:64
ds_read_b64_tr_b16 v[42:43], v21 offset:2368
v_mfma_f32_16x16x32_bf16 v[112:115], v[76:79], v[184:187], v[112:115]
ds_read_b64_tr_b16 v[44:45], v21 offset:96
ds_read_b64_tr_b16 v[46:47], v21 offset:2400
v_mfma_f32_16x16x32_bf16 v[148:151], v[76:79], v[188:191], v[148:151]
ds_read_b64_tr_b16 v[48:49], v21 offset:128
ds_read_b64_tr_b16 v[50:51], v21 offset:2432
s_waitcnt lgkmcnt(15)
v_mfma_f32_16x16x32_bf16 v[116:119], v[80:83], v[184:187], v[116:119]
ds_read_b64_tr_b16 v[52:53], v21 offset:160
ds_read_b64_tr_b16 v[54:55], v21 offset:2464
v_mfma_f32_16x16x32_bf16 v[152:155], v[80:83], v[188:191], v[152:155]
ds_read_b64_tr_b16 v[56:57], v21 offset:192
ds_read_b64_tr_b16 v[58:59], v21 offset:2496
v_mfma_f32_16x16x32_bf16 v[120:123], v[84:87], v[184:187], v[120:123]
ds_read_b64_tr_b16 v[60:61], v21 offset:224
ds_read_b64_tr_b16 v[62:63], v21 offset:2528
v_mfma_f32_16x16x32_bf16 v[156:159], v[84:87], v[188:191], v[156:159]
ds_read_b64_tr_b16 v[64:65], v21 offset:256
ds_read_b64_tr_b16 v[66:67], v21 offset:2560
v_mfma_f32_16x16x32_bf16 v[124:127], v[88:91], v[184:187], v[124:127]
v_mfma_f32_16x16x32_bf16 v[160:163], v[88:91], v[188:191], v[160:163]
v_mfma_f32_16x16x32_bf16 v[128:131], v[92:95], v[184:187], v[128:131]
v_mfma_f32_16x16x32_bf16 v[164:167], v[92:95], v[188:191], v[164:167]
s_waitcnt lgkmcnt(15)
v_mfma_f32_16x16x32_bf16 v[132:135], v[96:99], v[184:187], v[132:135]
v_mfma_f32_16x16x32_bf16 v[168:171], v[96:99], v[188:191], v[168:171]
v_mfma_f32_16x16x32_bf16 v[136:139], v[100:103], v[184:187], v[136:139]
v_mfma_f32_16x16x32_bf16 v[172:175], v[100:103], v[188:191], v[172:175]
v_mfma_f32_16x16x32_bf16 v[104:107], v[32:35], v[176:179], v[104:107]
ds_read_b128 v[184:187], v26 offset:2048
ds_read_b128 v[188:191], v26 offset:2304
v_mfma_f32_16x16x32_bf16 v[140:143], v[32:35], v[180:183], v[140:143]
ds_read_b64_tr_b16 v[68:69], v21 offset:9216
ds_read_b64_tr_b16 v[70:71], v21 offset:11520
s_waitcnt lgkmcnt(15)
v_mfma_f32_16x16x32_bf16 v[108:111], v[36:39], v[176:179], v[108:111]
ds_read_b64_tr_b16 v[72:73], v21 offset:9248
ds_read_b64_tr_b16 v[74:75], v21 offset:11552
v_mfma_f32_16x16x32_bf16 v[144:147], v[36:39], v[180:183], v[144:147]
ds_read_b64_tr_b16 v[76:77], v21 offset:9280
ds_read_b64_tr_b16 v[78:79], v21 offset:11584
v_mfma_f32_16x16x32_bf16 v[112:115], v[40:43], v[176:179], v[112:115]
ds_read_b64_tr_b16 v[80:81], v21 offset:9312
ds_read_b64_tr_b16 v[82:83], v21 offset:11616
v_mfma_f32_16x16x32_bf16 v[148:151], v[40:43], v[180:183], v[148:151]
ds_read_b64_tr_b16 v[84:85], v21 offset:9344
ds_read_b64_tr_b16 v[86:87], v21 offset:11648
s_waitcnt lgkmcnt(15)
v_mfma_f32_16x16x32_bf16 v[116:119], v[44:47], v[176:179], v[116:119]
ds_read_b64_tr_b16 v[88:89], v21 offset:9376
ds_read_b64_tr_b16 v[90:91], v21 offset:11680
v_mfma_f32_16x16x32_bf16 v[152:155], v[44:47], v[180:183], v[152:155]
ds_read_b64_tr_b16 v[92:93], v21 offset:9408
ds_read_b64_tr_b16 v[94:95], v21 offset:11712
v_mfma_f32_16x16x32_bf16 v[120:123], v[48:51], v[176:179], v[120:123]
ds_read_b64_tr_b16 v[96:97], v21 offset:9440
ds_read_b64_tr_b16 v[98:99], v21 offset:11744
v_mfma_f32_16x16x32_bf16 v[156:159], v[48:51], v[180:183], v[156:159]
ds_read_b64_tr_b16 v[100:101], v21 offset:9472
ds_read_b64_tr_b16 v[102:103], v21 offset:11776
v_mfma_f32_16x16x32_bf16 v[124:127], v[52:55], v[176:179], v[124:127]
v_mfma_f32_16x16x32_bf16 v[160:163], v[52:55], v[180:183], v[160:163]
v_mfma_f32_16x16x32_bf16 v[128:131], v[56:59], v[176:179], v[128:131]
v_mfma_f32_16x16x32_bf16 v[164:167], v[56:59], v[180:183], v[164:167]
s_waitcnt lgkmcnt(15)
v_mfma_f32_16x16x32_bf16 v[132:135], v[60:63], v[176:179], v[132:135]
v_mfma_f32_16x16x32_bf16 v[168:171], v[60:63], v[180:183], v[168:171]
v_mfma_f32_16x16x32_bf16 v[136:139], v[64:67], v[176:179], v[136:139]
v_mfma_f32_16x16x32_bf16 v[172:175], v[64:67], v[180:183], v[172:175]
s_barrier
v_mfma_f32_16x16x32_bf16 v[104:107], v[68:71], v[184:187], v[104:107]
ds_read_b128 v[176:179], v26 offset:36864
ds_read_b128 v[180:183], v26 offset:37120
v_mfma_f32_16x16x32_bf16 v[140:143], v[68:71], v[188:191], v[140:143]
ds_read_b64_tr_b16 v[32:33], v21 offset:36864
ds_read_b64_tr_b16 v[34:35], v21 offset:39168
s_waitcnt lgkmcnt(15)
v_mfma_f32_16x16x32_bf16 v[108:111], v[72:75], v[184:187], v[108:111]
ds_read_b64_tr_b16 v[36:37], v21 offset:36896
ds_read_b64_tr_b16 v[38:39], v21 offset:39200
v_mfma_f32_16x16x32_bf16 v[144:147], v[72:75], v[188:191], v[144:147]
ds_read_b64_tr_b16 v[40:41], v21 offset:36928
ds_read_b64_tr_b16 v[42:43], v21 offset:39232
v_mfma_f32_16x16x32_bf16 v[112:115], v[76:79], v[184:187], v[112:115]
ds_read_b64_tr_b16 v[44:45], v21 offset:36960
ds_read_b64_tr_b16 v[46:47], v21 offset:39264
v_mfma_f32_16x16x32_bf16 v[148:151], v[76:79], v[188:191], v[148:151]
ds_read_b64_tr_b16 v[48:49], v21 offset:36992
ds_read_b64_tr_b16 v[50:51], v21 offset:39296
s_waitcnt lgkmcnt(15)
v_mfma_f32_16x16x32_bf16 v[116:119], v[80:83], v[184:187], v[116:119]
ds_read_b64_tr_b16 v[52:53], v21 offset:37024
ds_read_b64_tr_b16 v[54:55], v21 offset:39328
v_mfma_f32_16x16x32_bf16 v[152:155], v[80:83], v[188:191], v[152:155]
ds_read_b64_tr_b16 v[56:57], v21 offset:37056
ds_read_b64_tr_b16 v[58:59], v21 offset:39360
v_mfma_f32_16x16x32_bf16 v[120:123], v[84:87], v[184:187], v[120:123]
ds_read_b64_tr_b16 v[60:61], v21 offset:37088
ds_read_b64_tr_b16 v[62:63], v21 offset:39392
v_mfma_f32_16x16x32_bf16 v[156:159], v[84:87], v[188:191], v[156:159]
ds_read_b64_tr_b16 v[64:65], v21 offset:37120
ds_read_b64_tr_b16 v[66:67], v21 offset:39424
v_mfma_f32_16x16x32_bf16 v[124:127], v[88:91], v[184:187], v[124:127]
v_mfma_f32_16x16x32_bf16 v[160:163], v[88:91], v[188:191], v[160:163]
v_mfma_f32_16x16x32_bf16 v[128:131], v[92:95], v[184:187], v[128:131]
v_mfma_f32_16x16x32_bf16 v[164:167], v[92:95], v[188:191], v[164:167]
s_waitcnt lgkmcnt(15)
v_mfma_f32_16x16x32_bf16 v[132:135], v[96:99], v[184:187], v[132:135]
v_mfma_f32_16x16x32_bf16 v[168:171], v[96:99], v[188:191], v[168:171]
v_mfma_f32_16x16x32_bf16 v[136:139], v[100:103], v[184:187], v[136:139]
v_mfma_f32_16x16x32_bf16 v[172:175], v[100:103], v[188:191], v[172:175]
v_mfma_f32_16x16x32_bf16 v[104:107], v[32:35], v[176:179], v[104:107]
ds_read_b128 v[184:187], v26 offset:38912
ds_read_b128 v[188:191], v26 offset:39168
v_mfma_f32_16x16x32_bf16 v[140:143], v[32:35], v[180:183], v[140:143]
ds_read_b64_tr_b16 v[68:69], v21 offset:46080
ds_read_b64_tr_b16 v[70:71], v21 offset:48384
s_waitcnt lgkmcnt(15)
v_mfma_f32_16x16x32_bf16 v[108:111], v[36:39], v[176:179], v[108:111]
ds_read_b64_tr_b16 v[72:73], v21 offset:46112
ds_read_b64_tr_b16 v[74:75], v21 offset:48416
v_mfma_f32_16x16x32_bf16 v[144:147], v[36:39], v[180:183], v[144:147]
ds_read_b64_tr_b16 v[76:77], v21 offset:46144
ds_read_b64_tr_b16 v[78:79], v21 offset:48448
v_mfma_f32_16x16x32_bf16 v[112:115], v[40:43], v[176:179], v[112:115]
ds_read_b64_tr_b16 v[80:81], v21 offset:46176
ds_read_b64_tr_b16 v[82:83], v21 offset:48480
v_mfma_f32_16x16x32_bf16 v[148:151], v[40:43], v[180:183], v[148:151]
ds_read_b64_tr_b16 v[84:85], v21 offset:46208
ds_read_b64_tr_b16 v[86:87], v21 offset:48512
s_waitcnt lgkmcnt(15)
v_mfma_f32_16x16x32_bf16 v[116:119], v[44:47], v[176:179], v[116:119]
ds_read_b64_tr_b16 v[88:89], v21 offset:46240
ds_read_b64_tr_b16 v[90:91], v21 offset:48544
v_mfma_f32_16x16x32_bf16 v[152:155], v[44:47], v[180:183], v[152:155]
ds_read_b64_tr_b16 v[92:93], v21 offset:46272
ds_read_b64_tr_b16 v[94:95], v21 offset:48576
v_mfma_f32_16x16x32_bf16 v[120:123], v[48:51], v[176:179], v[120:123]
ds_read_b64_tr_b16 v[96:97], v21 offset:46304
ds_read_b64_tr_b16 v[98:99], v21 offset:48608
v_mfma_f32_16x16x32_bf16 v[156:159], v[48:51], v[180:183], v[156:159]
ds_read_b64_tr_b16 v[100:101], v21 offset:46336
ds_read_b64_tr_b16 v[102:103], v21 offset:48640
v_mfma_f32_16x16x32_bf16 v[124:127], v[52:55], v[176:179], v[124:127]
v_mfma_f32_16x16x32_bf16 v[160:163], v[52:55], v[180:183], v[160:163]
v_mfma_f32_16x16x32_bf16 v[128:131], v[56:59], v[176:179], v[128:131]
v_mfma_f32_16x16x32_bf16 v[164:167], v[56:59], v[180:183], v[164:167]
s_waitcnt lgkmcnt(15)
v_mfma_f32_16x16x32_bf16 v[132:135], v[60:63], v[176:179], v[132:135]
v_mfma_f32_16x16x32_bf16 v[168:171], v[60:63], v[180:183], v[168:171]
v_mfma_f32_16x16x32_bf16 v[136:139], v[64:67], v[176:179], v[136:139]
v_mfma_f32_16x16x32_bf16 v[172:175], v[64:67], v[180:183], v[172:175]
s_barrier
v_mfma_f32_16x16x32_bf16 v[104:107], v[68:71], v[184:187], v[104:107]
ds_read_b128 v[176:179], v25 offset:0
ds_read_b128 v[180:183], v25 offset:256
v_mfma_f32_16x16x32_bf16 v[140:143], v[68:71], v[188:191], v[140:143]
ds_read_b64_tr_b16 v[32:33], v20 offset:0
ds_read_b64_tr_b16 v[34:35], v20 offset:2304
s_waitcnt lgkmcnt(15)
v_mfma_f32_16x16x32_bf16 v[108:111], v[72:75], v[184:187], v[108:111]
ds_read_b64_tr_b16 v[36:37], v20 offset:32
ds_read_b64_tr_b16 v[38:39], v20 offset:2336
v_mfma_f32_16x16x32_bf16 v[144:147], v[72:75], v[188:191], v[144:147]
ds_read_b64_tr_b16 v[40:41], v20 offset:64
ds_read_b64_tr_b16 v[42:43], v20 offset:2368
v_mfma_f32_16x16x32_bf16 v[112:115], v[76:79], v[184:187], v[112:115]
ds_read_b64_tr_b16 v[44:45], v20 offset:96
ds_read_b64_tr_b16 v[46:47], v20 offset:2400
v_mfma_f32_16x16x32_bf16 v[148:151], v[76:79], v[188:191], v[148:151]
ds_read_b64_tr_b16 v[48:49], v20 offset:128
ds_read_b64_tr_b16 v[50:51], v20 offset:2432
s_waitcnt lgkmcnt(15)
v_mfma_f32_16x16x32_bf16 v[116:119], v[80:83], v[184:187], v[116:119]
ds_read_b64_tr_b16 v[52:53], v20 offset:160
ds_read_b64_tr_b16 v[54:55], v20 offset:2464
v_mfma_f32_16x16x32_bf16 v[152:155], v[80:83], v[188:191], v[152:155]
ds_read_b64_tr_b16 v[56:57], v20 offset:192
ds_read_b64_tr_b16 v[58:59], v20 offset:2496
v_mfma_f32_16x16x32_bf16 v[120:123], v[84:87], v[184:187], v[120:123]
ds_read_b64_tr_b16 v[60:61], v20 offset:224
ds_read_b64_tr_b16 v[62:63], v20 offset:2528
v_mfma_f32_16x16x32_bf16 v[156:159], v[84:87], v[188:191], v[156:159]
ds_read_b64_tr_b16 v[64:65], v20 offset:256
ds_read_b64_tr_b16 v[66:67], v20 offset:2560
v_mfma_f32_16x16x32_bf16 v[124:127], v[88:91], v[184:187], v[124:127]
v_mfma_f32_16x16x32_bf16 v[160:163], v[88:91], v[188:191], v[160:163]
v_mfma_f32_16x16x32_bf16 v[128:131], v[92:95], v[184:187], v[128:131]
v_mfma_f32_16x16x32_bf16 v[164:167], v[92:95], v[188:191], v[164:167]
s_waitcnt lgkmcnt(15)
v_mfma_f32_16x16x32_bf16 v[132:135], v[96:99], v[184:187], v[132:135]
v_mfma_f32_16x16x32_bf16 v[168:171], v[96:99], v[188:191], v[168:171]
v_mfma_f32_16x16x32_bf16 v[136:139], v[100:103], v[184:187], v[136:139]
v_mfma_f32_16x16x32_bf16 v[172:175], v[100:103], v[188:191], v[172:175]
v_mfma_f32_16x16x32_bf16 v[104:107], v[32:35], v[176:179], v[104:107]
ds_read_b128 v[184:187], v25 offset:2048
ds_read_b128 v[188:191], v25 offset:2304
v_mfma_f32_16x16x32_bf16 v[140:143], v[32:35], v[180:183], v[140:143]
ds_read_b64_tr_b16 v[68:69], v20 offset:9216
ds_read_b64_tr_b16 v[70:71], v20 offset:11520
s_waitcnt lgkmcnt(15)
v_mfma_f32_16x16x32_bf16 v[108:111], v[36:39], v[176:179], v[108:111]
ds_read_b64_tr_b16 v[72:73], v20 offset:9248
ds_read_b64_tr_b16 v[74:75], v20 offset:11552
v_mfma_f32_16x16x32_bf16 v[144:147], v[36:39], v[180:183], v[144:147]
ds_read_b64_tr_b16 v[76:77], v20 offset:9280
ds_read_b64_tr_b16 v[78:79], v20 offset:11584
v_mfma_f32_16x16x32_bf16 v[112:115], v[40:43], v[176:179], v[112:115]
ds_read_b64_tr_b16 v[80:81], v20 offset:9312
ds_read_b64_tr_b16 v[82:83], v20 offset:11616
v_mfma_f32_16x16x32_bf16 v[148:151], v[40:43], v[180:183], v[148:151]
ds_read_b64_tr_b16 v[84:85], v20 offset:9344
ds_read_b64_tr_b16 v[86:87], v20 offset:11648
s_waitcnt lgkmcnt(15)
v_mfma_f32_16x16x32_bf16 v[116:119], v[44:47], v[176:179], v[116:119]
ds_read_b64_tr_b16 v[88:89], v20 offset:9376
ds_read_b64_tr_b16 v[90:91], v20 offset:11680
v_mfma_f32_16x16x32_bf16 v[152:155], v[44:47], v[180:183], v[152:155]
ds_read_b64_tr_b16 v[92:93], v20 offset:9408
ds_read_b64_tr_b16 v[94:95], v20 offset:11712
v_mfma_f32_16x16x32_bf16 v[120:123], v[48:51], v[176:179], v[120:123]
ds_read_b64_tr_b16 v[96:97], v20 offset:9440
ds_read_b64_tr_b16 v[98:99], v20 offset:11744
v_mfma_f32_16x16x32_bf16 v[156:159], v[48:51], v[180:183], v[156:159]
ds_read_b64_tr_b16 v[100:101], v20 offset:9472
ds_read_b64_tr_b16 v[102:103], v20 offset:11776
v_mfma_f32_16x16x32_bf16 v[124:127], v[52:55], v[176:179], v[124:127]
v_mfma_f32_16x16x32_bf16 v[160:163], v[52:55], v[180:183], v[160:163]
v_mfma_f32_16x16x32_bf16 v[128:131], v[56:59], v[176:179], v[128:131]
v_mfma_f32_16x16x32_bf16 v[164:167], v[56:59], v[180:183], v[164:167]
s_waitcnt lgkmcnt(15)
v_mfma_f32_16x16x32_bf16 v[132:135], v[60:63], v[176:179], v[132:135]
v_mfma_f32_16x16x32_bf16 v[168:171], v[60:63], v[180:183], v[168:171]
v_mfma_f32_16x16x32_bf16 v[136:139], v[64:67], v[176:179], v[136:139]
v_mfma_f32_16x16x32_bf16 v[172:175], v[64:67], v[180:183], v[172:175]
s_barrier
v_mfma_f32_16x16x32_bf16 v[104:107], v[68:71], v[184:187], v[104:107]
ds_read_b128 v[176:179], v25 offset:36864
ds_read_b128 v[180:183], v25 offset:37120
v_mfma_f32_16x16x32_bf16 v[140:143], v[68:71], v[188:191], v[140:143]
ds_read_b64_tr_b16 v[32:33], v20 offset:36864
ds_read_b64_tr_b16 v[34:35], v20 offset:39168
s_waitcnt lgkmcnt(15)
v_mfma_f32_16x16x32_bf16 v[108:111], v[72:75], v[184:187], v[108:111]
ds_read_b64_tr_b16 v[36:37], v20 offset:36896
ds_read_b64_tr_b16 v[38:39], v20 offset:39200
v_mfma_f32_16x16x32_bf16 v[144:147], v[72:75], v[188:191], v[144:147]
ds_read_b64_tr_b16 v[40:41], v20 offset:36928
ds_read_b64_tr_b16 v[42:43], v20 offset:39232
v_mfma_f32_16x16x32_bf16 v[112:115], v[76:79], v[184:187], v[112:115]
ds_read_b64_tr_b16 v[44:45], v20 offset:36960
ds_read_b64_tr_b16 v[46:47], v20 offset:39264
v_mfma_f32_16x16x32_bf16 v[148:151], v[76:79], v[188:191], v[148:151]
ds_read_b64_tr_b16 v[48:49], v20 offset:36992
ds_read_b64_tr_b16 v[50:51], v20 offset:39296
s_waitcnt lgkmcnt(15)
v_mfma_f32_16x16x32_bf16 v[116:119], v[80:83], v[184:187], v[116:119]
ds_read_b64_tr_b16 v[52:53], v20 offset:37024
ds_read_b64_tr_b16 v[54:55], v20 offset:39328
v_mfma_f32_16x16x32_bf16 v[152:155], v[80:83], v[188:191], v[152:155]
ds_read_b64_tr_b16 v[56:57], v20 offset:37056
ds_read_b64_tr_b16 v[58:59], v20 offset:39360
v_mfma_f32_16x16x32_bf16 v[120:123], v[84:87], v[184:187], v[120:123]
ds_read_b64_tr_b16 v[60:61], v20 offset:37088
ds_read_b64_tr_b16 v[62:63], v20 offset:39392
v_mfma_f32_16x16x32_bf16 v[156:159], v[84:87], v[188:191], v[156:159]
ds_read_b64_tr_b16 v[64:65], v20 offset:37120
ds_read_b64_tr_b16 v[66:67], v20 offset:39424
v_mfma_f32_16x16x32_bf16 v[124:127], v[88:91], v[184:187], v[124:127]
v_mfma_f32_16x16x32_bf16 v[160:163], v[88:91], v[188:191], v[160:163]
v_mfma_f32_16x16x32_bf16 v[128:131], v[92:95], v[184:187], v[128:131]
v_mfma_f32_16x16x32_bf16 v[164:167], v[92:95], v[188:191], v[164:167]
s_waitcnt lgkmcnt(15)
v_mfma_f32_16x16x32_bf16 v[132:135], v[96:99], v[184:187], v[132:135]
v_mfma_f32_16x16x32_bf16 v[168:171], v[96:99], v[188:191], v[168:171]
v_mfma_f32_16x16x32_bf16 v[136:139], v[100:103], v[184:187], v[136:139]
v_mfma_f32_16x16x32_bf16 v[172:175], v[100:103], v[188:191], v[172:175]
v_mfma_f32_16x16x32_bf16 v[104:107], v[32:35], v[176:179], v[104:107]
ds_read_b128 v[184:187], v25 offset:38912
ds_read_b128 v[188:191], v25 offset:39168
v_mfma_f32_16x16x32_bf16 v[140:143], v[32:35], v[180:183], v[140:143]
ds_read_b64_tr_b16 v[68:69], v20 offset:46080
ds_read_b64_tr_b16 v[70:71], v20 offset:48384
s_waitcnt lgkmcnt(15)
v_mfma_f32_16x16x32_bf16 v[108:111], v[36:39], v[176:179], v[108:111]
ds_read_b64_tr_b16 v[72:73], v20 offset:46112
ds_read_b64_tr_b16 v[74:75], v20 offset:48416
v_mfma_f32_16x16x32_bf16 v[144:147], v[36:39], v[180:183], v[144:147]
ds_read_b64_tr_b16 v[76:77], v20 offset:46144
ds_read_b64_tr_b16 v[78:79], v20 offset:48448
v_mfma_f32_16x16x32_bf16 v[112:115], v[40:43], v[176:179], v[112:115]
ds_read_b64_tr_b16 v[80:81], v20 offset:46176
ds_read_b64_tr_b16 v[82:83], v20 offset:48480
v_mfma_f32_16x16x32_bf16 v[148:151], v[40:43], v[180:183], v[148:151]
ds_read_b64_tr_b16 v[84:85], v20 offset:46208
ds_read_b64_tr_b16 v[86:87], v20 offset:48512
s_waitcnt lgkmcnt(15)
v_mfma_f32_16x16x32_bf16 v[116:119], v[44:47], v[176:179], v[116:119]
ds_read_b64_tr_b16 v[88:89], v20 offset:46240
ds_read_b64_tr_b16 v[90:91], v20 offset:48544
v_mfma_f32_16x16x32_bf16 v[152:155], v[44:47], v[180:183], v[152:155]
ds_read_b64_tr_b16 v[92:93], v20 offset:46272
ds_read_b64_tr_b16 v[94:95], v20 offset:48576
v_mfma_f32_16x16x32_bf16 v[120:123], v[48:51], v[176:179], v[120:123]
ds_read_b64_tr_b16 v[96:97], v20 offset:46304
ds_read_b64_tr_b16 v[98:99], v20 offset:48608
v_mfma_f32_16x16x32_bf16 v[156:159], v[48:51], v[180:183], v[156:159]
ds_read_b64_tr_b16 v[100:101], v20 offset:46336
ds_read_b64_tr_b16 v[102:103], v20 offset:48640
v_mfma_f32_16x16x32_bf16 v[124:127], v[52:55], v[176:179], v[124:127]
v_mfma_f32_16x16x32_bf16 v[160:163], v[52:55], v[180:183], v[160:163]
v_mfma_f32_16x16x32_bf16 v[128:131], v[56:59], v[176:179], v[128:131]
v_mfma_f32_16x16x32_bf16 v[164:167], v[56:59], v[180:183], v[164:167]
s_waitcnt lgkmcnt(15)
v_mfma_f32_16x16x32_bf16 v[132:135], v[60:63], v[176:179], v[132:135]
v_mfma_f32_16x16x32_bf16 v[168:171], v[60:63], v[180:183], v[168:171]
v_mfma_f32_16x16x32_bf16 v[136:139], v[64:67], v[176:179], v[136:139]
v_mfma_f32_16x16x32_bf16 v[172:175], v[64:67], v[180:183], v[172:175]
s_barrier
v_mfma_f32_16x16x32_bf16 v[104:107], v[68:71], v[184:187], v[104:107]
ds_read_b128 v[176:179], v26 offset:0
ds_read_b128 v[180:183], v26 offset:256
v_mfma_f32_16x16x32_bf16 v[140:143], v[68:71], v[188:191], v[140:143]
ds_read_b64_tr_b16 v[32:33], v21 offset:0
ds_read_b64_tr_b16 v[34:35], v21 offset:2304
s_waitcnt lgkmcnt(15)
v_mfma_f32_16x16x32_bf16 v[108:111], v[72:75], v[184:187], v[108:111]
ds_read_b64_tr_b16 v[36:37], v21 offset:32
ds_read_b64_tr_b16 v[38:39], v21 offset:2336
v_mfma_f32_16x16x32_bf16 v[144:147], v[72:75], v[188:191], v[144:147]
ds_read_b64_tr_b16 v[40:41], v21 offset:64
ds_read_b64_tr_b16 v[42:43], v21 offset:2368
v_mfma_f32_16x16x32_bf16 v[112:115], v[76:79], v[184:187], v[112:115]
ds_read_b64_tr_b16 v[44:45], v21 offset:96
ds_read_b64_tr_b16 v[46:47], v21 offset:2400
v_mfma_f32_16x16x32_bf16 v[148:151], v[76:79], v[188:191], v[148:151]
ds_read_b64_tr_b16 v[48:49], v21 offset:128
ds_read_b64_tr_b16 v[50:51], v21 offset:2432
s_waitcnt lgkmcnt(15)
v_mfma_f32_16x16x32_bf16 v[116:119], v[80:83], v[184:187], v[116:119]
ds_read_b64_tr_b16 v[52:53], v21 offset:160
ds_read_b64_tr_b16 v[54:55], v21 offset:2464
v_mfma_f32_16x16x32_bf16 v[152:155], v[80:83], v[188:191], v[152:155]
ds_read_b64_tr_b16 v[56:57], v21 offset:192
ds_read_b64_tr_b16 v[58:59], v21 offset:2496
v_mfma_f32_16x16x32_bf16 v[120:123], v[84:87], v[184:187], v[120:123]
ds_read_b64_tr_b16 v[60:61], v21 offset:224
ds_read_b64_tr_b16 v[62:63], v21 offset:2528
v_mfma_f32_16x16x32_bf16 v[156:159], v[84:87], v[188:191], v[156:159]
ds_read_b64_tr_b16 v[64:65], v21 offset:256
ds_read_b64_tr_b16 v[66:67], v21 offset:2560
v_mfma_f32_16x16x32_bf16 v[124:127], v[88:91], v[184:187], v[124:127]
v_mfma_f32_16x16x32_bf16 v[160:163], v[88:91], v[188:191], v[160:163]
v_mfma_f32_16x16x32_bf16 v[128:131], v[92:95], v[184:187], v[128:131]
v_mfma_f32_16x16x32_bf16 v[164:167], v[92:95], v[188:191], v[164:167]
s_waitcnt lgkmcnt(15)
v_mfma_f32_16x16x32_bf16 v[132:135], v[96:99], v[184:187], v[132:135]
v_mfma_f32_16x16x32_bf16 v[168:171], v[96:99], v[188:191], v[168:171]
v_mfma_f32_16x16x32_bf16 v[136:139], v[100:103], v[184:187], v[136:139]
v_mfma_f32_16x16x32_bf16 v[172:175], v[100:103], v[188:191], v[172:175]
v_mfma_f32_16x16x32_bf16 v[104:107], v[32:35], v[176:179], v[104:107]
ds_read_b128 v[184:187], v26 offset:2048
ds_read_b128 v[188:191], v26 offset:2304
v_mfma_f32_16x16x32_bf16 v[140:143], v[32:35], v[180:183], v[140:143]
ds_read_b64_tr_b16 v[68:69], v21 offset:9216
ds_read_b64_tr_b16 v[70:71], v21 offset:11520
s_waitcnt lgkmcnt(15)
v_mfma_f32_16x16x32_bf16 v[108:111], v[36:39], v[176:179], v[108:111]
ds_read_b64_tr_b16 v[72:73], v21 offset:9248
ds_read_b64_tr_b16 v[74:75], v21 offset:11552
v_mfma_f32_16x16x32_bf16 v[144:147], v[36:39], v[180:183], v[144:147]
ds_read_b64_tr_b16 v[76:77], v21 offset:9280
ds_read_b64_tr_b16 v[78:79], v21 offset:11584
v_mfma_f32_16x16x32_bf16 v[112:115], v[40:43], v[176:179], v[112:115]
ds_read_b64_tr_b16 v[80:81], v21 offset:9312
ds_read_b64_tr_b16 v[82:83], v21 offset:11616
v_mfma_f32_16x16x32_bf16 v[148:151], v[40:43], v[180:183], v[148:151]
ds_read_b64_tr_b16 v[84:85], v21 offset:9344
ds_read_b64_tr_b16 v[86:87], v21 offset:11648
s_waitcnt lgkmcnt(15)
v_mfma_f32_16x16x32_bf16 v[116:119], v[44:47], v[176:179], v[116:119]
ds_read_b64_tr_b16 v[88:89], v21 offset:9376
ds_read_b64_tr_b16 v[90:91], v21 offset:11680
v_mfma_f32_16x16x32_bf16 v[152:155], v[44:47], v[180:183], v[152:155]
ds_read_b64_tr_b16 v[92:93], v21 offset:9408
ds_read_b64_tr_b16 v[94:95], v21 offset:11712
v_mfma_f32_16x16x32_bf16 v[120:123], v[48:51], v[176:179], v[120:123]
ds_read_b64_tr_b16 v[96:97], v21 offset:9440
ds_read_b64_tr_b16 v[98:99], v21 offset:11744
v_mfma_f32_16x16x32_bf16 v[156:159], v[48:51], v[180:183], v[156:159]
ds_read_b64_tr_b16 v[100:101], v21 offset:9472
ds_read_b64_tr_b16 v[102:103], v21 offset:11776
v_mfma_f32_16x16x32_bf16 v[124:127], v[52:55], v[176:179], v[124:127]
v_mfma_f32_16x16x32_bf16 v[160:163], v[52:55], v[180:183], v[160:163]
v_mfma_f32_16x16x32_bf16 v[128:131], v[56:59], v[176:179], v[128:131]
v_mfma_f32_16x16x32_bf16 v[164:167], v[56:59], v[180:183], v[164:167]
s_waitcnt lgkmcnt(15)
v_mfma_f32_16x16x32_bf16 v[132:135], v[60:63], v[176:179], v[132:135]
v_mfma_f32_16x16x32_bf16 v[168:171], v[60:63], v[180:183], v[168:171]
v_mfma_f32_16x16x32_bf16 v[136:139], v[64:67], v[176:179], v[136:139]
v_mfma_f32_16x16x32_bf16 v[172:175], v[64:67], v[180:183], v[172:175]
s_barrier
v_mfma_f32_16x16x32_bf16 v[104:107], v[68:71], v[184:187], v[104:107]
ds_read_b128 v[176:179], v26 offset:36864
ds_read_b128 v[180:183], v26 offset:37120
v_mfma_f32_16x16x32_bf16 v[140:143], v[68:71], v[188:191], v[140:143]
ds_read_b64_tr_b16 v[32:33], v21 offset:36864
ds_read_b64_tr_b16 v[34:35], v21 offset:39168
s_waitcnt lgkmcnt(15)
v_mfma_f32_16x16x32_bf16 v[108:111], v[72:75], v[184:187], v[108:111]
ds_read_b64_tr_b16 v[36:37], v21 offset:36896
ds_read_b64_tr_b16 v[38:39], v21 offset:39200
v_mfma_f32_16x16x32_bf16 v[144:147], v[72:75], v[188:191], v[144:147]
ds_read_b64_tr_b16 v[40:41], v21 offset:36928
ds_read_b64_tr_b16 v[42:43], v21 offset:39232
v_mfma_f32_16x16x32_bf16 v[112:115], v[76:79], v[184:187], v[112:115]
ds_read_b64_tr_b16 v[44:45], v21 offset:36960
ds_read_b64_tr_b16 v[46:47], v21 offset:39264
v_mfma_f32_16x16x32_bf16 v[148:151], v[76:79], v[188:191], v[148:151]
ds_read_b64_tr_b16 v[48:49], v21 offset:36992
ds_read_b64_tr_b16 v[50:51], v21 offset:39296
s_waitcnt lgkmcnt(15)
v_mfma_f32_16x16x32_bf16 v[116:119], v[80:83], v[184:187], v[116:119]
ds_read_b64_tr_b16 v[52:53], v21 offset:37024
ds_read_b64_tr_b16 v[54:55], v21 offset:39328
v_mfma_f32_16x16x32_bf16 v[152:155], v[80:83], v[188:191], v[152:155]
ds_read_b64_tr_b16 v[56:57], v21 offset:37056
ds_read_b64_tr_b16 v[58:59], v21 offset:39360
v_mfma_f32_16x16x32_bf16 v[120:123], v[84:87], v[184:187], v[120:123]
ds_read_b64_tr_b16 v[60:61], v21 offset:37088
ds_read_b64_tr_b16 v[62:63], v21 offset:39392
v_mfma_f32_16x16x32_bf16 v[156:159], v[84:87], v[188:191], v[156:159]
ds_read_b64_tr_b16 v[64:65], v21 offset:37120
ds_read_b64_tr_b16 v[66:67], v21 offset:39424
v_mfma_f32_16x16x32_bf16 v[124:127], v[88:91], v[184:187], v[124:127]
v_mfma_f32_16x16x32_bf16 v[160:163], v[88:91], v[188:191], v[160:163]
v_mfma_f32_16x16x32_bf16 v[128:131], v[92:95], v[184:187], v[128:131]
v_mfma_f32_16x16x32_bf16 v[164:167], v[92:95], v[188:191], v[164:167]
s_waitcnt lgkmcnt(15)
v_mfma_f32_16x16x32_bf16 v[132:135], v[96:99], v[184:187], v[132:135]
v_mfma_f32_16x16x32_bf16 v[168:171], v[96:99], v[188:191], v[168:171]
v_mfma_f32_16x16x32_bf16 v[136:139], v[100:103], v[184:187], v[136:139]
v_mfma_f32_16x16x32_bf16 v[172:175], v[100:103], v[188:191], v[172:175]
v_mfma_f32_16x16x32_bf16 v[104:107], v[32:35], v[176:179], v[104:107]
ds_read_b128 v[184:187], v26 offset:38912
ds_read_b128 v[188:191], v26 offset:39168
v_mfma_f32_16x16x32_bf16 v[140:143], v[32:35], v[180:183], v[140:143]
ds_read_b64_tr_b16 v[68:69], v21 offset:46080
ds_read_b64_tr_b16 v[70:71], v21 offset:48384
s_waitcnt lgkmcnt(15)
v_mfma_f32_16x16x32_bf16 v[108:111], v[36:39], v[176:179], v[108:111]
ds_read_b64_tr_b16 v[72:73], v21 offset:46112
ds_read_b64_tr_b16 v[74:75], v21 offset:48416
v_mfma_f32_16x16x32_bf16 v[144:147], v[36:39], v[180:183], v[144:147]
ds_read_b64_tr_b16 v[76:77], v21 offset:46144
ds_read_b64_tr_b16 v[78:79], v21 offset:48448
v_mfma_f32_16x16x32_bf16 v[112:115], v[40:43], v[176:179], v[112:115]
ds_read_b64_tr_b16 v[80:81], v21 offset:46176
ds_read_b64_tr_b16 v[82:83], v21 offset:48480
v_mfma_f32_16x16x32_bf16 v[148:151], v[40:43], v[180:183], v[148:151]
ds_read_b64_tr_b16 v[84:85], v21 offset:46208
ds_read_b64_tr_b16 v[86:87], v21 offset:48512
s_waitcnt lgkmcnt(15)
v_mfma_f32_16x16x32_bf16 v[116:119], v[44:47], v[176:179], v[116:119]
ds_read_b64_tr_b16 v[88:89], v21 offset:46240
ds_read_b64_tr_b16 v[90:91], v21 offset:48544
v_mfma_f32_16x16x32_bf16 v[152:155], v[44:47], v[180:183], v[152:155]
ds_read_b64_tr_b16 v[92:93], v21 offset:46272
ds_read_b64_tr_b16 v[94:95], v21 offset:48576
v_mfma_f32_16x16x32_bf16 v[120:123], v[48:51], v[176:179], v[120:123]
ds_read_b64_tr_b16 v[96:97], v21 offset:46304
ds_read_b64_tr_b16 v[98:99], v21 offset:48608
v_mfma_f32_16x16x32_bf16 v[156:159], v[48:51], v[180:183], v[156:159]
ds_read_b64_tr_b16 v[100:101], v21 offset:46336
ds_read_b64_tr_b16 v[102:103], v21 offset:48640
v_mfma_f32_16x16x32_bf16 v[124:127], v[52:55], v[176:179], v[124:127]
v_mfma_f32_16x16x32_bf16 v[160:163], v[52:55], v[180:183], v[160:163]
v_mfma_f32_16x16x32_bf16 v[128:131], v[56:59], v[176:179], v[128:131]
v_mfma_f32_16x16x32_bf16 v[164:167], v[56:59], v[180:183], v[164:167]
s_waitcnt lgkmcnt(15)
v_mfma_f32_16x16x32_bf16 v[132:135], v[60:63], v[176:179], v[132:135]
v_mfma_f32_16x16x32_bf16 v[168:171], v[60:63], v[180:183], v[168:171]
v_mfma_f32_16x16x32_bf16 v[136:139], v[64:67], v[176:179], v[136:139]
v_mfma_f32_16x16x32_bf16 v[172:175], v[64:67], v[180:183], v[172:175]
s_barrier
v_mfma_f32_16x16x32_bf16 v[104:107], v[68:71], v[184:187], v[104:107]
ds_read_b128 v[176:179], v25 offset:0
ds_read_b128 v[180:183], v25 offset:256
v_mfma_f32_16x16x32_bf16 v[140:143], v[68:71], v[188:191], v[140:143]
ds_read_b64_tr_b16 v[32:33], v20 offset:0
ds_read_b64_tr_b16 v[34:35], v20 offset:2304
s_waitcnt lgkmcnt(15)
v_mfma_f32_16x16x32_bf16 v[108:111], v[72:75], v[184:187], v[108:111]
ds_read_b64_tr_b16 v[36:37], v20 offset:32
ds_read_b64_tr_b16 v[38:39], v20 offset:2336
v_mfma_f32_16x16x32_bf16 v[144:147], v[72:75], v[188:191], v[144:147]
ds_read_b64_tr_b16 v[40:41], v20 offset:64
ds_read_b64_tr_b16 v[42:43], v20 offset:2368
v_mfma_f32_16x16x32_bf16 v[112:115], v[76:79], v[184:187], v[112:115]
ds_read_b64_tr_b16 v[44:45], v20 offset:96
ds_read_b64_tr_b16 v[46:47], v20 offset:2400
v_mfma_f32_16x16x32_bf16 v[148:151], v[76:79], v[188:191], v[148:151]
ds_read_b64_tr_b16 v[48:49], v20 offset:128
ds_read_b64_tr_b16 v[50:51], v20 offset:2432
s_waitcnt lgkmcnt(15)
v_mfma_f32_16x16x32_bf16 v[116:119], v[80:83], v[184:187], v[116:119]
ds_read_b64_tr_b16 v[52:53], v20 offset:160
ds_read_b64_tr_b16 v[54:55], v20 offset:2464
v_mfma_f32_16x16x32_bf16 v[152:155], v[80:83], v[188:191], v[152:155]
ds_read_b64_tr_b16 v[56:57], v20 offset:192
ds_read_b64_tr_b16 v[58:59], v20 offset:2496
v_mfma_f32_16x16x32_bf16 v[120:123], v[84:87], v[184:187], v[120:123]
ds_read_b64_tr_b16 v[60:61], v20 offset:224
ds_read_b64_tr_b16 v[62:63], v20 offset:2528
v_mfma_f32_16x16x32_bf16 v[156:159], v[84:87], v[188:191], v[156:159]
ds_read_b64_tr_b16 v[64:65], v20 offset:256
ds_read_b64_tr_b16 v[66:67], v20 offset:2560
v_mfma_f32_16x16x32_bf16 v[124:127], v[88:91], v[184:187], v[124:127]
v_mfma_f32_16x16x32_bf16 v[160:163], v[88:91], v[188:191], v[160:163]
v_mfma_f32_16x16x32_bf16 v[128:131], v[92:95], v[184:187], v[128:131]
v_mfma_f32_16x16x32_bf16 v[164:167], v[92:95], v[188:191], v[164:167]
s_waitcnt lgkmcnt(15)
v_mfma_f32_16x16x32_bf16 v[132:135], v[96:99], v[184:187], v[132:135]
v_mfma_f32_16x16x32_bf16 v[168:171], v[96:99], v[188:191], v[168:171]
v_mfma_f32_16x16x32_bf16 v[136:139], v[100:103], v[184:187], v[136:139]
v_mfma_f32_16x16x32_bf16 v[172:175], v[100:103], v[188:191], v[172:175]
v_mfma_f32_16x16x32_bf16 v[104:107], v[32:35], v[176:179], v[104:107]
ds_read_b128 v[184:187], v25 offset:2048
ds_read_b128 v[188:191], v25 offset:2304
v_mfma_f32_16x16x32_bf16 v[140:143], v[32:35], v[180:183], v[140:143]
ds_read_b64_tr_b16 v[68:69], v20 offset:9216
ds_read_b64_tr_b16 v[70:71], v20 offset:11520
s_waitcnt lgkmcnt(15)
v_mfma_f32_16x16x32_bf16 v[108:111], v[36:39], v[176:179], v[108:111]
ds_read_b64_tr_b16 v[72:73], v20 offset:9248
ds_read_b64_tr_b16 v[74:75], v20 offset:11552
v_mfma_f32_16x16x32_bf16 v[144:147], v[36:39], v[180:183], v[144:147]
ds_read_b64_tr_b16 v[76:77], v20 offset:9280
ds_read_b64_tr_b16 v[78:79], v20 offset:11584
v_mfma_f32_16x16x32_bf16 v[112:115], v[40:43], v[176:179], v[112:115]
ds_read_b64_tr_b16 v[80:81], v20 offset:9312
ds_read_b64_tr_b16 v[82:83], v20 offset:11616
v_mfma_f32_16x16x32_bf16 v[148:151], v[40:43], v[180:183], v[148:151]
ds_read_b64_tr_b16 v[84:85], v20 offset:9344
ds_read_b64_tr_b16 v[86:87], v20 offset:11648
s_waitcnt lgkmcnt(15)
v_mfma_f32_16x16x32_bf16 v[116:119], v[44:47], v[176:179], v[116:119]
ds_read_b64_tr_b16 v[88:89], v20 offset:9376
ds_read_b64_tr_b16 v[90:91], v20 offset:11680
v_mfma_f32_16x16x32_bf16 v[152:155], v[44:47], v[180:183], v[152:155]
ds_read_b64_tr_b16 v[92:93], v20 offset:9408
ds_read_b64_tr_b16 v[94:95], v20 offset:11712
v_mfma_f32_16x16x32_bf16 v[120:123], v[48:51], v[176:179], v[120:123]
ds_read_b64_tr_b16 v[96:97], v20 offset:9440
ds_read_b64_tr_b16 v[98:99], v20 offset:11744
v_mfma_f32_16x16x32_bf16 v[156:159], v[48:51], v[180:183], v[156:159]
ds_read_b64_tr_b16 v[100:101], v20 offset:9472
ds_read_b64_tr_b16 v[102:103], v20 offset:11776
v_mfma_f32_16x16x32_bf16 v[124:127], v[52:55], v[176:179], v[124:127]
v_mfma_f32_16x16x32_bf16 v[160:163], v[52:55], v[180:183], v[160:163]
v_mfma_f32_16x16x32_bf16 v[128:131], v[56:59], v[176:179], v[128:131]
v_mfma_f32_16x16x32_bf16 v[164:167], v[56:59], v[180:183], v[164:167]
s_waitcnt lgkmcnt(15)
v_mfma_f32_16x16x32_bf16 v[132:135], v[60:63], v[176:179], v[132:135]
v_mfma_f32_16x16x32_bf16 v[168:171], v[60:63], v[180:183], v[168:171]
v_mfma_f32_16x16x32_bf16 v[136:139], v[64:67], v[176:179], v[136:139]
v_mfma_f32_16x16x32_bf16 v[172:175], v[64:67], v[180:183], v[172:175]
s_barrier
v_mfma_f32_16x16x32_bf16 v[104:107], v[68:71], v[184:187], v[104:107]
ds_read_b128 v[176:179], v25 offset:36864
ds_read_b128 v[180:183], v25 offset:37120
v_mfma_f32_16x16x32_bf16 v[140:143], v[68:71], v[188:191], v[140:143]
ds_read_b64_tr_b16 v[32:33], v20 offset:36864
ds_read_b64_tr_b16 v[34:35], v20 offset:39168
s_waitcnt lgkmcnt(15)
v_mfma_f32_16x16x32_bf16 v[108:111], v[72:75], v[184:187], v[108:111]
ds_read_b64_tr_b16 v[36:37], v20 offset:36896
ds_read_b64_tr_b16 v[38:39], v20 offset:39200
v_mfma_f32_16x16x32_bf16 v[144:147], v[72:75], v[188:191], v[144:147]
ds_read_b64_tr_b16 v[40:41], v20 offset:36928
ds_read_b64_tr_b16 v[42:43], v20 offset:39232
v_mfma_f32_16x16x32_bf16 v[112:115], v[76:79], v[184:187], v[112:115]
ds_read_b64_tr_b16 v[44:45], v20 offset:36960
ds_read_b64_tr_b16 v[46:47], v20 offset:39264
v_mfma_f32_16x16x32_bf16 v[148:151], v[76:79], v[188:191], v[148:151]
ds_read_b64_tr_b16 v[48:49], v20 offset:36992
ds_read_b64_tr_b16 v[50:51], v20 offset:39296
s_waitcnt lgkmcnt(15)
v_mfma_f32_16x16x32_bf16 v[116:119], v[80:83], v[184:187], v[116:119]
ds_read_b64_tr_b16 v[52:53], v20 offset:37024
ds_read_b64_tr_b16 v[54:55], v20 offset:39328
v_mfma_f32_16x16x32_bf16 v[152:155], v[80:83], v[188:191], v[152:155]
ds_read_b64_tr_b16 v[56:57], v20 offset:37056
ds_read_b64_tr_b16 v[58:59], v20 offset:39360
v_mfma_f32_16x16x32_bf16 v[120:123], v[84:87], v[184:187], v[120:123]
ds_read_b64_tr_b16 v[60:61], v20 offset:37088
ds_read_b64_tr_b16 v[62:63], v20 offset:39392
v_mfma_f32_16x16x32_bf16 v[156:159], v[84:87], v[188:191], v[156:159]
ds_read_b64_tr_b16 v[64:65], v20 offset:37120
ds_read_b64_tr_b16 v[66:67], v20 offset:39424
v_mfma_f32_16x16x32_bf16 v[124:127], v[88:91], v[184:187], v[124:127]
v_mfma_f32_16x16x32_bf16 v[160:163], v[88:91], v[188:191], v[160:163]
v_mfma_f32_16x16x32_bf16 v[128:131], v[92:95], v[184:187], v[128:131]
v_mfma_f32_16x16x32_bf16 v[164:167], v[92:95], v[188:191], v[164:167]
s_waitcnt lgkmcnt(15)
v_mfma_f32_16x16x32_bf16 v[132:135], v[96:99], v[184:187], v[132:135]
v_mfma_f32_16x16x32_bf16 v[168:171], v[96:99], v[188:191], v[168:171]
v_mfma_f32_16x16x32_bf16 v[136:139], v[100:103], v[184:187], v[136:139]
v_mfma_f32_16x16x32_bf16 v[172:175], v[100:103], v[188:191], v[172:175]
v_mfma_f32_16x16x32_bf16 v[104:107], v[32:35], v[176:179], v[104:107]
ds_read_b128 v[184:187], v25 offset:38912
ds_read_b128 v[188:191], v25 offset:39168
v_mfma_f32_16x16x32_bf16 v[140:143], v[32:35], v[180:183], v[140:143]
ds_read_b64_tr_b16 v[68:69], v20 offset:46080
ds_read_b64_tr_b16 v[70:71], v20 offset:48384
s_waitcnt lgkmcnt(15)
v_mfma_f32_16x16x32_bf16 v[108:111], v[36:39], v[176:179], v[108:111]
ds_read_b64_tr_b16 v[72:73], v20 offset:46112
ds_read_b64_tr_b16 v[74:75], v20 offset:48416
v_mfma_f32_16x16x32_bf16 v[144:147], v[36:39], v[180:183], v[144:147]
ds_read_b64_tr_b16 v[76:77], v20 offset:46144
ds_read_b64_tr_b16 v[78:79], v20 offset:48448
v_mfma_f32_16x16x32_bf16 v[112:115], v[40:43], v[176:179], v[112:115]
ds_read_b64_tr_b16 v[80:81], v20 offset:46176
ds_read_b64_tr_b16 v[82:83], v20 offset:48480
v_mfma_f32_16x16x32_bf16 v[148:151], v[40:43], v[180:183], v[148:151]
ds_read_b64_tr_b16 v[84:85], v20 offset:46208
ds_read_b64_tr_b16 v[86:87], v20 offset:48512
s_waitcnt lgkmcnt(15)
v_mfma_f32_16x16x32_bf16 v[116:119], v[44:47], v[176:179], v[116:119]
ds_read_b64_tr_b16 v[88:89], v20 offset:46240
ds_read_b64_tr_b16 v[90:91], v20 offset:48544
v_mfma_f32_16x16x32_bf16 v[152:155], v[44:47], v[180:183], v[152:155]
ds_read_b64_tr_b16 v[92:93], v20 offset:46272
ds_read_b64_tr_b16 v[94:95], v20 offset:48576
v_mfma_f32_16x16x32_bf16 v[120:123], v[48:51], v[176:179], v[120:123]
ds_read_b64_tr_b16 v[96:97], v20 offset:46304
ds_read_b64_tr_b16 v[98:99], v20 offset:48608
v_mfma_f32_16x16x32_bf16 v[156:159], v[48:51], v[180:183], v[156:159]
ds_read_b64_tr_b16 v[100:101], v20 offset:46336
ds_read_b64_tr_b16 v[102:103], v20 offset:48640
v_mfma_f32_16x16x32_bf16 v[124:127], v[52:55], v[176:179], v[124:127]
v_mfma_f32_16x16x32_bf16 v[160:163], v[52:55], v[180:183], v[160:163]
v_mfma_f32_16x16x32_bf16 v[128:131], v[56:59], v[176:179], v[128:131]
v_mfma_f32_16x16x32_bf16 v[164:167], v[56:59], v[180:183], v[164:167]
s_waitcnt lgkmcnt(15)
v_mfma_f32_16x16x32_bf16 v[132:135], v[60:63], v[176:179], v[132:135]
v_mfma_f32_16x16x32_bf16 v[168:171], v[60:63], v[180:183], v[168:171]
v_mfma_f32_16x16x32_bf16 v[136:139], v[64:67], v[176:179], v[136:139]
v_mfma_f32_16x16x32_bf16 v[172:175], v[64:67], v[180:183], v[172:175]
s_barrier
v_mfma_f32_16x16x32_bf16 v[104:107], v[68:71], v[184:187], v[104:107]
ds_read_b128 v[176:179], v26 offset:0
ds_read_b128 v[180:183], v26 offset:256
v_mfma_f32_16x16x32_bf16 v[140:143], v[68:71], v[188:191], v[140:143]
ds_read_b64_tr_b16 v[32:33], v21 offset:0
ds_read_b64_tr_b16 v[34:35], v21 offset:2304
s_waitcnt lgkmcnt(15)
v_mfma_f32_16x16x32_bf16 v[108:111], v[72:75], v[184:187], v[108:111]
ds_read_b64_tr_b16 v[36:37], v21 offset:32
ds_read_b64_tr_b16 v[38:39], v21 offset:2336
v_mfma_f32_16x16x32_bf16 v[144:147], v[72:75], v[188:191], v[144:147]
ds_read_b64_tr_b16 v[40:41], v21 offset:64
ds_read_b64_tr_b16 v[42:43], v21 offset:2368
v_mfma_f32_16x16x32_bf16 v[112:115], v[76:79], v[184:187], v[112:115]
ds_read_b64_tr_b16 v[44:45], v21 offset:96
ds_read_b64_tr_b16 v[46:47], v21 offset:2400
v_mfma_f32_16x16x32_bf16 v[148:151], v[76:79], v[188:191], v[148:151]
ds_read_b64_tr_b16 v[48:49], v21 offset:128
ds_read_b64_tr_b16 v[50:51], v21 offset:2432
s_waitcnt lgkmcnt(15)
v_mfma_f32_16x16x32_bf16 v[116:119], v[80:83], v[184:187], v[116:119]
ds_read_b64_tr_b16 v[52:53], v21 offset:160
ds_read_b64_tr_b16 v[54:55], v21 offset:2464
v_mfma_f32_16x16x32_bf16 v[152:155], v[80:83], v[188:191], v[152:155]
ds_read_b64_tr_b16 v[56:57], v21 offset:192
ds_read_b64_tr_b16 v[58:59], v21 offset:2496
v_mfma_f32_16x16x32_bf16 v[120:123], v[84:87], v[184:187], v[120:123]
ds_read_b64_tr_b16 v[60:61], v21 offset:224
ds_read_b64_tr_b16 v[62:63], v21 offset:2528
v_mfma_f32_16x16x32_bf16 v[156:159], v[84:87], v[188:191], v[156:159]
ds_read_b64_tr_b16 v[64:65], v21 offset:256
ds_read_b64_tr_b16 v[66:67], v21 offset:2560
v_mfma_f32_16x16x32_bf16 v[124:127], v[88:91], v[184:187], v[124:127]
v_mfma_f32_16x16x32_bf16 v[160:163], v[88:91], v[188:191], v[160:163]
v_mfma_f32_16x16x32_bf16 v[128:131], v[92:95], v[184:187], v[128:131]
v_mfma_f32_16x16x32_bf16 v[164:167], v[92:95], v[188:191], v[164:167]
s_waitcnt lgkmcnt(15)
v_mfma_f32_16x16x32_bf16 v[132:135], v[96:99], v[184:187], v[132:135]
v_mfma_f32_16x16x32_bf16 v[168:171], v[96:99], v[188:191], v[168:171]
v_mfma_f32_16x16x32_bf16 v[136:139], v[100:103], v[184:187], v[136:139]
v_mfma_f32_16x16x32_bf16 v[172:175], v[100:103], v[188:191], v[172:175]
v_mfma_f32_16x16x32_bf16 v[104:107], v[32:35], v[176:179], v[104:107]
ds_read_b128 v[184:187], v26 offset:2048
ds_read_b128 v[188:191], v26 offset:2304
v_mfma_f32_16x16x32_bf16 v[140:143], v[32:35], v[180:183], v[140:143]
ds_read_b64_tr_b16 v[68:69], v21 offset:9216
ds_read_b64_tr_b16 v[70:71], v21 offset:11520
s_waitcnt lgkmcnt(15)
v_mfma_f32_16x16x32_bf16 v[108:111], v[36:39], v[176:179], v[108:111]
ds_read_b64_tr_b16 v[72:73], v21 offset:9248
ds_read_b64_tr_b16 v[74:75], v21 offset:11552
v_mfma_f32_16x16x32_bf16 v[144:147], v[36:39], v[180:183], v[144:147]
ds_read_b64_tr_b16 v[76:77], v21 offset:9280
ds_read_b64_tr_b16 v[78:79], v21 offset:11584
v_mfma_f32_16x16x32_bf16 v[112:115], v[40:43], v[176:179], v[112:115]
ds_read_b64_tr_b16 v[80:81], v21 offset:9312
ds_read_b64_tr_b16 v[82:83], v21 offset:11616
v_mfma_f32_16x16x32_bf16 v[148:151], v[40:43], v[180:183], v[148:151]
ds_read_b64_tr_b16 v[84:85], v21 offset:9344
ds_read_b64_tr_b16 v[86:87], v21 offset:11648
s_waitcnt lgkmcnt(15)
v_mfma_f32_16x16x32_bf16 v[116:119], v[44:47], v[176:179], v[116:119]
ds_read_b64_tr_b16 v[88:89], v21 offset:9376
ds_read_b64_tr_b16 v[90:91], v21 offset:11680
v_mfma_f32_16x16x32_bf16 v[152:155], v[44:47], v[180:183], v[152:155]
ds_read_b64_tr_b16 v[92:93], v21 offset:9408
ds_read_b64_tr_b16 v[94:95], v21 offset:11712
v_mfma_f32_16x16x32_bf16 v[120:123], v[48:51], v[176:179], v[120:123]
ds_read_b64_tr_b16 v[96:97], v21 offset:9440
ds_read_b64_tr_b16 v[98:99], v21 offset:11744
v_mfma_f32_16x16x32_bf16 v[156:159], v[48:51], v[180:183], v[156:159]
ds_read_b64_tr_b16 v[100:101], v21 offset:9472
ds_read_b64_tr_b16 v[102:103], v21 offset:11776
v_mfma_f32_16x16x32_bf16 v[124:127], v[52:55], v[176:179], v[124:127]
v_mfma_f32_16x16x32_bf16 v[160:163], v[52:55], v[180:183], v[160:163]
v_mfma_f32_16x16x32_bf16 v[128:131], v[56:59], v[176:179], v[128:131]
v_mfma_f32_16x16x32_bf16 v[164:167], v[56:59], v[180:183], v[164:167]
s_waitcnt lgkmcnt(15)
v_mfma_f32_16x16x32_bf16 v[132:135], v[60:63], v[176:179], v[132:135]
v_mfma_f32_16x16x32_bf16 v[168:171], v[60:63], v[180:183], v[168:171]
v_mfma_f32_16x16x32_bf16 v[136:139], v[64:67], v[176:179], v[136:139]
v_mfma_f32_16x16x32_bf16 v[172:175], v[64:67], v[180:183], v[172:175]
s_barrier
v_mfma_f32_16x16x32_bf16 v[104:107], v[68:71], v[184:187], v[104:107]
ds_read_b128 v[176:179], v26 offset:36864
ds_read_b128 v[180:183], v26 offset:37120
v_mfma_f32_16x16x32_bf16 v[140:143], v[68:71], v[188:191], v[140:143]
ds_read_b64_tr_b16 v[32:33], v21 offset:36864
ds_read_b64_tr_b16 v[34:35], v21 offset:39168
s_waitcnt lgkmcnt(15)
v_mfma_f32_16x16x32_bf16 v[108:111], v[72:75], v[184:187], v[108:111]
ds_read_b64_tr_b16 v[36:37], v21 offset:36896
ds_read_b64_tr_b16 v[38:39], v21 offset:39200
v_mfma_f32_16x16x32_bf16 v[144:147], v[72:75], v[188:191], v[144:147]
ds_read_b64_tr_b16 v[40:41], v21 offset:36928
ds_read_b64_tr_b16 v[42:43], v21 offset:39232
v_mfma_f32_16x16x32_bf16 v[112:115], v[76:79], v[184:187], v[112:115]
ds_read_b64_tr_b16 v[44:45], v21 offset:36960
ds_read_b64_tr_b16 v[46:47], v21 offset:39264
v_mfma_f32_16x16x32_bf16 v[148:151], v[76:79], v[188:191], v[148:151]
ds_read_b64_tr_b16 v[48:49], v21 offset:36992
ds_read_b64_tr_b16 v[50:51], v21 offset:39296
s_waitcnt lgkmcnt(15)
v_mfma_f32_16x16x32_bf16 v[116:119], v[80:83], v[184:187], v[116:119]
ds_read_b64_tr_b16 v[52:53], v21 offset:37024
ds_read_b64_tr_b16 v[54:55], v21 offset:39328
v_mfma_f32_16x16x32_bf16 v[152:155], v[80:83], v[188:191], v[152:155]
ds_read_b64_tr_b16 v[56:57], v21 offset:37056
ds_read_b64_tr_b16 v[58:59], v21 offset:39360
v_mfma_f32_16x16x32_bf16 v[120:123], v[84:87], v[184:187], v[120:123]
ds_read_b64_tr_b16 v[60:61], v21 offset:37088
ds_read_b64_tr_b16 v[62:63], v21 offset:39392
v_mfma_f32_16x16x32_bf16 v[156:159], v[84:87], v[188:191], v[156:159]
ds_read_b64_tr_b16 v[64:65], v21 offset:37120
ds_read_b64_tr_b16 v[66:67], v21 offset:39424
v_mfma_f32_16x16x32_bf16 v[124:127], v[88:91], v[184:187], v[124:127]
v_mfma_f32_16x16x32_bf16 v[160:163], v[88:91], v[188:191], v[160:163]
v_mfma_f32_16x16x32_bf16 v[128:131], v[92:95], v[184:187], v[128:131]
v_mfma_f32_16x16x32_bf16 v[164:167], v[92:95], v[188:191], v[164:167]
s_waitcnt lgkmcnt(15)
v_mfma_f32_16x16x32_bf16 v[132:135], v[96:99], v[184:187], v[132:135]
v_mfma_f32_16x16x32_bf16 v[168:171], v[96:99], v[188:191], v[168:171]
v_mfma_f32_16x16x32_bf16 v[136:139], v[100:103], v[184:187], v[136:139]
v_mfma_f32_16x16x32_bf16 v[172:175], v[100:103], v[188:191], v[172:175]
v_mfma_f32_16x16x32_bf16 v[104:107], v[32:35], v[176:179], v[104:107]
ds_read_b128 v[184:187], v26 offset:38912
ds_read_b128 v[188:191], v26 offset:39168
v_mfma_f32_16x16x32_bf16 v[140:143], v[32:35], v[180:183], v[140:143]
ds_read_b64_tr_b16 v[68:69], v21 offset:46080
ds_read_b64_tr_b16 v[70:71], v21 offset:48384
s_waitcnt lgkmcnt(15)
v_mfma_f32_16x16x32_bf16 v[108:111], v[36:39], v[176:179], v[108:111]
ds_read_b64_tr_b16 v[72:73], v21 offset:46112
ds_read_b64_tr_b16 v[74:75], v21 offset:48416
v_mfma_f32_16x16x32_bf16 v[144:147], v[36:39], v[180:183], v[144:147]
ds_read_b64_tr_b16 v[76:77], v21 offset:46144
ds_read_b64_tr_b16 v[78:79], v21 offset:48448
v_mfma_f32_16x16x32_bf16 v[112:115], v[40:43], v[176:179], v[112:115]
ds_read_b64_tr_b16 v[80:81], v21 offset:46176
ds_read_b64_tr_b16 v[82:83], v21 offset:48480
v_mfma_f32_16x16x32_bf16 v[148:151], v[40:43], v[180:183], v[148:151]
ds_read_b64_tr_b16 v[84:85], v21 offset:46208
ds_read_b64_tr_b16 v[86:87], v21 offset:48512
s_waitcnt lgkmcnt(15)
v_mfma_f32_16x16x32_bf16 v[116:119], v[44:47], v[176:179], v[116:119]
ds_read_b64_tr_b16 v[88:89], v21 offset:46240
ds_read_b64_tr_b16 v[90:91], v21 offset:48544
v_mfma_f32_16x16x32_bf16 v[152:155], v[44:47], v[180:183], v[152:155]
ds_read_b64_tr_b16 v[92:93], v21 offset:46272
ds_read_b64_tr_b16 v[94:95], v21 offset:48576
v_mfma_f32_16x16x32_bf16 v[120:123], v[48:51], v[176:179], v[120:123]
ds_read_b64_tr_b16 v[96:97], v21 offset:46304
ds_read_b64_tr_b16 v[98:99], v21 offset:48608
v_mfma_f32_16x16x32_bf16 v[156:159], v[48:51], v[180:183], v[156:159]
ds_read_b64_tr_b16 v[100:101], v21 offset:46336
ds_read_b64_tr_b16 v[102:103], v21 offset:48640
v_mfma_f32_16x16x32_bf16 v[124:127], v[52:55], v[176:179], v[124:127]
v_mfma_f32_16x16x32_bf16 v[160:163], v[52:55], v[180:183], v[160:163]
v_mfma_f32_16x16x32_bf16 v[128:131], v[56:59], v[176:179], v[128:131]
v_mfma_f32_16x16x32_bf16 v[164:167], v[56:59], v[180:183], v[164:167]
s_waitcnt lgkmcnt(15)
v_mfma_f32_16x16x32_bf16 v[132:135], v[60:63], v[176:179], v[132:135]
v_mfma_f32_16x16x32_bf16 v[168:171], v[60:63], v[180:183], v[168:171]
v_mfma_f32_16x16x32_bf16 v[136:139], v[64:67], v[176:179], v[136:139]
v_mfma_f32_16x16x32_bf16 v[172:175], v[64:67], v[180:183], v[172:175]
s_barrier
v_mfma_f32_16x16x32_bf16 v[104:107], v[68:71], v[184:187], v[104:107]
ds_read_b128 v[176:179], v25 offset:0
ds_read_b128 v[180:183], v25 offset:256
v_mfma_f32_16x16x32_bf16 v[140:143], v[68:71], v[188:191], v[140:143]
ds_read_b64_tr_b16 v[32:33], v20 offset:0
ds_read_b64_tr_b16 v[34:35], v20 offset:2304
s_waitcnt lgkmcnt(15)
v_mfma_f32_16x16x32_bf16 v[108:111], v[72:75], v[184:187], v[108:111]
ds_read_b64_tr_b16 v[36:37], v20 offset:32
ds_read_b64_tr_b16 v[38:39], v20 offset:2336
v_mfma_f32_16x16x32_bf16 v[144:147], v[72:75], v[188:191], v[144:147]
ds_read_b64_tr_b16 v[40:41], v20 offset:64
ds_read_b64_tr_b16 v[42:43], v20 offset:2368
v_mfma_f32_16x16x32_bf16 v[112:115], v[76:79], v[184:187], v[112:115]
ds_read_b64_tr_b16 v[44:45], v20 offset:96
ds_read_b64_tr_b16 v[46:47], v20 offset:2400
v_mfma_f32_16x16x32_bf16 v[148:151], v[76:79], v[188:191], v[148:151]
ds_read_b64_tr_b16 v[48:49], v20 offset:128
ds_read_b64_tr_b16 v[50:51], v20 offset:2432
s_waitcnt lgkmcnt(15)
v_mfma_f32_16x16x32_bf16 v[116:119], v[80:83], v[184:187], v[116:119]
ds_read_b64_tr_b16 v[52:53], v20 offset:160
ds_read_b64_tr_b16 v[54:55], v20 offset:2464
v_mfma_f32_16x16x32_bf16 v[152:155], v[80:83], v[188:191], v[152:155]
ds_read_b64_tr_b16 v[56:57], v20 offset:192
ds_read_b64_tr_b16 v[58:59], v20 offset:2496
v_mfma_f32_16x16x32_bf16 v[120:123], v[84:87], v[184:187], v[120:123]
ds_read_b64_tr_b16 v[60:61], v20 offset:224
ds_read_b64_tr_b16 v[62:63], v20 offset:2528
v_mfma_f32_16x16x32_bf16 v[156:159], v[84:87], v[188:191], v[156:159]
ds_read_b64_tr_b16 v[64:65], v20 offset:256
ds_read_b64_tr_b16 v[66:67], v20 offset:2560
v_mfma_f32_16x16x32_bf16 v[124:127], v[88:91], v[184:187], v[124:127]
v_mfma_f32_16x16x32_bf16 v[160:163], v[88:91], v[188:191], v[160:163]
v_mfma_f32_16x16x32_bf16 v[128:131], v[92:95], v[184:187], v[128:131]
v_mfma_f32_16x16x32_bf16 v[164:167], v[92:95], v[188:191], v[164:167]
s_waitcnt lgkmcnt(15)
v_mfma_f32_16x16x32_bf16 v[132:135], v[96:99], v[184:187], v[132:135]
v_mfma_f32_16x16x32_bf16 v[168:171], v[96:99], v[188:191], v[168:171]
v_mfma_f32_16x16x32_bf16 v[136:139], v[100:103], v[184:187], v[136:139]
v_mfma_f32_16x16x32_bf16 v[172:175], v[100:103], v[188:191], v[172:175]
v_mfma_f32_16x16x32_bf16 v[104:107], v[32:35], v[176:179], v[104:107]
ds_read_b128 v[184:187], v25 offset:2048
ds_read_b128 v[188:191], v25 offset:2304
v_mfma_f32_16x16x32_bf16 v[140:143], v[32:35], v[180:183], v[140:143]
ds_read_b64_tr_b16 v[68:69], v20 offset:9216
ds_read_b64_tr_b16 v[70:71], v20 offset:11520
s_waitcnt lgkmcnt(15)
v_mfma_f32_16x16x32_bf16 v[108:111], v[36:39], v[176:179], v[108:111]
ds_read_b64_tr_b16 v[72:73], v20 offset:9248
ds_read_b64_tr_b16 v[74:75], v20 offset:11552
v_mfma_f32_16x16x32_bf16 v[144:147], v[36:39], v[180:183], v[144:147]
ds_read_b64_tr_b16 v[76:77], v20 offset:9280
ds_read_b64_tr_b16 v[78:79], v20 offset:11584
v_mfma_f32_16x16x32_bf16 v[112:115], v[40:43], v[176:179], v[112:115]
ds_read_b64_tr_b16 v[80:81], v20 offset:9312
ds_read_b64_tr_b16 v[82:83], v20 offset:11616
v_mfma_f32_16x16x32_bf16 v[148:151], v[40:43], v[180:183], v[148:151]
ds_read_b64_tr_b16 v[84:85], v20 offset:9344
ds_read_b64_tr_b16 v[86:87], v20 offset:11648
s_waitcnt lgkmcnt(15)
v_mfma_f32_16x16x32_bf16 v[116:119], v[44:47], v[176:179], v[116:119]
ds_read_b64_tr_b16 v[88:89], v20 offset:9376
ds_read_b64_tr_b16 v[90:91], v20 offset:11680
v_mfma_f32_16x16x32_bf16 v[152:155], v[44:47], v[180:183], v[152:155]
ds_read_b64_tr_b16 v[92:93], v20 offset:9408
ds_read_b64_tr_b16 v[94:95], v20 offset:11712
v_mfma_f32_16x16x32_bf16 v[120:123], v[48:51], v[176:179], v[120:123]
ds_read_b64_tr_b16 v[96:97], v20 offset:9440
ds_read_b64_tr_b16 v[98:99], v20 offset:11744
v_mfma_f32_16x16x32_bf16 v[156:159], v[48:51], v[180:183], v[156:159]
ds_read_b64_tr_b16 v[100:101], v20 offset:9472
ds_read_b64_tr_b16 v[102:103], v20 offset:11776
v_mfma_f32_16x16x32_bf16 v[124:127], v[52:55], v[176:179], v[124:127]
v_mfma_f32_16x16x32_bf16 v[160:163], v[52:55], v[180:183], v[160:163]
v_mfma_f32_16x16x32_bf16 v[128:131], v[56:59], v[176:179], v[128:131]
v_mfma_f32_16x16x32_bf16 v[164:167], v[56:59], v[180:183], v[164:167]
s_waitcnt lgkmcnt(15)
v_mfma_f32_16x16x32_bf16 v[132:135], v[60:63], v[176:179], v[132:135]
v_mfma_f32_16x16x32_bf16 v[168:171], v[60:63], v[180:183], v[168:171]
v_mfma_f32_16x16x32_bf16 v[136:139], v[64:67], v[176:179], v[136:139]
v_mfma_f32_16x16x32_bf16 v[172:175], v[64:67], v[180:183], v[172:175]
s_barrier
v_mfma_f32_16x16x32_bf16 v[104:107], v[68:71], v[184:187], v[104:107]
ds_read_b128 v[176:179], v25 offset:36864
ds_read_b128 v[180:183], v25 offset:37120
v_mfma_f32_16x16x32_bf16 v[140:143], v[68:71], v[188:191], v[140:143]
ds_read_b64_tr_b16 v[32:33], v20 offset:36864
ds_read_b64_tr_b16 v[34:35], v20 offset:39168
s_waitcnt lgkmcnt(15)
v_mfma_f32_16x16x32_bf16 v[108:111], v[72:75], v[184:187], v[108:111]
ds_read_b64_tr_b16 v[36:37], v20 offset:36896
ds_read_b64_tr_b16 v[38:39], v20 offset:39200
v_mfma_f32_16x16x32_bf16 v[144:147], v[72:75], v[188:191], v[144:147]
ds_read_b64_tr_b16 v[40:41], v20 offset:36928
ds_read_b64_tr_b16 v[42:43], v20 offset:39232
v_mfma_f32_16x16x32_bf16 v[112:115], v[76:79], v[184:187], v[112:115]
ds_read_b64_tr_b16 v[44:45], v20 offset:36960
ds_read_b64_tr_b16 v[46:47], v20 offset:39264
v_mfma_f32_16x16x32_bf16 v[148:151], v[76:79], v[188:191], v[148:151]
ds_read_b64_tr_b16 v[48:49], v20 offset:36992
ds_read_b64_tr_b16 v[50:51], v20 offset:39296
s_waitcnt lgkmcnt(15)
v_mfma_f32_16x16x32_bf16 v[116:119], v[80:83], v[184:187], v[116:119]
ds_read_b64_tr_b16 v[52:53], v20 offset:37024
ds_read_b64_tr_b16 v[54:55], v20 offset:39328
v_mfma_f32_16x16x32_bf16 v[152:155], v[80:83], v[188:191], v[152:155]
ds_read_b64_tr_b16 v[56:57], v20 offset:37056
ds_read_b64_tr_b16 v[58:59], v20 offset:39360
v_mfma_f32_16x16x32_bf16 v[120:123], v[84:87], v[184:187], v[120:123]
ds_read_b64_tr_b16 v[60:61], v20 offset:37088
ds_read_b64_tr_b16 v[62:63], v20 offset:39392
v_mfma_f32_16x16x32_bf16 v[156:159], v[84:87], v[188:191], v[156:159]
ds_read_b64_tr_b16 v[64:65], v20 offset:37120
ds_read_b64_tr_b16 v[66:67], v20 offset:39424
v_mfma_f32_16x16x32_bf16 v[124:127], v[88:91], v[184:187], v[124:127]
v_mfma_f32_16x16x32_bf16 v[160:163], v[88:91], v[188:191], v[160:163]
v_mfma_f32_16x16x32_bf16 v[128:131], v[92:95], v[184:187], v[128:131]
v_mfma_f32_16x16x32_bf16 v[164:167], v[92:95], v[188:191], v[164:167]
s_waitcnt lgkmcnt(15)
v_mfma_f32_16x16x32_bf16 v[132:135], v[96:99], v[184:187], v[132:135]
v_mfma_f32_16x16x32_bf16 v[168:171], v[96:99], v[188:191], v[168:171]
v_mfma_f32_16x16x32_bf16 v[136:139], v[100:103], v[184:187], v[136:139]
v_mfma_f32_16x16x32_bf16 v[172:175], v[100:103], v[188:191], v[172:175]
v_mfma_f32_16x16x32_bf16 v[104:107], v[32:35], v[176:179], v[104:107]
ds_read_b128 v[184:187], v25 offset:38912
ds_read_b128 v[188:191], v25 offset:39168
v_mfma_f32_16x16x32_bf16 v[140:143], v[32:35], v[180:183], v[140:143]
ds_read_b64_tr_b16 v[68:69], v20 offset:46080
ds_read_b64_tr_b16 v[70:71], v20 offset:48384
s_waitcnt lgkmcnt(15)
v_mfma_f32_16x16x32_bf16 v[108:111], v[36:39], v[176:179], v[108:111]
ds_read_b64_tr_b16 v[72:73], v20 offset:46112
ds_read_b64_tr_b16 v[74:75], v20 offset:48416
v_mfma_f32_16x16x32_bf16 v[144:147], v[36:39], v[180:183], v[144:147]
ds_read_b64_tr_b16 v[76:77], v20 offset:46144
ds_read_b64_tr_b16 v[78:79], v20 offset:48448
v_mfma_f32_16x16x32_bf16 v[112:115], v[40:43], v[176:179], v[112:115]
ds_read_b64_tr_b16 v[80:81], v20 offset:46176
ds_read_b64_tr_b16 v[82:83], v20 offset:48480
v_mfma_f32_16x16x32_bf16 v[148:151], v[40:43], v[180:183], v[148:151]
ds_read_b64_tr_b16 v[84:85], v20 offset:46208
ds_read_b64_tr_b16 v[86:87], v20 offset:48512
s_waitcnt lgkmcnt(15)
v_mfma_f32_16x16x32_bf16 v[116:119], v[44:47], v[176:179], v[116:119]
ds_read_b64_tr_b16 v[88:89], v20 offset:46240
ds_read_b64_tr_b16 v[90:91], v20 offset:48544
v_mfma_f32_16x16x32_bf16 v[152:155], v[44:47], v[180:183], v[152:155]
ds_read_b64_tr_b16 v[92:93], v20 offset:46272
ds_read_b64_tr_b16 v[94:95], v20 offset:48576
v_mfma_f32_16x16x32_bf16 v[120:123], v[48:51], v[176:179], v[120:123]
ds_read_b64_tr_b16 v[96:97], v20 offset:46304
ds_read_b64_tr_b16 v[98:99], v20 offset:48608
v_mfma_f32_16x16x32_bf16 v[156:159], v[48:51], v[180:183], v[156:159]
ds_read_b64_tr_b16 v[100:101], v20 offset:46336
ds_read_b64_tr_b16 v[102:103], v20 offset:48640
v_mfma_f32_16x16x32_bf16 v[124:127], v[52:55], v[176:179], v[124:127]
v_mfma_f32_16x16x32_bf16 v[160:163], v[52:55], v[180:183], v[160:163]
v_mfma_f32_16x16x32_bf16 v[128:131], v[56:59], v[176:179], v[128:131]
v_mfma_f32_16x16x32_bf16 v[164:167], v[56:59], v[180:183], v[164:167]
s_waitcnt lgkmcnt(15)
v_mfma_f32_16x16x32_bf16 v[132:135], v[60:63], v[176:179], v[132:135]
v_mfma_f32_16x16x32_bf16 v[168:171], v[60:63], v[180:183], v[168:171]
v_mfma_f32_16x16x32_bf16 v[136:139], v[64:67], v[176:179], v[136:139]
v_mfma_f32_16x16x32_bf16 v[172:175], v[64:67], v[180:183], v[172:175]
s_barrier
v_mfma_f32_16x16x32_bf16 v[104:107], v[68:71], v[184:187], v[104:107]
ds_read_b128 v[176:179], v26 offset:0
ds_read_b128 v[180:183], v26 offset:256
v_mfma_f32_16x16x32_bf16 v[140:143], v[68:71], v[188:191], v[140:143]
ds_read_b64_tr_b16 v[32:33], v21 offset:0
ds_read_b64_tr_b16 v[34:35], v21 offset:2304
s_waitcnt lgkmcnt(15)
v_mfma_f32_16x16x32_bf16 v[108:111], v[72:75], v[184:187], v[108:111]
ds_read_b64_tr_b16 v[36:37], v21 offset:32
ds_read_b64_tr_b16 v[38:39], v21 offset:2336
v_mfma_f32_16x16x32_bf16 v[144:147], v[72:75], v[188:191], v[144:147]
ds_read_b64_tr_b16 v[40:41], v21 offset:64
ds_read_b64_tr_b16 v[42:43], v21 offset:2368
v_mfma_f32_16x16x32_bf16 v[112:115], v[76:79], v[184:187], v[112:115]
ds_read_b64_tr_b16 v[44:45], v21 offset:96
ds_read_b64_tr_b16 v[46:47], v21 offset:2400
v_mfma_f32_16x16x32_bf16 v[148:151], v[76:79], v[188:191], v[148:151]
ds_read_b64_tr_b16 v[48:49], v21 offset:128
ds_read_b64_tr_b16 v[50:51], v21 offset:2432
s_waitcnt lgkmcnt(15)
v_mfma_f32_16x16x32_bf16 v[116:119], v[80:83], v[184:187], v[116:119]
ds_read_b64_tr_b16 v[52:53], v21 offset:160
ds_read_b64_tr_b16 v[54:55], v21 offset:2464
v_mfma_f32_16x16x32_bf16 v[152:155], v[80:83], v[188:191], v[152:155]
ds_read_b64_tr_b16 v[56:57], v21 offset:192
ds_read_b64_tr_b16 v[58:59], v21 offset:2496
v_mfma_f32_16x16x32_bf16 v[120:123], v[84:87], v[184:187], v[120:123]
ds_read_b64_tr_b16 v[60:61], v21 offset:224
ds_read_b64_tr_b16 v[62:63], v21 offset:2528
v_mfma_f32_16x16x32_bf16 v[156:159], v[84:87], v[188:191], v[156:159]
ds_read_b64_tr_b16 v[64:65], v21 offset:256
ds_read_b64_tr_b16 v[66:67], v21 offset:2560
v_mfma_f32_16x16x32_bf16 v[124:127], v[88:91], v[184:187], v[124:127]
v_mfma_f32_16x16x32_bf16 v[160:163], v[88:91], v[188:191], v[160:163]
v_mfma_f32_16x16x32_bf16 v[128:131], v[92:95], v[184:187], v[128:131]
v_mfma_f32_16x16x32_bf16 v[164:167], v[92:95], v[188:191], v[164:167]
s_waitcnt lgkmcnt(15)
v_mfma_f32_16x16x32_bf16 v[132:135], v[96:99], v[184:187], v[132:135]
v_mfma_f32_16x16x32_bf16 v[168:171], v[96:99], v[188:191], v[168:171]
v_mfma_f32_16x16x32_bf16 v[136:139], v[100:103], v[184:187], v[136:139]
v_mfma_f32_16x16x32_bf16 v[172:175], v[100:103], v[188:191], v[172:175]
v_mfma_f32_16x16x32_bf16 v[104:107], v[32:35], v[176:179], v[104:107]
ds_read_b128 v[184:187], v26 offset:2048
ds_read_b128 v[188:191], v26 offset:2304
v_mfma_f32_16x16x32_bf16 v[140:143], v[32:35], v[180:183], v[140:143]
ds_read_b64_tr_b16 v[68:69], v21 offset:9216
ds_read_b64_tr_b16 v[70:71], v21 offset:11520
s_waitcnt lgkmcnt(15)
v_mfma_f32_16x16x32_bf16 v[108:111], v[36:39], v[176:179], v[108:111]
ds_read_b64_tr_b16 v[72:73], v21 offset:9248
ds_read_b64_tr_b16 v[74:75], v21 offset:11552
v_mfma_f32_16x16x32_bf16 v[144:147], v[36:39], v[180:183], v[144:147]
ds_read_b64_tr_b16 v[76:77], v21 offset:9280
ds_read_b64_tr_b16 v[78:79], v21 offset:11584
v_mfma_f32_16x16x32_bf16 v[112:115], v[40:43], v[176:179], v[112:115]
ds_read_b64_tr_b16 v[80:81], v21 offset:9312
ds_read_b64_tr_b16 v[82:83], v21 offset:11616
v_mfma_f32_16x16x32_bf16 v[148:151], v[40:43], v[180:183], v[148:151]
ds_read_b64_tr_b16 v[84:85], v21 offset:9344
ds_read_b64_tr_b16 v[86:87], v21 offset:11648
s_waitcnt lgkmcnt(15)
v_mfma_f32_16x16x32_bf16 v[116:119], v[44:47], v[176:179], v[116:119]
ds_read_b64_tr_b16 v[88:89], v21 offset:9376
ds_read_b64_tr_b16 v[90:91], v21 offset:11680
v_mfma_f32_16x16x32_bf16 v[152:155], v[44:47], v[180:183], v[152:155]
ds_read_b64_tr_b16 v[92:93], v21 offset:9408
ds_read_b64_tr_b16 v[94:95], v21 offset:11712
v_mfma_f32_16x16x32_bf16 v[120:123], v[48:51], v[176:179], v[120:123]
ds_read_b64_tr_b16 v[96:97], v21 offset:9440
ds_read_b64_tr_b16 v[98:99], v21 offset:11744
v_mfma_f32_16x16x32_bf16 v[156:159], v[48:51], v[180:183], v[156:159]
ds_read_b64_tr_b16 v[100:101], v21 offset:9472
ds_read_b64_tr_b16 v[102:103], v21 offset:11776
v_mfma_f32_16x16x32_bf16 v[124:127], v[52:55], v[176:179], v[124:127]
v_mfma_f32_16x16x32_bf16 v[160:163], v[52:55], v[180:183], v[160:163]
v_mfma_f32_16x16x32_bf16 v[128:131], v[56:59], v[176:179], v[128:131]
v_mfma_f32_16x16x32_bf16 v[164:167], v[56:59], v[180:183], v[164:167]
s_waitcnt lgkmcnt(15)
v_mfma_f32_16x16x32_bf16 v[132:135], v[60:63], v[176:179], v[132:135]
v_mfma_f32_16x16x32_bf16 v[168:171], v[60:63], v[180:183], v[168:171]
v_mfma_f32_16x16x32_bf16 v[136:139], v[64:67], v[176:179], v[136:139]
v_mfma_f32_16x16x32_bf16 v[172:175], v[64:67], v[180:183], v[172:175]
s_barrier
v_mfma_f32_16x16x32_bf16 v[104:107], v[68:71], v[184:187], v[104:107]
ds_read_b128 v[176:179], v26 offset:36864
ds_read_b128 v[180:183], v26 offset:37120
v_mfma_f32_16x16x32_bf16 v[140:143], v[68:71], v[188:191], v[140:143]
ds_read_b64_tr_b16 v[32:33], v21 offset:36864
ds_read_b64_tr_b16 v[34:35], v21 offset:39168
s_waitcnt lgkmcnt(15)
v_mfma_f32_16x16x32_bf16 v[108:111], v[72:75], v[184:187], v[108:111]
ds_read_b64_tr_b16 v[36:37], v21 offset:36896
ds_read_b64_tr_b16 v[38:39], v21 offset:39200
v_mfma_f32_16x16x32_bf16 v[144:147], v[72:75], v[188:191], v[144:147]
ds_read_b64_tr_b16 v[40:41], v21 offset:36928
ds_read_b64_tr_b16 v[42:43], v21 offset:39232
v_mfma_f32_16x16x32_bf16 v[112:115], v[76:79], v[184:187], v[112:115]
ds_read_b64_tr_b16 v[44:45], v21 offset:36960
ds_read_b64_tr_b16 v[46:47], v21 offset:39264
v_mfma_f32_16x16x32_bf16 v[148:151], v[76:79], v[188:191], v[148:151]
ds_read_b64_tr_b16 v[48:49], v21 offset:36992
ds_read_b64_tr_b16 v[50:51], v21 offset:39296
s_waitcnt lgkmcnt(15)
v_mfma_f32_16x16x32_bf16 v[116:119], v[80:83], v[184:187], v[116:119]
ds_read_b64_tr_b16 v[52:53], v21 offset:37024
ds_read_b64_tr_b16 v[54:55], v21 offset:39328
v_mfma_f32_16x16x32_bf16 v[152:155], v[80:83], v[188:191], v[152:155]
ds_read_b64_tr_b16 v[56:57], v21 offset:37056
ds_read_b64_tr_b16 v[58:59], v21 offset:39360
v_mfma_f32_16x16x32_bf16 v[120:123], v[84:87], v[184:187], v[120:123]
ds_read_b64_tr_b16 v[60:61], v21 offset:37088
ds_read_b64_tr_b16 v[62:63], v21 offset:39392
v_mfma_f32_16x16x32_bf16 v[156:159], v[84:87], v[188:191], v[156:159]
ds_read_b64_tr_b16 v[64:65], v21 offset:37120
ds_read_b64_tr_b16 v[66:67], v21 offset:39424
v_mfma_f32_16x16x32_bf16 v[124:127], v[88:91], v[184:187], v[124:127]
v_mfma_f32_16x16x32_bf16 v[160:163], v[88:91], v[188:191], v[160:163]
v_mfma_f32_16x16x32_bf16 v[128:131], v[92:95], v[184:187], v[128:131]
v_mfma_f32_16x16x32_bf16 v[164:167], v[92:95], v[188:191], v[164:167]
s_waitcnt lgkmcnt(15)
v_mfma_f32_16x16x32_bf16 v[132:135], v[96:99], v[184:187], v[132:135]
v_mfma_f32_16x16x32_bf16 v[168:171], v[96:99], v[188:191], v[168:171]
v_mfma_f32_16x16x32_bf16 v[136:139], v[100:103], v[184:187], v[136:139]
v_mfma_f32_16x16x32_bf16 v[172:175], v[100:103], v[188:191], v[172:175]
v_mfma_f32_16x16x32_bf16 v[104:107], v[32:35], v[176:179], v[104:107]
ds_read_b128 v[184:187], v26 offset:38912
ds_read_b128 v[188:191], v26 offset:39168
v_mfma_f32_16x16x32_bf16 v[140:143], v[32:35], v[180:183], v[140:143]
ds_read_b64_tr_b16 v[68:69], v21 offset:46080
ds_read_b64_tr_b16 v[70:71], v21 offset:48384
s_waitcnt lgkmcnt(15)
v_mfma_f32_16x16x32_bf16 v[108:111], v[36:39], v[176:179], v[108:111]
ds_read_b64_tr_b16 v[72:73], v21 offset:46112
ds_read_b64_tr_b16 v[74:75], v21 offset:48416
v_mfma_f32_16x16x32_bf16 v[144:147], v[36:39], v[180:183], v[144:147]
ds_read_b64_tr_b16 v[76:77], v21 offset:46144
ds_read_b64_tr_b16 v[78:79], v21 offset:48448
v_mfma_f32_16x16x32_bf16 v[112:115], v[40:43], v[176:179], v[112:115]
ds_read_b64_tr_b16 v[80:81], v21 offset:46176
ds_read_b64_tr_b16 v[82:83], v21 offset:48480
v_mfma_f32_16x16x32_bf16 v[148:151], v[40:43], v[180:183], v[148:151]
ds_read_b64_tr_b16 v[84:85], v21 offset:46208
ds_read_b64_tr_b16 v[86:87], v21 offset:48512
s_waitcnt lgkmcnt(15)
v_mfma_f32_16x16x32_bf16 v[116:119], v[44:47], v[176:179], v[116:119]
ds_read_b64_tr_b16 v[88:89], v21 offset:46240
ds_read_b64_tr_b16 v[90:91], v21 offset:48544
v_mfma_f32_16x16x32_bf16 v[152:155], v[44:47], v[180:183], v[152:155]
ds_read_b64_tr_b16 v[92:93], v21 offset:46272
ds_read_b64_tr_b16 v[94:95], v21 offset:48576
v_mfma_f32_16x16x32_bf16 v[120:123], v[48:51], v[176:179], v[120:123]
ds_read_b64_tr_b16 v[96:97], v21 offset:46304
ds_read_b64_tr_b16 v[98:99], v21 offset:48608
v_mfma_f32_16x16x32_bf16 v[156:159], v[48:51], v[180:183], v[156:159]
ds_read_b64_tr_b16 v[100:101], v21 offset:46336
ds_read_b64_tr_b16 v[102:103], v21 offset:48640
v_mfma_f32_16x16x32_bf16 v[124:127], v[52:55], v[176:179], v[124:127]
v_mfma_f32_16x16x32_bf16 v[160:163], v[52:55], v[180:183], v[160:163]
v_mfma_f32_16x16x32_bf16 v[128:131], v[56:59], v[176:179], v[128:131]
v_mfma_f32_16x16x32_bf16 v[164:167], v[56:59], v[180:183], v[164:167]
s_waitcnt lgkmcnt(15)
v_mfma_f32_16x16x32_bf16 v[132:135], v[60:63], v[176:179], v[132:135]
v_mfma_f32_16x16x32_bf16 v[168:171], v[60:63], v[180:183], v[168:171]
v_mfma_f32_16x16x32_bf16 v[136:139], v[64:67], v[176:179], v[136:139]
v_mfma_f32_16x16x32_bf16 v[172:175], v[64:67], v[180:183], v[172:175]
s_barrier
v_mfma_f32_16x16x32_bf16 v[104:107], v[68:71], v[184:187], v[104:107]
ds_read_b128 v[176:179], v25 offset:0
ds_read_b128 v[180:183], v25 offset:256
v_mfma_f32_16x16x32_bf16 v[140:143], v[68:71], v[188:191], v[140:143]
ds_read_b64_tr_b16 v[32:33], v20 offset:0
ds_read_b64_tr_b16 v[34:35], v20 offset:2304
s_waitcnt lgkmcnt(15)
v_mfma_f32_16x16x32_bf16 v[108:111], v[72:75], v[184:187], v[108:111]
ds_read_b64_tr_b16 v[36:37], v20 offset:32
ds_read_b64_tr_b16 v[38:39], v20 offset:2336
v_mfma_f32_16x16x32_bf16 v[144:147], v[72:75], v[188:191], v[144:147]
ds_read_b64_tr_b16 v[40:41], v20 offset:64
ds_read_b64_tr_b16 v[42:43], v20 offset:2368
v_mfma_f32_16x16x32_bf16 v[112:115], v[76:79], v[184:187], v[112:115]
ds_read_b64_tr_b16 v[44:45], v20 offset:96
ds_read_b64_tr_b16 v[46:47], v20 offset:2400
v_mfma_f32_16x16x32_bf16 v[148:151], v[76:79], v[188:191], v[148:151]
ds_read_b64_tr_b16 v[48:49], v20 offset:128
ds_read_b64_tr_b16 v[50:51], v20 offset:2432
s_waitcnt lgkmcnt(15)
v_mfma_f32_16x16x32_bf16 v[116:119], v[80:83], v[184:187], v[116:119]
ds_read_b64_tr_b16 v[52:53], v20 offset:160
ds_read_b64_tr_b16 v[54:55], v20 offset:2464
v_mfma_f32_16x16x32_bf16 v[152:155], v[80:83], v[188:191], v[152:155]
ds_read_b64_tr_b16 v[56:57], v20 offset:192
ds_read_b64_tr_b16 v[58:59], v20 offset:2496
v_mfma_f32_16x16x32_bf16 v[120:123], v[84:87], v[184:187], v[120:123]
ds_read_b64_tr_b16 v[60:61], v20 offset:224
ds_read_b64_tr_b16 v[62:63], v20 offset:2528
v_mfma_f32_16x16x32_bf16 v[156:159], v[84:87], v[188:191], v[156:159]
ds_read_b64_tr_b16 v[64:65], v20 offset:256
ds_read_b64_tr_b16 v[66:67], v20 offset:2560
v_mfma_f32_16x16x32_bf16 v[124:127], v[88:91], v[184:187], v[124:127]
v_mfma_f32_16x16x32_bf16 v[160:163], v[88:91], v[188:191], v[160:163]
v_mfma_f32_16x16x32_bf16 v[128:131], v[92:95], v[184:187], v[128:131]
v_mfma_f32_16x16x32_bf16 v[164:167], v[92:95], v[188:191], v[164:167]
s_waitcnt lgkmcnt(15)
v_mfma_f32_16x16x32_bf16 v[132:135], v[96:99], v[184:187], v[132:135]
v_mfma_f32_16x16x32_bf16 v[168:171], v[96:99], v[188:191], v[168:171]
v_mfma_f32_16x16x32_bf16 v[136:139], v[100:103], v[184:187], v[136:139]
v_mfma_f32_16x16x32_bf16 v[172:175], v[100:103], v[188:191], v[172:175]
v_mfma_f32_16x16x32_bf16 v[104:107], v[32:35], v[176:179], v[104:107]
ds_read_b128 v[184:187], v25 offset:2048
ds_read_b128 v[188:191], v25 offset:2304
v_mfma_f32_16x16x32_bf16 v[140:143], v[32:35], v[180:183], v[140:143]
ds_read_b64_tr_b16 v[68:69], v20 offset:9216
ds_read_b64_tr_b16 v[70:71], v20 offset:11520
s_waitcnt lgkmcnt(15)
v_mfma_f32_16x16x32_bf16 v[108:111], v[36:39], v[176:179], v[108:111]
ds_read_b64_tr_b16 v[72:73], v20 offset:9248
ds_read_b64_tr_b16 v[74:75], v20 offset:11552
v_mfma_f32_16x16x32_bf16 v[144:147], v[36:39], v[180:183], v[144:147]
ds_read_b64_tr_b16 v[76:77], v20 offset:9280
ds_read_b64_tr_b16 v[78:79], v20 offset:11584
v_mfma_f32_16x16x32_bf16 v[112:115], v[40:43], v[176:179], v[112:115]
ds_read_b64_tr_b16 v[80:81], v20 offset:9312
ds_read_b64_tr_b16 v[82:83], v20 offset:11616
v_mfma_f32_16x16x32_bf16 v[148:151], v[40:43], v[180:183], v[148:151]
ds_read_b64_tr_b16 v[84:85], v20 offset:9344
ds_read_b64_tr_b16 v[86:87], v20 offset:11648
s_waitcnt lgkmcnt(15)
v_mfma_f32_16x16x32_bf16 v[116:119], v[44:47], v[176:179], v[116:119]
ds_read_b64_tr_b16 v[88:89], v20 offset:9376
ds_read_b64_tr_b16 v[90:91], v20 offset:11680
v_mfma_f32_16x16x32_bf16 v[152:155], v[44:47], v[180:183], v[152:155]
ds_read_b64_tr_b16 v[92:93], v20 offset:9408
ds_read_b64_tr_b16 v[94:95], v20 offset:11712
v_mfma_f32_16x16x32_bf16 v[120:123], v[48:51], v[176:179], v[120:123]
ds_read_b64_tr_b16 v[96:97], v20 offset:9440
ds_read_b64_tr_b16 v[98:99], v20 offset:11744
v_mfma_f32_16x16x32_bf16 v[156:159], v[48:51], v[180:183], v[156:159]
ds_read_b64_tr_b16 v[100:101], v20 offset:9472
ds_read_b64_tr_b16 v[102:103], v20 offset:11776
v_mfma_f32_16x16x32_bf16 v[124:127], v[52:55], v[176:179], v[124:127]
v_mfma_f32_16x16x32_bf16 v[160:163], v[52:55], v[180:183], v[160:163]
v_mfma_f32_16x16x32_bf16 v[128:131], v[56:59], v[176:179], v[128:131]
v_mfma_f32_16x16x32_bf16 v[164:167], v[56:59], v[180:183], v[164:167]
s_waitcnt lgkmcnt(15)
v_mfma_f32_16x16x32_bf16 v[132:135], v[60:63], v[176:179], v[132:135]
v_mfma_f32_16x16x32_bf16 v[168:171], v[60:63], v[180:183], v[168:171]
v_mfma_f32_16x16x32_bf16 v[136:139], v[64:67], v[176:179], v[136:139]
v_mfma_f32_16x16x32_bf16 v[172:175], v[64:67], v[180:183], v[172:175]
s_barrier
v_mfma_f32_16x16x32_bf16 v[104:107], v[68:71], v[184:187], v[104:107]
ds_read_b128 v[176:179], v25 offset:36864
ds_read_b128 v[180:183], v25 offset:37120
v_mfma_f32_16x16x32_bf16 v[140:143], v[68:71], v[188:191], v[140:143]
ds_read_b64_tr_b16 v[32:33], v20 offset:36864
ds_read_b64_tr_b16 v[34:35], v20 offset:39168
s_waitcnt lgkmcnt(15)
v_mfma_f32_16x16x32_bf16 v[108:111], v[72:75], v[184:187], v[108:111]
ds_read_b64_tr_b16 v[36:37], v20 offset:36896
ds_read_b64_tr_b16 v[38:39], v20 offset:39200
v_mfma_f32_16x16x32_bf16 v[144:147], v[72:75], v[188:191], v[144:147]
ds_read_b64_tr_b16 v[40:41], v20 offset:36928
ds_read_b64_tr_b16 v[42:43], v20 offset:39232
v_mfma_f32_16x16x32_bf16 v[112:115], v[76:79], v[184:187], v[112:115]
ds_read_b64_tr_b16 v[44:45], v20 offset:36960
ds_read_b64_tr_b16 v[46:47], v20 offset:39264
v_mfma_f32_16x16x32_bf16 v[148:151], v[76:79], v[188:191], v[148:151]
ds_read_b64_tr_b16 v[48:49], v20 offset:36992
ds_read_b64_tr_b16 v[50:51], v20 offset:39296
s_waitcnt lgkmcnt(15)
v_mfma_f32_16x16x32_bf16 v[116:119], v[80:83], v[184:187], v[116:119]
ds_read_b64_tr_b16 v[52:53], v20 offset:37024
ds_read_b64_tr_b16 v[54:55], v20 offset:39328
v_mfma_f32_16x16x32_bf16 v[152:155], v[80:83], v[188:191], v[152:155]
ds_read_b64_tr_b16 v[56:57], v20 offset:37056
ds_read_b64_tr_b16 v[58:59], v20 offset:39360
v_mfma_f32_16x16x32_bf16 v[120:123], v[84:87], v[184:187], v[120:123]
ds_read_b64_tr_b16 v[60:61], v20 offset:37088
ds_read_b64_tr_b16 v[62:63], v20 offset:39392
v_mfma_f32_16x16x32_bf16 v[156:159], v[84:87], v[188:191], v[156:159]
ds_read_b64_tr_b16 v[64:65], v20 offset:37120
ds_read_b64_tr_b16 v[66:67], v20 offset:39424
v_mfma_f32_16x16x32_bf16 v[124:127], v[88:91], v[184:187], v[124:127]
v_mfma_f32_16x16x32_bf16 v[160:163], v[88:91], v[188:191], v[160:163]
v_mfma_f32_16x16x32_bf16 v[128:131], v[92:95], v[184:187], v[128:131]
v_mfma_f32_16x16x32_bf16 v[164:167], v[92:95], v[188:191], v[164:167]
s_waitcnt lgkmcnt(15)
v_mfma_f32_16x16x32_bf16 v[132:135], v[96:99], v[184:187], v[132:135]
v_mfma_f32_16x16x32_bf16 v[168:171], v[96:99], v[188:191], v[168:171]
v_mfma_f32_16x16x32_bf16 v[136:139], v[100:103], v[184:187], v[136:139]
v_mfma_f32_16x16x32_bf16 v[172:175], v[100:103], v[188:191], v[172:175]
v_mfma_f32_16x16x32_bf16 v[104:107], v[32:35], v[176:179], v[104:107]
ds_read_b128 v[184:187], v25 offset:38912
ds_read_b128 v[188:191], v25 offset:39168
v_mfma_f32_16x16x32_bf16 v[140:143], v[32:35], v[180:183], v[140:143]
ds_read_b64_tr_b16 v[68:69], v20 offset:46080
ds_read_b64_tr_b16 v[70:71], v20 offset:48384
s_waitcnt lgkmcnt(15)
v_mfma_f32_16x16x32_bf16 v[108:111], v[36:39], v[176:179], v[108:111]
ds_read_b64_tr_b16 v[72:73], v20 offset:46112
ds_read_b64_tr_b16 v[74:75], v20 offset:48416
v_mfma_f32_16x16x32_bf16 v[144:147], v[36:39], v[180:183], v[144:147]
ds_read_b64_tr_b16 v[76:77], v20 offset:46144
ds_read_b64_tr_b16 v[78:79], v20 offset:48448
v_mfma_f32_16x16x32_bf16 v[112:115], v[40:43], v[176:179], v[112:115]
ds_read_b64_tr_b16 v[80:81], v20 offset:46176
ds_read_b64_tr_b16 v[82:83], v20 offset:48480
v_mfma_f32_16x16x32_bf16 v[148:151], v[40:43], v[180:183], v[148:151]
ds_read_b64_tr_b16 v[84:85], v20 offset:46208
ds_read_b64_tr_b16 v[86:87], v20 offset:48512
s_waitcnt lgkmcnt(15)
v_mfma_f32_16x16x32_bf16 v[116:119], v[44:47], v[176:179], v[116:119]
ds_read_b64_tr_b16 v[88:89], v20 offset:46240
ds_read_b64_tr_b16 v[90:91], v20 offset:48544
v_mfma_f32_16x16x32_bf16 v[152:155], v[44:47], v[180:183], v[152:155]
ds_read_b64_tr_b16 v[92:93], v20 offset:46272
ds_read_b64_tr_b16 v[94:95], v20 offset:48576
v_mfma_f32_16x16x32_bf16 v[120:123], v[48:51], v[176:179], v[120:123]
ds_read_b64_tr_b16 v[96:97], v20 offset:46304
ds_read_b64_tr_b16 v[98:99], v20 offset:48608
v_mfma_f32_16x16x32_bf16 v[156:159], v[48:51], v[180:183], v[156:159]
ds_read_b64_tr_b16 v[100:101], v20 offset:46336
ds_read_b64_tr_b16 v[102:103], v20 offset:48640
v_mfma_f32_16x16x32_bf16 v[124:127], v[52:55], v[176:179], v[124:127]
v_mfma_f32_16x16x32_bf16 v[160:163], v[52:55], v[180:183], v[160:163]
v_mfma_f32_16x16x32_bf16 v[128:131], v[56:59], v[176:179], v[128:131]
v_mfma_f32_16x16x32_bf16 v[164:167], v[56:59], v[180:183], v[164:167]
s_waitcnt lgkmcnt(15)
v_mfma_f32_16x16x32_bf16 v[132:135], v[60:63], v[176:179], v[132:135]
v_mfma_f32_16x16x32_bf16 v[168:171], v[60:63], v[180:183], v[168:171]
v_mfma_f32_16x16x32_bf16 v[136:139], v[64:67], v[176:179], v[136:139]
v_mfma_f32_16x16x32_bf16 v[172:175], v[64:67], v[180:183], v[172:175]
v_mfma_f32_16x16x32_bf16 v[104:107], v[68:71], v[184:187], v[104:107]
v_mfma_f32_16x16x32_bf16 v[140:143], v[68:71], v[188:191], v[140:143]
s_waitcnt lgkmcnt(14)
v_mfma_f32_16x16x32_bf16 v[108:111], v[72:75], v[184:187], v[108:111]
v_mfma_f32_16x16x32_bf16 v[144:147], v[72:75], v[188:191], v[144:147]
s_waitcnt lgkmcnt(12)
v_mfma_f32_16x16x32_bf16 v[112:115], v[76:79], v[184:187], v[112:115]
v_mfma_f32_16x16x32_bf16 v[148:151], v[76:79], v[188:191], v[148:151]
s_waitcnt lgkmcnt(10)
v_mfma_f32_16x16x32_bf16 v[116:119], v[80:83], v[184:187], v[116:119]
v_mfma_f32_16x16x32_bf16 v[152:155], v[80:83], v[188:191], v[152:155]
s_waitcnt lgkmcnt(8)
v_mfma_f32_16x16x32_bf16 v[120:123], v[84:87], v[184:187], v[120:123]
v_mfma_f32_16x16x32_bf16 v[156:159], v[84:87], v[188:191], v[156:159]
s_waitcnt lgkmcnt(6)
v_mfma_f32_16x16x32_bf16 v[124:127], v[88:91], v[184:187], v[124:127]
v_mfma_f32_16x16x32_bf16 v[160:163], v[88:91], v[188:191], v[160:163]
s_waitcnt lgkmcnt(4)
v_mfma_f32_16x16x32_bf16 v[128:131], v[92:95], v[184:187], v[128:131]
v_mfma_f32_16x16x32_bf16 v[164:167], v[92:95], v[188:191], v[164:167]
s_waitcnt lgkmcnt(2)
v_mfma_f32_16x16x32_bf16 v[132:135], v[96:99], v[184:187], v[132:135]
v_mfma_f32_16x16x32_bf16 v[168:171], v[96:99], v[188:191], v[168:171]
s_waitcnt lgkmcnt(0)
v_mfma_f32_16x16x32_bf16 v[136:139], v[100:103], v[184:187], v[136:139]
v_mfma_f32_16x16x32_bf16 v[172:175], v[100:103], v[188:191], v[172:175]
v_lshrrev_b32 v24, 5, v2
v_lshlrev_b32 v24, 9, v24
v_and_b32 v26, 31, v2
v_lshl_add_u32 v24, v26, 4, v24
v_cvt_pk_bf16_f32 v32, v104, v105
v_cvt_pk_bf16_f32 v33, v106, v107
v_cvt_pk_bf16_f32 v34, v140, v141
v_cvt_pk_bf16_f32 v35, v142, v143
v_cvt_pk_bf16_f32 v36, v108, v109
v_cvt_pk_bf16_f32 v37, v110, v111
v_cvt_pk_bf16_f32 v38, v144, v145
v_cvt_pk_bf16_f32 v39, v146, v147
s_add_u32 s36, s33, 0
v_permlane16_swap_b32 v32, v34
v_permlane16_swap_b32 v33, v35
buffer_store_dwordx4 v[32:35], v24, s[12:15], s36 offen offset:0 sc1
v_cvt_pk_bf16_f32 v40, v112, v113
v_cvt_pk_bf16_f32 v41, v114, v115
v_cvt_pk_bf16_f32 v42, v148, v149
v_cvt_pk_bf16_f32 v43, v150, v151
v_permlane16_swap_b32 v36, v38
v_permlane16_swap_b32 v37, v39
buffer_store_dwordx4 v[36:39], v24, s[12:15], s36 offen offset:1024 sc1
v_cvt_pk_bf16_f32 v44, v116, v117
v_cvt_pk_bf16_f32 v45, v118, v119
v_cvt_pk_bf16_f32 v46, v152, v153
v_cvt_pk_bf16_f32 v47, v154, v155
v_permlane16_swap_b32 v40, v42
v_permlane16_swap_b32 v41, v43
buffer_store_dwordx4 v[40:43], v24, s[12:15], s36 offen offset:2048 sc1
v_cvt_pk_bf16_f32 v48, v120, v121
v_cvt_pk_bf16_f32 v49, v122, v123
v_cvt_pk_bf16_f32 v50, v156, v157
v_cvt_pk_bf16_f32 v51, v158, v159
v_permlane16_swap_b32 v44, v46
v_permlane16_swap_b32 v45, v47
buffer_store_dwordx4 v[44:47], v24, s[12:15], s36 offen offset:3072 sc1
v_cvt_pk_bf16_f32 v52, v124, v125
v_cvt_pk_bf16_f32 v53, v126, v127
v_cvt_pk_bf16_f32 v54, v160, v161
v_cvt_pk_bf16_f32 v55, v162, v163
s_add_u32 s36, s33, 4096
v_permlane16_swap_b32 v48, v50
v_permlane16_swap_b32 v49, v51
buffer_store_dwordx4 v[48:51], v24, s[12:15], s36 offen offset:0 sc1
v_cvt_pk_bf16_f32 v56, v128, v129
v_cvt_pk_bf16_f32 v57, v130, v131
v_cvt_pk_bf16_f32 v58, v164, v165
v_cvt_pk_bf16_f32 v59, v166, v167
v_permlane16_swap_b32 v52, v54
v_permlane16_swap_b32 v53, v55
buffer_store_dwordx4 v[52:55], v24, s[12:15], s36 offen offset:1024 sc1
v_cvt_pk_bf16_f32 v60, v132, v133
v_cvt_pk_bf16_f32 v61, v134, v135
v_cvt_pk_bf16_f32 v62, v168, v169
v_cvt_pk_bf16_f32 v63, v170, v171
v_permlane16_swap_b32 v56, v58
v_permlane16_swap_b32 v57, v59
buffer_store_dwordx4 v[56:59], v24, s[12:15], s36 offen offset:2048 sc1
v_cvt_pk_bf16_f32 v64, v136, v137
v_cvt_pk_bf16_f32 v65, v138, v139
v_cvt_pk_bf16_f32 v66, v172, v173
v_cvt_pk_bf16_f32 v67, v174, v175
v_permlane16_swap_b32 v60, v62
v_permlane16_swap_b32 v61, v63
buffer_store_dwordx4 v[60:63], v24, s[12:15], s36 offen offset:3072 sc1
s_add_u32 s36, s33, 8192
v_permlane16_swap_b32 v64, v66
v_permlane16_swap_b32 v65, v67
buffer_store_dwordx4 v[64:67], v24, s[12:15], s36 offen offset:0 sc1
s_waitcnt vmcnt(0)
L_k4_kernel_end:
s_endpgm
.globl r2_kernel
.p2align 8
.type r2_kernel,@function
r2_kernel:
s_cmp_ge_u32 s2, 256
s_cbranch_scc1 L_r2_kernel_end
s_load_dwordx2 s[4:5], s[0:1], 0
s_mov_b32 s6, 0x240000
s_mov_b32 s7, 0x00020000
s_load_dwordx2 s[12:13], s[0:1], 104
s_mov_b32 s14, 0x10000000
s_mov_b32 s15, 0x00020000
s_load_dwordx2 s[8:9], s[0:1], 88
s_mov_b32 s10, 0x240000
s_mov_b32 s11, 0x00020000
v_lshrrev_b32 v1, 3, v0
v_and_b32 v2, 7, v0
s_lshl_b32 s16, s2, 3
v_add_u32 v3, s16, v2
v_mul_u32_u24 v4, 1152, v3
v_lshl_add_u32 v4, v1, 4, v4
s_lshr_b32 s17, s2, 2
s_mul_i32 s17, s17, 72*512
v_and_b32 v5, 31, v3
v_lshlrev_b32 v5, 4, v5
v_lshl_add_u32 v5, v1, 9, v5
v_add_u32 v5, s17, v5
v_lshlrev_b32 v6, 5, v1
s_waitcnt lgkmcnt(0)
s_mov_b32 s19, 2621440
buffer_load_dwordx4 v[8:11], v5, s[12:15], s19 offen
s_mov_b32 s20, 8388608
buffer_load_dwordx4 v[12:15], v5, s[12:15], s20 offen
s_mov_b32 s20, 10747904
buffer_load_dwordx4 v[16:19], v5, s[12:15], s20 offen
s_mov_b32 s20, 13107200
buffer_load_dwordx4 v[20:23], v5, s[12:15], s20 offen
s_mov_b32 s20, 15466496
buffer_load_dwordx4 v[24:27], v5, s[12:15], s20 offen
s_movk_i32 s18, 11520
buffer_load_dwordx4 v[32:35], v6, s[12:15], s18 offen
buffer_load_dwordx4 v[36:39], v6, s[12:15], s18 offen offset:16
s_waitcnt vmcnt(6)
v_lshlrev_b32 v56, 16, v8
v_and_b32 v57, 0xffff0000, v8
v_lshlrev_b32 v58, 16, v9
v_and_b32 v59, 0xffff0000, v9
v_lshlrev_b32 v60, 16, v10
v_and_b32 v61, 0xffff0000, v10
v_lshlrev_b32 v62, 16, v11
v_and_b32 v63, 0xffff0000, v11
s_waitcnt vmcnt(5)
v_lshlrev_b32 v64, 16, v12
v_and_b32 v65, 0xffff0000, v12
v_lshlrev_b32 v66, 16, v13
v_and_b32 v67, 0xffff0000, v13
v_lshlrev_b32 v68, 16, v14
v_and_b32 v69, 0xffff0000, v14
v_lshlrev_b32 v70, 16, v15
v_and_b32 v71, 0xffff0000, v15
s_waitcnt vmcnt(4)
v_lshlrev_b32 v72, 16, v16
v_and_b32 v73, 0xffff0000, v16
v_lshlrev_b32 v74, 16, v17
v_and_b32 v75, 0xffff0000, v17
v_lshlrev_b32 v76, 16, v18
v_and_b32 v77, 0xffff0000, v18
v_lshlrev_b32 v78, 16, v19
v_and_b32 v79, 0xffff0000, v19
v_add_f32 v64, v64, v72
v_add_f32 v65, v65, v73
v_add_f32 v66, v66, v74
v_add_f32 v67, v67, v75
v_add_f32 v68, v68, v76
v_add_f32 v69, v69, v77
v_add_f32 v70, v70, v78
v_add_f32 v71, v71, v79
s_waitcnt vmcnt(3)
v_lshlrev_b32 v72, 16, v20
v_and_b32 v73, 0xffff0000, v20
v_lshlrev_b32 v74, 16, v21
v_and_b32 v75, 0xffff0000, v21
v_lshlrev_b32 v76, 16, v22
v_and_b32 v77, 0xffff0000, v22
v_lshlrev_b32 v78, 16, v23
v_and_b32 v79, 0xffff0000, v23
v_add_f32 v64, v64, v72
v_add_f32 v65, v65, v73
v_add_f32 v66, v66, v74
v_add_f32 v67, v67, v75
v_add_f32 v68, v68, v76
v_add_f32 v69, v69, v77
v_add_f32 v70, v70, v78
v_add_f32 v71, v71, v79
s_waitcnt vmcnt(2)
v_lshlrev_b32 v72, 16, v24
v_and_b32 v73, 0xffff0000, v24
v_lshlrev_b32 v74, 16, v25
v_and_b32 v75, 0xffff0000, v25
v_lshlrev_b32 v76, 16, v26
v_and_b32 v77, 0xffff0000, v26
v_lshlrev_b32 v78, 16, v27
v_and_b32 v79, 0xffff0000, v27
v_add_f32 v64, v64, v72
v_add_f32 v65, v65, v73
v_add_f32 v66, v66, v74
v_add_f32 v67, v67, v75
v_add_f32 v68, v68, v76
v_add_f32 v69, v69, v77
v_add_f32 v70, v70, v78
v_add_f32 v71, v71, v79
s_waitcnt vmcnt(0)
v_fmac_f32 v56, v64, v32
v_fmac_f32 v57, v65, v33
v_fmac_f32 v58, v66, v34
v_fmac_f32 v59, v67, v35
v_fmac_f32 v60, v68, v36
v_fmac_f32 v61, v69, v37
v_fmac_f32 v62, v70, v38
v_fmac_f32 v63, v71, v39
v_cvt_pk_bf16_f32 v8, v56, v57
v_cvt_pk_bf16_f32 v9, v58, v59
v_cvt_pk_bf16_f32 v10, v60, v61
v_cvt_pk_bf16_f32 v11, v62, v63
buffer_store_dwordx4 v[8:11], v4, s[8:11], 0 offen sc1
s_waitcnt vmcnt(0)
L_r2_kernel_end:
s_endpgm
.section .rodata,"a"
.p2align 6
.amdhsa_kernel k0a_kernel
  .amdhsa_next_free_vgpr 128
  .amdhsa_next_free_sgpr 102
  .amdhsa_accum_offset 128
  .amdhsa_group_segment_fixed_size 0
  .amdhsa_kernarg_size 112
  .amdhsa_user_sgpr_count 2
  .amdhsa_user_sgpr_kernarg_segment_ptr 1
  .amdhsa_system_sgpr_workgroup_id_x 1
.end_amdhsa_kernel
.p2align 6
.amdhsa_kernel k0b_kernel
  .amdhsa_next_free_vgpr 128
  .amdhsa_next_free_sgpr 102
  .amdhsa_accum_offset 128
  .amdhsa_group_segment_fixed_size 0
  .amdhsa_kernarg_size 112
  .amdhsa_user_sgpr_count 2
  .amdhsa_user_sgpr_kernarg_segment_ptr 1
  .amdhsa_system_sgpr_workgroup_id_x 1
.end_amdhsa_kernel
.p2align 6
.amdhsa_kernel k1_kernel
  .amdhsa_next_free_vgpr 256
  .amdhsa_next_free_sgpr 102
  .amdhsa_accum_offset 256
  .amdhsa_group_segment_fixed_size 0
  .amdhsa_kernarg_size 112
  .amdhsa_user_sgpr_count 2
  .amdhsa_user_sgpr_kernarg_segment_ptr 1
  .amdhsa_system_sgpr_workgroup_id_x 1
.end_amdhsa_kernel
.p2align 6
.amdhsa_kernel k2_kernel
  .amdhsa_next_free_vgpr 256
  .amdhsa_next_free_sgpr 102
  .amdhsa_accum_offset 256
  .amdhsa_group_segment_fixed_size 0
  .amdhsa_kernarg_size 112
  .amdhsa_user_sgpr_count 2
  .amdhsa_user_sgpr_kernarg_segment_ptr 1
  .amdhsa_system_sgpr_workgroup_id_x 1
.end_amdhsa_kernel
.p2align 6
.amdhsa_kernel r1_kernel
  .amdhsa_next_free_vgpr 128
  .amdhsa_next_free_sgpr 102
  .amdhsa_accum_offset 128
  .amdhsa_group_segment_fixed_size 0
  .amdhsa_kernarg_size 112
  .amdhsa_user_sgpr_count 2
  .amdhsa_user_sgpr_kernarg_segment_ptr 1
  .amdhsa_system_sgpr_workgroup_id_x 1
.end_amdhsa_kernel
.p2align 6
.amdhsa_kernel k3_kernel
  .amdhsa_next_free_vgpr 256
  .amdhsa_next_free_sgpr 102
  .amdhsa_accum_offset 256
  .amdhsa_group_segment_fixed_size 0
  .amdhsa_kernarg_size 112
  .amdhsa_user_sgpr_count 2
  .amdhsa_user_sgpr_kernarg_segment_ptr 1
  .amdhsa_system_sgpr_workgroup_id_x 1
.end_amdhsa_kernel
.p2align 6
.amdhsa_kernel k4_kernel
  .amdhsa_next_free_vgpr 256
  .amdhsa_next_free_sgpr 102
  .amdhsa_accum_offset 256
  .amdhsa_group_segment_fixed_size 0
  .amdhsa_kernarg_size 112
  .amdhsa_user_sgpr_count 2
  .amdhsa_user_sgpr_kernarg_segment_ptr 1
  .amdhsa_system_sgpr_workgroup_id_x 1
.end_amdhsa_kernel
.p2align 6
.amdhsa_kernel r2_kernel
  .amdhsa_next_free_vgpr 128
  .amdhsa_next_free_sgpr 102
  .amdhsa_accum_offset 128
  .amdhsa_group_segment_fixed_size 0
  .amdhsa_kernarg_size 112
  .amdhsa_user_sgpr_count 2
  .amdhsa_user_sgpr_kernarg_segment_ptr 1
  .amdhsa_system_sgpr_workgroup_id_x 1
.end_amdhsa_kernel
```
